```python
import torch

def _softmax(x, axis=-1):
    return torch.softmax(x, dim=axis)
def _gelu(x):
    return torch.nn.functional.gelu(x, approximate="tanh")
def _silu(x):
    return torch.nn.functional.silu(x)
def _sigmoid(x):
    return torch.sigmoid(x)
def _layernorm(x, axis=-1, eps=1e-5):
    m = x.mean(dim=axis, keepdim=True)
    v = x.var(dim=axis, keepdim=True, unbiased=False)
    return (x - m) / torch.sqrt(v + eps)
def _scatter_add(tgt, idx, src, axis=0):
    return tgt.clone().index_add_(axis, idx, src)
def _segment_sum(src, seg, n):
    out = torch.zeros((n,) + src.shape[1:], dtype=src.dtype)
    return out.index_add_(0, seg, src)
def _pad(x, pw):
    flat = tuple(v for pair in reversed(pw) for v in pair)
    return torch.nn.functional.pad(x, flat)

kernel_name = 'interleave_layers__grouped_kv_mqa__mixer_token_mlp__prompt'

def setup_inputs():

    _w = (lambda a: (lambda t: t.to(torch.bfloat16) if t.is_floating_point() else t)(torch.as_tensor(a)))
    def _A_setup():
        B, S, D, H = 1, 2048, 640, 32
        Dh = D // H
        return {
            "x": _w((lambda *s: torch.randn(*s, dtype=torch.bfloat16) * 0.05)(B, S, D)),
            "wq": _w((lambda *s: torch.randn(*s, dtype=torch.bfloat16) * 0.05)(D, H * Dh)),
            "wk": _w((lambda *s: torch.randn(*s, dtype=torch.bfloat16) * 0.05)(D, Dh)),
            "wv": _w((lambda *s: torch.randn(*s, dtype=torch.bfloat16) * 0.05)(D, Dh)),
            "wo": _w((lambda *s: torch.randn(*s, dtype=torch.bfloat16) * 0.05)(H * Dh, D)),
        }
    _A_in = _A_setup()

    def _B_setup():
        B, S, D, F = 1, 2048, 640, 1728
        return {
            "x": _w((lambda *s: torch.randn(*s, dtype=torch.bfloat16) * 0.05)(B, S, D)),
            "w1": _w((lambda *s: torch.randn(*s, dtype=torch.bfloat16) * 0.4)(S, F) * (S ** -0.5)),
            "b1": _w((lambda *s: torch.randn(*s, dtype=torch.bfloat16) * 0.4)(F) * 0.02),
            "w2": _w((lambda *s: torch.randn(*s, dtype=torch.bfloat16) * 0.4)(F, S) * (F ** -0.5)),
            "b2": _w((lambda *s: torch.randn(*s, dtype=torch.bfloat16) * 0.4)(S) * 0.02),
        }
    _B_in = _B_setup()

    return {
        "A_x": _A_in["x"],
        "A_wq": _A_in["wq"],
        "A_wk": _A_in["wk"],
        "A_wv": _A_in["wv"],
        "A_wo": _A_in["wo"],
        "B_x": _B_in["x"],
        "B_w1": _B_in["w1"],
        "B_b1": _B_in["b1"],
        "B_w2": _B_in["w2"],
        "B_b2": _B_in["b2"],
    }

def reference(A_x, A_wq, A_wk, A_wv, A_wo, B_x, B_w1, B_b1, B_w2, B_b2):
    def _A_ref(x, wq, wk, wv, wo):
        B, S, D = x.shape
        H = 32
        Dh = D // H
        q = (lambda x, *d: x.permute(*d))((x @ wq).reshape(B, S, H, Dh), 0, 2, 1, 3)
        k = x @ wk
        v = x @ wv
        scores = torch.einsum("bhqd,bkd->bhqk", q, k) * (Dh ** -0.5)
        p = _softmax(scores, axis=-1)
        o = torch.einsum("bhqk,bkd->bhqd", p, v)
        return (lambda x, *d: x.permute(*d))(o, 0, 2, 1, 3).reshape(B, S, H * Dh) @ wo

    def _B_ref(x, w1, b1, w2, b2):
        B, S, D = x.shape
        h = _layernorm(x, axis=-1)
        u = torch.einsum("bsd,sf->bdf", h, w1) + b1
        u = _gelu(u)
        y = torch.einsum("bdf,fs->bds", u, w2) + b2
        return (lambda x, *d: x.permute(*d))(y, 0, 2, 1)

    x = A_x
    x = x + _A_ref(_layernorm(x, axis=-1), A_wq, A_wk, A_wv, A_wo)
    x = x + _B_ref(_layernorm(x, axis=-1), B_w1, B_b1, B_w2, B_b2)
    x = x + _A_ref(_layernorm(x, axis=-1), A_wq, A_wk, A_wv, A_wo)
    x = x + _B_ref(_layernorm(x, axis=-1), B_w1, B_b1, B_w2, B_b2)
    return x
```

```asm
; @launch kernel=qkv0_kernel grid=(256,1,1) block=(256,1,1) lds=160256
; @launch kernel=attn0_kernel grid=(256,1,1) block=(320,1,1) lds=122944
; @launch kernel=oproj0_kernel grid=(256,1,1) block=(256,1,1) lds=102400
; @launch kernel=mlpa0_kernel grid=(240,1,1) block=(512,1,1) lds=163840
; @launch kernel=mlpb0_kernel grid=(256,1,1) block=(256,1,1) lds=81920
; @launch kernel=qkv1_kernel grid=(256,1,1) block=(256,1,1) lds=132608
; @launch kernel=attn1_kernel grid=(256,1,1) block=(320,1,1) lds=122944
; @launch kernel=oproj1_kernel grid=(256,1,1) block=(256,1,1) lds=102400
; @launch kernel=mlpa1_kernel grid=(240,1,1) block=(512,1,1) lds=163840
; @launch kernel=mlpb1_kernel grid=(256,1,1) block=(256,1,1) lds=81920
.amdgcn_target "amdgcn-amd-amdhsa--gfx950"
.text
.globl qkv0_kernel
.p2align 8
.type qkv0_kernel,@function
qkv0_kernel:
    s_cmp_ge_u32 s2, 256
    s_cbranch_scc1 qkv0_kernel_end
    s_load_dwordx2 s[4:5], s[0:1], 96
    s_load_dwordx2 s[6:7], s[0:1], 0
    s_load_dwordx2 s[8:9], s[0:1], 8
    s_load_dwordx4 s[12:15], s[0:1], 16
    s_and_b32 s16, s2, 7
    s_lshr_b32 s17, s2, 3
    s_and_b32 s18, s17, 3
    s_lshl_b32 s16, s16, 2
    s_add_u32 s16, s16, s18
    s_lshr_b32 s17, s17, 2
    v_lshrrev_b32 v2, 6, v0
    v_and_b32 v1, 63, v0
    v_readfirstlane_b32 s3, v2
    v_lshrrev_b32 v2, 4, v1
    v_and_b32 v3, 15, v1
    s_lshl_b32 s20, s16, 6
    s_lshl_b32 s21, s3, 4
    s_add_u32 s20, s20, s21
    s_lshr_b32 s21, s20, 4
    s_mul_i32 s21, s21, 20480
    s_mul_i32 s24, s17, 5
    s_lshr_b32 s24, s24, 1
    s_lshl_b32 s24, s24, 10
    s_add_u32 s24, s24, s21
    s_and_b32 s25, s17, 1
    v_lshlrev_b32 v5, 4, v1
    s_waitcnt lgkmcnt(0)
    s_mov_b32 s32, s6
    s_mov_b32 s33, s7
    s_mov_b32 s34, 2621440
    s_mov_b32 s35, 0x00020000
    s_add_u32 s56, s4, 20971520
    s_addc_u32 s57, s5, 0
    s_mov_b32 s58, 2621440
    s_mov_b32 s59, 0x00020000
    s_mov_b32 s36, s8
    s_mov_b32 s37, s9
    s_mov_b32 s38, 819200
    s_mov_b32 s39, 0x00020000
    s_cmp_lt_u32 s17, 2
    s_cselect_b32 s40, s12, s14
    s_cselect_b32 s41, s13, s15
    s_cmp_lt_u32 s17, 4
    s_cselect_b32 s42, 25600, 0
    s_mov_b32 s43, 0x00020000
    s_add_u32 s44, s4, 0
    s_addc_u32 s45, s5, 0
    s_mov_b32 s46, 2621440
    s_mov_b32 s47, 0x00020000
    s_add_u32 s48, s4, 3145728
    s_addc_u32 s49, s5, 0
    s_mov_b32 s50, 196608
    s_mov_b32 s51, 0x00020000
    s_add_u32 s52, s4, 3407872
    s_addc_u32 s53, s5, 0
    s_mov_b32 s54, 1024
    s_mov_b32 s55, 0x00020000
    v_lshrrev_b32 v4, 2, v1
    v_add_u32 v4, s20, v4
    v_mul_u32_u24 v4, 1280, v4
    v_and_b32 v6, 3, v1
    v_lshl_add_u32 v4, v6, 4, v4
    v_add_u32 v11, 0, v1
    v_mul_u32_u24 v12, 6554, v11
    v_lshrrev_b32 v12, 16, v12
    v_mul_u32_u24 v13, 10, v12
    v_sub_u32 v13, v11, v13
    v_mul_u32_u24 v12, 1280, v12
    v_lshl_add_u32 v6, v13, 4, v12
    v_add_u32 v11, 64, v1
    v_mul_u32_u24 v12, 6554, v11
    v_lshrrev_b32 v12, 16, v12
    v_mul_u32_u24 v13, 10, v12
    v_sub_u32 v13, v11, v13
    v_mul_u32_u24 v12, 1280, v12
    v_lshl_add_u32 v7, v13, 4, v12
    v_add_u32 v11, 128, v1
    v_mul_u32_u24 v12, 6554, v11
    v_lshrrev_b32 v12, 16, v12
    v_mul_u32_u24 v13, 10, v12
    v_sub_u32 v13, v11, v13
    v_mul_u32_u24 v12, 1280, v12
    v_lshl_add_u32 v8, v13, 4, v12
    v_add_u32 v11, 192, v1
    v_mul_u32_u24 v12, 6554, v11
    v_lshrrev_b32 v12, 16, v12
    v_mul_u32_u24 v13, 10, v12
    v_sub_u32 v13, v11, v13
    v_mul_u32_u24 v12, 1280, v12
    v_lshl_add_u32 v9, v13, 4, v12
    v_add_u32 v11, 256, v1
    v_mul_u32_u24 v12, 6554, v11
    v_lshrrev_b32 v12, 16, v12
    v_mul_u32_u24 v13, 10, v12
    v_sub_u32 v13, v11, v13
    v_mul_u32_u24 v12, 1280, v12
    v_lshl_add_u32 v10, v13, 4, v12
    s_mul_i32 s26, s17, 160
    s_mul_i32 s27, s3, 40960
    s_add_u32 s26, s26, s27
    s_mul_i32 s27, s3, 5120
    s_lshl_b32 s31, s3, 10
    buffer_load_dwordx4 v[16:19], v4, s[32:35], 0 offen offset:0
    buffer_load_dwordx4 v[20:23], v4, s[32:35], 0 offen offset:64
    buffer_load_dwordx4 v[24:27], v4, s[32:35], 0 offen offset:128
    buffer_load_dwordx4 v[28:31], v4, s[32:35], 0 offen offset:192
    s_add_u32 m0, s27, 0
    s_nop 0
    buffer_load_dwordx4 v6, s[36:39], s26 offen lds
    s_add_u32 m0, s27, 1024
    s_nop 0
    buffer_load_dwordx4 v7, s[36:39], s26 offen lds
    s_add_u32 m0, s27, 2048
    s_nop 0
    buffer_load_dwordx4 v8, s[36:39], s26 offen lds
    s_add_u32 m0, s27, 3072
    s_nop 0
    buffer_load_dwordx4 v9, s[36:39], s26 offen lds
    s_add_u32 m0, s27, 4096
    s_nop 0
    buffer_load_dwordx4 v10, s[36:39], s26 offen lds
    s_add_u32 s26, s26, 163840
    s_add_u32 s27, s27, 20480
    s_add_u32 m0, s31, 102400
    s_add_u32 s30, s31, 4096
    buffer_load_dwordx4 v5, s[40:43], s31 offen lds
    s_add_u32 m0, s30, 102400
    s_nop 0
    buffer_load_dwordx4 v5, s[40:43], s30 offen lds
    s_add_u32 s31, s31, 5120
    buffer_load_dwordx4 v[32:35], v4, s[32:35], 0 offen offset:256
    buffer_load_dwordx4 v[36:39], v4, s[32:35], 0 offen offset:320
    buffer_load_dwordx4 v[40:43], v4, s[32:35], 0 offen offset:384
    buffer_load_dwordx4 v[44:47], v4, s[32:35], 0 offen offset:448
    s_add_u32 m0, s27, 0
    s_nop 0
    buffer_load_dwordx4 v6, s[36:39], s26 offen lds
    s_add_u32 m0, s27, 1024
    s_nop 0
    buffer_load_dwordx4 v7, s[36:39], s26 offen lds
    s_add_u32 m0, s27, 2048
    s_nop 0
    buffer_load_dwordx4 v8, s[36:39], s26 offen lds
    s_add_u32 m0, s27, 3072
    s_nop 0
    buffer_load_dwordx4 v9, s[36:39], s26 offen lds
    s_add_u32 m0, s27, 4096
    s_nop 0
    buffer_load_dwordx4 v10, s[36:39], s26 offen lds
    s_add_u32 s26, s26, 163840
    s_add_u32 s27, s27, 20480
    s_add_u32 m0, s31, 102400
    s_add_u32 s30, s31, 4096
    buffer_load_dwordx4 v5, s[40:43], s31 offen lds
    s_add_u32 m0, s30, 102400
    s_nop 0
    buffer_load_dwordx4 v5, s[40:43], s30 offen lds
    s_add_u32 s31, s31, 5120
    v_lshrrev_b32 v12, 2, v1
    v_mul_u32_u24 v12, 160, v12
    v_and_b32 v13, 3, v1
    v_lshl_add_u32 v12, v13, 3, v12
    v_add_u32 v13, 51200, v12
    v_lshrrev_b32 v11, 2, v1
    v_mul_u32_u24 v11, 40, v11
    v_and_b32 v14, 3, v1
    v_lshl_add_u32 v11, v14, 3, v11
    s_lshl_b32 s29, s25, 5
    s_add_u32 s29, s29, 102400
    v_add_u32 v11, s29, v11
    s_mul_i32 s28, s3, 6912
    s_add_u32 s28, s28, 132608
    v_and_b32 v14, 1, v1
    v_mul_u32_u24 v14, 576, v14
    v_lshrrev_b32 v15, 2, v1
    v_lshl_add_u32 v14, v15, 4, v14
    v_bfe_u32 v15, v1, 1, 1
    v_lshl_add_u32 v14, v15, 3, v14
    v_add_u32 v14, s28, v14
    v_mul_u32_u24 v15, 288, v2
    v_lshl_add_u32 v15, v3, 4, v15
    v_add_u32 v15, s28, v15
    v_mov_b32 v96, 0
    v_mov_b32 v97, 0
    v_mov_b32 v98, 0
    v_mov_b32 v99, 0
    v_mov_b32 v100, 0
    v_mov_b32 v101, 0
    v_mov_b32 v102, 0
    v_mov_b32 v103, 0
    v_mov_b32 v104, 0
    v_mov_b32 v105, 0
    v_mov_b32 v106, 0
    v_mov_b32 v107, 0
    v_mov_b32 v108, 0
    v_mov_b32 v109, 0
    v_mov_b32 v110, 0
    v_mov_b32 v111, 0
    v_mov_b32 v112, 0
    v_mov_b32 v113, 0
    v_mov_b32 v114, 0
    v_mov_b32 v115, 0
    v_mov_b32 v116, 0
    v_mov_b32 v117, 0
    v_mov_b32 v118, 0
    v_mov_b32 v119, 0
    v_mov_b32 v120, 0
    v_mov_b32 v121, 0
    v_mov_b32 v122, 0
    v_mov_b32 v123, 0
    v_mov_b32 v124, 0
    v_mov_b32 v125, 0
    v_mov_b32 v126, 0
    v_mov_b32 v127, 0
    v_mov_b32 v128, 0
    v_mov_b32 v129, 0
    v_mov_b32 v130, 0
    v_mov_b32 v131, 0
    v_mov_b32 v132, 0
    v_mov_b32 v133, 0
    v_mov_b32 v134, 0
    v_mov_b32 v135, 0
    v_mov_b32 v136, 0
    v_mov_b32 v137, 0
    v_mov_b32 v138, 0
    v_mov_b32 v139, 0
    v_mov_b32 v140, 0
    v_mov_b32 v141, 0
    v_mov_b32 v142, 0
    v_mov_b32 v143, 0
    v_mov_b32 v236, 0x3f803f80
    v_mov_b32 v237, 0x3f803f80
    v_mov_b32 v238, 0x3f803f80
    v_mov_b32 v239, 0x3f803f80
    v_mov_b32 v240, 0
    v_mov_b32 v241, 0
    v_mov_b32 v242, 0
    v_mov_b32 v243, 0
    v_mov_b32 v244, 0
    v_mov_b32 v245, 0
    v_mov_b32 v246, 0
    v_mov_b32 v247, 0
    s_waitcnt vmcnt(11)
    s_barrier
    ds_write_b64 v14, v[16:17] offset:0
    ds_write_b64 v14, v[18:19] offset:288
    ds_read_b128 v[16:19], v15 offset:0
    ds_write_b64 v14, v[20:21] offset:1152
    ds_write_b64 v14, v[22:23] offset:1440
    ds_read_b128 v[20:23], v15 offset:1152
    ds_write_b64 v14, v[24:25] offset:2304
    ds_write_b64 v14, v[26:27] offset:2592
    ds_read_b128 v[24:27], v15 offset:2304
    ds_write_b64 v14, v[28:29] offset:3456
    ds_write_b64 v14, v[30:31] offset:3744
    ds_read_b128 v[28:31], v15 offset:3456
    ds_read_b64_tr_b16 v[144:145], v12 offset:0
    ds_read_b64_tr_b16 v[146:147], v12 offset:2560
    ds_read_b64_tr_b16 v[148:149], v12 offset:32
    ds_read_b64_tr_b16 v[150:151], v12 offset:2592
    ds_read_b64_tr_b16 v[152:153], v12 offset:64
    ds_read_b64_tr_b16 v[154:155], v12 offset:2624
    ds_read_b64_tr_b16 v[156:157], v12 offset:96
    ds_read_b64_tr_b16 v[158:159], v12 offset:2656
    ds_read_b64_tr_b16 v[160:161], v12 offset:128
    ds_read_b64_tr_b16 v[162:163], v12 offset:2688
    ds_read_b64_tr_b16 v[164:165], v11 offset:0
    ds_read_b64_tr_b16 v[166:167], v11 offset:640
    ds_read_b64_tr_b16 v[168:169], v12 offset:5120
    ds_read_b64_tr_b16 v[170:171], v12 offset:7680
    ds_read_b64_tr_b16 v[172:173], v12 offset:5152
    ds_read_b64_tr_b16 v[174:175], v12 offset:7712
    ds_read_b64_tr_b16 v[176:177], v12 offset:5184
    ds_read_b64_tr_b16 v[178:179], v12 offset:7744
    ds_read_b64_tr_b16 v[180:181], v12 offset:5216
    ds_read_b64_tr_b16 v[182:183], v12 offset:7776
    ds_read_b64_tr_b16 v[184:185], v12 offset:5248
    ds_read_b64_tr_b16 v[186:187], v12 offset:7808
    ds_read_b64_tr_b16 v[188:189], v11 offset:1280
    ds_read_b64_tr_b16 v[190:191], v11 offset:1920
    s_waitcnt lgkmcnt(12)
    v_mfma_f32_16x16x32_bf16 v[96:99], v[144:147], v[16:19], v[96:99]
    ds_read_b64_tr_b16 v[192:193], v12 offset:10240
    ds_read_b64_tr_b16 v[194:195], v12 offset:12800
    v_mfma_f32_16x16x32_bf16 v[100:103], v[148:151], v[16:19], v[100:103]
    ds_read_b64_tr_b16 v[196:197], v12 offset:10272
    ds_read_b64_tr_b16 v[198:199], v12 offset:12832
    buffer_load_dwordx4 v[48:51], v4, s[32:35], 0 offen offset:512
    v_mfma_f32_16x16x32_bf16 v[104:107], v[152:155], v[16:19], v[104:107]
    ds_read_b64_tr_b16 v[200:201], v12 offset:10304
    ds_read_b64_tr_b16 v[202:203], v12 offset:12864
    v_mfma_f32_16x16x32_bf16 v[108:111], v[156:159], v[16:19], v[108:111]
    ds_read_b64_tr_b16 v[204:205], v12 offset:10336
    ds_read_b64_tr_b16 v[206:207], v12 offset:12896
    buffer_load_dwordx4 v[52:55], v4, s[32:35], 0 offen offset:576
    v_mfma_f32_16x16x32_bf16 v[112:115], v[160:163], v[16:19], v[112:115]
    ds_read_b64_tr_b16 v[208:209], v12 offset:10368
    ds_read_b64_tr_b16 v[210:211], v12 offset:12928
    v_mfma_f32_16x16x32_bf16 v[116:119], v[164:167], v[16:19], v[116:119]
    ds_read_b64_tr_b16 v[212:213], v11 offset:2560
    ds_read_b64_tr_b16 v[214:215], v11 offset:3200
    buffer_load_dwordx4 v[56:59], v4, s[32:35], 0 offen offset:640
    v_mfma_f32_16x16x32_bf16 v[240:243], v[236:239], v[16:19], v[240:243]
    v_mfma_f32_16x16x32_bf16 v[244:247], v[16:19], v[16:19], v[244:247]
    s_cmp_lg_u32 s3, 0
    s_cbranch_scc1 qkv0_kernel_cs1
    v_mfma_f32_16x16x32_bf16 v[120:123], v[144:147], v[236:239], v[120:123]
    v_mfma_f32_16x16x32_bf16 v[124:127], v[148:151], v[236:239], v[124:127]
    v_mfma_f32_16x16x32_bf16 v[128:131], v[152:155], v[236:239], v[128:131]
    v_mfma_f32_16x16x32_bf16 v[132:135], v[156:159], v[236:239], v[132:135]
    v_mfma_f32_16x16x32_bf16 v[136:139], v[160:163], v[236:239], v[136:139]
    v_mfma_f32_16x16x32_bf16 v[140:143], v[164:167], v[236:239], v[140:143]
qkv0_kernel_cs1:
    s_cmp_lg_u32 s17, 0
    s_cbranch_scc1 qkv0_kernel_sk2
    s_add_u32 s22, s21, 0
    buffer_store_dwordx4 v[16:19], v5, s[56:59], s22 offen
qkv0_kernel_sk2:
    s_waitcnt lgkmcnt(12)
    v_mfma_f32_16x16x32_bf16 v[96:99], v[168:171], v[20:23], v[96:99]
    ds_read_b64_tr_b16 v[144:145], v12 offset:15360
    ds_read_b64_tr_b16 v[146:147], v12 offset:17920
    v_mfma_f32_16x16x32_bf16 v[100:103], v[172:175], v[20:23], v[100:103]
    ds_read_b64_tr_b16 v[148:149], v12 offset:15392
    ds_read_b64_tr_b16 v[150:151], v12 offset:17952
    buffer_load_dwordx4 v[60:63], v4, s[32:35], 0 offen offset:704
    v_mfma_f32_16x16x32_bf16 v[104:107], v[176:179], v[20:23], v[104:107]
    ds_read_b64_tr_b16 v[152:153], v12 offset:15424
    ds_read_b64_tr_b16 v[154:155], v12 offset:17984
    v_mfma_f32_16x16x32_bf16 v[108:111], v[180:183], v[20:23], v[108:111]
    ds_read_b64_tr_b16 v[156:157], v12 offset:15456
    ds_read_b64_tr_b16 v[158:159], v12 offset:18016
    s_add_u32 m0, s27, 0
    s_nop 0
    buffer_load_dwordx4 v6, s[36:39], s26 offen lds
    v_mfma_f32_16x16x32_bf16 v[112:115], v[184:187], v[20:23], v[112:115]
    ds_read_b64_tr_b16 v[160:161], v12 offset:15488
    ds_read_b64_tr_b16 v[162:163], v12 offset:18048
    v_mfma_f32_16x16x32_bf16 v[116:119], v[188:191], v[20:23], v[116:119]
    ds_read_b64_tr_b16 v[164:165], v11 offset:3840
    ds_read_b64_tr_b16 v[166:167], v11 offset:4480
    s_add_u32 m0, s27, 1024
    s_nop 0
    buffer_load_dwordx4 v7, s[36:39], s26 offen lds
    v_mfma_f32_16x16x32_bf16 v[240:243], v[236:239], v[20:23], v[240:243]
    v_mfma_f32_16x16x32_bf16 v[244:247], v[20:23], v[20:23], v[244:247]
    s_cmp_lg_u32 s3, 1
    s_cbranch_scc1 qkv0_kernel_cs3
    v_mfma_f32_16x16x32_bf16 v[120:123], v[168:171], v[236:239], v[120:123]
    v_mfma_f32_16x16x32_bf16 v[124:127], v[172:175], v[236:239], v[124:127]
    v_mfma_f32_16x16x32_bf16 v[128:131], v[176:179], v[236:239], v[128:131]
    v_mfma_f32_16x16x32_bf16 v[132:135], v[180:183], v[236:239], v[132:135]
    v_mfma_f32_16x16x32_bf16 v[136:139], v[184:187], v[236:239], v[136:139]
    v_mfma_f32_16x16x32_bf16 v[140:143], v[188:191], v[236:239], v[140:143]
qkv0_kernel_cs3:
    s_cmp_lg_u32 s17, 1
    s_cbranch_scc1 qkv0_kernel_sk4
    s_add_u32 s22, s21, 1024
    buffer_store_dwordx4 v[20:23], v5, s[56:59], s22 offen
qkv0_kernel_sk4:
    s_waitcnt vmcnt(6)
    s_barrier
    ds_write_b64 v14, v[32:33] offset:4608
    ds_write_b64 v14, v[34:35] offset:4896
    ds_read_b128 v[32:35], v15 offset:4608
    ds_write_b64 v14, v[36:37] offset:5760
    ds_write_b64 v14, v[38:39] offset:6048
    ds_read_b128 v[36:39], v15 offset:5760
    ds_write_b64 v14, v[40:41] offset:0
    ds_write_b64 v14, v[42:43] offset:288
    ds_read_b128 v[40:43], v15 offset:0
    ds_write_b64 v14, v[44:45] offset:1152
    ds_write_b64 v14, v[46:47] offset:1440
    ds_read_b128 v[44:47], v15 offset:1152
    s_waitcnt lgkmcnt(12)
    v_mfma_f32_16x16x32_bf16 v[96:99], v[192:195], v[24:27], v[96:99]
    ds_read_b64_tr_b16 v[168:169], v12 offset:20480
    ds_read_b64_tr_b16 v[170:171], v12 offset:23040
    v_mfma_f32_16x16x32_bf16 v[100:103], v[196:199], v[24:27], v[100:103]
    ds_read_b64_tr_b16 v[172:173], v12 offset:20512
    ds_read_b64_tr_b16 v[174:175], v12 offset:23072
    s_add_u32 m0, s27, 2048
    s_nop 0
    buffer_load_dwordx4 v8, s[36:39], s26 offen lds
    v_mfma_f32_16x16x32_bf16 v[104:107], v[200:203], v[24:27], v[104:107]
    ds_read_b64_tr_b16 v[176:177], v12 offset:20544
    ds_read_b64_tr_b16 v[178:179], v12 offset:23104
    v_mfma_f32_16x16x32_bf16 v[108:111], v[204:207], v[24:27], v[108:111]
    ds_read_b64_tr_b16 v[180:181], v12 offset:20576
    ds_read_b64_tr_b16 v[182:183], v12 offset:23136
    s_add_u32 m0, s27, 3072
    s_nop 0
    buffer_load_dwordx4 v9, s[36:39], s26 offen lds
    v_mfma_f32_16x16x32_bf16 v[112:115], v[208:211], v[24:27], v[112:115]
    ds_read_b64_tr_b16 v[184:185], v12 offset:20608
    ds_read_b64_tr_b16 v[186:187], v12 offset:23168
    v_mfma_f32_16x16x32_bf16 v[116:119], v[212:215], v[24:27], v[116:119]
    ds_read_b64_tr_b16 v[188:189], v11 offset:5120
    ds_read_b64_tr_b16 v[190:191], v11 offset:5760
    s_add_u32 m0, s27, 4096
    s_nop 0
    buffer_load_dwordx4 v10, s[36:39], s26 offen lds
    s_add_u32 s26, s26, 163840
    s_add_u32 s27, s27, 20480
    v_mfma_f32_16x16x32_bf16 v[240:243], v[236:239], v[24:27], v[240:243]
    v_mfma_f32_16x16x32_bf16 v[244:247], v[24:27], v[24:27], v[244:247]
    s_cmp_lg_u32 s3, 2
    s_cbranch_scc1 qkv0_kernel_cs5
    v_mfma_f32_16x16x32_bf16 v[120:123], v[192:195], v[236:239], v[120:123]
    v_mfma_f32_16x16x32_bf16 v[124:127], v[196:199], v[236:239], v[124:127]
    v_mfma_f32_16x16x32_bf16 v[128:131], v[200:203], v[236:239], v[128:131]
    v_mfma_f32_16x16x32_bf16 v[132:135], v[204:207], v[236:239], v[132:135]
    v_mfma_f32_16x16x32_bf16 v[136:139], v[208:211], v[236:239], v[136:139]
    v_mfma_f32_16x16x32_bf16 v[140:143], v[212:215], v[236:239], v[140:143]
qkv0_kernel_cs5:
    s_cmp_lg_u32 s17, 2
    s_cbranch_scc1 qkv0_kernel_sk6
    s_add_u32 s22, s21, 2048
    buffer_store_dwordx4 v[24:27], v5, s[56:59], s22 offen
qkv0_kernel_sk6:
    s_waitcnt lgkmcnt(12)
    v_mfma_f32_16x16x32_bf16 v[96:99], v[144:147], v[28:31], v[96:99]
    ds_read_b64_tr_b16 v[192:193], v12 offset:25600
    ds_read_b64_tr_b16 v[194:195], v12 offset:28160
    v_mfma_f32_16x16x32_bf16 v[100:103], v[148:151], v[28:31], v[100:103]
    ds_read_b64_tr_b16 v[196:197], v12 offset:25632
    ds_read_b64_tr_b16 v[198:199], v12 offset:28192
    s_add_u32 m0, s31, 102400
    s_add_u32 s30, s31, 4096
    buffer_load_dwordx4 v5, s[40:43], s31 offen lds
    v_mfma_f32_16x16x32_bf16 v[104:107], v[152:155], v[28:31], v[104:107]
    ds_read_b64_tr_b16 v[200:201], v12 offset:25664
    ds_read_b64_tr_b16 v[202:203], v12 offset:28224
    v_mfma_f32_16x16x32_bf16 v[108:111], v[156:159], v[28:31], v[108:111]
    ds_read_b64_tr_b16 v[204:205], v12 offset:25696
    ds_read_b64_tr_b16 v[206:207], v12 offset:28256
    s_add_u32 m0, s30, 102400
    s_nop 0
    buffer_load_dwordx4 v5, s[40:43], s30 offen lds
    s_add_u32 s31, s31, 5120
    v_mfma_f32_16x16x32_bf16 v[112:115], v[160:163], v[28:31], v[112:115]
    ds_read_b64_tr_b16 v[208:209], v12 offset:25728
    ds_read_b64_tr_b16 v[210:211], v12 offset:28288
    v_mfma_f32_16x16x32_bf16 v[116:119], v[164:167], v[28:31], v[116:119]
    ds_read_b64_tr_b16 v[212:213], v11 offset:6400
    ds_read_b64_tr_b16 v[214:215], v11 offset:7040
    buffer_load_dwordx4 v[64:67], v4, s[32:35], 0 offen offset:768
    v_mfma_f32_16x16x32_bf16 v[240:243], v[236:239], v[28:31], v[240:243]
    v_mfma_f32_16x16x32_bf16 v[244:247], v[28:31], v[28:31], v[244:247]
    s_cmp_lg_u32 s3, 3
    s_cbranch_scc1 qkv0_kernel_cs7
    v_mfma_f32_16x16x32_bf16 v[120:123], v[144:147], v[236:239], v[120:123]
    v_mfma_f32_16x16x32_bf16 v[124:127], v[148:151], v[236:239], v[124:127]
    v_mfma_f32_16x16x32_bf16 v[128:131], v[152:155], v[236:239], v[128:131]
    v_mfma_f32_16x16x32_bf16 v[132:135], v[156:159], v[236:239], v[132:135]
    v_mfma_f32_16x16x32_bf16 v[136:139], v[160:163], v[236:239], v[136:139]
    v_mfma_f32_16x16x32_bf16 v[140:143], v[164:167], v[236:239], v[140:143]
qkv0_kernel_cs7:
    s_cmp_lg_u32 s17, 3
    s_cbranch_scc1 qkv0_kernel_sk8
    s_add_u32 s22, s21, 3072
    buffer_store_dwordx4 v[28:31], v5, s[56:59], s22 offen
qkv0_kernel_sk8:
    s_waitcnt lgkmcnt(12)
    v_mfma_f32_16x16x32_bf16 v[96:99], v[168:171], v[32:35], v[96:99]
    ds_read_b64_tr_b16 v[144:145], v12 offset:30720
    ds_read_b64_tr_b16 v[146:147], v12 offset:33280
    v_mfma_f32_16x16x32_bf16 v[100:103], v[172:175], v[32:35], v[100:103]
    ds_read_b64_tr_b16 v[148:149], v12 offset:30752
    ds_read_b64_tr_b16 v[150:151], v12 offset:33312
    buffer_load_dwordx4 v[68:71], v4, s[32:35], 0 offen offset:832
    v_mfma_f32_16x16x32_bf16 v[104:107], v[176:179], v[32:35], v[104:107]
    ds_read_b64_tr_b16 v[152:153], v12 offset:30784
    ds_read_b64_tr_b16 v[154:155], v12 offset:33344
    v_mfma_f32_16x16x32_bf16 v[108:111], v[180:183], v[32:35], v[108:111]
    ds_read_b64_tr_b16 v[156:157], v12 offset:30816
    ds_read_b64_tr_b16 v[158:159], v12 offset:33376
    buffer_load_dwordx4 v[72:75], v4, s[32:35], 0 offen offset:896
    v_mfma_f32_16x16x32_bf16 v[112:115], v[184:187], v[32:35], v[112:115]
    ds_read_b64_tr_b16 v[160:161], v12 offset:30848
    ds_read_b64_tr_b16 v[162:163], v12 offset:33408
    v_mfma_f32_16x16x32_bf16 v[116:119], v[188:191], v[32:35], v[116:119]
    ds_read_b64_tr_b16 v[164:165], v11 offset:7680
    ds_read_b64_tr_b16 v[166:167], v11 offset:8320
    buffer_load_dwordx4 v[76:79], v4, s[32:35], 0 offen offset:960
    v_mfma_f32_16x16x32_bf16 v[240:243], v[236:239], v[32:35], v[240:243]
    v_mfma_f32_16x16x32_bf16 v[244:247], v[32:35], v[32:35], v[244:247]
    s_cmp_lg_u32 s3, 0
    s_cbranch_scc1 qkv0_kernel_cs9
    v_mfma_f32_16x16x32_bf16 v[120:123], v[168:171], v[236:239], v[120:123]
    v_mfma_f32_16x16x32_bf16 v[124:127], v[172:175], v[236:239], v[124:127]
    v_mfma_f32_16x16x32_bf16 v[128:131], v[176:179], v[236:239], v[128:131]
    v_mfma_f32_16x16x32_bf16 v[132:135], v[180:183], v[236:239], v[132:135]
    v_mfma_f32_16x16x32_bf16 v[136:139], v[184:187], v[236:239], v[136:139]
    v_mfma_f32_16x16x32_bf16 v[140:143], v[188:191], v[236:239], v[140:143]
qkv0_kernel_cs9:
    s_cmp_lg_u32 s17, 4
    s_cbranch_scc1 qkv0_kernel_sk10
    s_add_u32 s22, s21, 4096
    buffer_store_dwordx4 v[32:35], v5, s[56:59], s22 offen
qkv0_kernel_sk10:
    s_waitcnt lgkmcnt(12)
    v_mfma_f32_16x16x32_bf16 v[96:99], v[192:195], v[36:39], v[96:99]
    ds_read_b64_tr_b16 v[168:169], v12 offset:35840
    ds_read_b64_tr_b16 v[170:171], v12 offset:38400
    v_mfma_f32_16x16x32_bf16 v[100:103], v[196:199], v[36:39], v[100:103]
    ds_read_b64_tr_b16 v[172:173], v12 offset:35872
    ds_read_b64_tr_b16 v[174:175], v12 offset:38432
    s_add_u32 m0, s27, 0
    s_nop 0
    buffer_load_dwordx4 v6, s[36:39], s26 offen lds
    v_mfma_f32_16x16x32_bf16 v[104:107], v[200:203], v[36:39], v[104:107]
    ds_read_b64_tr_b16 v[176:177], v12 offset:35904
    ds_read_b64_tr_b16 v[178:179], v12 offset:38464
    v_mfma_f32_16x16x32_bf16 v[108:111], v[204:207], v[36:39], v[108:111]
    ds_read_b64_tr_b16 v[180:181], v12 offset:35936
    ds_read_b64_tr_b16 v[182:183], v12 offset:38496
    s_add_u32 m0, s27, 1024
    s_nop 0
    buffer_load_dwordx4 v7, s[36:39], s26 offen lds
    v_mfma_f32_16x16x32_bf16 v[112:115], v[208:211], v[36:39], v[112:115]
    ds_read_b64_tr_b16 v[184:185], v12 offset:35968
    ds_read_b64_tr_b16 v[186:187], v12 offset:38528
    v_mfma_f32_16x16x32_bf16 v[116:119], v[212:215], v[36:39], v[116:119]
    ds_read_b64_tr_b16 v[188:189], v11 offset:8960
    ds_read_b64_tr_b16 v[190:191], v11 offset:9600
    s_add_u32 m0, s27, 2048
    s_nop 0
    buffer_load_dwordx4 v8, s[36:39], s26 offen lds
    v_mfma_f32_16x16x32_bf16 v[240:243], v[236:239], v[36:39], v[240:243]
    v_mfma_f32_16x16x32_bf16 v[244:247], v[36:39], v[36:39], v[244:247]
    s_cmp_lg_u32 s3, 1
    s_cbranch_scc1 qkv0_kernel_cs11
    v_mfma_f32_16x16x32_bf16 v[120:123], v[192:195], v[236:239], v[120:123]
    v_mfma_f32_16x16x32_bf16 v[124:127], v[196:199], v[236:239], v[124:127]
    v_mfma_f32_16x16x32_bf16 v[128:131], v[200:203], v[236:239], v[128:131]
    v_mfma_f32_16x16x32_bf16 v[132:135], v[204:207], v[236:239], v[132:135]
    v_mfma_f32_16x16x32_bf16 v[136:139], v[208:211], v[236:239], v[136:139]
    v_mfma_f32_16x16x32_bf16 v[140:143], v[212:215], v[236:239], v[140:143]
qkv0_kernel_cs11:
    s_cmp_lg_u32 s17, 5
    s_cbranch_scc1 qkv0_kernel_sk12
    s_add_u32 s22, s21, 5120
    buffer_store_dwordx4 v[36:39], v5, s[56:59], s22 offen
qkv0_kernel_sk12:
    s_waitcnt vmcnt(7)
    s_barrier
    ds_write_b64 v14, v[48:49] offset:2304
    ds_write_b64 v14, v[50:51] offset:2592
    ds_read_b128 v[48:51], v15 offset:2304
    ds_write_b64 v14, v[52:53] offset:3456
    ds_write_b64 v14, v[54:55] offset:3744
    ds_read_b128 v[52:55], v15 offset:3456
    ds_write_b64 v14, v[56:57] offset:4608
    ds_write_b64 v14, v[58:59] offset:4896
    ds_read_b128 v[56:59], v15 offset:4608
    ds_write_b64 v14, v[60:61] offset:5760
    ds_write_b64 v14, v[62:63] offset:6048
    ds_read_b128 v[60:63], v15 offset:5760
    s_waitcnt lgkmcnt(12)
    v_mfma_f32_16x16x32_bf16 v[96:99], v[144:147], v[40:43], v[96:99]
    ds_read_b64_tr_b16 v[192:193], v12 offset:40960
    ds_read_b64_tr_b16 v[194:195], v12 offset:43520
    v_mfma_f32_16x16x32_bf16 v[100:103], v[148:151], v[40:43], v[100:103]
    ds_read_b64_tr_b16 v[196:197], v12 offset:40992
    ds_read_b64_tr_b16 v[198:199], v12 offset:43552
    s_add_u32 m0, s27, 3072
    s_nop 0
    buffer_load_dwordx4 v9, s[36:39], s26 offen lds
    v_mfma_f32_16x16x32_bf16 v[104:107], v[152:155], v[40:43], v[104:107]
    ds_read_b64_tr_b16 v[200:201], v12 offset:41024
    ds_read_b64_tr_b16 v[202:203], v12 offset:43584
    v_mfma_f32_16x16x32_bf16 v[108:111], v[156:159], v[40:43], v[108:111]
    ds_read_b64_tr_b16 v[204:205], v12 offset:41056
    ds_read_b64_tr_b16 v[206:207], v12 offset:43616
    s_add_u32 m0, s27, 4096
    s_nop 0
    buffer_load_dwordx4 v10, s[36:39], s26 offen lds
    s_add_u32 s26, s26, 163840
    s_add_u32 s27, s27, 20480
    v_mfma_f32_16x16x32_bf16 v[112:115], v[160:163], v[40:43], v[112:115]
    ds_read_b64_tr_b16 v[208:209], v12 offset:41088
    ds_read_b64_tr_b16 v[210:211], v12 offset:43648
    v_mfma_f32_16x16x32_bf16 v[116:119], v[164:167], v[40:43], v[116:119]
    ds_read_b64_tr_b16 v[212:213], v11 offset:10240
    ds_read_b64_tr_b16 v[214:215], v11 offset:10880
    s_add_u32 m0, s31, 102400
    s_add_u32 s30, s31, 4096
    buffer_load_dwordx4 v5, s[40:43], s31 offen lds
    v_mfma_f32_16x16x32_bf16 v[240:243], v[236:239], v[40:43], v[240:243]
    v_mfma_f32_16x16x32_bf16 v[244:247], v[40:43], v[40:43], v[244:247]
    s_cmp_lg_u32 s3, 2
    s_cbranch_scc1 qkv0_kernel_cs13
    v_mfma_f32_16x16x32_bf16 v[120:123], v[144:147], v[236:239], v[120:123]
    v_mfma_f32_16x16x32_bf16 v[124:127], v[148:151], v[236:239], v[124:127]
    v_mfma_f32_16x16x32_bf16 v[128:131], v[152:155], v[236:239], v[128:131]
    v_mfma_f32_16x16x32_bf16 v[132:135], v[156:159], v[236:239], v[132:135]
    v_mfma_f32_16x16x32_bf16 v[136:139], v[160:163], v[236:239], v[136:139]
    v_mfma_f32_16x16x32_bf16 v[140:143], v[164:167], v[236:239], v[140:143]
qkv0_kernel_cs13:
    s_cmp_lg_u32 s17, 6
    s_cbranch_scc1 qkv0_kernel_sk14
    s_add_u32 s22, s21, 6144
    buffer_store_dwordx4 v[40:43], v5, s[56:59], s22 offen
qkv0_kernel_sk14:
    s_waitcnt lgkmcnt(12)
    v_mfma_f32_16x16x32_bf16 v[96:99], v[168:171], v[44:47], v[96:99]
    ds_read_b64_tr_b16 v[144:145], v12 offset:46080
    ds_read_b64_tr_b16 v[146:147], v12 offset:48640
    v_mfma_f32_16x16x32_bf16 v[100:103], v[172:175], v[44:47], v[100:103]
    ds_read_b64_tr_b16 v[148:149], v12 offset:46112
    ds_read_b64_tr_b16 v[150:151], v12 offset:48672
    s_add_u32 m0, s30, 102400
    s_nop 0
    buffer_load_dwordx4 v5, s[40:43], s30 offen lds
    s_add_u32 s31, s31, 5120
    v_mfma_f32_16x16x32_bf16 v[104:107], v[176:179], v[44:47], v[104:107]
    ds_read_b64_tr_b16 v[152:153], v12 offset:46144
    ds_read_b64_tr_b16 v[154:155], v12 offset:48704
    v_mfma_f32_16x16x32_bf16 v[108:111], v[180:183], v[44:47], v[108:111]
    ds_read_b64_tr_b16 v[156:157], v12 offset:46176
    ds_read_b64_tr_b16 v[158:159], v12 offset:48736
    buffer_load_dwordx4 v[80:83], v4, s[32:35], 0 offen offset:1024
    v_mfma_f32_16x16x32_bf16 v[112:115], v[184:187], v[44:47], v[112:115]
    ds_read_b64_tr_b16 v[160:161], v12 offset:46208
    ds_read_b64_tr_b16 v[162:163], v12 offset:48768
    v_mfma_f32_16x16x32_bf16 v[116:119], v[188:191], v[44:47], v[116:119]
    ds_read_b64_tr_b16 v[164:165], v11 offset:11520
    ds_read_b64_tr_b16 v[166:167], v11 offset:12160
    buffer_load_dwordx4 v[84:87], v4, s[32:35], 0 offen offset:1088
    v_mfma_f32_16x16x32_bf16 v[240:243], v[236:239], v[44:47], v[240:243]
    v_mfma_f32_16x16x32_bf16 v[244:247], v[44:47], v[44:47], v[244:247]
    s_cmp_lg_u32 s3, 3
    s_cbranch_scc1 qkv0_kernel_cs15
    v_mfma_f32_16x16x32_bf16 v[120:123], v[168:171], v[236:239], v[120:123]
    v_mfma_f32_16x16x32_bf16 v[124:127], v[172:175], v[236:239], v[124:127]
    v_mfma_f32_16x16x32_bf16 v[128:131], v[176:179], v[236:239], v[128:131]
    v_mfma_f32_16x16x32_bf16 v[132:135], v[180:183], v[236:239], v[132:135]
    v_mfma_f32_16x16x32_bf16 v[136:139], v[184:187], v[236:239], v[136:139]
    v_mfma_f32_16x16x32_bf16 v[140:143], v[188:191], v[236:239], v[140:143]
qkv0_kernel_cs15:
    s_cmp_lg_u32 s17, 7
    s_cbranch_scc1 qkv0_kernel_sk16
    s_add_u32 s22, s21, 7168
    buffer_store_dwordx4 v[44:47], v5, s[56:59], s22 offen
qkv0_kernel_sk16:
    s_waitcnt lgkmcnt(12)
    v_mfma_f32_16x16x32_bf16 v[96:99], v[192:195], v[48:51], v[96:99]
    ds_read_b64_tr_b16 v[168:169], v13 offset:0
    ds_read_b64_tr_b16 v[170:171], v13 offset:2560
    v_mfma_f32_16x16x32_bf16 v[100:103], v[196:199], v[48:51], v[100:103]
    ds_read_b64_tr_b16 v[172:173], v13 offset:32
    ds_read_b64_tr_b16 v[174:175], v13 offset:2592
    buffer_load_dwordx4 v[88:91], v4, s[32:35], 0 offen offset:1152
    v_mfma_f32_16x16x32_bf16 v[104:107], v[200:203], v[48:51], v[104:107]
    ds_read_b64_tr_b16 v[176:177], v13 offset:64
    ds_read_b64_tr_b16 v[178:179], v13 offset:2624
    v_mfma_f32_16x16x32_bf16 v[108:111], v[204:207], v[48:51], v[108:111]
    ds_read_b64_tr_b16 v[180:181], v13 offset:96
    ds_read_b64_tr_b16 v[182:183], v13 offset:2656
    buffer_load_dwordx4 v[92:95], v4, s[32:35], 0 offen offset:1216
    v_mfma_f32_16x16x32_bf16 v[112:115], v[208:211], v[48:51], v[112:115]
    ds_read_b64_tr_b16 v[184:185], v13 offset:128
    ds_read_b64_tr_b16 v[186:187], v13 offset:2688
    v_mfma_f32_16x16x32_bf16 v[116:119], v[212:215], v[48:51], v[116:119]
    ds_read_b64_tr_b16 v[188:189], v11 offset:12800
    ds_read_b64_tr_b16 v[190:191], v11 offset:13440
    s_add_u32 m0, s27, 0
    s_nop 0
    buffer_load_dwordx4 v6, s[36:39], s26 offen lds
    v_mfma_f32_16x16x32_bf16 v[240:243], v[236:239], v[48:51], v[240:243]
    v_mfma_f32_16x16x32_bf16 v[244:247], v[48:51], v[48:51], v[244:247]
    s_cmp_lg_u32 s3, 0
    s_cbranch_scc1 qkv0_kernel_cs17
    v_mfma_f32_16x16x32_bf16 v[120:123], v[192:195], v[236:239], v[120:123]
    v_mfma_f32_16x16x32_bf16 v[124:127], v[196:199], v[236:239], v[124:127]
    v_mfma_f32_16x16x32_bf16 v[128:131], v[200:203], v[236:239], v[128:131]
    v_mfma_f32_16x16x32_bf16 v[132:135], v[204:207], v[236:239], v[132:135]
    v_mfma_f32_16x16x32_bf16 v[136:139], v[208:211], v[236:239], v[136:139]
    v_mfma_f32_16x16x32_bf16 v[140:143], v[212:215], v[236:239], v[140:143]
qkv0_kernel_cs17:
    s_cmp_lg_u32 s17, 0
    s_cbranch_scc1 qkv0_kernel_sk18
    s_add_u32 s22, s21, 8192
    buffer_store_dwordx4 v[48:51], v5, s[56:59], s22 offen
qkv0_kernel_sk18:
    s_waitcnt lgkmcnt(12)
    v_mfma_f32_16x16x32_bf16 v[96:99], v[144:147], v[52:55], v[96:99]
    ds_read_b64_tr_b16 v[192:193], v13 offset:5120
    ds_read_b64_tr_b16 v[194:195], v13 offset:7680
    v_mfma_f32_16x16x32_bf16 v[100:103], v[148:151], v[52:55], v[100:103]
    ds_read_b64_tr_b16 v[196:197], v13 offset:5152
    ds_read_b64_tr_b16 v[198:199], v13 offset:7712
    s_add_u32 m0, s27, 1024
    s_nop 0
    buffer_load_dwordx4 v7, s[36:39], s26 offen lds
    v_mfma_f32_16x16x32_bf16 v[104:107], v[152:155], v[52:55], v[104:107]
    ds_read_b64_tr_b16 v[200:201], v13 offset:5184
    ds_read_b64_tr_b16 v[202:203], v13 offset:7744
    v_mfma_f32_16x16x32_bf16 v[108:111], v[156:159], v[52:55], v[108:111]
    ds_read_b64_tr_b16 v[204:205], v13 offset:5216
    ds_read_b64_tr_b16 v[206:207], v13 offset:7776
    s_add_u32 m0, s27, 2048
    s_nop 0
    buffer_load_dwordx4 v8, s[36:39], s26 offen lds
    v_mfma_f32_16x16x32_bf16 v[112:115], v[160:163], v[52:55], v[112:115]
    ds_read_b64_tr_b16 v[208:209], v13 offset:5248
    ds_read_b64_tr_b16 v[210:211], v13 offset:7808
    v_mfma_f32_16x16x32_bf16 v[116:119], v[164:167], v[52:55], v[116:119]
    ds_read_b64_tr_b16 v[212:213], v11 offset:14080
    ds_read_b64_tr_b16 v[214:215], v11 offset:14720
    s_add_u32 m0, s27, 3072
    s_nop 0
    buffer_load_dwordx4 v9, s[36:39], s26 offen lds
    v_mfma_f32_16x16x32_bf16 v[240:243], v[236:239], v[52:55], v[240:243]
    v_mfma_f32_16x16x32_bf16 v[244:247], v[52:55], v[52:55], v[244:247]
    s_cmp_lg_u32 s3, 1
    s_cbranch_scc1 qkv0_kernel_cs19
    v_mfma_f32_16x16x32_bf16 v[120:123], v[144:147], v[236:239], v[120:123]
    v_mfma_f32_16x16x32_bf16 v[124:127], v[148:151], v[236:239], v[124:127]
    v_mfma_f32_16x16x32_bf16 v[128:131], v[152:155], v[236:239], v[128:131]
    v_mfma_f32_16x16x32_bf16 v[132:135], v[156:159], v[236:239], v[132:135]
    v_mfma_f32_16x16x32_bf16 v[136:139], v[160:163], v[236:239], v[136:139]
    v_mfma_f32_16x16x32_bf16 v[140:143], v[164:167], v[236:239], v[140:143]
qkv0_kernel_cs19:
    s_cmp_lg_u32 s17, 1
    s_cbranch_scc1 qkv0_kernel_sk20
    s_add_u32 s22, s21, 9216
    buffer_store_dwordx4 v[52:55], v5, s[56:59], s22 offen
qkv0_kernel_sk20:
    s_waitcnt vmcnt(8)
    s_barrier
    ds_write_b64 v14, v[64:65] offset:0
    ds_write_b64 v14, v[66:67] offset:288
    ds_read_b128 v[64:67], v15 offset:0
    ds_write_b64 v14, v[68:69] offset:1152
    ds_write_b64 v14, v[70:71] offset:1440
    ds_read_b128 v[68:71], v15 offset:1152
    ds_write_b64 v14, v[72:73] offset:2304
    ds_write_b64 v14, v[74:75] offset:2592
    ds_read_b128 v[72:75], v15 offset:2304
    ds_write_b64 v14, v[76:77] offset:3456
    ds_write_b64 v14, v[78:79] offset:3744
    ds_read_b128 v[76:79], v15 offset:3456
    s_waitcnt lgkmcnt(12)
    v_mfma_f32_16x16x32_bf16 v[96:99], v[168:171], v[56:59], v[96:99]
    ds_read_b64_tr_b16 v[144:145], v13 offset:10240
    ds_read_b64_tr_b16 v[146:147], v13 offset:12800
    v_mfma_f32_16x16x32_bf16 v[100:103], v[172:175], v[56:59], v[100:103]
    ds_read_b64_tr_b16 v[148:149], v13 offset:10272
    ds_read_b64_tr_b16 v[150:151], v13 offset:12832
    s_add_u32 m0, s27, 4096
    s_nop 0
    buffer_load_dwordx4 v10, s[36:39], s26 offen lds
    v_mfma_f32_16x16x32_bf16 v[104:107], v[176:179], v[56:59], v[104:107]
    ds_read_b64_tr_b16 v[152:153], v13 offset:10304
    ds_read_b64_tr_b16 v[154:155], v13 offset:12864
    v_mfma_f32_16x16x32_bf16 v[108:111], v[180:183], v[56:59], v[108:111]
    ds_read_b64_tr_b16 v[156:157], v13 offset:10336
    ds_read_b64_tr_b16 v[158:159], v13 offset:12896
    s_add_u32 m0, s31, 102400
    s_add_u32 s30, s31, 4096
    buffer_load_dwordx4 v5, s[40:43], s31 offen lds
    v_mfma_f32_16x16x32_bf16 v[112:115], v[184:187], v[56:59], v[112:115]
    ds_read_b64_tr_b16 v[160:161], v13 offset:10368
    ds_read_b64_tr_b16 v[162:163], v13 offset:12928
    v_mfma_f32_16x16x32_bf16 v[116:119], v[188:191], v[56:59], v[116:119]
    ds_read_b64_tr_b16 v[164:165], v11 offset:15360
    ds_read_b64_tr_b16 v[166:167], v11 offset:16000
    s_add_u32 m0, s30, 102400
    s_nop 0
    buffer_load_dwordx4 v5, s[40:43], s30 offen lds
    s_add_u32 s31, s31, 5120
    v_mfma_f32_16x16x32_bf16 v[240:243], v[236:239], v[56:59], v[240:243]
    v_mfma_f32_16x16x32_bf16 v[244:247], v[56:59], v[56:59], v[244:247]
    s_cmp_lg_u32 s3, 2
    s_cbranch_scc1 qkv0_kernel_cs21
    v_mfma_f32_16x16x32_bf16 v[120:123], v[168:171], v[236:239], v[120:123]
    v_mfma_f32_16x16x32_bf16 v[124:127], v[172:175], v[236:239], v[124:127]
    v_mfma_f32_16x16x32_bf16 v[128:131], v[176:179], v[236:239], v[128:131]
    v_mfma_f32_16x16x32_bf16 v[132:135], v[180:183], v[236:239], v[132:135]
    v_mfma_f32_16x16x32_bf16 v[136:139], v[184:187], v[236:239], v[136:139]
    v_mfma_f32_16x16x32_bf16 v[140:143], v[188:191], v[236:239], v[140:143]
qkv0_kernel_cs21:
    s_cmp_lg_u32 s17, 2
    s_cbranch_scc1 qkv0_kernel_sk22
    s_add_u32 s22, s21, 10240
    buffer_store_dwordx4 v[56:59], v5, s[56:59], s22 offen
qkv0_kernel_sk22:
    s_waitcnt lgkmcnt(12)
    v_mfma_f32_16x16x32_bf16 v[96:99], v[192:195], v[60:63], v[96:99]
    ds_read_b64_tr_b16 v[168:169], v13 offset:15360
    ds_read_b64_tr_b16 v[170:171], v13 offset:17920
    v_mfma_f32_16x16x32_bf16 v[100:103], v[196:199], v[60:63], v[100:103]
    ds_read_b64_tr_b16 v[172:173], v13 offset:15392
    ds_read_b64_tr_b16 v[174:175], v13 offset:17952
    v_mfma_f32_16x16x32_bf16 v[104:107], v[200:203], v[60:63], v[104:107]
    ds_read_b64_tr_b16 v[176:177], v13 offset:15424
    ds_read_b64_tr_b16 v[178:179], v13 offset:17984
    v_mfma_f32_16x16x32_bf16 v[108:111], v[204:207], v[60:63], v[108:111]
    ds_read_b64_tr_b16 v[180:181], v13 offset:15456
    ds_read_b64_tr_b16 v[182:183], v13 offset:18016
    v_mfma_f32_16x16x32_bf16 v[112:115], v[208:211], v[60:63], v[112:115]
    ds_read_b64_tr_b16 v[184:185], v13 offset:15488
    ds_read_b64_tr_b16 v[186:187], v13 offset:18048
    v_mfma_f32_16x16x32_bf16 v[116:119], v[212:215], v[60:63], v[116:119]
    ds_read_b64_tr_b16 v[188:189], v11 offset:16640
    ds_read_b64_tr_b16 v[190:191], v11 offset:17280
    v_mfma_f32_16x16x32_bf16 v[240:243], v[236:239], v[60:63], v[240:243]
    v_mfma_f32_16x16x32_bf16 v[244:247], v[60:63], v[60:63], v[244:247]
    s_cmp_lg_u32 s3, 3
    s_cbranch_scc1 qkv0_kernel_cs23
    v_mfma_f32_16x16x32_bf16 v[120:123], v[192:195], v[236:239], v[120:123]
    v_mfma_f32_16x16x32_bf16 v[124:127], v[196:199], v[236:239], v[124:127]
    v_mfma_f32_16x16x32_bf16 v[128:131], v[200:203], v[236:239], v[128:131]
    v_mfma_f32_16x16x32_bf16 v[132:135], v[204:207], v[236:239], v[132:135]
    v_mfma_f32_16x16x32_bf16 v[136:139], v[208:211], v[236:239], v[136:139]
    v_mfma_f32_16x16x32_bf16 v[140:143], v[212:215], v[236:239], v[140:143]
qkv0_kernel_cs23:
    s_cmp_lg_u32 s17, 3
    s_cbranch_scc1 qkv0_kernel_sk24
    s_add_u32 s22, s21, 11264
    buffer_store_dwordx4 v[60:63], v5, s[56:59], s22 offen
qkv0_kernel_sk24:
    s_waitcnt lgkmcnt(12)
    v_mfma_f32_16x16x32_bf16 v[96:99], v[144:147], v[64:67], v[96:99]
    ds_read_b64_tr_b16 v[192:193], v13 offset:20480
    ds_read_b64_tr_b16 v[194:195], v13 offset:23040
    v_mfma_f32_16x16x32_bf16 v[100:103], v[148:151], v[64:67], v[100:103]
    ds_read_b64_tr_b16 v[196:197], v13 offset:20512
    ds_read_b64_tr_b16 v[198:199], v13 offset:23072
    v_mfma_f32_16x16x32_bf16 v[104:107], v[152:155], v[64:67], v[104:107]
    ds_read_b64_tr_b16 v[200:201], v13 offset:20544
    ds_read_b64_tr_b16 v[202:203], v13 offset:23104
    v_mfma_f32_16x16x32_bf16 v[108:111], v[156:159], v[64:67], v[108:111]
    ds_read_b64_tr_b16 v[204:205], v13 offset:20576
    ds_read_b64_tr_b16 v[206:207], v13 offset:23136
    v_mfma_f32_16x16x32_bf16 v[112:115], v[160:163], v[64:67], v[112:115]
    ds_read_b64_tr_b16 v[208:209], v13 offset:20608
    ds_read_b64_tr_b16 v[210:211], v13 offset:23168
    v_mfma_f32_16x16x32_bf16 v[116:119], v[164:167], v[64:67], v[116:119]
    ds_read_b64_tr_b16 v[212:213], v11 offset:17920
    ds_read_b64_tr_b16 v[214:215], v11 offset:18560
    v_mfma_f32_16x16x32_bf16 v[240:243], v[236:239], v[64:67], v[240:243]
    v_mfma_f32_16x16x32_bf16 v[244:247], v[64:67], v[64:67], v[244:247]
    s_cmp_lg_u32 s3, 0
    s_cbranch_scc1 qkv0_kernel_cs25
    v_mfma_f32_16x16x32_bf16 v[120:123], v[144:147], v[236:239], v[120:123]
    v_mfma_f32_16x16x32_bf16 v[124:127], v[148:151], v[236:239], v[124:127]
    v_mfma_f32_16x16x32_bf16 v[128:131], v[152:155], v[236:239], v[128:131]
    v_mfma_f32_16x16x32_bf16 v[132:135], v[156:159], v[236:239], v[132:135]
    v_mfma_f32_16x16x32_bf16 v[136:139], v[160:163], v[236:239], v[136:139]
    v_mfma_f32_16x16x32_bf16 v[140:143], v[164:167], v[236:239], v[140:143]
qkv0_kernel_cs25:
    s_cmp_lg_u32 s17, 4
    s_cbranch_scc1 qkv0_kernel_sk26
    s_add_u32 s22, s21, 12288
    buffer_store_dwordx4 v[64:67], v5, s[56:59], s22 offen
qkv0_kernel_sk26:
    s_waitcnt lgkmcnt(12)
    v_mfma_f32_16x16x32_bf16 v[96:99], v[168:171], v[68:71], v[96:99]
    ds_read_b64_tr_b16 v[144:145], v13 offset:25600
    ds_read_b64_tr_b16 v[146:147], v13 offset:28160
    v_mfma_f32_16x16x32_bf16 v[100:103], v[172:175], v[68:71], v[100:103]
    ds_read_b64_tr_b16 v[148:149], v13 offset:25632
    ds_read_b64_tr_b16 v[150:151], v13 offset:28192
    v_mfma_f32_16x16x32_bf16 v[104:107], v[176:179], v[68:71], v[104:107]
    ds_read_b64_tr_b16 v[152:153], v13 offset:25664
    ds_read_b64_tr_b16 v[154:155], v13 offset:28224
    v_mfma_f32_16x16x32_bf16 v[108:111], v[180:183], v[68:71], v[108:111]
    ds_read_b64_tr_b16 v[156:157], v13 offset:25696
    ds_read_b64_tr_b16 v[158:159], v13 offset:28256
    v_mfma_f32_16x16x32_bf16 v[112:115], v[184:187], v[68:71], v[112:115]
    ds_read_b64_tr_b16 v[160:161], v13 offset:25728
    ds_read_b64_tr_b16 v[162:163], v13 offset:28288
    v_mfma_f32_16x16x32_bf16 v[116:119], v[188:191], v[68:71], v[116:119]
    ds_read_b64_tr_b16 v[164:165], v11 offset:19200
    ds_read_b64_tr_b16 v[166:167], v11 offset:19840
    v_mfma_f32_16x16x32_bf16 v[240:243], v[236:239], v[68:71], v[240:243]
    v_mfma_f32_16x16x32_bf16 v[244:247], v[68:71], v[68:71], v[244:247]
    s_cmp_lg_u32 s3, 1
    s_cbranch_scc1 qkv0_kernel_cs27
    v_mfma_f32_16x16x32_bf16 v[120:123], v[168:171], v[236:239], v[120:123]
    v_mfma_f32_16x16x32_bf16 v[124:127], v[172:175], v[236:239], v[124:127]
    v_mfma_f32_16x16x32_bf16 v[128:131], v[176:179], v[236:239], v[128:131]
    v_mfma_f32_16x16x32_bf16 v[132:135], v[180:183], v[236:239], v[132:135]
    v_mfma_f32_16x16x32_bf16 v[136:139], v[184:187], v[236:239], v[136:139]
    v_mfma_f32_16x16x32_bf16 v[140:143], v[188:191], v[236:239], v[140:143]
qkv0_kernel_cs27:
    s_cmp_lg_u32 s17, 5
    s_cbranch_scc1 qkv0_kernel_sk28
    s_add_u32 s22, s21, 13312
    buffer_store_dwordx4 v[68:71], v5, s[56:59], s22 offen
qkv0_kernel_sk28:
    s_waitcnt vmcnt(0)
    s_barrier
    ds_write_b64 v14, v[80:81] offset:4608
    ds_write_b64 v14, v[82:83] offset:4896
    ds_read_b128 v[80:83], v15 offset:4608
    ds_write_b64 v14, v[84:85] offset:5760
    ds_write_b64 v14, v[86:87] offset:6048
    ds_read_b128 v[84:87], v15 offset:5760
    ds_write_b64 v14, v[88:89] offset:0
    ds_write_b64 v14, v[90:91] offset:288
    ds_read_b128 v[88:91], v15 offset:0
    ds_write_b64 v14, v[92:93] offset:1152
    ds_write_b64 v14, v[94:95] offset:1440
    ds_read_b128 v[92:95], v15 offset:1152
    s_waitcnt lgkmcnt(12)
    v_mfma_f32_16x16x32_bf16 v[96:99], v[192:195], v[72:75], v[96:99]
    ds_read_b64_tr_b16 v[168:169], v13 offset:30720
    ds_read_b64_tr_b16 v[170:171], v13 offset:33280
    v_mfma_f32_16x16x32_bf16 v[100:103], v[196:199], v[72:75], v[100:103]
    ds_read_b64_tr_b16 v[172:173], v13 offset:30752
    ds_read_b64_tr_b16 v[174:175], v13 offset:33312
    v_mfma_f32_16x16x32_bf16 v[104:107], v[200:203], v[72:75], v[104:107]
    ds_read_b64_tr_b16 v[176:177], v13 offset:30784
    ds_read_b64_tr_b16 v[178:179], v13 offset:33344
    v_mfma_f32_16x16x32_bf16 v[108:111], v[204:207], v[72:75], v[108:111]
    ds_read_b64_tr_b16 v[180:181], v13 offset:30816
    ds_read_b64_tr_b16 v[182:183], v13 offset:33376
    v_mfma_f32_16x16x32_bf16 v[112:115], v[208:211], v[72:75], v[112:115]
    ds_read_b64_tr_b16 v[184:185], v13 offset:30848
    ds_read_b64_tr_b16 v[186:187], v13 offset:33408
    v_mfma_f32_16x16x32_bf16 v[116:119], v[212:215], v[72:75], v[116:119]
    ds_read_b64_tr_b16 v[188:189], v11 offset:20480
    ds_read_b64_tr_b16 v[190:191], v11 offset:21120
    v_mfma_f32_16x16x32_bf16 v[240:243], v[236:239], v[72:75], v[240:243]
    v_mfma_f32_16x16x32_bf16 v[244:247], v[72:75], v[72:75], v[244:247]
    s_cmp_lg_u32 s3, 2
    s_cbranch_scc1 qkv0_kernel_cs29
    v_mfma_f32_16x16x32_bf16 v[120:123], v[192:195], v[236:239], v[120:123]
    v_mfma_f32_16x16x32_bf16 v[124:127], v[196:199], v[236:239], v[124:127]
    v_mfma_f32_16x16x32_bf16 v[128:131], v[200:203], v[236:239], v[128:131]
    v_mfma_f32_16x16x32_bf16 v[132:135], v[204:207], v[236:239], v[132:135]
    v_mfma_f32_16x16x32_bf16 v[136:139], v[208:211], v[236:239], v[136:139]
    v_mfma_f32_16x16x32_bf16 v[140:143], v[212:215], v[236:239], v[140:143]
qkv0_kernel_cs29:
    s_cmp_lg_u32 s17, 6
    s_cbranch_scc1 qkv0_kernel_sk30
    s_add_u32 s22, s21, 14336
    buffer_store_dwordx4 v[72:75], v5, s[56:59], s22 offen
qkv0_kernel_sk30:
    s_waitcnt lgkmcnt(12)
    v_mfma_f32_16x16x32_bf16 v[96:99], v[144:147], v[76:79], v[96:99]
    ds_read_b64_tr_b16 v[192:193], v13 offset:35840
    ds_read_b64_tr_b16 v[194:195], v13 offset:38400
    v_mfma_f32_16x16x32_bf16 v[100:103], v[148:151], v[76:79], v[100:103]
    ds_read_b64_tr_b16 v[196:197], v13 offset:35872
    ds_read_b64_tr_b16 v[198:199], v13 offset:38432
    v_mfma_f32_16x16x32_bf16 v[104:107], v[152:155], v[76:79], v[104:107]
    ds_read_b64_tr_b16 v[200:201], v13 offset:35904
    ds_read_b64_tr_b16 v[202:203], v13 offset:38464
    v_mfma_f32_16x16x32_bf16 v[108:111], v[156:159], v[76:79], v[108:111]
    ds_read_b64_tr_b16 v[204:205], v13 offset:35936
    ds_read_b64_tr_b16 v[206:207], v13 offset:38496
    v_mfma_f32_16x16x32_bf16 v[112:115], v[160:163], v[76:79], v[112:115]
    ds_read_b64_tr_b16 v[208:209], v13 offset:35968
    ds_read_b64_tr_b16 v[210:211], v13 offset:38528
    v_mfma_f32_16x16x32_bf16 v[116:119], v[164:167], v[76:79], v[116:119]
    ds_read_b64_tr_b16 v[212:213], v11 offset:21760
    ds_read_b64_tr_b16 v[214:215], v11 offset:22400
    v_mfma_f32_16x16x32_bf16 v[240:243], v[236:239], v[76:79], v[240:243]
    v_mfma_f32_16x16x32_bf16 v[244:247], v[76:79], v[76:79], v[244:247]
    s_cmp_lg_u32 s3, 3
    s_cbranch_scc1 qkv0_kernel_cs31
    v_mfma_f32_16x16x32_bf16 v[120:123], v[144:147], v[236:239], v[120:123]
    v_mfma_f32_16x16x32_bf16 v[124:127], v[148:151], v[236:239], v[124:127]
    v_mfma_f32_16x16x32_bf16 v[128:131], v[152:155], v[236:239], v[128:131]
    v_mfma_f32_16x16x32_bf16 v[132:135], v[156:159], v[236:239], v[132:135]
    v_mfma_f32_16x16x32_bf16 v[136:139], v[160:163], v[236:239], v[136:139]
    v_mfma_f32_16x16x32_bf16 v[140:143], v[164:167], v[236:239], v[140:143]
qkv0_kernel_cs31:
    s_cmp_lg_u32 s17, 7
    s_cbranch_scc1 qkv0_kernel_sk32
    s_add_u32 s22, s21, 15360
    buffer_store_dwordx4 v[76:79], v5, s[56:59], s22 offen
qkv0_kernel_sk32:
    s_waitcnt lgkmcnt(12)
    v_mfma_f32_16x16x32_bf16 v[96:99], v[168:171], v[80:83], v[96:99]
    ds_read_b64_tr_b16 v[144:145], v13 offset:40960
    ds_read_b64_tr_b16 v[146:147], v13 offset:43520
    v_mfma_f32_16x16x32_bf16 v[100:103], v[172:175], v[80:83], v[100:103]
    ds_read_b64_tr_b16 v[148:149], v13 offset:40992
    ds_read_b64_tr_b16 v[150:151], v13 offset:43552
    v_mfma_f32_16x16x32_bf16 v[104:107], v[176:179], v[80:83], v[104:107]
    ds_read_b64_tr_b16 v[152:153], v13 offset:41024
    ds_read_b64_tr_b16 v[154:155], v13 offset:43584
    v_mfma_f32_16x16x32_bf16 v[108:111], v[180:183], v[80:83], v[108:111]
    ds_read_b64_tr_b16 v[156:157], v13 offset:41056
    ds_read_b64_tr_b16 v[158:159], v13 offset:43616
    v_mfma_f32_16x16x32_bf16 v[112:115], v[184:187], v[80:83], v[112:115]
    ds_read_b64_tr_b16 v[160:161], v13 offset:41088
    ds_read_b64_tr_b16 v[162:163], v13 offset:43648
    v_mfma_f32_16x16x32_bf16 v[116:119], v[188:191], v[80:83], v[116:119]
    ds_read_b64_tr_b16 v[164:165], v11 offset:23040
    ds_read_b64_tr_b16 v[166:167], v11 offset:23680
    v_mfma_f32_16x16x32_bf16 v[240:243], v[236:239], v[80:83], v[240:243]
    v_mfma_f32_16x16x32_bf16 v[244:247], v[80:83], v[80:83], v[244:247]
    s_cmp_lg_u32 s3, 0
    s_cbranch_scc1 qkv0_kernel_cs33
    v_mfma_f32_16x16x32_bf16 v[120:123], v[168:171], v[236:239], v[120:123]
    v_mfma_f32_16x16x32_bf16 v[124:127], v[172:175], v[236:239], v[124:127]
    v_mfma_f32_16x16x32_bf16 v[128:131], v[176:179], v[236:239], v[128:131]
    v_mfma_f32_16x16x32_bf16 v[132:135], v[180:183], v[236:239], v[132:135]
    v_mfma_f32_16x16x32_bf16 v[136:139], v[184:187], v[236:239], v[136:139]
    v_mfma_f32_16x16x32_bf16 v[140:143], v[188:191], v[236:239], v[140:143]
qkv0_kernel_cs33:
    s_cmp_lg_u32 s17, 0
    s_cbranch_scc1 qkv0_kernel_sk34
    s_add_u32 s22, s21, 16384
    buffer_store_dwordx4 v[80:83], v5, s[56:59], s22 offen
qkv0_kernel_sk34:
    s_waitcnt lgkmcnt(12)
    v_mfma_f32_16x16x32_bf16 v[96:99], v[192:195], v[84:87], v[96:99]
    ds_read_b64_tr_b16 v[168:169], v13 offset:46080
    ds_read_b64_tr_b16 v[170:171], v13 offset:48640
    v_mfma_f32_16x16x32_bf16 v[100:103], v[196:199], v[84:87], v[100:103]
    ds_read_b64_tr_b16 v[172:173], v13 offset:46112
    ds_read_b64_tr_b16 v[174:175], v13 offset:48672
    v_mfma_f32_16x16x32_bf16 v[104:107], v[200:203], v[84:87], v[104:107]
    ds_read_b64_tr_b16 v[176:177], v13 offset:46144
    ds_read_b64_tr_b16 v[178:179], v13 offset:48704
    v_mfma_f32_16x16x32_bf16 v[108:111], v[204:207], v[84:87], v[108:111]
    ds_read_b64_tr_b16 v[180:181], v13 offset:46176
    ds_read_b64_tr_b16 v[182:183], v13 offset:48736
    v_mfma_f32_16x16x32_bf16 v[112:115], v[208:211], v[84:87], v[112:115]
    ds_read_b64_tr_b16 v[184:185], v13 offset:46208
    ds_read_b64_tr_b16 v[186:187], v13 offset:48768
    v_mfma_f32_16x16x32_bf16 v[116:119], v[212:215], v[84:87], v[116:119]
    ds_read_b64_tr_b16 v[188:189], v11 offset:24320
    ds_read_b64_tr_b16 v[190:191], v11 offset:24960
    v_mfma_f32_16x16x32_bf16 v[240:243], v[236:239], v[84:87], v[240:243]
    v_mfma_f32_16x16x32_bf16 v[244:247], v[84:87], v[84:87], v[244:247]
    s_cmp_lg_u32 s3, 1
    s_cbranch_scc1 qkv0_kernel_cs35
    v_mfma_f32_16x16x32_bf16 v[120:123], v[192:195], v[236:239], v[120:123]
    v_mfma_f32_16x16x32_bf16 v[124:127], v[196:199], v[236:239], v[124:127]
    v_mfma_f32_16x16x32_bf16 v[128:131], v[200:203], v[236:239], v[128:131]
    v_mfma_f32_16x16x32_bf16 v[132:135], v[204:207], v[236:239], v[132:135]
    v_mfma_f32_16x16x32_bf16 v[136:139], v[208:211], v[236:239], v[136:139]
    v_mfma_f32_16x16x32_bf16 v[140:143], v[212:215], v[236:239], v[140:143]
qkv0_kernel_cs35:
    s_cmp_lg_u32 s17, 1
    s_cbranch_scc1 qkv0_kernel_sk36
    s_add_u32 s22, s21, 17408
    buffer_store_dwordx4 v[84:87], v5, s[56:59], s22 offen
qkv0_kernel_sk36:
    s_waitcnt lgkmcnt(12)
    v_mfma_f32_16x16x32_bf16 v[96:99], v[144:147], v[88:91], v[96:99]
    v_mfma_f32_16x16x32_bf16 v[100:103], v[148:151], v[88:91], v[100:103]
    v_mfma_f32_16x16x32_bf16 v[104:107], v[152:155], v[88:91], v[104:107]
    v_mfma_f32_16x16x32_bf16 v[108:111], v[156:159], v[88:91], v[108:111]
    v_mfma_f32_16x16x32_bf16 v[112:115], v[160:163], v[88:91], v[112:115]
    v_mfma_f32_16x16x32_bf16 v[116:119], v[164:167], v[88:91], v[116:119]
    v_mfma_f32_16x16x32_bf16 v[240:243], v[236:239], v[88:91], v[240:243]
    v_mfma_f32_16x16x32_bf16 v[244:247], v[88:91], v[88:91], v[244:247]
    s_cmp_lg_u32 s3, 2
    s_cbranch_scc1 qkv0_kernel_cs37
    v_mfma_f32_16x16x32_bf16 v[120:123], v[144:147], v[236:239], v[120:123]
    v_mfma_f32_16x16x32_bf16 v[124:127], v[148:151], v[236:239], v[124:127]
    v_mfma_f32_16x16x32_bf16 v[128:131], v[152:155], v[236:239], v[128:131]
    v_mfma_f32_16x16x32_bf16 v[132:135], v[156:159], v[236:239], v[132:135]
    v_mfma_f32_16x16x32_bf16 v[136:139], v[160:163], v[236:239], v[136:139]
    v_mfma_f32_16x16x32_bf16 v[140:143], v[164:167], v[236:239], v[140:143]
qkv0_kernel_cs37:
    s_cmp_lg_u32 s17, 2
    s_cbranch_scc1 qkv0_kernel_sk38
    s_add_u32 s22, s21, 18432
    buffer_store_dwordx4 v[88:91], v5, s[56:59], s22 offen
qkv0_kernel_sk38:
    s_waitcnt lgkmcnt(0)
    v_mfma_f32_16x16x32_bf16 v[96:99], v[168:171], v[92:95], v[96:99]
    v_mfma_f32_16x16x32_bf16 v[100:103], v[172:175], v[92:95], v[100:103]
    v_mfma_f32_16x16x32_bf16 v[104:107], v[176:179], v[92:95], v[104:107]
    v_mfma_f32_16x16x32_bf16 v[108:111], v[180:183], v[92:95], v[108:111]
    v_mfma_f32_16x16x32_bf16 v[112:115], v[184:187], v[92:95], v[112:115]
    v_mfma_f32_16x16x32_bf16 v[116:119], v[188:191], v[92:95], v[116:119]
    v_mfma_f32_16x16x32_bf16 v[240:243], v[236:239], v[92:95], v[240:243]
    v_mfma_f32_16x16x32_bf16 v[244:247], v[92:95], v[92:95], v[244:247]
    s_cmp_lg_u32 s3, 3
    s_cbranch_scc1 qkv0_kernel_cs39
    v_mfma_f32_16x16x32_bf16 v[120:123], v[168:171], v[236:239], v[120:123]
    v_mfma_f32_16x16x32_bf16 v[124:127], v[172:175], v[236:239], v[124:127]
    v_mfma_f32_16x16x32_bf16 v[128:131], v[176:179], v[236:239], v[128:131]
    v_mfma_f32_16x16x32_bf16 v[132:135], v[180:183], v[236:239], v[132:135]
    v_mfma_f32_16x16x32_bf16 v[136:139], v[184:187], v[236:239], v[136:139]
    v_mfma_f32_16x16x32_bf16 v[140:143], v[188:191], v[236:239], v[140:143]
qkv0_kernel_cs39:
    s_cmp_lg_u32 s17, 3
    s_cbranch_scc1 qkv0_kernel_sk40
    s_add_u32 s22, s21, 19456
    buffer_store_dwordx4 v[92:95], v5, s[56:59], s22 offen
qkv0_kernel_sk40:
    s_mul_i32 s28, s3, 384
    s_add_u32 s28, s28, 131072
    v_lshlrev_b32 v12, 4, v2
    v_add_u32 v13, s28, v12
    v_add_u32 v12, 131072, v12
    v_lshrrev_b32 v14, 2, v3
    v_and_b32 v15, 3, v3
    s_nop 2
    ds_write_b128 v13, v[120:123] offset:0
    ds_write_b128 v13, v[124:127] offset:64
    ds_write_b128 v13, v[128:131] offset:128
    ds_write_b128 v13, v[132:135] offset:192
    ds_write_b128 v13, v[136:139] offset:256
    ds_write_b128 v13, v[140:143] offset:320
    v_mov_b32 v216, v240
    v_mov_b32 v218, v244
    v_cmp_eq_u32 vcc, 1, v15
    s_nop 1
    v_cndmask_b32 v218, v218, v245, vcc
    v_cmp_eq_u32 vcc, 2, v15
    s_nop 1
    v_cndmask_b32 v218, v218, v246, vcc
    v_cmp_eq_u32 vcc, 3, v15
    s_nop 1
    v_cndmask_b32 v218, v218, v247, vcc
    v_cmp_eq_u32 vcc, v14, v2
    s_nop 1
    v_cndmask_b32 v218, 0, v218, vcc
    v_mov_b32 v221, v218
    s_nop 1
    v_permlane16_swap_b32 v218, v221
    v_add_f32 v218, v218, v221
    v_mov_b32 v221, v218
    s_nop 1
    v_permlane32_swap_b32 v218, v221
    v_add_f32 v218, v218, v221
    s_waitcnt lgkmcnt(0)
    s_barrier
    ds_read_b128 v[16:19], v12 offset:0
    ds_read_b128 v[20:23], v12 offset:64
    ds_read_b128 v[24:27], v12 offset:128
    ds_read_b128 v[28:31], v12 offset:192
    ds_read_b128 v[32:35], v12 offset:256
    ds_read_b128 v[36:39], v12 offset:320
    ds_read_b128 v[40:43], v12 offset:384
    ds_read_b128 v[44:47], v12 offset:448
    ds_read_b128 v[48:51], v12 offset:512
    ds_read_b128 v[52:55], v12 offset:576
    ds_read_b128 v[56:59], v12 offset:640
    ds_read_b128 v[60:63], v12 offset:704
    ds_read_b128 v[64:67], v12 offset:768
    ds_read_b128 v[68:71], v12 offset:832
    ds_read_b128 v[72:75], v12 offset:896
    ds_read_b128 v[76:79], v12 offset:960
    ds_read_b128 v[80:83], v12 offset:1024
    ds_read_b128 v[84:87], v12 offset:1088
    ds_read_b128 v[144:147], v12 offset:1152
    ds_read_b128 v[148:151], v12 offset:1216
    ds_read_b128 v[152:155], v12 offset:1280
    ds_read_b128 v[156:159], v12 offset:1344
    ds_read_b128 v[160:163], v12 offset:1408
    ds_read_b128 v[164:167], v12 offset:1472
    v_mul_f32 v216, 0x3acccccd, v216
    v_mul_f32 v218, 0x3acccccd, v218
    v_fma_f32 v218, -v216, v216, v218
    v_max_f32 v218, 0, v218
    v_add_f32 v218, 0x3727c5ac, v218
    v_rsq_f32 v217, v218
    v_sub_f32 v216, 0, v216
    v_mul_f32 v219, 0x3ea52b5c, v217
    s_waitcnt lgkmcnt(0)
    v_add_f32 v16, v16, v40
    v_add_f32 v64, v64, v144
    v_add_f32 v17, v17, v41
    v_add_f32 v65, v65, v145
    v_add_f32 v18, v18, v42
    v_add_f32 v66, v66, v146
    v_add_f32 v19, v19, v43
    v_add_f32 v67, v67, v147
    v_add_f32 v20, v20, v44
    v_add_f32 v68, v68, v148
    v_add_f32 v21, v21, v45
    v_add_f32 v69, v69, v149
    v_add_f32 v22, v22, v46
    v_add_f32 v70, v70, v150
    v_add_f32 v23, v23, v47
    v_add_f32 v71, v71, v151
    v_add_f32 v24, v24, v48
    v_add_f32 v72, v72, v152
    v_add_f32 v25, v25, v49
    v_add_f32 v73, v73, v153
    v_add_f32 v26, v26, v50
    v_add_f32 v74, v74, v154
    v_add_f32 v27, v27, v51
    v_add_f32 v75, v75, v155
    v_add_f32 v28, v28, v52
    v_add_f32 v76, v76, v156
    v_add_f32 v29, v29, v53
    v_add_f32 v77, v77, v157
    v_add_f32 v30, v30, v54
    v_add_f32 v78, v78, v158
    v_add_f32 v31, v31, v55
    v_add_f32 v79, v79, v159
    v_add_f32 v32, v32, v56
    v_add_f32 v80, v80, v160
    v_add_f32 v33, v33, v57
    v_add_f32 v81, v81, v161
    v_add_f32 v34, v34, v58
    v_add_f32 v82, v82, v162
    v_add_f32 v35, v35, v59
    v_add_f32 v83, v83, v163
    v_add_f32 v36, v36, v60
    v_add_f32 v84, v84, v164
    v_add_f32 v37, v37, v61
    v_add_f32 v85, v85, v165
    v_add_f32 v38, v38, v62
    v_add_f32 v86, v86, v166
    v_add_f32 v39, v39, v63
    v_add_f32 v87, v87, v167
    v_add_f32 v16, v16, v64
    v_fma_f32 v96, v16, v216, v96
    v_mul_f32 v96, v96, v219
    v_add_f32 v17, v17, v65
    v_fma_f32 v97, v17, v216, v97
    v_mul_f32 v97, v97, v219
    v_add_f32 v18, v18, v66
    v_fma_f32 v98, v18, v216, v98
    v_mul_f32 v98, v98, v219
    v_add_f32 v19, v19, v67
    v_fma_f32 v99, v19, v216, v99
    v_mul_f32 v99, v99, v219
    v_add_f32 v20, v20, v68
    v_fma_f32 v100, v20, v216, v100
    v_mul_f32 v100, v100, v219
    v_add_f32 v21, v21, v69
    v_fma_f32 v101, v21, v216, v101
    v_mul_f32 v101, v101, v219
    v_add_f32 v22, v22, v70
    v_fma_f32 v102, v22, v216, v102
    v_mul_f32 v102, v102, v219
    v_add_f32 v23, v23, v71
    v_fma_f32 v103, v23, v216, v103
    v_mul_f32 v103, v103, v219
    v_add_f32 v24, v24, v72
    v_fma_f32 v104, v24, v216, v104
    v_mul_f32 v104, v104, v219
    v_add_f32 v25, v25, v73
    v_fma_f32 v105, v25, v216, v105
    v_mul_f32 v105, v105, v219
    v_add_f32 v26, v26, v74
    v_fma_f32 v106, v26, v216, v106
    v_mul_f32 v106, v106, v219
    v_add_f32 v27, v27, v75
    v_fma_f32 v107, v27, v216, v107
    v_mul_f32 v107, v107, v219
    v_add_f32 v28, v28, v76
    v_fma_f32 v108, v28, v216, v108
    v_mul_f32 v108, v108, v219
    v_add_f32 v29, v29, v77
    v_fma_f32 v109, v29, v216, v109
    v_mul_f32 v109, v109, v219
    v_add_f32 v30, v30, v78
    v_fma_f32 v110, v30, v216, v110
    v_mul_f32 v110, v110, v219
    v_add_f32 v31, v31, v79
    v_fma_f32 v111, v31, v216, v111
    v_mul_f32 v111, v111, v219
    v_add_f32 v32, v32, v80
    v_fma_f32 v112, v32, v216, v112
    v_mul_f32 v112, v112, v219
    v_add_f32 v33, v33, v81
    v_fma_f32 v113, v33, v216, v113
    v_mul_f32 v113, v113, v219
    v_add_f32 v34, v34, v82
    v_fma_f32 v114, v34, v216, v114
    v_mul_f32 v114, v114, v219
    v_add_f32 v35, v35, v83
    v_fma_f32 v115, v35, v216, v115
    v_mul_f32 v115, v115, v219
    v_add_f32 v36, v36, v84
    v_fma_f32 v116, v36, v216, v116
    v_mul_f32 v116, v116, v217
    v_add_f32 v37, v37, v85
    v_fma_f32 v117, v37, v216, v117
    v_mul_f32 v117, v117, v217
    v_add_f32 v38, v38, v86
    v_fma_f32 v118, v38, v216, v118
    v_mul_f32 v118, v118, v217
    v_add_f32 v39, v39, v87
    v_fma_f32 v119, v39, v216, v119
    v_mul_f32 v119, v119, v217
    v_cvt_pk_bf16_f32 v222, v96, v97
    v_cvt_pk_bf16_f32 v223, v98, v99
    v_cvt_pk_bf16_f32 v224, v100, v101
    v_cvt_pk_bf16_f32 v225, v102, v103
    v_cvt_pk_bf16_f32 v226, v104, v105
    v_cvt_pk_bf16_f32 v227, v106, v107
    v_cvt_pk_bf16_f32 v228, v108, v109
    v_cvt_pk_bf16_f32 v229, v110, v111
    v_cvt_pk_bf16_f32 v230, v112, v113
    v_cvt_pk_bf16_f32 v231, v114, v115
    v_cvt_pk_bf16_f32 v232, v116, v117
    v_cvt_pk_bf16_f32 v233, v118, v119
    s_cmp_eq_u32 s25, 1
    s_cbranch_scc1 qkv0_kernel_odd41
    buffer_store_dwordx4 v[222:225], v5, s[44:47], s24 offen
    buffer_store_dwordx4 v[226:229], v5, s[44:47], s24 offen offset:1024
    buffer_store_dwordx2 v[230:231], v5, s[44:47], s24 offen offset:2048
    s_branch qkv0_kernel_done42
qkv0_kernel_odd41:
    buffer_store_dwordx2 v[222:223], v5, s[44:47], s24 offen offset:8
    buffer_store_dwordx4 v[224:227], v5, s[44:47], s24 offen offset:1024
    buffer_store_dwordx4 v[228:231], v5, s[44:47], s24 offen offset:2048
qkv0_kernel_done42:
    s_cmp_ge_u32 s17, 4
    s_cbranch_scc1 qkv0_kernel_kvdone43
    s_lshr_b32 s26, s20, 5
    s_mul_i32 s26, s26, 3072
    s_and_b32 s27, s3, 1
    s_lshl_b32 s29, s27, 4
    v_add_u32 v13, s29, v3
    v_mov_b32 v18, 0x7ffffff0
    s_cmp_ge_u32 s17, 2
    s_cbranch_scc1 qkv0_kernel_isV44
    v_lshrrev_b32 v14, 1, v2
    v_lshl_add_u32 v14, v14, 5, v13
    v_lshlrev_b32 v14, 4, v14
    v_and_b32 v15, 1, v2
    v_lshl_add_u32 v14, v15, 3, v14
    v_lshlrev_b32 v15, 3, v13
    v_lshl_add_u32 v15, v2, 8, v15
    v_add_u32 v15, 1024, v15
    v_mov_b32 v22, 0x3f80
    v_cmp_gt_u32 vcc, 2, v2
    s_nop 1
    v_cndmask_b32 v15, v18, v15, vcc
    v_cmp_eq_u32 vcc, 0, v2
    s_nop 1
    v_cndmask_b32 v19, 0, v232, vcc
    v_cndmask_b32 v20, 0, v233, vcc
    v_cndmask_b32 v22, v22, v232, vcc
    v_cndmask_b32 v23, 0, v233, vcc
    s_cmp_eq_u32 s25, 0
    s_cselect_b64 vcc, -1, 0
    s_nop 1
    v_cndmask_b32 v14, v15, v14, vcc
    v_cndmask_b32 v19, v19, v232, vcc
    v_cndmask_b32 v20, v20, v233, vcc
    v_cndmask_b32 v232, v22, v232, vcc
    v_cndmask_b32 v233, v23, v233, vcc
    buffer_store_dwordx2 v[232:233], v14, s[48:51], s26 offen
    v_mov_b32 v21, 0
    v_dot2_f32_bf16 v21, v19, v19, v21
    v_dot2_f32_bf16 v21, v20, v20, v21
    s_nop 2
    v_mov_b32 v24, v21
    s_nop 1
    v_permlane16_swap_b32 v21, v24
    v_add_f32 v21, v21, v24
    v_mov_b32 v24, v21
    s_nop 1
    v_permlane32_swap_b32 v21, v24
    v_add_f32 v21, v21, v24
    s_nop 1
    v_max_f32_dpp v21, v21, v21 row_ror:8 row_mask:0xf bank_mask:0xf
    s_nop 1
    v_max_f32_dpp v21, v21, v21 row_ror:4 row_mask:0xf bank_mask:0xf
    s_nop 1
    v_max_f32_dpp v21, v21, v21 row_ror:2 row_mask:0xf bank_mask:0xf
    s_nop 1
    v_max_f32_dpp v21, v21, v21 row_ror:1 row_mask:0xf bank_mask:0xf
    s_lshl_b32 s29, s25, 7
    s_lshl_b32 s30, s16, 2
    s_add_u32 s29, s29, s30
    s_add_u32 s29, s29, s3
    s_lshl_b32 s29, s29, 2
    v_mov_b32 v13, 0
    v_cmp_eq_u32 vcc, 0, v1
    s_nop 1
    v_cndmask_b32 v13, v18, v13, vcc
    buffer_store_dword v21, v13, s[52:55], s29 offen
    s_branch qkv0_kernel_kvdone43
qkv0_kernel_isV44:
    s_mul_i32 s29, s27, 768
    s_lshl_b32 s30, s25, 8
    s_add_u32 s29, s29, s30
    s_add_u32 s29, s29, 1536
    v_bfe_u32 v14, v3, 2, 1
    v_mul_u32_u24 v14, 384, v14
    v_lshl_add_u32 v14, v2, 6, v14
    v_and_b32 v15, 3, v3
    v_lshl_add_u32 v14, v15, 1, v14
    v_lshrrev_b32 v15, 3, v3
    v_lshl_add_u32 v14, v15, 3, v14
    v_add_u32 v14, s29, v14
    v_mov_b32 v19, v14
    v_mov_b32 v20, v14
    s_cmp_eq_u32 s25, 0
    s_cbranch_scc1 qkv0_kernel_isV44_st
    v_cmp_eq_u32 vcc, 1, v2
    v_mov_b32 v21, 0x3f80
    s_nop 0
    v_cndmask_b32 v232, v232, v21, vcc
    v_cmp_gt_u32 vcc, 2, v2
    s_nop 1
    v_cndmask_b32 v19, v18, v14, vcc
    v_cmp_gt_u32 vcc, 1, v2
    s_nop 1
    v_cndmask_b32 v20, v18, v14, vcc
qkv0_kernel_isV44_st:
    buffer_store_short v232, v19, s[48:51], s26 offen
    buffer_store_short_d16_hi v232, v19, s[48:51], s26 offen offset:16
    buffer_store_short v233, v20, s[48:51], s26 offen offset:32
    buffer_store_short_d16_hi v233, v20, s[48:51], s26 offen offset:48
qkv0_kernel_kvdone43:
qkv0_kernel_end:
    s_endpgm

.globl attn0_kernel
.p2align 8
.type attn0_kernel,@function
attn0_kernel:
    s_cmp_ge_u32 s2, 256
    s_cbranch_scc1 attn0_kernel_end
    s_load_dwordx2 s[4:5], s[0:1], 96
    s_load_dwordx2 s[6:7], s[0:1], 8
    s_load_dwordx2 s[8:9], s[0:1], 32
    s_load_dwordx2 s[10:11], s[0:1], 48
    s_load_dwordx2 s[12:13], s[0:1], 64
    v_lshrrev_b32 v2, 6, v0
    v_and_b32 v1, 63, v0
    v_readfirstlane_b32 s3, v2
    v_lshrrev_b32 v2, 5, v1
    v_and_b32 v3, 31, v1
    v_lshlrev_b32 v4, 4, v1
    s_lshr_b32 s20, s2, 1
    s_mul_i32 s20, s20, 20480
    s_and_b32 s21, s2, 1
    s_lshl_b32 s21, s21, 7
    s_add_u32 s20, s20, s21
    s_mov_b32 s15, 0
    s_waitcnt lgkmcnt(0)
    s_cmp_eq_u32 s3, 4
    s_cbranch_scc1 attn0_kernel_loader1
    s_add_u32 s32, s4, 0
    s_addc_u32 s33, s5, 0
    s_mov_b32 s34, 2621440
    s_mov_b32 s35, 0x00020000
    s_add_u32 s40, s4, 3407872
    s_addc_u32 s41, s5, 0
    s_mov_b32 s42, 1024
    s_mov_b32 s43, 0x00020000
    v_lshrrev_b32 v5, 3, v0
    v_lshlrev_b32 v5, 8, v5
    v_and_b32 v6, 7, v0
    v_lshl_add_u32 v5, v6, 4, v5
    v_lshrrev_b32 v7, 1, v1
    v_lshlrev_b32 v7, 8, v7
    v_and_b32 v8, 1, v1
    v_lshl_add_u32 v7, v8, 4, v7
    s_lshl_b32 s21, s3, 5
    s_add_u32 s21, s21, s20
    s_mul_i32 s22, s3, 3072
    s_add_u32 m0, s22, 98304
    v_lshlrev_b32 v6, 2, v1
    buffer_load_dwordx4 v7, s[32:35], s21 offen lds
    s_add_u32 m0, s22, 99328
    s_add_u32 s21, s21, 8192
    buffer_load_dwordx4 v7, s[32:35], s21 offen lds
    s_add_u32 m0, s22, 100352
    s_add_u32 s21, s21, 8192
    buffer_load_dwordx4 v7, s[32:35], s21 offen lds
    buffer_load_dword v16, v6, s[40:43], 0 offen
    buffer_load_dword v17, v6, s[40:43], 0 offen offset:256
    buffer_load_dword v18, v6, s[40:43], 0 offen offset:512
    buffer_load_dword v19, v6, s[40:43], 0 offen offset:768
    s_add_u32 s44, s4, 4194304
    s_addc_u32 s45, s5, 0
    s_mov_b32 s46, 2621440
    s_mov_b32 s47, 0x00020000
    s_add_u32 s21, s22, 98304
    s_lshl_b32 s22, s3, 5
    s_add_u32 s22, s22, 98304
    v_mul_u32_u24 v21, 5, v3
    v_lshl_add_u32 v21, v2, 1, v21
    v_add_u32 v7, 0, v21
    v_lshrrev_b32 v8, 3, v7
    v_lshlrev_b32 v8, 2, v8
    v_and_b32 v9, 3, v7
    v_add_u32 v8, v8, v9
    v_lshlrev_b32 v8, 5, v8
    v_bfe_u32 v9, v7, 2, 1
    v_lshl_add_u32 v8, v9, 3, v8
    v_add_u32 v22, s21, v8
    v_add_u32 v7, 1, v21
    v_lshrrev_b32 v8, 3, v7
    v_lshlrev_b32 v8, 2, v8
    v_and_b32 v9, 3, v7
    v_add_u32 v8, v8, v9
    v_lshlrev_b32 v8, 5, v8
    v_bfe_u32 v9, v7, 2, 1
    v_lshl_add_u32 v8, v9, 3, v8
    v_add_u32 v23, s21, v8
    v_mul_u32_u24 v21, 5, v3
    v_add_u32 v7, 4, v21
    v_lshrrev_b32 v8, 3, v7
    v_lshlrev_b32 v8, 2, v8
    v_and_b32 v9, 3, v7
    v_add_u32 v8, v8, v9
    v_lshlrev_b32 v8, 5, v8
    v_bfe_u32 v9, v7, 2, 1
    v_lshl_add_u32 v8, v9, 3, v8
    v_add_u32 v24, s21, v8
    v_add_u32 v7, 4, v21
    v_lshrrev_b32 v8, 3, v7
    v_lshlrev_b32 v8, 2, v8
    v_and_b32 v9, 3, v7
    v_add_u32 v8, v8, v9
    v_lshlrev_b32 v8, 7, v8
    v_bfe_u32 v9, v7, 2, 1
    v_lshl_add_u32 v8, v9, 3, v8
    v_add_u32 v13, s22, v8
    v_add_u32 v21, v21, v2
    v_add_u32 v7, 0, v21
    v_lshrrev_b32 v8, 3, v7
    v_lshlrev_b32 v8, 2, v8
    v_and_b32 v9, 3, v7
    v_add_u32 v8, v8, v9
    v_lshlrev_b32 v8, 7, v8
    v_bfe_u32 v9, v7, 2, 1
    v_lshl_add_u32 v8, v9, 3, v8
    v_add_u32 v10, s22, v8
    v_add_u32 v7, 2, v21
    v_lshrrev_b32 v8, 3, v7
    v_lshlrev_b32 v8, 2, v8
    v_and_b32 v9, 3, v7
    v_add_u32 v8, v8, v9
    v_lshlrev_b32 v8, 7, v8
    v_bfe_u32 v9, v7, 2, 1
    v_lshl_add_u32 v8, v9, 3, v8
    v_add_u32 v11, s22, v8
    v_lshlrev_b32 v25, 3, v1
    v_add_u32 v25, 1024, v25
    v_min_u32 v26, 21, v3
    v_lshlrev_b32 v26, 4, v26
    v_mul_u32_u24 v27, 384, v2
    v_add_u32 v26, v26, v27
    v_add_u32 v26, 1536, v26
    v_mov_b32 v7, 110624
    v_cmp_gt_u32 vcc, 32, v1
    s_nop 1
    v_cndmask_b32 v12, v7, v13, vcc
    s_waitcnt vmcnt(0)
    v_max_f32 v16, v16, v17
    v_max_f32 v18, v18, v19
    s_nop 1
    v_max_f32_dpp v16, v16, v16 row_ror:8 row_mask:0xf bank_mask:0xf
    s_nop 1
    v_max_f32_dpp v16, v16, v16 row_ror:4 row_mask:0xf bank_mask:0xf
    s_nop 1
    v_max_f32_dpp v16, v16, v16 row_ror:2 row_mask:0xf bank_mask:0xf
    s_nop 1
    v_max_f32_dpp v16, v16, v16 row_ror:1 row_mask:0xf bank_mask:0xf
    v_mov_b32 v17, v16
    s_nop 1
    v_permlane16_swap_b32 v16, v17
    v_max_f32 v16, v16, v17
    v_mov_b32 v17, v16
    s_nop 1
    v_permlane32_swap_b32 v16, v17
    v_max_f32 v16, v16, v17
    s_nop 1
    v_max_f32_dpp v18, v18, v18 row_ror:8 row_mask:0xf bank_mask:0xf
    s_nop 1
    v_max_f32_dpp v18, v18, v18 row_ror:4 row_mask:0xf bank_mask:0xf
    s_nop 1
    v_max_f32_dpp v18, v18, v18 row_ror:2 row_mask:0xf bank_mask:0xf
    s_nop 1
    v_max_f32_dpp v18, v18, v18 row_ror:1 row_mask:0xf bank_mask:0xf
    v_mov_b32 v17, v18
    s_nop 1
    v_permlane16_swap_b32 v18, v17
    v_max_f32 v18, v18, v17
    v_mov_b32 v17, v18
    s_nop 1
    v_permlane32_swap_b32 v18, v17
    v_max_f32 v18, v18, v17
    v_add_f32 v16, v16, v18
    ds_read_b64 v[32:33], v22 offset:0
    ds_read_b64 v[34:35], v23 offset:0
    ds_read_b64 v[36:37], v24 offset:0
    ds_read_b64 v[40:41], v22 offset:16
    ds_read_b64 v[42:43], v23 offset:16
    ds_read_b64 v[44:45], v24 offset:16
    s_waitcnt lgkmcnt(0)
    v_cndmask_b32 v36, 0, v36, vcc
    v_cndmask_b32 v37, 0, v37, vcc
    v_mov_b32 v17, 0
    v_dot2_f32_bf16 v17, v32, v32, v17
    v_dot2_f32_bf16 v17, v33, v33, v17
    v_dot2_f32_bf16 v17, v34, v34, v17
    v_dot2_f32_bf16 v17, v35, v35, v17
    v_dot2_f32_bf16 v17, v36, v36, v17
    v_dot2_f32_bf16 v17, v37, v37, v17
    s_nop 2
    v_mov_b32 v18, v17
    s_nop 1
    v_permlane32_swap_b32 v17, v18
    v_add_f32 v17, v17, v18
    v_mul_f32 v17, v17, v16
    v_sqrt_f32 v17, v17
    s_nop 0
    v_mul_f32 v17, 0xbf8147ae, v17
    v_cvt_pk_bf16_f32 v17, v17, 0
    v_cndmask_b32 v36, v17, v36, vcc
    v_cndmask_b32 v44, 0, v44, vcc
    v_cndmask_b32 v45, 0, v45, vcc
    v_mov_b32 v17, 0
    v_dot2_f32_bf16 v17, v40, v40, v17
    v_dot2_f32_bf16 v17, v41, v41, v17
    v_dot2_f32_bf16 v17, v42, v42, v17
    v_dot2_f32_bf16 v17, v43, v43, v17
    v_dot2_f32_bf16 v17, v44, v44, v17
    v_dot2_f32_bf16 v17, v45, v45, v17
    s_nop 2
    v_mov_b32 v18, v17
    s_nop 1
    v_permlane32_swap_b32 v17, v18
    v_add_f32 v17, v17, v18
    v_mul_f32 v17, v17, v16
    v_sqrt_f32 v17, v17
    s_nop 0
    v_mul_f32 v17, 0xbf8147ae, v17
    v_cvt_pk_bf16_f32 v17, v17, 0
    v_cndmask_b32 v44, v17, v44, vcc
attn0_kernel_mainpass2:
    v_mov_b32 v128, 0
    v_mov_b32 v129, 0
    v_mov_b32 v130, 0
    v_mov_b32 v131, 0
    v_mov_b32 v132, 0
    v_mov_b32 v133, 0
    v_mov_b32 v134, 0
    v_mov_b32 v135, 0
    v_mov_b32 v136, 0
    v_mov_b32 v137, 0
    v_mov_b32 v138, 0
    v_mov_b32 v139, 0
    v_mov_b32 v140, 0
    v_mov_b32 v141, 0
    v_mov_b32 v142, 0
    v_mov_b32 v143, 0
    v_mov_b32 v144, 0
    v_mov_b32 v145, 0
    v_mov_b32 v146, 0
    v_mov_b32 v147, 0
    v_mov_b32 v148, 0
    v_mov_b32 v149, 0
    v_mov_b32 v150, 0
    v_mov_b32 v151, 0
    v_mov_b32 v152, 0
    v_mov_b32 v153, 0
    v_mov_b32 v154, 0
    v_mov_b32 v155, 0
    v_mov_b32 v156, 0
    v_mov_b32 v157, 0
    v_mov_b32 v158, 0
    v_mov_b32 v159, 0
    v_mov_b32 v124, 0
    v_mov_b32 v125, 0
    v_mov_b32 v126, 0
    v_mov_b32 v127, 0
    v_mov_b32 v108, 0
    v_mov_b32 v109, 0
    v_mov_b32 v110, 0
    v_mov_b32 v111, 0
    v_mov_b32 v188, 0
    v_mov_b32 v189, 0
    v_mov_b32 v190, 0
    v_mov_b32 v191, 0
    v_mov_b32 v28, v4
    v_add_u32 v192, 24576, v4
    v_mov_b32 v29, v25
    v_add_u32 v193, 24576, v25
    v_mov_b32 v30, v26
    v_add_u32 v194, 24576, v26
    s_mov_b32 s23, 49152
    s_barrier
    ds_read_b128 v[160:163], v28 offset:0
    ds_read_b64 v[168:169], v29 offset:0
    s_waitcnt lgkmcnt(0)
    v_mfma_f32_32x32x16_bf16 v[48:63], v[160:163], v[32:35], 0
    v_mfma_f32_32x32x8_bf16 v[48:63], v[168:169], v[36:37], v[48:63]
    v_mfma_f32_32x32x16_bf16 v[80:95], v[160:163], v[40:43], 0
    v_mfma_f32_32x32x8_bf16 v[80:95], v[168:169], v[44:45], v[80:95]
    ds_read_b128 v[164:167], v28 offset:3072
    ds_read_b64 v[172:173], v29 offset:3072
    ds_read_b128 v[176:179], v30 offset:0
    ds_read_b128 v[180:183], v30 offset:768
    s_nop 7
    s_nop 3
    s_mov_b32 s24, 8
attn0_kernel_loop3:
    s_waitcnt lgkmcnt(0)
    v_mfma_f32_32x32x16_bf16 v[64:79], v[164:167], v[32:35], 0
    v_cvt_pk_bf16_f32 v126, v108, v109
    v_cvt_pk_bf16_f32 v127, v110, v111
    v_exp_f32 v48, v48
    v_exp_f32 v49, v49
    v_exp_f32 v50, v50
    v_exp_f32 v51, v51
    v_mfma_f32_32x32x16_bf16 v[144:159], v[188:191], v[124:127], v[144:159]
    ds_read_b128 v[160:163], v28 offset:6144
    ds_read_b64 v[168:169], v29 offset:6144
    ds_read_b128 v[184:187], v30 offset:3072
    ds_read_b128 v[188:191], v30 offset:3840
    v_cvt_pk_bf16_f32 v112, v48, v49
    v_cvt_pk_bf16_f32 v113, v50, v51
    v_exp_f32 v52, v52
    v_exp_f32 v53, v53
    v_exp_f32 v54, v54
    v_exp_f32 v55, v55
    v_mfma_f32_32x32x8_bf16 v[64:79], v[172:173], v[36:37], v[64:79]
    v_cvt_pk_bf16_f32 v114, v52, v53
    v_cvt_pk_bf16_f32 v115, v54, v55
    v_exp_f32 v56, v56
    v_exp_f32 v57, v57
    v_exp_f32 v58, v58
    v_exp_f32 v59, v59
    v_mfma_f32_32x32x16_bf16 v[128:143], v[176:179], v[112:115], v[128:143]
    v_cvt_pk_bf16_f32 v116, v56, v57
    v_cvt_pk_bf16_f32 v117, v58, v59
    v_exp_f32 v60, v60
    v_exp_f32 v61, v61
    v_exp_f32 v62, v62
    v_exp_f32 v63, v63
    v_mfma_f32_32x32x16_bf16 v[96:111], v[164:167], v[40:43], 0
    v_cvt_pk_bf16_f32 v118, v60, v61
    v_cvt_pk_bf16_f32 v119, v62, v63
    v_exp_f32 v80, v80
    v_exp_f32 v81, v81
    v_exp_f32 v82, v82
    v_exp_f32 v83, v83
    v_mfma_f32_32x32x16_bf16 v[128:143], v[180:183], v[116:119], v[128:143]
    v_cvt_pk_bf16_f32 v120, v80, v81
    v_cvt_pk_bf16_f32 v121, v82, v83
    v_exp_f32 v84, v84
    v_exp_f32 v85, v85
    v_exp_f32 v86, v86
    v_exp_f32 v87, v87
    v_mfma_f32_32x32x8_bf16 v[96:111], v[172:173], v[44:45], v[96:111]
    v_cvt_pk_bf16_f32 v122, v84, v85
    v_cvt_pk_bf16_f32 v123, v86, v87
    v_exp_f32 v88, v88
    v_exp_f32 v89, v89
    v_exp_f32 v90, v90
    v_exp_f32 v91, v91
    v_mfma_f32_32x32x16_bf16 v[144:159], v[176:179], v[120:123], v[144:159]
    v_cvt_pk_bf16_f32 v124, v88, v89
    v_cvt_pk_bf16_f32 v125, v90, v91
    v_exp_f32 v92, v92
    v_exp_f32 v93, v93
    v_exp_f32 v94, v94
    v_exp_f32 v95, v95
    s_waitcnt lgkmcnt(0)
    v_mfma_f32_32x32x16_bf16 v[48:63], v[160:163], v[32:35], 0
    v_cvt_pk_bf16_f32 v126, v92, v93
    v_cvt_pk_bf16_f32 v127, v94, v95
    v_exp_f32 v64, v64
    v_exp_f32 v65, v65
    v_exp_f32 v66, v66
    v_exp_f32 v67, v67
    v_mfma_f32_32x32x16_bf16 v[144:159], v[180:183], v[124:127], v[144:159]
    ds_read_b128 v[164:167], v28 offset:9216
    ds_read_b64 v[172:173], v29 offset:9216
    ds_read_b128 v[176:179], v30 offset:6144
    ds_read_b128 v[180:183], v30 offset:6912
    v_cvt_pk_bf16_f32 v112, v64, v65
    v_cvt_pk_bf16_f32 v113, v66, v67
    v_exp_f32 v68, v68
    v_exp_f32 v69, v69
    v_exp_f32 v70, v70
    v_exp_f32 v71, v71
    v_mfma_f32_32x32x8_bf16 v[48:63], v[168:169], v[36:37], v[48:63]
    v_cvt_pk_bf16_f32 v114, v68, v69
    v_cvt_pk_bf16_f32 v115, v70, v71
    v_exp_f32 v72, v72
    v_exp_f32 v73, v73
    v_exp_f32 v74, v74
    v_exp_f32 v75, v75
    v_mfma_f32_32x32x16_bf16 v[128:143], v[184:187], v[112:115], v[128:143]
    v_cvt_pk_bf16_f32 v116, v72, v73
    v_cvt_pk_bf16_f32 v117, v74, v75
    v_exp_f32 v76, v76
    v_exp_f32 v77, v77
    v_exp_f32 v78, v78
    v_exp_f32 v79, v79
    v_mfma_f32_32x32x16_bf16 v[80:95], v[160:163], v[40:43], 0
    v_cvt_pk_bf16_f32 v118, v76, v77
    v_cvt_pk_bf16_f32 v119, v78, v79
    v_exp_f32 v96, v96
    v_exp_f32 v97, v97
    v_exp_f32 v98, v98
    v_exp_f32 v99, v99
    v_mfma_f32_32x32x16_bf16 v[128:143], v[188:191], v[116:119], v[128:143]
    v_cvt_pk_bf16_f32 v120, v96, v97
    v_cvt_pk_bf16_f32 v121, v98, v99
    v_exp_f32 v100, v100
    v_exp_f32 v101, v101
    v_exp_f32 v102, v102
    v_exp_f32 v103, v103
    v_mfma_f32_32x32x8_bf16 v[80:95], v[168:169], v[44:45], v[80:95]
    v_cvt_pk_bf16_f32 v122, v100, v101
    v_cvt_pk_bf16_f32 v123, v102, v103
    v_exp_f32 v104, v104
    v_exp_f32 v105, v105
    v_exp_f32 v106, v106
    v_exp_f32 v107, v107
    v_mfma_f32_32x32x16_bf16 v[144:159], v[184:187], v[120:123], v[144:159]
    v_cvt_pk_bf16_f32 v124, v104, v105
    v_cvt_pk_bf16_f32 v125, v106, v107
    v_exp_f32 v108, v108
    v_exp_f32 v109, v109
    v_exp_f32 v110, v110
    v_exp_f32 v111, v111
    s_waitcnt lgkmcnt(0)
    v_mfma_f32_32x32x16_bf16 v[64:79], v[164:167], v[32:35], 0
    v_cvt_pk_bf16_f32 v126, v108, v109
    v_cvt_pk_bf16_f32 v127, v110, v111
    v_exp_f32 v48, v48
    v_exp_f32 v49, v49
    v_exp_f32 v50, v50
    v_exp_f32 v51, v51
    v_mfma_f32_32x32x16_bf16 v[144:159], v[188:191], v[124:127], v[144:159]
    ds_read_b128 v[160:163], v28 offset:12288
    ds_read_b64 v[168:169], v29 offset:12288
    ds_read_b128 v[184:187], v30 offset:9216
    ds_read_b128 v[188:191], v30 offset:9984
    v_cvt_pk_bf16_f32 v112, v48, v49
    v_cvt_pk_bf16_f32 v113, v50, v51
    v_exp_f32 v52, v52
    v_exp_f32 v53, v53
    v_exp_f32 v54, v54
    v_exp_f32 v55, v55
    v_mfma_f32_32x32x8_bf16 v[64:79], v[172:173], v[36:37], v[64:79]
    v_cvt_pk_bf16_f32 v114, v52, v53
    v_cvt_pk_bf16_f32 v115, v54, v55
    v_exp_f32 v56, v56
    v_exp_f32 v57, v57
    v_exp_f32 v58, v58
    v_exp_f32 v59, v59
    v_mfma_f32_32x32x16_bf16 v[128:143], v[176:179], v[112:115], v[128:143]
    v_cvt_pk_bf16_f32 v116, v56, v57
    v_cvt_pk_bf16_f32 v117, v58, v59
    v_exp_f32 v60, v60
    v_exp_f32 v61, v61
    v_exp_f32 v62, v62
    v_exp_f32 v63, v63
    v_mfma_f32_32x32x16_bf16 v[96:111], v[164:167], v[40:43], 0
    v_cvt_pk_bf16_f32 v118, v60, v61
    v_cvt_pk_bf16_f32 v119, v62, v63
    v_exp_f32 v80, v80
    v_exp_f32 v81, v81
    v_exp_f32 v82, v82
    v_exp_f32 v83, v83
    v_mfma_f32_32x32x16_bf16 v[128:143], v[180:183], v[116:119], v[128:143]
    v_cvt_pk_bf16_f32 v120, v80, v81
    v_cvt_pk_bf16_f32 v121, v82, v83
    v_exp_f32 v84, v84
    v_exp_f32 v85, v85
    v_exp_f32 v86, v86
    v_exp_f32 v87, v87
    v_mfma_f32_32x32x8_bf16 v[96:111], v[172:173], v[44:45], v[96:111]
    v_cvt_pk_bf16_f32 v122, v84, v85
    v_cvt_pk_bf16_f32 v123, v86, v87
    v_exp_f32 v88, v88
    v_exp_f32 v89, v89
    v_exp_f32 v90, v90
    v_exp_f32 v91, v91
    v_mfma_f32_32x32x16_bf16 v[144:159], v[176:179], v[120:123], v[144:159]
    v_cvt_pk_bf16_f32 v124, v88, v89
    v_cvt_pk_bf16_f32 v125, v90, v91
    v_exp_f32 v92, v92
    v_exp_f32 v93, v93
    v_exp_f32 v94, v94
    v_exp_f32 v95, v95
    s_waitcnt lgkmcnt(0)
    v_mfma_f32_32x32x16_bf16 v[48:63], v[160:163], v[32:35], 0
    v_cvt_pk_bf16_f32 v126, v92, v93
    v_cvt_pk_bf16_f32 v127, v94, v95
    v_exp_f32 v64, v64
    v_exp_f32 v65, v65
    v_exp_f32 v66, v66
    v_exp_f32 v67, v67
    v_mfma_f32_32x32x16_bf16 v[144:159], v[180:183], v[124:127], v[144:159]
    ds_read_b128 v[164:167], v28 offset:15360
    ds_read_b64 v[172:173], v29 offset:15360
    ds_read_b128 v[176:179], v30 offset:12288
    ds_read_b128 v[180:183], v30 offset:13056
    v_cvt_pk_bf16_f32 v112, v64, v65
    v_cvt_pk_bf16_f32 v113, v66, v67
    v_exp_f32 v68, v68
    v_exp_f32 v69, v69
    v_exp_f32 v70, v70
    v_exp_f32 v71, v71
    v_mfma_f32_32x32x8_bf16 v[48:63], v[168:169], v[36:37], v[48:63]
    v_cvt_pk_bf16_f32 v114, v68, v69
    v_cvt_pk_bf16_f32 v115, v70, v71
    v_exp_f32 v72, v72
    v_exp_f32 v73, v73
    v_exp_f32 v74, v74
    v_exp_f32 v75, v75
    v_mfma_f32_32x32x16_bf16 v[128:143], v[184:187], v[112:115], v[128:143]
    v_cvt_pk_bf16_f32 v116, v72, v73
    v_cvt_pk_bf16_f32 v117, v74, v75
    v_exp_f32 v76, v76
    v_exp_f32 v77, v77
    v_exp_f32 v78, v78
    v_exp_f32 v79, v79
    v_mfma_f32_32x32x16_bf16 v[80:95], v[160:163], v[40:43], 0
    v_cvt_pk_bf16_f32 v118, v76, v77
    v_cvt_pk_bf16_f32 v119, v78, v79
    v_exp_f32 v96, v96
    v_exp_f32 v97, v97
    v_exp_f32 v98, v98
    v_exp_f32 v99, v99
    v_mfma_f32_32x32x16_bf16 v[128:143], v[188:191], v[116:119], v[128:143]
    v_cvt_pk_bf16_f32 v120, v96, v97
    v_cvt_pk_bf16_f32 v121, v98, v99
    v_exp_f32 v100, v100
    v_exp_f32 v101, v101
    v_exp_f32 v102, v102
    v_exp_f32 v103, v103
    v_mfma_f32_32x32x8_bf16 v[80:95], v[168:169], v[44:45], v[80:95]
    v_cvt_pk_bf16_f32 v122, v100, v101
    v_cvt_pk_bf16_f32 v123, v102, v103
    v_exp_f32 v104, v104
    v_exp_f32 v105, v105
    v_exp_f32 v106, v106
    v_exp_f32 v107, v107
    v_mfma_f32_32x32x16_bf16 v[144:159], v[184:187], v[120:123], v[144:159]
    v_cvt_pk_bf16_f32 v124, v104, v105
    v_cvt_pk_bf16_f32 v125, v106, v107
    v_exp_f32 v108, v108
    v_exp_f32 v109, v109
    v_exp_f32 v110, v110
    v_exp_f32 v111, v111
    s_waitcnt lgkmcnt(0)
    v_mfma_f32_32x32x16_bf16 v[64:79], v[164:167], v[32:35], 0
    v_cvt_pk_bf16_f32 v126, v108, v109
    v_cvt_pk_bf16_f32 v127, v110, v111
    v_exp_f32 v48, v48
    v_exp_f32 v49, v49
    v_exp_f32 v50, v50
    v_exp_f32 v51, v51
    v_mfma_f32_32x32x16_bf16 v[144:159], v[188:191], v[124:127], v[144:159]
    ds_read_b128 v[160:163], v28 offset:18432
    ds_read_b64 v[168:169], v29 offset:18432
    ds_read_b128 v[184:187], v30 offset:15360
    ds_read_b128 v[188:191], v30 offset:16128
    v_cvt_pk_bf16_f32 v112, v48, v49
    v_cvt_pk_bf16_f32 v113, v50, v51
    v_exp_f32 v52, v52
    v_exp_f32 v53, v53
    v_exp_f32 v54, v54
    v_exp_f32 v55, v55
    v_mfma_f32_32x32x8_bf16 v[64:79], v[172:173], v[36:37], v[64:79]
    v_cvt_pk_bf16_f32 v114, v52, v53
    v_cvt_pk_bf16_f32 v115, v54, v55
    v_exp_f32 v56, v56
    v_exp_f32 v57, v57
    v_exp_f32 v58, v58
    v_exp_f32 v59, v59
    v_mfma_f32_32x32x16_bf16 v[128:143], v[176:179], v[112:115], v[128:143]
    v_cvt_pk_bf16_f32 v116, v56, v57
    v_cvt_pk_bf16_f32 v117, v58, v59
    v_exp_f32 v60, v60
    v_exp_f32 v61, v61
    v_exp_f32 v62, v62
    v_exp_f32 v63, v63
    v_mfma_f32_32x32x16_bf16 v[96:111], v[164:167], v[40:43], 0
    v_cvt_pk_bf16_f32 v118, v60, v61
    v_cvt_pk_bf16_f32 v119, v62, v63
    v_exp_f32 v80, v80
    v_exp_f32 v81, v81
    v_exp_f32 v82, v82
    v_exp_f32 v83, v83
    v_mfma_f32_32x32x16_bf16 v[128:143], v[180:183], v[116:119], v[128:143]
    v_cvt_pk_bf16_f32 v120, v80, v81
    v_cvt_pk_bf16_f32 v121, v82, v83
    v_exp_f32 v84, v84
    v_exp_f32 v85, v85
    v_exp_f32 v86, v86
    v_exp_f32 v87, v87
    v_mfma_f32_32x32x8_bf16 v[96:111], v[172:173], v[44:45], v[96:111]
    v_cvt_pk_bf16_f32 v122, v84, v85
    v_cvt_pk_bf16_f32 v123, v86, v87
    v_exp_f32 v88, v88
    v_exp_f32 v89, v89
    v_exp_f32 v90, v90
    v_exp_f32 v91, v91
    v_mfma_f32_32x32x16_bf16 v[144:159], v[176:179], v[120:123], v[144:159]
    v_cvt_pk_bf16_f32 v124, v88, v89
    v_cvt_pk_bf16_f32 v125, v90, v91
    v_exp_f32 v92, v92
    v_exp_f32 v93, v93
    v_exp_f32 v94, v94
    v_exp_f32 v95, v95
    s_waitcnt lgkmcnt(0)
    v_mfma_f32_32x32x16_bf16 v[48:63], v[160:163], v[32:35], 0
    v_cvt_pk_bf16_f32 v126, v92, v93
    v_cvt_pk_bf16_f32 v127, v94, v95
    v_exp_f32 v64, v64
    v_exp_f32 v65, v65
    v_exp_f32 v66, v66
    v_exp_f32 v67, v67
    v_mfma_f32_32x32x16_bf16 v[144:159], v[180:183], v[124:127], v[144:159]
    ds_read_b128 v[164:167], v28 offset:21504
    ds_read_b64 v[172:173], v29 offset:21504
    ds_read_b128 v[176:179], v30 offset:18432
    ds_read_b128 v[180:183], v30 offset:19200
    v_cvt_pk_bf16_f32 v112, v64, v65
    v_cvt_pk_bf16_f32 v113, v66, v67
    v_exp_f32 v68, v68
    v_exp_f32 v69, v69
    v_exp_f32 v70, v70
    v_exp_f32 v71, v71
    v_mfma_f32_32x32x8_bf16 v[48:63], v[168:169], v[36:37], v[48:63]
    v_cvt_pk_bf16_f32 v114, v68, v69
    v_cvt_pk_bf16_f32 v115, v70, v71
    v_exp_f32 v72, v72
    v_exp_f32 v73, v73
    v_exp_f32 v74, v74
    v_exp_f32 v75, v75
    v_mfma_f32_32x32x16_bf16 v[128:143], v[184:187], v[112:115], v[128:143]
    v_cvt_pk_bf16_f32 v116, v72, v73
    v_cvt_pk_bf16_f32 v117, v74, v75
    v_exp_f32 v76, v76
    v_exp_f32 v77, v77
    v_exp_f32 v78, v78
    v_exp_f32 v79, v79
    v_mfma_f32_32x32x16_bf16 v[80:95], v[160:163], v[40:43], 0
    v_cvt_pk_bf16_f32 v118, v76, v77
    v_cvt_pk_bf16_f32 v119, v78, v79
    v_exp_f32 v96, v96
    v_exp_f32 v97, v97
    v_exp_f32 v98, v98
    v_exp_f32 v99, v99
    v_mfma_f32_32x32x16_bf16 v[128:143], v[188:191], v[116:119], v[128:143]
    v_cvt_pk_bf16_f32 v120, v96, v97
    v_cvt_pk_bf16_f32 v121, v98, v99
    v_exp_f32 v100, v100
    v_exp_f32 v101, v101
    v_exp_f32 v102, v102
    v_exp_f32 v103, v103
    v_mfma_f32_32x32x8_bf16 v[80:95], v[168:169], v[44:45], v[80:95]
    v_cvt_pk_bf16_f32 v122, v100, v101
    v_cvt_pk_bf16_f32 v123, v102, v103
    v_exp_f32 v104, v104
    v_exp_f32 v105, v105
    v_exp_f32 v106, v106
    v_exp_f32 v107, v107
    v_mfma_f32_32x32x16_bf16 v[144:159], v[184:187], v[120:123], v[144:159]
    v_cvt_pk_bf16_f32 v124, v104, v105
    v_cvt_pk_bf16_f32 v125, v106, v107
    v_exp_f32 v108, v108
    v_exp_f32 v109, v109
    v_exp_f32 v110, v110
    v_exp_f32 v111, v111
    s_waitcnt lgkmcnt(0)
    v_mfma_f32_32x32x16_bf16 v[64:79], v[164:167], v[32:35], 0
    v_cvt_pk_bf16_f32 v126, v108, v109
    v_cvt_pk_bf16_f32 v127, v110, v111
    v_exp_f32 v48, v48
    v_exp_f32 v49, v49
    v_exp_f32 v50, v50
    v_exp_f32 v51, v51
    v_mfma_f32_32x32x16_bf16 v[144:159], v[188:191], v[124:127], v[144:159]
    s_barrier
    ds_read_b128 v[160:163], v192 offset:0
    ds_read_b64 v[168:169], v193 offset:0
    ds_read_b128 v[184:187], v30 offset:21504
    ds_read_b128 v[188:191], v30 offset:22272
    v_cvt_pk_bf16_f32 v112, v48, v49
    v_cvt_pk_bf16_f32 v113, v50, v51
    v_exp_f32 v52, v52
    v_exp_f32 v53, v53
    v_exp_f32 v54, v54
    v_exp_f32 v55, v55
    v_mfma_f32_32x32x8_bf16 v[64:79], v[172:173], v[36:37], v[64:79]
    v_cvt_pk_bf16_f32 v114, v52, v53
    v_cvt_pk_bf16_f32 v115, v54, v55
    v_exp_f32 v56, v56
    v_exp_f32 v57, v57
    v_exp_f32 v58, v58
    v_exp_f32 v59, v59
    v_mfma_f32_32x32x16_bf16 v[128:143], v[176:179], v[112:115], v[128:143]
    v_cvt_pk_bf16_f32 v116, v56, v57
    v_cvt_pk_bf16_f32 v117, v58, v59
    v_exp_f32 v60, v60
    v_exp_f32 v61, v61
    v_exp_f32 v62, v62
    v_exp_f32 v63, v63
    v_mfma_f32_32x32x16_bf16 v[96:111], v[164:167], v[40:43], 0
    v_cvt_pk_bf16_f32 v118, v60, v61
    v_cvt_pk_bf16_f32 v119, v62, v63
    v_exp_f32 v80, v80
    v_exp_f32 v81, v81
    v_exp_f32 v82, v82
    v_exp_f32 v83, v83
    v_mfma_f32_32x32x16_bf16 v[128:143], v[180:183], v[116:119], v[128:143]
    v_cvt_pk_bf16_f32 v120, v80, v81
    v_cvt_pk_bf16_f32 v121, v82, v83
    v_exp_f32 v84, v84
    v_exp_f32 v85, v85
    v_exp_f32 v86, v86
    v_exp_f32 v87, v87
    v_mfma_f32_32x32x8_bf16 v[96:111], v[172:173], v[44:45], v[96:111]
    v_cvt_pk_bf16_f32 v122, v84, v85
    v_cvt_pk_bf16_f32 v123, v86, v87
    v_exp_f32 v88, v88
    v_exp_f32 v89, v89
    v_exp_f32 v90, v90
    v_exp_f32 v91, v91
    v_mfma_f32_32x32x16_bf16 v[144:159], v[176:179], v[120:123], v[144:159]
    v_cvt_pk_bf16_f32 v124, v88, v89
    v_cvt_pk_bf16_f32 v125, v90, v91
    v_exp_f32 v92, v92
    v_exp_f32 v93, v93
    v_exp_f32 v94, v94
    v_exp_f32 v95, v95
    s_waitcnt lgkmcnt(0)
    v_mfma_f32_32x32x16_bf16 v[48:63], v[160:163], v[32:35], 0
    v_cvt_pk_bf16_f32 v126, v92, v93
    v_cvt_pk_bf16_f32 v127, v94, v95
    v_exp_f32 v64, v64
    v_exp_f32 v65, v65
    v_exp_f32 v66, v66
    v_exp_f32 v67, v67
    v_mfma_f32_32x32x16_bf16 v[144:159], v[180:183], v[124:127], v[144:159]
    ds_read_b128 v[164:167], v192 offset:3072
    ds_read_b64 v[172:173], v193 offset:3072
    ds_read_b128 v[176:179], v194 offset:0
    ds_read_b128 v[180:183], v194 offset:768
    v_cvt_pk_bf16_f32 v112, v64, v65
    v_cvt_pk_bf16_f32 v113, v66, v67
    v_exp_f32 v68, v68
    v_exp_f32 v69, v69
    v_exp_f32 v70, v70
    v_exp_f32 v71, v71
    v_mfma_f32_32x32x8_bf16 v[48:63], v[168:169], v[36:37], v[48:63]
    v_cvt_pk_bf16_f32 v114, v68, v69
    v_cvt_pk_bf16_f32 v115, v70, v71
    v_exp_f32 v72, v72
    v_exp_f32 v73, v73
    v_exp_f32 v74, v74
    v_exp_f32 v75, v75
    v_mfma_f32_32x32x16_bf16 v[128:143], v[184:187], v[112:115], v[128:143]
    v_cvt_pk_bf16_f32 v116, v72, v73
    v_cvt_pk_bf16_f32 v117, v74, v75
    v_exp_f32 v76, v76
    v_exp_f32 v77, v77
    v_exp_f32 v78, v78
    v_exp_f32 v79, v79
    v_mfma_f32_32x32x16_bf16 v[80:95], v[160:163], v[40:43], 0
    v_cvt_pk_bf16_f32 v118, v76, v77
    v_cvt_pk_bf16_f32 v119, v78, v79
    v_exp_f32 v96, v96
    v_exp_f32 v97, v97
    v_exp_f32 v98, v98
    v_exp_f32 v99, v99
    v_mfma_f32_32x32x16_bf16 v[128:143], v[188:191], v[116:119], v[128:143]
    v_cvt_pk_bf16_f32 v120, v96, v97
    v_cvt_pk_bf16_f32 v121, v98, v99
    v_exp_f32 v100, v100
    v_exp_f32 v101, v101
    v_exp_f32 v102, v102
    v_exp_f32 v103, v103
    v_mfma_f32_32x32x8_bf16 v[80:95], v[168:169], v[44:45], v[80:95]
    v_cvt_pk_bf16_f32 v122, v100, v101
    v_cvt_pk_bf16_f32 v123, v102, v103
    v_exp_f32 v104, v104
    v_exp_f32 v105, v105
    v_exp_f32 v106, v106
    v_exp_f32 v107, v107
    v_mfma_f32_32x32x16_bf16 v[144:159], v[184:187], v[120:123], v[144:159]
    v_cvt_pk_bf16_f32 v124, v104, v105
    v_cvt_pk_bf16_f32 v125, v106, v107
    v_exp_f32 v108, v108
    v_exp_f32 v109, v109
    v_exp_f32 v110, v110
    v_exp_f32 v111, v111
    v_mov_b32 v28, v192
    v_add_u32 v192, s23, v4
    v_mov_b32 v29, v193
    v_add_u32 v193, s23, v25
    v_mov_b32 v30, v194
    v_add_u32 v194, s23, v26
    s_add_u32 s23, s23, 24576
    s_cmp_ge_u32 s23, 98304
    s_cselect_b32 s19, 98304, 0
    s_sub_u32 s23, s23, s19
    s_sub_u32 s24, s24, 1
    s_cmp_lg_u32 s24, 0
    s_cbranch_scc1 attn0_kernel_loop3
    v_cvt_pk_bf16_f32 v126, v108, v109
    v_cvt_pk_bf16_f32 v127, v110, v111
    s_waitcnt lgkmcnt(0)
    s_nop 0
    v_mfma_f32_32x32x16_bf16 v[144:159], v[188:191], v[124:127], v[144:159]
    s_nop 7
    s_nop 7
    v_mov_b32 v18, v136
    v_mov_b32 v16, v136
    v_mov_b32 v19, v152
    v_mov_b32 v17, v152
    s_nop 1
    v_permlane32_swap_b32 v18, v16
    v_permlane32_swap_b32 v19, v17
    v_mov_b32 v18, 0x2b800000
    v_min_f32 v19, v16, v17
    v_cmp_nge_f32 vcc, v19, v18
    v_cmp_u_f32 s[28:29], v16, v17
    s_or_b64 vcc, vcc, s[28:29]
    s_cmp_lg_u64 vcc, 0
    s_cselect_b32 s25, 1, 0
    v_mov_b32 v18, s25
    s_lshl_b32 s26, s3, 2
    s_add_u32 s26, s26, 110592
    v_mov_b32 v19, s26
    ds_write_b32 v19, v18
    v_rcp_f32 v16, v16
    v_rcp_f32 v17, v17
    s_nop 0
    v_mul_f32 v128, v128, v16
    v_mul_f32 v129, v129, v16
    v_mul_f32 v130, v130, v16
    v_mul_f32 v131, v131, v16
    v_mul_f32 v132, v132, v16
    v_mul_f32 v133, v133, v16
    v_mul_f32 v134, v134, v16
    v_mul_f32 v135, v135, v16
    v_mul_f32 v136, v136, v16
    v_mul_f32 v137, v137, v16
    v_mul_f32 v138, v138, v16
    v_mul_f32 v139, v139, v16
    v_cvt_pk_bf16_f32 v48, v128, v129
    v_cvt_pk_bf16_f32 v49, v130, v131
    v_cvt_pk_bf16_f32 v50, v132, v133
    v_cvt_pk_bf16_f32 v51, v134, v135
    v_cvt_pk_bf16_f32 v52, v136, v137
    v_cvt_pk_bf16_f32 v53, v138, v139
    ds_write_b64 v10, v[48:49] offset:0
    ds_write_b64 v11, v[50:51] offset:0
    ds_write_b64 v12, v[52:53] offset:0
    v_mul_f32 v144, v144, v17
    v_mul_f32 v145, v145, v17
    v_mul_f32 v146, v146, v17
    v_mul_f32 v147, v147, v17
    v_mul_f32 v148, v148, v17
    v_mul_f32 v149, v149, v17
    v_mul_f32 v150, v150, v17
    v_mul_f32 v151, v151, v17
    v_mul_f32 v152, v152, v17
    v_mul_f32 v153, v153, v17
    v_mul_f32 v154, v154, v17
    v_mul_f32 v155, v155, v17
    v_cvt_pk_bf16_f32 v80, v144, v145
    v_cvt_pk_bf16_f32 v81, v146, v147
    v_cvt_pk_bf16_f32 v82, v148, v149
    v_cvt_pk_bf16_f32 v83, v150, v151
    v_cvt_pk_bf16_f32 v84, v152, v153
    v_cvt_pk_bf16_f32 v85, v154, v155
    ds_write_b64 v10, v[80:81] offset:16
    ds_write_b64 v11, v[82:83] offset:16
    ds_write_b64 v12, v[84:85] offset:16
    v_lshlrev_b32 v6, 4, v0
    v_add_u32 v6, 98304, v6
    v_mov_b32 v19, 110592
    s_waitcnt lgkmcnt(0)
    s_barrier
    ds_read_b128 v[16:19], v19
    ds_read_b128 v[48:51], v6
    ds_read_b128 v[52:55], v6 offset:4096
    ds_read_b128 v[56:59], v6 offset:8192
    s_waitcnt lgkmcnt(3)
    v_or_b32 v16, v16, v17
    v_or3_b32 v16, v16, v18, v19
    s_nop 0
    v_readfirstlane_b32 s25, v16
    s_cmp_lg_u32 s15, 0
    s_cbranch_scc1 attn0_kernel_fin4
    s_cmp_eq_u32 s25, 0
    s_cbranch_scc1 attn0_kernel_fin4
    s_waitcnt lgkmcnt(0)
    v_cmp_gt_u32 vcc, 32, v1
    s_nop 1
    v_cndmask_b32 v36, 0, v36, vcc
    v_cndmask_b32 v44, 0, v44, vcc
    v_mov_b32 v16, 0xff7fffff
    v_mov_b32 v17, 0xff7fffff
    s_mov_b32 s24, 0
attn0_kernel_mloop5:
    s_barrier
    s_barrier
    ds_read_b128 v[160:163], v4 offset:0
    ds_read_b64 v[168:169], v25 offset:0
    s_waitcnt lgkmcnt(0)
    v_mfma_f32_32x32x16_bf16 v[48:63], v[160:163], v[32:35], 0
    v_mfma_f32_32x32x8_bf16 v[48:63], v[168:169], v[36:37], v[48:63]
    v_mfma_f32_32x32x16_bf16 v[80:95], v[160:163], v[40:43], 0
    v_mfma_f32_32x32x8_bf16 v[80:95], v[168:169], v[44:45], v[80:95]
    s_nop 7
    s_nop 7
    v_max3_f32 v16, v16, v48, v49
    v_max3_f32 v16, v16, v50, v51
    v_max3_f32 v16, v16, v52, v53
    v_max3_f32 v16, v16, v54, v55
    v_max3_f32 v16, v16, v56, v57
    v_max3_f32 v16, v16, v58, v59
    v_max3_f32 v16, v16, v60, v61
    v_max3_f32 v16, v16, v62, v63
    v_max3_f32 v17, v17, v80, v81
    v_max3_f32 v17, v17, v82, v83
    v_max3_f32 v17, v17, v84, v85
    v_max3_f32 v17, v17, v86, v87
    v_max3_f32 v17, v17, v88, v89
    v_max3_f32 v17, v17, v90, v91
    v_max3_f32 v17, v17, v92, v93
    v_max3_f32 v17, v17, v94, v95
    ds_read_b128 v[160:163], v4 offset:3072
    ds_read_b64 v[168:169], v25 offset:3072
    s_waitcnt lgkmcnt(0)
    v_mfma_f32_32x32x16_bf16 v[48:63], v[160:163], v[32:35], 0
    v_mfma_f32_32x32x8_bf16 v[48:63], v[168:169], v[36:37], v[48:63]
    v_mfma_f32_32x32x16_bf16 v[80:95], v[160:163], v[40:43], 0
    v_mfma_f32_32x32x8_bf16 v[80:95], v[168:169], v[44:45], v[80:95]
    s_nop 7
    s_nop 7
    v_max3_f32 v16, v16, v48, v49
    v_max3_f32 v16, v16, v50, v51
    v_max3_f32 v16, v16, v52, v53
    v_max3_f32 v16, v16, v54, v55
    v_max3_f32 v16, v16, v56, v57
    v_max3_f32 v16, v16, v58, v59
    v_max3_f32 v16, v16, v60, v61
    v_max3_f32 v16, v16, v62, v63
    v_max3_f32 v17, v17, v80, v81
    v_max3_f32 v17, v17, v82, v83
    v_max3_f32 v17, v17, v84, v85
    v_max3_f32 v17, v17, v86, v87
    v_max3_f32 v17, v17, v88, v89
    v_max3_f32 v17, v17, v90, v91
    v_max3_f32 v17, v17, v92, v93
    v_max3_f32 v17, v17, v94, v95
    ds_read_b128 v[160:163], v4 offset:6144
    ds_read_b64 v[168:169], v25 offset:6144
    s_waitcnt lgkmcnt(0)
    v_mfma_f32_32x32x16_bf16 v[48:63], v[160:163], v[32:35], 0
    v_mfma_f32_32x32x8_bf16 v[48:63], v[168:169], v[36:37], v[48:63]
    v_mfma_f32_32x32x16_bf16 v[80:95], v[160:163], v[40:43], 0
    v_mfma_f32_32x32x8_bf16 v[80:95], v[168:169], v[44:45], v[80:95]
    s_nop 7
    s_nop 7
    v_max3_f32 v16, v16, v48, v49
    v_max3_f32 v16, v16, v50, v51
    v_max3_f32 v16, v16, v52, v53
    v_max3_f32 v16, v16, v54, v55
    v_max3_f32 v16, v16, v56, v57
    v_max3_f32 v16, v16, v58, v59
    v_max3_f32 v16, v16, v60, v61
    v_max3_f32 v16, v16, v62, v63
    v_max3_f32 v17, v17, v80, v81
    v_max3_f32 v17, v17, v82, v83
    v_max3_f32 v17, v17, v84, v85
    v_max3_f32 v17, v17, v86, v87
    v_max3_f32 v17, v17, v88, v89
    v_max3_f32 v17, v17, v90, v91
    v_max3_f32 v17, v17, v92, v93
    v_max3_f32 v17, v17, v94, v95
    ds_read_b128 v[160:163], v4 offset:9216
    ds_read_b64 v[168:169], v25 offset:9216
    s_waitcnt lgkmcnt(0)
    v_mfma_f32_32x32x16_bf16 v[48:63], v[160:163], v[32:35], 0
    v_mfma_f32_32x32x8_bf16 v[48:63], v[168:169], v[36:37], v[48:63]
    v_mfma_f32_32x32x16_bf16 v[80:95], v[160:163], v[40:43], 0
    v_mfma_f32_32x32x8_bf16 v[80:95], v[168:169], v[44:45], v[80:95]
    s_nop 7
    s_nop 7
    v_max3_f32 v16, v16, v48, v49
    v_max3_f32 v16, v16, v50, v51
    v_max3_f32 v16, v16, v52, v53
    v_max3_f32 v16, v16, v54, v55
    v_max3_f32 v16, v16, v56, v57
    v_max3_f32 v16, v16, v58, v59
    v_max3_f32 v16, v16, v60, v61
    v_max3_f32 v16, v16, v62, v63
    v_max3_f32 v17, v17, v80, v81
    v_max3_f32 v17, v17, v82, v83
    v_max3_f32 v17, v17, v84, v85
    v_max3_f32 v17, v17, v86, v87
    v_max3_f32 v17, v17, v88, v89
    v_max3_f32 v17, v17, v90, v91
    v_max3_f32 v17, v17, v92, v93
    v_max3_f32 v17, v17, v94, v95
    ds_read_b128 v[160:163], v4 offset:12288
    ds_read_b64 v[168:169], v25 offset:12288
    s_waitcnt lgkmcnt(0)
    v_mfma_f32_32x32x16_bf16 v[48:63], v[160:163], v[32:35], 0
    v_mfma_f32_32x32x8_bf16 v[48:63], v[168:169], v[36:37], v[48:63]
    v_mfma_f32_32x32x16_bf16 v[80:95], v[160:163], v[40:43], 0
    v_mfma_f32_32x32x8_bf16 v[80:95], v[168:169], v[44:45], v[80:95]
    s_nop 7
    s_nop 7
    v_max3_f32 v16, v16, v48, v49
    v_max3_f32 v16, v16, v50, v51
    v_max3_f32 v16, v16, v52, v53
    v_max3_f32 v16, v16, v54, v55
    v_max3_f32 v16, v16, v56, v57
    v_max3_f32 v16, v16, v58, v59
    v_max3_f32 v16, v16, v60, v61
    v_max3_f32 v16, v16, v62, v63
    v_max3_f32 v17, v17, v80, v81
    v_max3_f32 v17, v17, v82, v83
    v_max3_f32 v17, v17, v84, v85
    v_max3_f32 v17, v17, v86, v87
    v_max3_f32 v17, v17, v88, v89
    v_max3_f32 v17, v17, v90, v91
    v_max3_f32 v17, v17, v92, v93
    v_max3_f32 v17, v17, v94, v95
    ds_read_b128 v[160:163], v4 offset:15360
    ds_read_b64 v[168:169], v25 offset:15360
    s_waitcnt lgkmcnt(0)
    v_mfma_f32_32x32x16_bf16 v[48:63], v[160:163], v[32:35], 0
    v_mfma_f32_32x32x8_bf16 v[48:63], v[168:169], v[36:37], v[48:63]
    v_mfma_f32_32x32x16_bf16 v[80:95], v[160:163], v[40:43], 0
    v_mfma_f32_32x32x8_bf16 v[80:95], v[168:169], v[44:45], v[80:95]
    s_nop 7
    s_nop 7
    v_max3_f32 v16, v16, v48, v49
    v_max3_f32 v16, v16, v50, v51
    v_max3_f32 v16, v16, v52, v53
    v_max3_f32 v16, v16, v54, v55
    v_max3_f32 v16, v16, v56, v57
    v_max3_f32 v16, v16, v58, v59
    v_max3_f32 v16, v16, v60, v61
    v_max3_f32 v16, v16, v62, v63
    v_max3_f32 v17, v17, v80, v81
    v_max3_f32 v17, v17, v82, v83
    v_max3_f32 v17, v17, v84, v85
    v_max3_f32 v17, v17, v86, v87
    v_max3_f32 v17, v17, v88, v89
    v_max3_f32 v17, v17, v90, v91
    v_max3_f32 v17, v17, v92, v93
    v_max3_f32 v17, v17, v94, v95
    ds_read_b128 v[160:163], v4 offset:18432
    ds_read_b64 v[168:169], v25 offset:18432
    s_waitcnt lgkmcnt(0)
    v_mfma_f32_32x32x16_bf16 v[48:63], v[160:163], v[32:35], 0
    v_mfma_f32_32x32x8_bf16 v[48:63], v[168:169], v[36:37], v[48:63]
    v_mfma_f32_32x32x16_bf16 v[80:95], v[160:163], v[40:43], 0
    v_mfma_f32_32x32x8_bf16 v[80:95], v[168:169], v[44:45], v[80:95]
    s_nop 7
    s_nop 7
    v_max3_f32 v16, v16, v48, v49
    v_max3_f32 v16, v16, v50, v51
    v_max3_f32 v16, v16, v52, v53
    v_max3_f32 v16, v16, v54, v55
    v_max3_f32 v16, v16, v56, v57
    v_max3_f32 v16, v16, v58, v59
    v_max3_f32 v16, v16, v60, v61
    v_max3_f32 v16, v16, v62, v63
    v_max3_f32 v17, v17, v80, v81
    v_max3_f32 v17, v17, v82, v83
    v_max3_f32 v17, v17, v84, v85
    v_max3_f32 v17, v17, v86, v87
    v_max3_f32 v17, v17, v88, v89
    v_max3_f32 v17, v17, v90, v91
    v_max3_f32 v17, v17, v92, v93
    v_max3_f32 v17, v17, v94, v95
    ds_read_b128 v[160:163], v4 offset:21504
    ds_read_b64 v[168:169], v25 offset:21504
    s_waitcnt lgkmcnt(0)
    v_mfma_f32_32x32x16_bf16 v[48:63], v[160:163], v[32:35], 0
    v_mfma_f32_32x32x8_bf16 v[48:63], v[168:169], v[36:37], v[48:63]
    v_mfma_f32_32x32x16_bf16 v[80:95], v[160:163], v[40:43], 0
    v_mfma_f32_32x32x8_bf16 v[80:95], v[168:169], v[44:45], v[80:95]
    s_nop 7
    s_nop 7
    v_max3_f32 v16, v16, v48, v49
    v_max3_f32 v16, v16, v50, v51
    v_max3_f32 v16, v16, v52, v53
    v_max3_f32 v16, v16, v54, v55
    v_max3_f32 v16, v16, v56, v57
    v_max3_f32 v16, v16, v58, v59
    v_max3_f32 v16, v16, v60, v61
    v_max3_f32 v16, v16, v62, v63
    v_max3_f32 v17, v17, v80, v81
    v_max3_f32 v17, v17, v82, v83
    v_max3_f32 v17, v17, v84, v85
    v_max3_f32 v17, v17, v86, v87
    v_max3_f32 v17, v17, v88, v89
    v_max3_f32 v17, v17, v90, v91
    v_max3_f32 v17, v17, v92, v93
    v_max3_f32 v17, v17, v94, v95
    s_add_u32 s24, s24, 1
    s_cmp_lt_u32 s24, 8
    s_cbranch_scc1 attn0_kernel_mloop5
    v_cmp_gt_u32 vcc, 32, v1
    v_mov_b32 v18, v16
    s_nop 1
    v_permlane32_swap_b32 v16, v18
    v_max_f32 v16, v16, v18
    v_sub_f32 v16, 0, v16
    v_cvt_pk_bf16_f32 v16, v16, 0
    v_cndmask_b32 v36, v16, v36, vcc
    v_mov_b32 v18, v17
    s_nop 1
    v_permlane32_swap_b32 v17, v18
    v_max_f32 v17, v17, v18
    v_sub_f32 v17, 0, v17
    v_cvt_pk_bf16_f32 v17, v17, 0
    v_cndmask_b32 v44, v17, v44, vcc
    s_mov_b32 s15, 1
    s_barrier
    s_branch attn0_kernel_mainpass2
attn0_kernel_fin4:
    s_add_u32 s21, s20, 8192
    s_add_u32 s22, s20, 16384
    s_waitcnt lgkmcnt(0)
    buffer_store_dwordx4 v[48:51], v5, s[44:47], s20 offen
    buffer_store_dwordx4 v[52:55], v5, s[44:47], s21 offen
    s_cmp_ge_u32 s3, 2
    s_cbranch_scc1 attn0_kernel_o26
    buffer_store_dwordx4 v[56:59], v5, s[44:47], s22 offen
attn0_kernel_o26:
    s_endpgm
attn0_kernel_loader1:
    s_add_u32 s36, s4, 3145728
    s_addc_u32 s37, s5, 0
    s_mov_b32 s38, 196608
    s_mov_b32 s39, 0x00020000
    s_add_u32 s48, s4, 10485760
    s_addc_u32 s49, s5, 0
    s_mov_b32 s50, 16384
    s_mov_b32 s51, 0x00020000
    s_mov_b32 s17, 0
    s_mov_b32 s18, 0
    s_add_u32 m0, s18, 0
    s_add_u32 s19, s17, 0
    buffer_load_dwordx4 v4, s[36:39], s19 offen offset:0 lds
    buffer_load_dwordx4 v4, s[36:39], s19 offen offset:1024 lds
    buffer_load_dwordx4 v4, s[36:39], s19 offen offset:2048 lds
    buffer_load_dwordx4 v4, s[36:39], s19 offen offset:3072 lds
    s_add_u32 m0, s18, 4096
    s_add_u32 s19, s17, 4096
    buffer_load_dwordx4 v4, s[36:39], s19 offen offset:0 lds
    buffer_load_dwordx4 v4, s[36:39], s19 offen offset:1024 lds
    buffer_load_dwordx4 v4, s[36:39], s19 offen offset:2048 lds
    buffer_load_dwordx4 v4, s[36:39], s19 offen offset:3072 lds
    s_add_u32 m0, s18, 8192
    s_add_u32 s19, s17, 8192
    buffer_load_dwordx4 v4, s[36:39], s19 offen offset:0 lds
    buffer_load_dwordx4 v4, s[36:39], s19 offen offset:1024 lds
    buffer_load_dwordx4 v4, s[36:39], s19 offen offset:2048 lds
    buffer_load_dwordx4 v4, s[36:39], s19 offen offset:3072 lds
    s_add_u32 m0, s18, 12288
    s_add_u32 s19, s17, 12288
    buffer_load_dwordx4 v4, s[36:39], s19 offen offset:0 lds
    buffer_load_dwordx4 v4, s[36:39], s19 offen offset:1024 lds
    buffer_load_dwordx4 v4, s[36:39], s19 offen offset:2048 lds
    buffer_load_dwordx4 v4, s[36:39], s19 offen offset:3072 lds
    s_add_u32 m0, s18, 16384
    s_add_u32 s19, s17, 16384
    buffer_load_dwordx4 v4, s[36:39], s19 offen offset:0 lds
    buffer_load_dwordx4 v4, s[36:39], s19 offen offset:1024 lds
    buffer_load_dwordx4 v4, s[36:39], s19 offen offset:2048 lds
    buffer_load_dwordx4 v4, s[36:39], s19 offen offset:3072 lds
    s_add_u32 m0, s18, 20480
    s_add_u32 s19, s17, 20480
    buffer_load_dwordx4 v4, s[36:39], s19 offen offset:0 lds
    buffer_load_dwordx4 v4, s[36:39], s19 offen offset:1024 lds
    buffer_load_dwordx4 v4, s[36:39], s19 offen offset:2048 lds
    buffer_load_dwordx4 v4, s[36:39], s19 offen offset:3072 lds
    s_add_u32 s17, s17, 24576
    s_add_u32 s18, s18, 24576
    s_cmp_ge_u32 s18, 98304
    s_cselect_b32 s19, 98304, 0
    s_sub_u32 s18, s18, s19
    s_add_u32 m0, s18, 0
    s_add_u32 s19, s17, 0
    buffer_load_dwordx4 v4, s[36:39], s19 offen offset:0 lds
    buffer_load_dwordx4 v4, s[36:39], s19 offen offset:1024 lds
    buffer_load_dwordx4 v4, s[36:39], s19 offen offset:2048 lds
    buffer_load_dwordx4 v4, s[36:39], s19 offen offset:3072 lds
    s_add_u32 m0, s18, 4096
    s_add_u32 s19, s17, 4096
    buffer_load_dwordx4 v4, s[36:39], s19 offen offset:0 lds
    buffer_load_dwordx4 v4, s[36:39], s19 offen offset:1024 lds
    buffer_load_dwordx4 v4, s[36:39], s19 offen offset:2048 lds
    buffer_load_dwordx4 v4, s[36:39], s19 offen offset:3072 lds
    s_add_u32 m0, s18, 8192
    s_add_u32 s19, s17, 8192
    buffer_load_dwordx4 v4, s[36:39], s19 offen offset:0 lds
    buffer_load_dwordx4 v4, s[36:39], s19 offen offset:1024 lds
    buffer_load_dwordx4 v4, s[36:39], s19 offen offset:2048 lds
    buffer_load_dwordx4 v4, s[36:39], s19 offen offset:3072 lds
    s_add_u32 m0, s18, 12288
    s_add_u32 s19, s17, 12288
    buffer_load_dwordx4 v4, s[36:39], s19 offen offset:0 lds
    buffer_load_dwordx4 v4, s[36:39], s19 offen offset:1024 lds
    buffer_load_dwordx4 v4, s[36:39], s19 offen offset:2048 lds
    buffer_load_dwordx4 v4, s[36:39], s19 offen offset:3072 lds
    s_add_u32 m0, s18, 16384
    s_add_u32 s19, s17, 16384
    buffer_load_dwordx4 v4, s[36:39], s19 offen offset:0 lds
    buffer_load_dwordx4 v4, s[36:39], s19 offen offset:1024 lds
    buffer_load_dwordx4 v4, s[36:39], s19 offen offset:2048 lds
    buffer_load_dwordx4 v4, s[36:39], s19 offen offset:3072 lds
    s_add_u32 m0, s18, 20480
    s_add_u32 s19, s17, 20480
    buffer_load_dwordx4 v4, s[36:39], s19 offen offset:0 lds
    buffer_load_dwordx4 v4, s[36:39], s19 offen offset:1024 lds
    buffer_load_dwordx4 v4, s[36:39], s19 offen offset:2048 lds
    buffer_load_dwordx4 v4, s[36:39], s19 offen offset:3072 lds
    s_add_u32 s17, s17, 24576
    s_add_u32 s18, s18, 24576
    s_cmp_ge_u32 s18, 98304
    s_cselect_b32 s19, 98304, 0
    s_sub_u32 s18, s18, s19
    s_lshl_b32 s21, s2, 6
    v_lshlrev_b32 v6, 2, v1
    v_mov_b32 v7, 0x7ffffff0
    v_cmp_gt_u32 vcc, 16, v1
    v_mov_b32 v20, 0
    s_nop 0
    v_cndmask_b32 v7, v7, v6, vcc
    buffer_store_dword v20, v7, s[48:51], s21 offen
    s_add_u32 s56, s4, 33554432
    s_addc_u32 s57, s5, 0
    s_mov_b32 s58, 18644992
    s_mov_b32 s59, 0x00020000
    v_lshrrev_b32 v16, 2, v1
    v_lshlrev_b32 v17, 7, v16
    v_and_b32 v18, 3, v1
    v_lshl_add_u32 v17, v18, 3, v17
    v_add_u32 v17, 110656, v17
    v_bfe_u32 v16, v16, 1, 2
    v_xor_b32 v18, 0, v16
    v_lshl_add_u32 v20, v18, 5, v17
    v_xor_b32 v18, 1, v16
    v_lshl_add_u32 v21, v18, 5, v17
    v_xor_b32 v18, 2, v16
    v_lshl_add_u32 v22, v18, 5, v17
    v_xor_b32 v18, 3, v16
    v_lshl_add_u32 v23, v18, 5, v17
    v_and_b32 v16, 7, v1
    v_lshrrev_b32 v17, 4, v1
    v_lshlrev_b32 v17, 1, v17
    v_xor_b32 v16, v16, v17
    v_lshlrev_b32 v16, 4, v16
    v_lshrrev_b32 v17, 3, v1
    s_waitcnt vmcnt(25)
attn0_kernel_lmain7:
    s_barrier
    s_add_u32 m0, s18, 0
    s_add_u32 s19, s17, 0
    buffer_load_dwordx4 v4, s[36:39], s19 offen offset:0 lds
    buffer_load_dwordx4 v4, s[36:39], s19 offen offset:1024 lds
    buffer_load_dwordx4 v4, s[36:39], s19 offen offset:2048 lds
    buffer_load_dwordx4 v4, s[36:39], s19 offen offset:3072 lds
    s_add_u32 m0, s18, 4096
    s_add_u32 s19, s17, 4096
    buffer_load_dwordx4 v4, s[36:39], s19 offen offset:0 lds
    buffer_load_dwordx4 v4, s[36:39], s19 offen offset:1024 lds
    buffer_load_dwordx4 v4, s[36:39], s19 offen offset:2048 lds
    buffer_load_dwordx4 v4, s[36:39], s19 offen offset:3072 lds
    s_add_u32 m0, s18, 8192
    s_add_u32 s19, s17, 8192
    buffer_load_dwordx4 v4, s[36:39], s19 offen offset:0 lds
    buffer_load_dwordx4 v4, s[36:39], s19 offen offset:1024 lds
    buffer_load_dwordx4 v4, s[36:39], s19 offen offset:2048 lds
    buffer_load_dwordx4 v4, s[36:39], s19 offen offset:3072 lds
    s_add_u32 m0, s18, 12288
    s_add_u32 s19, s17, 12288
    buffer_load_dwordx4 v4, s[36:39], s19 offen offset:0 lds
    buffer_load_dwordx4 v4, s[36:39], s19 offen offset:1024 lds
    buffer_load_dwordx4 v4, s[36:39], s19 offen offset:2048 lds
    buffer_load_dwordx4 v4, s[36:39], s19 offen offset:3072 lds
    s_add_u32 m0, s18, 16384
    s_add_u32 s19, s17, 16384
    buffer_load_dwordx4 v4, s[36:39], s19 offen offset:0 lds
    buffer_load_dwordx4 v4, s[36:39], s19 offen offset:1024 lds
    buffer_load_dwordx4 v4, s[36:39], s19 offen offset:2048 lds
    buffer_load_dwordx4 v4, s[36:39], s19 offen offset:3072 lds
    s_add_u32 m0, s18, 20480
    s_add_u32 s19, s17, 20480
    buffer_load_dwordx4 v4, s[36:39], s19 offen offset:0 lds
    buffer_load_dwordx4 v4, s[36:39], s19 offen offset:1024 lds
    buffer_load_dwordx4 v4, s[36:39], s19 offen offset:2048 lds
    buffer_load_dwordx4 v4, s[36:39], s19 offen offset:3072 lds
    s_add_u32 s17, s17, 24576
    s_add_u32 s18, s18, 24576
    s_cmp_ge_u32 s18, 98304
    s_cselect_b32 s19, 98304, 0
    s_sub_u32 s18, s18, s19
    s_mov_b32 s24, 8
attn0_kernel_lloop8:
    s_waitcnt vmcnt(24)
    s_barrier
    s_add_u32 m0, s18, 0
    s_add_u32 s19, s17, 0
    buffer_load_dwordx4 v4, s[36:39], s19 offen offset:0 lds
    buffer_load_dwordx4 v4, s[36:39], s19 offen offset:1024 lds
    buffer_load_dwordx4 v4, s[36:39], s19 offen offset:2048 lds
    buffer_load_dwordx4 v4, s[36:39], s19 offen offset:3072 lds
    s_add_u32 m0, s18, 4096
    s_add_u32 s19, s17, 4096
    buffer_load_dwordx4 v4, s[36:39], s19 offen offset:0 lds
    buffer_load_dwordx4 v4, s[36:39], s19 offen offset:1024 lds
    buffer_load_dwordx4 v4, s[36:39], s19 offen offset:2048 lds
    buffer_load_dwordx4 v4, s[36:39], s19 offen offset:3072 lds
    s_add_u32 m0, s18, 8192
    s_add_u32 s19, s17, 8192
    buffer_load_dwordx4 v4, s[36:39], s19 offen offset:0 lds
    buffer_load_dwordx4 v4, s[36:39], s19 offen offset:1024 lds
    buffer_load_dwordx4 v4, s[36:39], s19 offen offset:2048 lds
    buffer_load_dwordx4 v4, s[36:39], s19 offen offset:3072 lds
    s_add_u32 m0, s18, 12288
    s_add_u32 s19, s17, 12288
    buffer_load_dwordx4 v4, s[36:39], s19 offen offset:0 lds
    buffer_load_dwordx4 v4, s[36:39], s19 offen offset:1024 lds
    buffer_load_dwordx4 v4, s[36:39], s19 offen offset:2048 lds
    buffer_load_dwordx4 v4, s[36:39], s19 offen offset:3072 lds
    s_add_u32 m0, s18, 16384
    s_add_u32 s19, s17, 16384
    buffer_load_dwordx4 v4, s[36:39], s19 offen offset:0 lds
    buffer_load_dwordx4 v4, s[36:39], s19 offen offset:1024 lds
    buffer_load_dwordx4 v4, s[36:39], s19 offen offset:2048 lds
    buffer_load_dwordx4 v4, s[36:39], s19 offen offset:3072 lds
    s_add_u32 m0, s18, 20480
    s_add_u32 s19, s17, 20480
    buffer_load_dwordx4 v4, s[36:39], s19 offen offset:0 lds
    buffer_load_dwordx4 v4, s[36:39], s19 offen offset:1024 lds
    buffer_load_dwordx4 v4, s[36:39], s19 offen offset:2048 lds
    buffer_load_dwordx4 v4, s[36:39], s19 offen offset:3072 lds
    s_add_u32 s17, s17, 24576
    s_add_u32 s18, s18, 24576
    s_cmp_ge_u32 s18, 98304
    s_cselect_b32 s19, 98304, 0
    s_sub_u32 s18, s18, s19
    s_cmp_lt_u32 s24, 2
    s_cbranch_scc1 attn0_kernel_rskip9
    s_cmp_eq_u32 s24, 8
    s_cbranch_scc1 attn0_kernel_rnoproc10
    s_waitcnt vmcnt(24)
    ds_read_b64_tr_b16 v[32:33], v20 offset:0
    ds_read_b64_tr_b16 v[34:35], v20 offset:2048
    ds_read_b64_tr_b16 v[36:37], v21 offset:0
    ds_read_b64_tr_b16 v[38:39], v21 offset:2048
    ds_read_b64_tr_b16 v[40:41], v22 offset:0
    ds_read_b64_tr_b16 v[42:43], v22 offset:2048
    ds_read_b64_tr_b16 v[44:45], v23 offset:0
    ds_read_b64_tr_b16 v[46:47], v23 offset:2048
    ds_read_b64_tr_b16 v[48:49], v20 offset:4096
    ds_read_b64_tr_b16 v[50:51], v20 offset:6144
    ds_read_b64_tr_b16 v[52:53], v21 offset:4096
    ds_read_b64_tr_b16 v[54:55], v21 offset:6144
    ds_read_b64_tr_b16 v[56:57], v22 offset:4096
    ds_read_b64_tr_b16 v[58:59], v22 offset:6144
    ds_read_b64_tr_b16 v[60:61], v23 offset:4096
    ds_read_b64_tr_b16 v[62:63], v23 offset:6144
    ds_read_b64_tr_b16 v[64:65], v20 offset:8192
    ds_read_b64_tr_b16 v[66:67], v20 offset:10240
    ds_read_b64_tr_b16 v[68:69], v21 offset:8192
    ds_read_b64_tr_b16 v[70:71], v21 offset:10240
    ds_read_b64_tr_b16 v[72:73], v22 offset:8192
    ds_read_b64_tr_b16 v[74:75], v22 offset:10240
    ds_read_b64_tr_b16 v[76:77], v23 offset:8192
    ds_read_b64_tr_b16 v[78:79], v23 offset:10240
    s_waitcnt lgkmcnt(0)
    buffer_store_dwordx4 v[32:35], v4, s[56:59], s40 offen offset:0 sc0 sc1
    buffer_store_dwordx4 v[36:39], v4, s[56:59], s40 offen offset:1024 sc0 sc1
    buffer_store_dwordx4 v[40:43], v4, s[56:59], s40 offen offset:2048 sc0 sc1
    buffer_store_dwordx4 v[44:47], v4, s[56:59], s40 offen offset:3072 sc0 sc1
    buffer_store_dwordx4 v[48:51], v4, s[56:59], s41 offen offset:0 sc0 sc1
    buffer_store_dwordx4 v[52:55], v4, s[56:59], s41 offen offset:1024 sc0 sc1
    buffer_store_dwordx4 v[56:59], v4, s[56:59], s41 offen offset:2048 sc0 sc1
    buffer_store_dwordx4 v[60:63], v4, s[56:59], s41 offen offset:3072 sc0 sc1
    buffer_store_dwordx4 v[64:67], v4, s[56:59], s42 offen offset:0 sc0 sc1
    buffer_store_dwordx4 v[68:71], v4, s[56:59], s42 offen offset:1024 sc0 sc1
    buffer_store_dwordx4 v[72:75], v4, s[56:59], s42 offen offset:2048 sc0 sc1
    buffer_store_dwordx4 v[76:79], v4, s[56:59], s42 offen offset:3072 sc0 sc1
attn0_kernel_rnoproc10:
    s_cmp_eq_u32 s24, 2
    s_cbranch_scc1 attn0_kernel_rskip9
    s_sub_u32 s29, 8, s24
    s_mul_i32 s29, s29, 768
    s_add_u32 s28, s29, s2
    s_add_u32 s28, s28, 0
    s_cmp_ge_u32 s28, 1728
    s_cbranch_scc1 attn0_kernel_rn12
    s_sub_u32 s28, s28, 0
    s_mul_i32 s29, s28, 2428
    s_lshr_b32 s29, s29, 16
    s_mul_i32 s30, s29, 27
    s_sub_u32 s28, s28, s30
    s_mul_i32 s40, s29, 112640
    s_lshl_b32 s30, s28, 12
    s_add_u32 s40, s40, s30
    s_add_u32 s40, s40, 0
    s_mul_i32 s29, s29, 110592
    s_lshl_b32 s28, s28, 7
    s_add_u32 s28, s28, s29
    s_mov_b32 s29, 27648
    s_mov_b32 s52, s10
    s_mov_b32 s53, s11
    s_mov_b32 s54, 7077888
    s_mov_b32 s55, 0x00020000
    v_mul_u32_u24 v18, 3456, v17
    s_branch attn0_kernel_rsel11
attn0_kernel_rn12:
    s_cmp_ge_u32 s28, 3456
    s_cbranch_scc1 attn0_kernel_rn13
    s_sub_u32 s28, s28, 1728
    s_mul_i32 s29, s28, 2049
    s_lshr_b32 s29, s29, 16
    s_mul_i32 s30, s29, 32
    s_sub_u32 s28, s28, s30
    s_mul_i32 s40, s29, 131072
    s_lshl_b32 s30, s28, 12
    s_add_u32 s40, s40, s30
    s_add_u32 s40, s40, 8388608
    s_mul_i32 s29, s29, 131072
    s_lshl_b32 s28, s28, 7
    s_add_u32 s28, s28, s29
    s_mov_b32 s29, 32768
    s_mov_b32 s52, s12
    s_mov_b32 s53, s13
    s_mov_b32 s54, 7077888
    s_mov_b32 s55, 0x00020000
    v_mul_u32_u24 v18, 4096, v17
    s_branch attn0_kernel_rsel11
attn0_kernel_rn13:
    s_cmp_ge_u32 s28, 3656
    s_cbranch_scc1 attn0_kernel_rn14
    s_sub_u32 s28, s28, 3456
    s_mul_i32 s29, s28, 6554
    s_lshr_b32 s29, s29, 16
    s_mul_i32 s30, s29, 10
    s_sub_u32 s28, s28, s30
    s_mul_i32 s40, s29, 40960
    s_lshl_b32 s30, s28, 12
    s_add_u32 s40, s40, s30
    s_add_u32 s40, s40, 16777216
    s_mul_i32 s29, s29, 40960
    s_lshl_b32 s28, s28, 7
    s_add_u32 s28, s28, s29
    s_mov_b32 s29, 10240
    s_mov_b32 s52, s8
    s_mov_b32 s53, s9
    s_mov_b32 s54, 819200
    s_mov_b32 s55, 0x00020000
    v_mul_u32_u24 v18, 1280, v17
    s_branch attn0_kernel_rsel11
attn0_kernel_rn14:
    s_sub_u32 s28, s28, 3656
    s_mul_i32 s29, s28, 6554
    s_lshr_b32 s29, s29, 16
    s_mul_i32 s30, s29, 10
    s_sub_u32 s28, s28, s30
    s_mul_i32 s40, s29, 40960
    s_lshl_b32 s30, s28, 12
    s_add_u32 s40, s40, s30
    s_add_u32 s40, s40, 17825792
    s_mul_i32 s29, s29, 40960
    s_lshl_b32 s28, s28, 7
    s_add_u32 s28, s28, s29
    s_mov_b32 s29, 10240
    s_mov_b32 s52, s6
    s_mov_b32 s53, s7
    s_mov_b32 s54, 819200
    s_mov_b32 s55, 0x00020000
    v_mul_u32_u24 v18, 1280, v17
    s_branch attn0_kernel_rsel11
attn0_kernel_rsel11:
    v_add_u32 v18, v18, v16
    s_mov_b32 m0, 110656
    s_nop 0
    buffer_load_dwordx4 v18, s[52:55], s28 offen lds
    s_add_u32 s28, s28, s29
    s_mov_b32 m0, 111680
    s_nop 0
    buffer_load_dwordx4 v18, s[52:55], s28 offen lds
    s_add_u32 s28, s28, s29
    s_mov_b32 m0, 112704
    s_nop 0
    buffer_load_dwordx4 v18, s[52:55], s28 offen lds
    s_add_u32 s28, s28, s29
    s_mov_b32 m0, 113728
    s_nop 0
    buffer_load_dwordx4 v18, s[52:55], s28 offen lds
    s_sub_u32 s29, 8, s24
    s_mul_i32 s29, s29, 768
    s_add_u32 s28, s29, s2
    s_add_u32 s28, s28, 256
    s_cmp_ge_u32 s28, 1728
    s_cbranch_scc1 attn0_kernel_rn17
    s_sub_u32 s28, s28, 0
    s_mul_i32 s29, s28, 2428
    s_lshr_b32 s29, s29, 16
    s_mul_i32 s30, s29, 27
    s_sub_u32 s28, s28, s30
    s_mul_i32 s41, s29, 112640
    s_lshl_b32 s30, s28, 12
    s_add_u32 s41, s41, s30
    s_add_u32 s41, s41, 0
    s_mul_i32 s29, s29, 110592
    s_lshl_b32 s28, s28, 7
    s_add_u32 s28, s28, s29
    s_mov_b32 s29, 27648
    s_mov_b32 s52, s10
    s_mov_b32 s53, s11
    s_mov_b32 s54, 7077888
    s_mov_b32 s55, 0x00020000
    v_mul_u32_u24 v18, 3456, v17
    s_branch attn0_kernel_rsel16
attn0_kernel_rn17:
    s_cmp_ge_u32 s28, 3456
    s_cbranch_scc1 attn0_kernel_rn18
    s_sub_u32 s28, s28, 1728
    s_mul_i32 s29, s28, 2049
    s_lshr_b32 s29, s29, 16
    s_mul_i32 s30, s29, 32
    s_sub_u32 s28, s28, s30
    s_mul_i32 s41, s29, 131072
    s_lshl_b32 s30, s28, 12
    s_add_u32 s41, s41, s30
    s_add_u32 s41, s41, 8388608
    s_mul_i32 s29, s29, 131072
    s_lshl_b32 s28, s28, 7
    s_add_u32 s28, s28, s29
    s_mov_b32 s29, 32768
    s_mov_b32 s52, s12
    s_mov_b32 s53, s13
    s_mov_b32 s54, 7077888
    s_mov_b32 s55, 0x00020000
    v_mul_u32_u24 v18, 4096, v17
    s_branch attn0_kernel_rsel16
attn0_kernel_rn18:
    s_cmp_ge_u32 s28, 3656
    s_cbranch_scc1 attn0_kernel_rn19
    s_sub_u32 s28, s28, 3456
    s_mul_i32 s29, s28, 6554
    s_lshr_b32 s29, s29, 16
    s_mul_i32 s30, s29, 10
    s_sub_u32 s28, s28, s30
    s_mul_i32 s41, s29, 40960
    s_lshl_b32 s30, s28, 12
    s_add_u32 s41, s41, s30
    s_add_u32 s41, s41, 16777216
    s_mul_i32 s29, s29, 40960
    s_lshl_b32 s28, s28, 7
    s_add_u32 s28, s28, s29
    s_mov_b32 s29, 10240
    s_mov_b32 s52, s8
    s_mov_b32 s53, s9
    s_mov_b32 s54, 819200
    s_mov_b32 s55, 0x00020000
    v_mul_u32_u24 v18, 1280, v17
    s_branch attn0_kernel_rsel16
attn0_kernel_rn19:
    s_sub_u32 s28, s28, 3656
    s_mul_i32 s29, s28, 6554
    s_lshr_b32 s29, s29, 16
    s_mul_i32 s30, s29, 10
    s_sub_u32 s28, s28, s30
    s_mul_i32 s41, s29, 40960
    s_lshl_b32 s30, s28, 12
    s_add_u32 s41, s41, s30
    s_add_u32 s41, s41, 17825792
    s_mul_i32 s29, s29, 40960
    s_lshl_b32 s28, s28, 7
    s_add_u32 s28, s28, s29
    s_mov_b32 s29, 10240
    s_mov_b32 s52, s6
    s_mov_b32 s53, s7
    s_mov_b32 s54, 819200
    s_mov_b32 s55, 0x00020000
    v_mul_u32_u24 v18, 1280, v17
    s_branch attn0_kernel_rsel16
attn0_kernel_rsel16:
    v_add_u32 v18, v18, v16
    s_mov_b32 m0, 114752
    s_nop 0
    buffer_load_dwordx4 v18, s[52:55], s28 offen lds
    s_add_u32 s28, s28, s29
    s_mov_b32 m0, 115776
    s_nop 0
    buffer_load_dwordx4 v18, s[52:55], s28 offen lds
    s_add_u32 s28, s28, s29
    s_mov_b32 m0, 116800
    s_nop 0
    buffer_load_dwordx4 v18, s[52:55], s28 offen lds
    s_add_u32 s28, s28, s29
    s_mov_b32 m0, 117824
    s_nop 0
    buffer_load_dwordx4 v18, s[52:55], s28 offen lds
    s_sub_u32 s29, 8, s24
    s_mul_i32 s29, s29, 768
    s_add_u32 s28, s29, s2
    s_add_u32 s28, s28, 512
    s_cmp_ge_u32 s28, 1728
    s_cbranch_scc1 attn0_kernel_rn22
    s_sub_u32 s28, s28, 0
    s_mul_i32 s29, s28, 2428
    s_lshr_b32 s29, s29, 16
    s_mul_i32 s30, s29, 27
    s_sub_u32 s28, s28, s30
    s_mul_i32 s42, s29, 112640
    s_lshl_b32 s30, s28, 12
    s_add_u32 s42, s42, s30
    s_add_u32 s42, s42, 0
    s_mul_i32 s29, s29, 110592
    s_lshl_b32 s28, s28, 7
    s_add_u32 s28, s28, s29
    s_mov_b32 s29, 27648
    s_mov_b32 s52, s10
    s_mov_b32 s53, s11
    s_mov_b32 s54, 7077888
    s_mov_b32 s55, 0x00020000
    v_mul_u32_u24 v18, 3456, v17
    s_branch attn0_kernel_rsel21
attn0_kernel_rn22:
    s_cmp_ge_u32 s28, 3456
    s_cbranch_scc1 attn0_kernel_rn23
    s_sub_u32 s28, s28, 1728
    s_mul_i32 s29, s28, 2049
    s_lshr_b32 s29, s29, 16
    s_mul_i32 s30, s29, 32
    s_sub_u32 s28, s28, s30
    s_mul_i32 s42, s29, 131072
    s_lshl_b32 s30, s28, 12
    s_add_u32 s42, s42, s30
    s_add_u32 s42, s42, 8388608
    s_mul_i32 s29, s29, 131072
    s_lshl_b32 s28, s28, 7
    s_add_u32 s28, s28, s29
    s_mov_b32 s29, 32768
    s_mov_b32 s52, s12
    s_mov_b32 s53, s13
    s_mov_b32 s54, 7077888
    s_mov_b32 s55, 0x00020000
    v_mul_u32_u24 v18, 4096, v17
    s_branch attn0_kernel_rsel21
attn0_kernel_rn23:
    s_cmp_ge_u32 s28, 3656
    s_cbranch_scc1 attn0_kernel_rn24
    s_sub_u32 s28, s28, 3456
    s_mul_i32 s29, s28, 6554
    s_lshr_b32 s29, s29, 16
    s_mul_i32 s30, s29, 10
    s_sub_u32 s28, s28, s30
    s_mul_i32 s42, s29, 40960
    s_lshl_b32 s30, s28, 12
    s_add_u32 s42, s42, s30
    s_add_u32 s42, s42, 16777216
    s_mul_i32 s29, s29, 40960
    s_lshl_b32 s28, s28, 7
    s_add_u32 s28, s28, s29
    s_mov_b32 s29, 10240
    s_mov_b32 s52, s8
    s_mov_b32 s53, s9
    s_mov_b32 s54, 819200
    s_mov_b32 s55, 0x00020000
    v_mul_u32_u24 v18, 1280, v17
    s_branch attn0_kernel_rsel21
attn0_kernel_rn24:
    s_sub_u32 s28, s28, 3656
    s_mul_i32 s29, s28, 6554
    s_lshr_b32 s29, s29, 16
    s_mul_i32 s30, s29, 10
    s_sub_u32 s28, s28, s30
    s_mul_i32 s42, s29, 40960
    s_lshl_b32 s30, s28, 12
    s_add_u32 s42, s42, s30
    s_add_u32 s42, s42, 17825792
    s_mul_i32 s29, s29, 40960
    s_lshl_b32 s28, s28, 7
    s_add_u32 s28, s28, s29
    s_mov_b32 s29, 10240
    s_mov_b32 s52, s6
    s_mov_b32 s53, s7
    s_mov_b32 s54, 819200
    s_mov_b32 s55, 0x00020000
    v_mul_u32_u24 v18, 1280, v17
    s_branch attn0_kernel_rsel21
attn0_kernel_rsel21:
    v_add_u32 v18, v18, v16
    s_mov_b32 m0, 118848
    s_nop 0
    buffer_load_dwordx4 v18, s[52:55], s28 offen lds
    s_add_u32 s28, s28, s29
    s_mov_b32 m0, 119872
    s_nop 0
    buffer_load_dwordx4 v18, s[52:55], s28 offen lds
    s_add_u32 s28, s28, s29
    s_mov_b32 m0, 120896
    s_nop 0
    buffer_load_dwordx4 v18, s[52:55], s28 offen lds
    s_add_u32 s28, s28, s29
    s_mov_b32 m0, 121920
    s_nop 0
    buffer_load_dwordx4 v18, s[52:55], s28 offen lds
attn0_kernel_rskip9:
    s_sub_u32 s24, s24, 1
    s_cmp_lg_u32 s24, 0
    s_cbranch_scc1 attn0_kernel_lloop8
    v_mov_b32 v19, 110592
    s_waitcnt vmcnt(0)
    s_barrier
    ds_read_b128 v[24:27], v19
    s_waitcnt lgkmcnt(0)
    v_or_b32 v24, v24, v25
    v_or3_b32 v24, v24, v26, v27
    s_nop 0
    v_readfirstlane_b32 s25, v24
    s_cmp_lg_u32 s15, 0
    s_cbranch_scc1 attn0_kernel_end
    s_cmp_eq_u32 s25, 0
    s_cbranch_scc1 attn0_kernel_end
    s_mov_b32 s24, 0
attn0_kernel_lmloop26:
    s_barrier
    s_mul_i32 s17, s24, 24576
    s_mov_b32 s18, 0
    s_add_u32 m0, s18, 0
    s_add_u32 s19, s17, 0
    buffer_load_dwordx4 v4, s[36:39], s19 offen offset:0 lds
    buffer_load_dwordx4 v4, s[36:39], s19 offen offset:1024 lds
    buffer_load_dwordx4 v4, s[36:39], s19 offen offset:2048 lds
    buffer_load_dwordx4 v4, s[36:39], s19 offen offset:3072 lds
    s_add_u32 m0, s18, 4096
    s_add_u32 s19, s17, 4096
    buffer_load_dwordx4 v4, s[36:39], s19 offen offset:0 lds
    buffer_load_dwordx4 v4, s[36:39], s19 offen offset:1024 lds
    buffer_load_dwordx4 v4, s[36:39], s19 offen offset:2048 lds
    buffer_load_dwordx4 v4, s[36:39], s19 offen offset:3072 lds
    s_add_u32 m0, s18, 8192
    s_add_u32 s19, s17, 8192
    buffer_load_dwordx4 v4, s[36:39], s19 offen offset:0 lds
    buffer_load_dwordx4 v4, s[36:39], s19 offen offset:1024 lds
    buffer_load_dwordx4 v4, s[36:39], s19 offen offset:2048 lds
    buffer_load_dwordx4 v4, s[36:39], s19 offen offset:3072 lds
    s_add_u32 m0, s18, 12288
    s_add_u32 s19, s17, 12288
    buffer_load_dwordx4 v4, s[36:39], s19 offen offset:0 lds
    buffer_load_dwordx4 v4, s[36:39], s19 offen offset:1024 lds
    buffer_load_dwordx4 v4, s[36:39], s19 offen offset:2048 lds
    buffer_load_dwordx4 v4, s[36:39], s19 offen offset:3072 lds
    s_add_u32 m0, s18, 16384
    s_add_u32 s19, s17, 16384
    buffer_load_dwordx4 v4, s[36:39], s19 offen offset:0 lds
    buffer_load_dwordx4 v4, s[36:39], s19 offen offset:1024 lds
    buffer_load_dwordx4 v4, s[36:39], s19 offen offset:2048 lds
    buffer_load_dwordx4 v4, s[36:39], s19 offen offset:3072 lds
    s_add_u32 m0, s18, 20480
    s_add_u32 s19, s17, 20480
    buffer_load_dwordx4 v4, s[36:39], s19 offen offset:0 lds
    buffer_load_dwordx4 v4, s[36:39], s19 offen offset:1024 lds
    buffer_load_dwordx4 v4, s[36:39], s19 offen offset:2048 lds
    buffer_load_dwordx4 v4, s[36:39], s19 offen offset:3072 lds
    s_add_u32 s17, s17, 24576
    s_add_u32 s18, s18, 24576
    s_cmp_ge_u32 s18, 98304
    s_cselect_b32 s19, 98304, 0
    s_sub_u32 s18, s18, s19
    s_waitcnt vmcnt(0)
    s_barrier
    s_add_u32 s24, s24, 1
    s_cmp_lt_u32 s24, 8
    s_cbranch_scc1 attn0_kernel_lmloop26
    s_mov_b32 s15, 1
    s_barrier
    s_mov_b32 s17, 0
    s_mov_b32 s18, 0
    s_add_u32 m0, s18, 0
    s_add_u32 s19, s17, 0
    buffer_load_dwordx4 v4, s[36:39], s19 offen offset:0 lds
    buffer_load_dwordx4 v4, s[36:39], s19 offen offset:1024 lds
    buffer_load_dwordx4 v4, s[36:39], s19 offen offset:2048 lds
    buffer_load_dwordx4 v4, s[36:39], s19 offen offset:3072 lds
    s_add_u32 m0, s18, 4096
    s_add_u32 s19, s17, 4096
    buffer_load_dwordx4 v4, s[36:39], s19 offen offset:0 lds
    buffer_load_dwordx4 v4, s[36:39], s19 offen offset:1024 lds
    buffer_load_dwordx4 v4, s[36:39], s19 offen offset:2048 lds
    buffer_load_dwordx4 v4, s[36:39], s19 offen offset:3072 lds
    s_add_u32 m0, s18, 8192
    s_add_u32 s19, s17, 8192
    buffer_load_dwordx4 v4, s[36:39], s19 offen offset:0 lds
    buffer_load_dwordx4 v4, s[36:39], s19 offen offset:1024 lds
    buffer_load_dwordx4 v4, s[36:39], s19 offen offset:2048 lds
    buffer_load_dwordx4 v4, s[36:39], s19 offen offset:3072 lds
    s_add_u32 m0, s18, 12288
    s_add_u32 s19, s17, 12288
    buffer_load_dwordx4 v4, s[36:39], s19 offen offset:0 lds
    buffer_load_dwordx4 v4, s[36:39], s19 offen offset:1024 lds
    buffer_load_dwordx4 v4, s[36:39], s19 offen offset:2048 lds
    buffer_load_dwordx4 v4, s[36:39], s19 offen offset:3072 lds
    s_add_u32 m0, s18, 16384
    s_add_u32 s19, s17, 16384
    buffer_load_dwordx4 v4, s[36:39], s19 offen offset:0 lds
    buffer_load_dwordx4 v4, s[36:39], s19 offen offset:1024 lds
    buffer_load_dwordx4 v4, s[36:39], s19 offen offset:2048 lds
    buffer_load_dwordx4 v4, s[36:39], s19 offen offset:3072 lds
    s_add_u32 m0, s18, 20480
    s_add_u32 s19, s17, 20480
    buffer_load_dwordx4 v4, s[36:39], s19 offen offset:0 lds
    buffer_load_dwordx4 v4, s[36:39], s19 offen offset:1024 lds
    buffer_load_dwordx4 v4, s[36:39], s19 offen offset:2048 lds
    buffer_load_dwordx4 v4, s[36:39], s19 offen offset:3072 lds
    s_add_u32 s17, s17, 24576
    s_add_u32 s18, s18, 24576
    s_cmp_ge_u32 s18, 98304
    s_cselect_b32 s19, 98304, 0
    s_sub_u32 s18, s18, s19
    s_add_u32 m0, s18, 0
    s_add_u32 s19, s17, 0
    buffer_load_dwordx4 v4, s[36:39], s19 offen offset:0 lds
    buffer_load_dwordx4 v4, s[36:39], s19 offen offset:1024 lds
    buffer_load_dwordx4 v4, s[36:39], s19 offen offset:2048 lds
    buffer_load_dwordx4 v4, s[36:39], s19 offen offset:3072 lds
    s_add_u32 m0, s18, 4096
    s_add_u32 s19, s17, 4096
    buffer_load_dwordx4 v4, s[36:39], s19 offen offset:0 lds
    buffer_load_dwordx4 v4, s[36:39], s19 offen offset:1024 lds
    buffer_load_dwordx4 v4, s[36:39], s19 offen offset:2048 lds
    buffer_load_dwordx4 v4, s[36:39], s19 offen offset:3072 lds
    s_add_u32 m0, s18, 8192
    s_add_u32 s19, s17, 8192
    buffer_load_dwordx4 v4, s[36:39], s19 offen offset:0 lds
    buffer_load_dwordx4 v4, s[36:39], s19 offen offset:1024 lds
    buffer_load_dwordx4 v4, s[36:39], s19 offen offset:2048 lds
    buffer_load_dwordx4 v4, s[36:39], s19 offen offset:3072 lds
    s_add_u32 m0, s18, 12288
    s_add_u32 s19, s17, 12288
    buffer_load_dwordx4 v4, s[36:39], s19 offen offset:0 lds
    buffer_load_dwordx4 v4, s[36:39], s19 offen offset:1024 lds
    buffer_load_dwordx4 v4, s[36:39], s19 offen offset:2048 lds
    buffer_load_dwordx4 v4, s[36:39], s19 offen offset:3072 lds
    s_add_u32 m0, s18, 16384
    s_add_u32 s19, s17, 16384
    buffer_load_dwordx4 v4, s[36:39], s19 offen offset:0 lds
    buffer_load_dwordx4 v4, s[36:39], s19 offen offset:1024 lds
    buffer_load_dwordx4 v4, s[36:39], s19 offen offset:2048 lds
    buffer_load_dwordx4 v4, s[36:39], s19 offen offset:3072 lds
    s_add_u32 m0, s18, 20480
    s_add_u32 s19, s17, 20480
    buffer_load_dwordx4 v4, s[36:39], s19 offen offset:0 lds
    buffer_load_dwordx4 v4, s[36:39], s19 offen offset:1024 lds
    buffer_load_dwordx4 v4, s[36:39], s19 offen offset:2048 lds
    buffer_load_dwordx4 v4, s[36:39], s19 offen offset:3072 lds
    s_add_u32 s17, s17, 24576
    s_add_u32 s18, s18, 24576
    s_cmp_ge_u32 s18, 98304
    s_cselect_b32 s19, 98304, 0
    s_sub_u32 s18, s18, s19
    s_waitcnt vmcnt(24)
    s_branch attn0_kernel_lmain7
attn0_kernel_end:
    s_endpgm

.globl oproj0_kernel
.p2align 8
.type oproj0_kernel,@function
oproj0_kernel:
    s_cmp_ge_u32 s2, 256
    s_cbranch_scc1 oproj0_kernel_end
    s_load_dwordx2 s[4:5], s[0:1], 96
    s_load_dwordx2 s[8:9], s[0:1], 32
    s_and_b32 s16, s2, 7
    s_lshr_b32 s17, s2, 3
    s_and_b32 s18, s17, 3
    s_lshl_b32 s16, s16, 2
    s_add_u32 s16, s16, s18
    s_lshr_b32 s17, s17, 2
    v_lshrrev_b32 v2, 6, v0
    v_and_b32 v1, 63, v0
    v_readfirstlane_b32 s3, v2
    v_lshrrev_b32 v2, 4, v1
    v_and_b32 v3, 15, v1
    s_lshl_b32 s20, s16, 6
    s_lshl_b32 s21, s3, 4
    s_add_u32 s20, s20, s21
    s_lshr_b32 s21, s20, 4
    s_mul_i32 s21, s21, 20480
    s_mul_i32 s24, s17, 5
    s_lshr_b32 s24, s24, 1
    s_lshl_b32 s24, s24, 10
    s_add_u32 s24, s24, s21
    s_and_b32 s25, s17, 1
    v_lshlrev_b32 v5, 4, v1
    s_waitcnt lgkmcnt(0)
    s_add_u32 s32, s4, 4194304
    s_addc_u32 s33, s5, 0
    s_mov_b32 s34, 2621440
    s_mov_b32 s35, 0x00020000
    s_add_u32 s36, s4, 50331648
    s_addc_u32 s37, s5, 0
    s_mov_b32 s38, 819200
    s_mov_b32 s39, 0x00020000
    s_add_u32 s40, s4, 20971520
    s_addc_u32 s41, s5, 0
    s_mov_b32 s42, 2621440
    s_mov_b32 s43, 0x00020000
    s_add_u32 s44, s4, 7340032
    s_addc_u32 s45, s5, 0
    s_mov_b32 s46, 2621440
    s_mov_b32 s47, 0x00020000
    s_add_u32 s48, s4, 10485760
    s_addc_u32 s49, s5, 0
    s_mov_b32 s50, 16384
    s_mov_b32 s51, 0x00020000
    s_mul_i32 s26, s17, 5120
    s_mul_i32 s27, s3, 40960
    s_add_u32 s26, s26, s27
    s_mul_i32 s27, s3, 5120
    s_lshl_b32 s31, s3, 10
    v_add_u32 v6, 4096, v5
    s_add_u32 s22, s21, 0
    buffer_load_dwordx4 v[16:19], v5, s[32:35], s22 offen offset:0
    buffer_load_dwordx4 v[20:23], v5, s[32:35], s22 offen offset:1024
    buffer_load_dwordx4 v[24:27], v5, s[32:35], s22 offen offset:2048
    buffer_load_dwordx4 v[28:31], v5, s[32:35], s22 offen offset:3072
    s_mov_b32 m0, s27
    s_nop 0
    buffer_load_dwordx4 v5, s[36:39], s26 offen lds
    s_mov_b32 m0, s27
    s_nop 0
    buffer_load_dwordx4 v5, s[36:39], s26 offen offset:1024 lds
    s_mov_b32 m0, s27
    s_nop 0
    buffer_load_dwordx4 v5, s[36:39], s26 offen offset:2048 lds
    s_mov_b32 m0, s27
    s_nop 0
    buffer_load_dwordx4 v5, s[36:39], s26 offen offset:3072 lds
    s_add_u32 m0, s27, 4096
    s_nop 0
    buffer_load_dwordx4 v6, s[36:39], s26 offen lds
    s_add_u32 s26, s26, 163840
    s_add_u32 s27, s27, 20480
    s_add_u32 s22, s21, 4096
    buffer_load_dwordx4 v[32:35], v5, s[32:35], s22 offen offset:0
    buffer_load_dwordx4 v[36:39], v5, s[32:35], s22 offen offset:1024
    buffer_load_dwordx4 v[40:43], v5, s[32:35], s22 offen offset:2048
    buffer_load_dwordx4 v[44:47], v5, s[32:35], s22 offen offset:3072
    s_mov_b32 m0, s27
    s_nop 0
    buffer_load_dwordx4 v5, s[36:39], s26 offen lds
    s_mov_b32 m0, s27
    s_nop 0
    buffer_load_dwordx4 v5, s[36:39], s26 offen offset:1024 lds
    s_mov_b32 m0, s27
    s_nop 0
    buffer_load_dwordx4 v5, s[36:39], s26 offen offset:2048 lds
    s_mov_b32 m0, s27
    s_nop 0
    buffer_load_dwordx4 v5, s[36:39], s26 offen offset:3072 lds
    s_add_u32 m0, s27, 4096
    s_nop 0
    buffer_load_dwordx4 v6, s[36:39], s26 offen lds
    s_add_u32 s26, s26, 163840
    s_add_u32 s27, s27, 20480
    s_add_u32 s22, s21, 8192
    buffer_load_dwordx4 v[48:51], v5, s[32:35], s22 offen offset:0
    buffer_load_dwordx4 v[52:55], v5, s[32:35], s22 offen offset:1024
    buffer_load_dwordx4 v[56:59], v5, s[32:35], s22 offen offset:2048
    buffer_load_dwordx4 v[60:63], v5, s[32:35], s22 offen offset:3072
    s_mov_b32 m0, s27
    s_nop 0
    buffer_load_dwordx4 v5, s[36:39], s26 offen lds
    s_mov_b32 m0, s27
    s_nop 0
    buffer_load_dwordx4 v5, s[36:39], s26 offen offset:1024 lds
    s_mov_b32 m0, s27
    s_nop 0
    buffer_load_dwordx4 v5, s[36:39], s26 offen offset:2048 lds
    s_mov_b32 m0, s27
    s_nop 0
    buffer_load_dwordx4 v5, s[36:39], s26 offen offset:3072 lds
    s_add_u32 m0, s27, 4096
    s_nop 0
    buffer_load_dwordx4 v6, s[36:39], s26 offen lds
    s_add_u32 s26, s26, 163840
    s_add_u32 s27, s27, 20480
    v_mov_b32 v12, v5
    v_add_u32 v13, 51200, v5
    v_mov_b32 v96, 0
    v_mov_b32 v97, 0
    v_mov_b32 v98, 0
    v_mov_b32 v99, 0
    v_mov_b32 v100, 0
    v_mov_b32 v101, 0
    v_mov_b32 v102, 0
    v_mov_b32 v103, 0
    v_mov_b32 v104, 0
    v_mov_b32 v105, 0
    v_mov_b32 v106, 0
    v_mov_b32 v107, 0
    v_mov_b32 v108, 0
    v_mov_b32 v109, 0
    v_mov_b32 v110, 0
    v_mov_b32 v111, 0
    v_mov_b32 v112, 0
    v_mov_b32 v113, 0
    v_mov_b32 v114, 0
    v_mov_b32 v115, 0
    v_mov_b32 v116, 0
    v_mov_b32 v117, 0
    v_mov_b32 v118, 0
    v_mov_b32 v119, 0
    v_lshrrev_b32 v168, 2, v3
    v_cmp_eq_u32 vcc, v168, v2
    v_and_b32 v168, 1, v3
    v_lshlrev_b32 v168, 4, v168
    v_mov_b32 v169, 0x3f80
    v_lshlrev_b32 v169, v168, v169
    v_cndmask_b32 v169, 0, v169, vcc
    v_and_b32 v168, 2, v3
    v_cmp_eq_u32 vcc, 0, v168
    v_mov_b32 v162, 0
    v_mov_b32 v163, 0
    v_cndmask_b32 v160, 0, v169, vcc
    v_cndmask_b32 v161, v169, 0, vcc
    v_mov_b32 v164, 0
    v_mov_b32 v165, 0
    v_mov_b32 v166, v160
    v_mov_b32 v167, v161
    s_waitcnt vmcnt(18)
    s_barrier
    ds_read_b128 v[120:123], v12 offset:0
    ds_read_b128 v[124:127], v12 offset:1024
    ds_read_b128 v[128:131], v12 offset:2048
    ds_read_b128 v[132:135], v12 offset:3072
    ds_read_b128 v[136:139], v12 offset:4096
    ds_read_b128 v[140:143], v12 offset:5120
    ds_read_b128 v[144:147], v12 offset:6144
    ds_read_b128 v[148:151], v12 offset:7168
    ds_read_b128 v[152:155], v12 offset:8192
    ds_read_b128 v[156:159], v12 offset:9216
    s_waitcnt lgkmcnt(5)
    v_mfma_f32_16x16x32_bf16 v[96:99], v[16:19], v[120:123], v[96:99]
    ds_read_b128 v[192:195], v12 offset:10240
    v_mfma_f32_16x16x32_bf16 v[100:103], v[16:19], v[124:127], v[100:103]
    ds_read_b128 v[196:199], v12 offset:11264
    s_add_u32 s22, s21, 12288
    buffer_load_dwordx4 v[64:67], v5, s[32:35], s22 offen offset:0
    v_mfma_f32_16x16x32_bf16 v[104:107], v[16:19], v[128:131], v[104:107]
    ds_read_b128 v[200:203], v12 offset:12288
    v_mfma_f32_16x16x32_bf16 v[108:111], v[16:19], v[132:135], v[108:111]
    ds_read_b128 v[204:207], v12 offset:13312
    buffer_load_dwordx4 v[68:71], v5, s[32:35], s22 offen offset:1024
    v_mfma_f32_16x16x32_bf16 v[112:115], v[16:19], v[136:139], v[112:115]
    ds_read_b128 v[208:211], v12 offset:14336
    buffer_load_dwordx4 v[72:75], v5, s[32:35], s22 offen offset:2048
    s_waitcnt lgkmcnt(5)
    v_mfma_f32_16x16x32_bf16 v[96:99], v[20:23], v[140:143], v[96:99]
    ds_read_b128 v[120:123], v12 offset:15360
    v_mfma_f32_16x16x32_bf16 v[100:103], v[20:23], v[144:147], v[100:103]
    ds_read_b128 v[124:127], v12 offset:16384
    buffer_load_dwordx4 v[76:79], v5, s[32:35], s22 offen offset:3072
    v_mfma_f32_16x16x32_bf16 v[104:107], v[20:23], v[148:151], v[104:107]
    ds_read_b128 v[128:131], v12 offset:17408
    v_mfma_f32_16x16x32_bf16 v[108:111], v[20:23], v[152:155], v[108:111]
    ds_read_b128 v[132:135], v12 offset:18432
    s_mov_b32 m0, s27
    s_nop 0
    buffer_load_dwordx4 v5, s[36:39], s26 offen lds
    v_mfma_f32_16x16x32_bf16 v[112:115], v[20:23], v[156:159], v[112:115]
    ds_read_b128 v[136:139], v12 offset:19456
    s_waitcnt vmcnt(14)
    s_barrier
    s_waitcnt lgkmcnt(5)
    v_mfma_f32_16x16x32_bf16 v[96:99], v[24:27], v[192:195], v[96:99]
    ds_read_b128 v[140:143], v12 offset:20480
    v_mfma_f32_16x16x32_bf16 v[100:103], v[24:27], v[196:199], v[100:103]
    ds_read_b128 v[144:147], v12 offset:21504
    s_mov_b32 m0, s27
    s_nop 0
    buffer_load_dwordx4 v5, s[36:39], s26 offen offset:1024 lds
    v_mfma_f32_16x16x32_bf16 v[104:107], v[24:27], v[200:203], v[104:107]
    ds_read_b128 v[148:151], v12 offset:22528
    v_mfma_f32_16x16x32_bf16 v[108:111], v[24:27], v[204:207], v[108:111]
    ds_read_b128 v[152:155], v12 offset:23552
    s_mov_b32 m0, s27
    s_nop 0
    buffer_load_dwordx4 v5, s[36:39], s26 offen offset:2048 lds
    v_mfma_f32_16x16x32_bf16 v[112:115], v[24:27], v[208:211], v[112:115]
    ds_read_b128 v[156:159], v12 offset:24576
    s_waitcnt lgkmcnt(5)
    v_mfma_f32_16x16x32_bf16 v[96:99], v[28:31], v[120:123], v[96:99]
    ds_read_b128 v[192:195], v12 offset:25600
    v_mfma_f32_16x16x32_bf16 v[100:103], v[28:31], v[124:127], v[100:103]
    ds_read_b128 v[196:199], v12 offset:26624
    s_mov_b32 m0, s27
    s_nop 0
    buffer_load_dwordx4 v5, s[36:39], s26 offen offset:3072 lds
    v_mfma_f32_16x16x32_bf16 v[104:107], v[28:31], v[128:131], v[104:107]
    ds_read_b128 v[200:203], v12 offset:27648
    v_mfma_f32_16x16x32_bf16 v[108:111], v[28:31], v[132:135], v[108:111]
    ds_read_b128 v[204:207], v12 offset:28672
    s_add_u32 m0, s27, 4096
    s_nop 0
    buffer_load_dwordx4 v6, s[36:39], s26 offen lds
    s_add_u32 s26, s26, 163840
    s_add_u32 s27, s27, 20480
    v_mfma_f32_16x16x32_bf16 v[112:115], v[28:31], v[136:139], v[112:115]
    ds_read_b128 v[208:211], v12 offset:29696
    s_waitcnt lgkmcnt(5)
    v_mfma_f32_16x16x32_bf16 v[96:99], v[32:35], v[140:143], v[96:99]
    ds_read_b128 v[120:123], v12 offset:30720
    v_mfma_f32_16x16x32_bf16 v[100:103], v[32:35], v[144:147], v[100:103]
    ds_read_b128 v[124:127], v12 offset:31744
    s_add_u32 s22, s21, 16384
    buffer_load_dwordx4 v[80:83], v5, s[32:35], s22 offen offset:0
    v_mfma_f32_16x16x32_bf16 v[104:107], v[32:35], v[148:151], v[104:107]
    ds_read_b128 v[128:131], v12 offset:32768
    v_mfma_f32_16x16x32_bf16 v[108:111], v[32:35], v[152:155], v[108:111]
    ds_read_b128 v[132:135], v12 offset:33792
    buffer_load_dwordx4 v[84:87], v5, s[32:35], s22 offen offset:1024
    v_mfma_f32_16x16x32_bf16 v[112:115], v[32:35], v[156:159], v[112:115]
    ds_read_b128 v[136:139], v12 offset:34816
    buffer_load_dwordx4 v[88:91], v5, s[32:35], s22 offen offset:2048
    s_waitcnt lgkmcnt(5)
    v_mfma_f32_16x16x32_bf16 v[96:99], v[36:39], v[192:195], v[96:99]
    ds_read_b128 v[140:143], v12 offset:35840
    v_mfma_f32_16x16x32_bf16 v[100:103], v[36:39], v[196:199], v[100:103]
    ds_read_b128 v[144:147], v12 offset:36864
    buffer_load_dwordx4 v[92:95], v5, s[32:35], s22 offen offset:3072
    v_mfma_f32_16x16x32_bf16 v[104:107], v[36:39], v[200:203], v[104:107]
    ds_read_b128 v[148:151], v12 offset:37888
    v_mfma_f32_16x16x32_bf16 v[108:111], v[36:39], v[204:207], v[108:111]
    ds_read_b128 v[152:155], v12 offset:38912
    s_mov_b32 m0, s27
    s_nop 0
    buffer_load_dwordx4 v5, s[36:39], s26 offen lds
    v_mfma_f32_16x16x32_bf16 v[112:115], v[36:39], v[208:211], v[112:115]
    ds_read_b128 v[156:159], v12 offset:39936
    s_waitcnt vmcnt(14)
    s_barrier
    s_waitcnt lgkmcnt(5)
    v_mfma_f32_16x16x32_bf16 v[96:99], v[40:43], v[120:123], v[96:99]
    ds_read_b128 v[192:195], v12 offset:40960
    v_mfma_f32_16x16x32_bf16 v[100:103], v[40:43], v[124:127], v[100:103]
    ds_read_b128 v[196:199], v12 offset:41984
    s_mov_b32 m0, s27
    s_nop 0
    buffer_load_dwordx4 v5, s[36:39], s26 offen offset:1024 lds
    v_mfma_f32_16x16x32_bf16 v[104:107], v[40:43], v[128:131], v[104:107]
    ds_read_b128 v[200:203], v12 offset:43008
    v_mfma_f32_16x16x32_bf16 v[108:111], v[40:43], v[132:135], v[108:111]
    ds_read_b128 v[204:207], v12 offset:44032
    s_mov_b32 m0, s27
    s_nop 0
    buffer_load_dwordx4 v5, s[36:39], s26 offen offset:2048 lds
    v_mfma_f32_16x16x32_bf16 v[112:115], v[40:43], v[136:139], v[112:115]
    ds_read_b128 v[208:211], v12 offset:45056
    s_waitcnt lgkmcnt(5)
    v_mfma_f32_16x16x32_bf16 v[96:99], v[44:47], v[140:143], v[96:99]
    ds_read_b128 v[120:123], v12 offset:46080
    v_mfma_f32_16x16x32_bf16 v[100:103], v[44:47], v[144:147], v[100:103]
    ds_read_b128 v[124:127], v12 offset:47104
    s_mov_b32 m0, s27
    s_nop 0
    buffer_load_dwordx4 v5, s[36:39], s26 offen offset:3072 lds
    v_mfma_f32_16x16x32_bf16 v[104:107], v[44:47], v[148:151], v[104:107]
    ds_read_b128 v[128:131], v12 offset:48128
    v_mfma_f32_16x16x32_bf16 v[108:111], v[44:47], v[152:155], v[108:111]
    ds_read_b128 v[132:135], v12 offset:49152
    s_add_u32 m0, s27, 4096
    s_nop 0
    buffer_load_dwordx4 v6, s[36:39], s26 offen lds
    v_mfma_f32_16x16x32_bf16 v[112:115], v[44:47], v[156:159], v[112:115]
    ds_read_b128 v[136:139], v12 offset:50176
    s_waitcnt lgkmcnt(5)
    v_mfma_f32_16x16x32_bf16 v[96:99], v[48:51], v[192:195], v[96:99]
    ds_read_b128 v[140:143], v13 offset:0
    v_mfma_f32_16x16x32_bf16 v[100:103], v[48:51], v[196:199], v[100:103]
    ds_read_b128 v[144:147], v13 offset:1024
    buffer_load_dwordx4 v[176:179], v5, s[40:43], s24 offen offset:0
    v_mfma_f32_16x16x32_bf16 v[104:107], v[48:51], v[200:203], v[104:107]
    ds_read_b128 v[148:151], v13 offset:2048
    v_mfma_f32_16x16x32_bf16 v[108:111], v[48:51], v[204:207], v[108:111]
    ds_read_b128 v[152:155], v13 offset:3072
    buffer_load_dwordx4 v[180:183], v5, s[40:43], s24 offen offset:1024
    v_mfma_f32_16x16x32_bf16 v[112:115], v[48:51], v[208:211], v[112:115]
    ds_read_b128 v[156:159], v13 offset:4096
    buffer_load_dwordx4 v[184:187], v5, s[40:43], s24 offen offset:2048
    s_waitcnt lgkmcnt(5)
    v_mfma_f32_16x16x32_bf16 v[96:99], v[52:55], v[120:123], v[96:99]
    ds_read_b128 v[192:195], v13 offset:5120
    v_mfma_f32_16x16x32_bf16 v[100:103], v[52:55], v[124:127], v[100:103]
    ds_read_b128 v[196:199], v13 offset:6144
    v_mfma_f32_16x16x32_bf16 v[104:107], v[52:55], v[128:131], v[104:107]
    ds_read_b128 v[200:203], v13 offset:7168
    v_mfma_f32_16x16x32_bf16 v[108:111], v[52:55], v[132:135], v[108:111]
    ds_read_b128 v[204:207], v13 offset:8192
    v_mfma_f32_16x16x32_bf16 v[112:115], v[52:55], v[136:139], v[112:115]
    ds_read_b128 v[208:211], v13 offset:9216
    s_waitcnt vmcnt(12)
    s_barrier
    s_waitcnt lgkmcnt(5)
    v_mfma_f32_16x16x32_bf16 v[96:99], v[56:59], v[140:143], v[96:99]
    ds_read_b128 v[120:123], v13 offset:10240
    v_mfma_f32_16x16x32_bf16 v[100:103], v[56:59], v[144:147], v[100:103]
    ds_read_b128 v[124:127], v13 offset:11264
    v_mfma_f32_16x16x32_bf16 v[104:107], v[56:59], v[148:151], v[104:107]
    ds_read_b128 v[128:131], v13 offset:12288
    v_mfma_f32_16x16x32_bf16 v[108:111], v[56:59], v[152:155], v[108:111]
    ds_read_b128 v[132:135], v13 offset:13312
    v_mfma_f32_16x16x32_bf16 v[112:115], v[56:59], v[156:159], v[112:115]
    ds_read_b128 v[136:139], v13 offset:14336
    s_waitcnt lgkmcnt(5)
    v_mfma_f32_16x16x32_bf16 v[96:99], v[60:63], v[192:195], v[96:99]
    ds_read_b128 v[140:143], v13 offset:15360
    v_mfma_f32_16x16x32_bf16 v[100:103], v[60:63], v[196:199], v[100:103]
    ds_read_b128 v[144:147], v13 offset:16384
    v_mfma_f32_16x16x32_bf16 v[104:107], v[60:63], v[200:203], v[104:107]
    ds_read_b128 v[148:151], v13 offset:17408
    v_mfma_f32_16x16x32_bf16 v[108:111], v[60:63], v[204:207], v[108:111]
    ds_read_b128 v[152:155], v13 offset:18432
    v_mfma_f32_16x16x32_bf16 v[112:115], v[60:63], v[208:211], v[112:115]
    ds_read_b128 v[156:159], v13 offset:19456
    s_waitcnt lgkmcnt(5)
    v_mfma_f32_16x16x32_bf16 v[96:99], v[64:67], v[120:123], v[96:99]
    ds_read_b128 v[192:195], v13 offset:20480
    v_mfma_f32_16x16x32_bf16 v[100:103], v[64:67], v[124:127], v[100:103]
    ds_read_b128 v[196:199], v13 offset:21504
    v_mfma_f32_16x16x32_bf16 v[104:107], v[64:67], v[128:131], v[104:107]
    ds_read_b128 v[200:203], v13 offset:22528
    v_mfma_f32_16x16x32_bf16 v[108:111], v[64:67], v[132:135], v[108:111]
    ds_read_b128 v[204:207], v13 offset:23552
    v_mfma_f32_16x16x32_bf16 v[112:115], v[64:67], v[136:139], v[112:115]
    ds_read_b128 v[208:211], v13 offset:24576
    s_waitcnt lgkmcnt(5)
    v_mfma_f32_16x16x32_bf16 v[96:99], v[68:71], v[140:143], v[96:99]
    ds_read_b128 v[120:123], v13 offset:25600
    v_mfma_f32_16x16x32_bf16 v[100:103], v[68:71], v[144:147], v[100:103]
    ds_read_b128 v[124:127], v13 offset:26624
    v_mfma_f32_16x16x32_bf16 v[104:107], v[68:71], v[148:151], v[104:107]
    ds_read_b128 v[128:131], v13 offset:27648
    v_mfma_f32_16x16x32_bf16 v[108:111], v[68:71], v[152:155], v[108:111]
    ds_read_b128 v[132:135], v13 offset:28672
    v_mfma_f32_16x16x32_bf16 v[112:115], v[68:71], v[156:159], v[112:115]
    ds_read_b128 v[136:139], v13 offset:29696
    s_waitcnt vmcnt(3)
    s_barrier
    s_waitcnt lgkmcnt(5)
    v_mfma_f32_16x16x32_bf16 v[96:99], v[72:75], v[192:195], v[96:99]
    ds_read_b128 v[140:143], v13 offset:30720
    v_mfma_f32_16x16x32_bf16 v[100:103], v[72:75], v[196:199], v[100:103]
    ds_read_b128 v[144:147], v13 offset:31744
    v_mfma_f32_16x16x32_bf16 v[104:107], v[72:75], v[200:203], v[104:107]
    ds_read_b128 v[148:151], v13 offset:32768
    v_mfma_f32_16x16x32_bf16 v[108:111], v[72:75], v[204:207], v[108:111]
    ds_read_b128 v[152:155], v13 offset:33792
    v_mfma_f32_16x16x32_bf16 v[112:115], v[72:75], v[208:211], v[112:115]
    ds_read_b128 v[156:159], v13 offset:34816
    s_waitcnt lgkmcnt(5)
    v_mfma_f32_16x16x32_bf16 v[96:99], v[76:79], v[120:123], v[96:99]
    ds_read_b128 v[192:195], v13 offset:35840
    v_mfma_f32_16x16x32_bf16 v[100:103], v[76:79], v[124:127], v[100:103]
    ds_read_b128 v[196:199], v13 offset:36864
    v_mfma_f32_16x16x32_bf16 v[104:107], v[76:79], v[128:131], v[104:107]
    ds_read_b128 v[200:203], v13 offset:37888
    v_mfma_f32_16x16x32_bf16 v[108:111], v[76:79], v[132:135], v[108:111]
    ds_read_b128 v[204:207], v13 offset:38912
    v_mfma_f32_16x16x32_bf16 v[112:115], v[76:79], v[136:139], v[112:115]
    ds_read_b128 v[208:211], v13 offset:39936
    s_waitcnt lgkmcnt(5)
    v_mfma_f32_16x16x32_bf16 v[96:99], v[80:83], v[140:143], v[96:99]
    ds_read_b128 v[120:123], v13 offset:40960
    v_mfma_f32_16x16x32_bf16 v[100:103], v[80:83], v[144:147], v[100:103]
    ds_read_b128 v[124:127], v13 offset:41984
    v_mfma_f32_16x16x32_bf16 v[104:107], v[80:83], v[148:151], v[104:107]
    ds_read_b128 v[128:131], v13 offset:43008
    v_mfma_f32_16x16x32_bf16 v[108:111], v[80:83], v[152:155], v[108:111]
    ds_read_b128 v[132:135], v13 offset:44032
    v_mfma_f32_16x16x32_bf16 v[112:115], v[80:83], v[156:159], v[112:115]
    ds_read_b128 v[136:139], v13 offset:45056
    s_waitcnt lgkmcnt(5)
    v_mfma_f32_16x16x32_bf16 v[96:99], v[84:87], v[192:195], v[96:99]
    ds_read_b128 v[140:143], v13 offset:46080
    v_mfma_f32_16x16x32_bf16 v[100:103], v[84:87], v[196:199], v[100:103]
    ds_read_b128 v[144:147], v13 offset:47104
    v_mfma_f32_16x16x32_bf16 v[104:107], v[84:87], v[200:203], v[104:107]
    ds_read_b128 v[148:151], v13 offset:48128
    v_mfma_f32_16x16x32_bf16 v[108:111], v[84:87], v[204:207], v[108:111]
    ds_read_b128 v[152:155], v13 offset:49152
    v_mfma_f32_16x16x32_bf16 v[112:115], v[84:87], v[208:211], v[112:115]
    ds_read_b128 v[156:159], v13 offset:50176
    s_waitcnt lgkmcnt(5)
    v_mfma_f32_16x16x32_bf16 v[96:99], v[88:91], v[120:123], v[96:99]
    v_mfma_f32_16x16x32_bf16 v[100:103], v[88:91], v[124:127], v[100:103]
    v_mfma_f32_16x16x32_bf16 v[104:107], v[88:91], v[128:131], v[104:107]
    v_mfma_f32_16x16x32_bf16 v[108:111], v[88:91], v[132:135], v[108:111]
    v_mfma_f32_16x16x32_bf16 v[112:115], v[88:91], v[136:139], v[112:115]
    s_waitcnt lgkmcnt(0)
    v_mfma_f32_16x16x32_bf16 v[96:99], v[92:95], v[140:143], v[96:99]
    v_mfma_f32_16x16x32_bf16 v[100:103], v[92:95], v[144:147], v[100:103]
    v_mfma_f32_16x16x32_bf16 v[104:107], v[92:95], v[148:151], v[104:107]
    v_mfma_f32_16x16x32_bf16 v[108:111], v[92:95], v[152:155], v[108:111]
    v_mfma_f32_16x16x32_bf16 v[112:115], v[92:95], v[156:159], v[112:115]
    s_waitcnt vmcnt(0)
    s_cmp_eq_u32 s25, 1
    s_cbranch_scc1 oproj0_kernel_odd1
    v_mfma_f32_16x16x32_bf16 v[96:99], v[176:179], v[160:163], v[96:99]
    v_mfma_f32_16x16x32_bf16 v[100:103], v[176:179], v[164:167], v[100:103]
    v_mfma_f32_16x16x32_bf16 v[104:107], v[180:183], v[160:163], v[104:107]
    v_mfma_f32_16x16x32_bf16 v[108:111], v[180:183], v[164:167], v[108:111]
    v_mfma_f32_16x16x32_bf16 v[112:115], v[184:187], v[160:163], v[112:115]
    s_branch oproj0_kernel_done2
oproj0_kernel_odd1:
    v_mfma_f32_16x16x32_bf16 v[96:99], v[176:179], v[164:167], v[96:99]
    v_mfma_f32_16x16x32_bf16 v[100:103], v[180:183], v[160:163], v[100:103]
    v_mfma_f32_16x16x32_bf16 v[104:107], v[180:183], v[164:167], v[104:107]
    v_mfma_f32_16x16x32_bf16 v[108:111], v[184:187], v[160:163], v[108:111]
    v_mfma_f32_16x16x32_bf16 v[112:115], v[184:187], v[164:167], v[112:115]
oproj0_kernel_done2:
    s_lshr_b32 s26, s20, 5
    s_mul_i32 s26, s26, 40960
    s_mul_i32 s27, s17, 5120
    s_add_u32 s26, s26, s27
    s_and_b32 s27, s3, 1
    s_lshl_b32 s27, s27, 3
    s_add_u32 s26, s26, s27
    s_nop 3
    v_cvt_pk_bf16_f32 v16, v96, v97
    v_cvt_pk_bf16_f32 v17, v98, v99
    buffer_store_dwordx2 v[16:17], v5, s[44:47], s26 offen offset:0
    v_cvt_pk_bf16_f32 v18, v100, v101
    v_cvt_pk_bf16_f32 v19, v102, v103
    buffer_store_dwordx2 v[18:19], v5, s[44:47], s26 offen offset:1024
    v_cvt_pk_bf16_f32 v20, v104, v105
    v_cvt_pk_bf16_f32 v21, v106, v107
    buffer_store_dwordx2 v[20:21], v5, s[44:47], s26 offen offset:2048
    v_cvt_pk_bf16_f32 v22, v108, v109
    v_cvt_pk_bf16_f32 v23, v110, v111
    buffer_store_dwordx2 v[22:23], v5, s[44:47], s26 offen offset:3072
    v_cvt_pk_bf16_f32 v24, v112, v113
    v_cvt_pk_bf16_f32 v25, v114, v115
    buffer_store_dwordx2 v[24:25], v6, s[44:47], s26 offen
    v_lshlrev_b32 v40, 16, v16
    v_and_b32 v41, 0xffff0000, v16
    v_lshlrev_b32 v42, 16, v17
    v_and_b32 v43, 0xffff0000, v17
    v_mov_b32 v32, v40
    v_mul_f32 v33, v40, v40
    v_mov_b32 v34, v41
    v_mul_f32 v35, v41, v41
    v_mov_b32 v36, v42
    v_mul_f32 v37, v42, v42
    v_mov_b32 v38, v43
    v_mul_f32 v39, v43, v43
    v_lshlrev_b32 v40, 16, v18
    v_and_b32 v41, 0xffff0000, v18
    v_lshlrev_b32 v42, 16, v19
    v_and_b32 v43, 0xffff0000, v19
    v_add_f32 v32, v32, v40
    v_fmac_f32 v33, v40, v40
    v_add_f32 v34, v34, v41
    v_fmac_f32 v35, v41, v41
    v_add_f32 v36, v36, v42
    v_fmac_f32 v37, v42, v42
    v_add_f32 v38, v38, v43
    v_fmac_f32 v39, v43, v43
    v_lshlrev_b32 v40, 16, v20
    v_and_b32 v41, 0xffff0000, v20
    v_lshlrev_b32 v42, 16, v21
    v_and_b32 v43, 0xffff0000, v21
    v_add_f32 v32, v32, v40
    v_fmac_f32 v33, v40, v40
    v_add_f32 v34, v34, v41
    v_fmac_f32 v35, v41, v41
    v_add_f32 v36, v36, v42
    v_fmac_f32 v37, v42, v42
    v_add_f32 v38, v38, v43
    v_fmac_f32 v39, v43, v43
    v_lshlrev_b32 v40, 16, v22
    v_and_b32 v41, 0xffff0000, v22
    v_lshlrev_b32 v42, 16, v23
    v_and_b32 v43, 0xffff0000, v23
    v_add_f32 v32, v32, v40
    v_fmac_f32 v33, v40, v40
    v_add_f32 v34, v34, v41
    v_fmac_f32 v35, v41, v41
    v_add_f32 v36, v36, v42
    v_fmac_f32 v37, v42, v42
    v_add_f32 v38, v38, v43
    v_fmac_f32 v39, v43, v43
    v_lshlrev_b32 v40, 16, v24
    v_and_b32 v41, 0xffff0000, v24
    v_lshlrev_b32 v42, 16, v25
    v_and_b32 v43, 0xffff0000, v25
    v_add_f32 v32, v32, v40
    v_fmac_f32 v33, v40, v40
    v_add_f32 v34, v34, v41
    v_fmac_f32 v35, v41, v41
    v_add_f32 v36, v36, v42
    v_fmac_f32 v37, v42, v42
    v_add_f32 v38, v38, v43
    v_fmac_f32 v39, v43, v43
    s_nop 1
    v_add_f32_dpp v32, v32, v32 row_ror:8 row_mask:0xf bank_mask:0xf
    v_add_f32_dpp v33, v33, v33 row_ror:8 row_mask:0xf bank_mask:0xf
    v_add_f32_dpp v34, v34, v34 row_ror:8 row_mask:0xf bank_mask:0xf
    v_add_f32_dpp v35, v35, v35 row_ror:8 row_mask:0xf bank_mask:0xf
    v_add_f32_dpp v36, v36, v36 row_ror:8 row_mask:0xf bank_mask:0xf
    v_add_f32_dpp v37, v37, v37 row_ror:8 row_mask:0xf bank_mask:0xf
    v_add_f32_dpp v38, v38, v38 row_ror:8 row_mask:0xf bank_mask:0xf
    v_add_f32_dpp v39, v39, v39 row_ror:8 row_mask:0xf bank_mask:0xf
    s_nop 1
    v_add_f32_dpp v32, v32, v32 row_ror:4 row_mask:0xf bank_mask:0xf
    v_add_f32_dpp v33, v33, v33 row_ror:4 row_mask:0xf bank_mask:0xf
    v_add_f32_dpp v34, v34, v34 row_ror:4 row_mask:0xf bank_mask:0xf
    v_add_f32_dpp v35, v35, v35 row_ror:4 row_mask:0xf bank_mask:0xf
    v_add_f32_dpp v36, v36, v36 row_ror:4 row_mask:0xf bank_mask:0xf
    v_add_f32_dpp v37, v37, v37 row_ror:4 row_mask:0xf bank_mask:0xf
    v_add_f32_dpp v38, v38, v38 row_ror:4 row_mask:0xf bank_mask:0xf
    v_add_f32_dpp v39, v39, v39 row_ror:4 row_mask:0xf bank_mask:0xf
    s_nop 1
    v_add_f32_dpp v32, v32, v32 row_ror:2 row_mask:0xf bank_mask:0xf
    v_add_f32_dpp v33, v33, v33 row_ror:2 row_mask:0xf bank_mask:0xf
    v_add_f32_dpp v34, v34, v34 row_ror:2 row_mask:0xf bank_mask:0xf
    v_add_f32_dpp v35, v35, v35 row_ror:2 row_mask:0xf bank_mask:0xf
    v_add_f32_dpp v36, v36, v36 row_ror:2 row_mask:0xf bank_mask:0xf
    v_add_f32_dpp v37, v37, v37 row_ror:2 row_mask:0xf bank_mask:0xf
    v_add_f32_dpp v38, v38, v38 row_ror:2 row_mask:0xf bank_mask:0xf
    v_add_f32_dpp v39, v39, v39 row_ror:2 row_mask:0xf bank_mask:0xf
    s_nop 1
    v_add_f32_dpp v32, v32, v32 row_ror:1 row_mask:0xf bank_mask:0xf
    v_add_f32_dpp v33, v33, v33 row_ror:1 row_mask:0xf bank_mask:0xf
    v_add_f32_dpp v34, v34, v34 row_ror:1 row_mask:0xf bank_mask:0xf
    v_add_f32_dpp v35, v35, v35 row_ror:1 row_mask:0xf bank_mask:0xf
    v_add_f32_dpp v36, v36, v36 row_ror:1 row_mask:0xf bank_mask:0xf
    v_add_f32_dpp v37, v37, v37 row_ror:1 row_mask:0xf bank_mask:0xf
    v_add_f32_dpp v38, v38, v38 row_ror:1 row_mask:0xf bank_mask:0xf
    v_add_f32_dpp v39, v39, v39 row_ror:1 row_mask:0xf bank_mask:0xf
    v_mov_b32 v40, v32
    v_cmp_eq_u32 vcc, 1, v3
    s_nop 1
    v_cndmask_b32 v40, v40, v33, vcc
    v_cmp_eq_u32 vcc, 2, v3
    s_nop 1
    v_cndmask_b32 v40, v40, v34, vcc
    v_cmp_eq_u32 vcc, 3, v3
    s_nop 1
    v_cndmask_b32 v40, v40, v35, vcc
    v_cmp_eq_u32 vcc, 4, v3
    s_nop 1
    v_cndmask_b32 v40, v40, v36, vcc
    v_cmp_eq_u32 vcc, 5, v3
    s_nop 1
    v_cndmask_b32 v40, v40, v37, vcc
    v_cmp_eq_u32 vcc, 6, v3
    s_nop 1
    v_cndmask_b32 v40, v40, v38, vcc
    v_cmp_eq_u32 vcc, 7, v3
    s_nop 1
    v_cndmask_b32 v40, v40, v39, vcc
    v_lshlrev_b32 v12, 5, v2
    v_lshl_add_u32 v12, v3, 2, v12
    s_lshl_b32 s26, s20, 3
    v_mov_b32 v13, 0x7ffffff0
    v_cmp_gt_u32 vcc, 8, v3
    s_nop 1
    v_cndmask_b32 v12, v13, v12, vcc
    buffer_atomic_add_f32 v40, v12, s[48:51], s26 offen
oproj0_kernel_end:
    s_endpgm

.globl mlpa0_kernel
.p2align 8
.type mlpa0_kernel,@function
mlpa0_kernel:
    s_cmp_ge_u32 s2, 240
    s_cbranch_scc1 mlpa0_kernel_end
    s_lshr_b32 s18, s2, 3
    s_mul_i32 s17, s18, 13108
    s_lshr_b32 s17, s17, 16
    s_mul_i32 s16, s17, 5
    s_sub_u32 s16, s18, s16
    s_and_b32 s18, s2, 1
    s_mul_i32 s18, s18, 5
    s_add_u32 s16, s16, s18
    s_bfe_u32 s18, s2, 0x20001
    s_cmp_ge_u32 s18, 2
    s_cselect_b32 s19, 5, 6
    s_cmp_ge_u32 s17, s19
    s_cbranch_scc1 mlpa0_kernel_end
    s_mul_i32 s19, s18, 6
    s_cmp_eq_u32 s18, 3
    s_cselect_b32 s18, 1, 0
    s_sub_u32 s19, s19, s18
    s_add_u32 s17, s17, s19
    s_setprio 3
    s_load_dwordx2 s[4:5], s[0:1], 96
    s_load_dwordx2 s[10:11], s[0:1], 56
    v_lshrrev_b32 v2, 6, v0
    v_and_b32 v1, 63, v0
    v_readfirstlane_b32 s3, v2
    v_lshrrev_b32 v2, 4, v1
    v_and_b32 v3, 15, v1
    v_lshlrev_b32 v5, 4, v1
    v_add_u32 v6, 4096, v5
    s_waitcnt lgkmcnt(0)
    s_add_u32 s32, s4, 7340032
    s_addc_u32 s33, s5, 0
    s_mov_b32 s34, 2621440
    s_mov_b32 s35, 0x00020000
    s_add_u32 s36, s4, 33554432
    s_addc_u32 s37, s5, 0
    s_mov_b32 s38, 7208960
    s_mov_b32 s39, 0x00020000
    s_mov_b32 s40, s10
    s_mov_b32 s41, s11
    s_mov_b32 s42, 3456
    s_mov_b32 s43, 0x00020000
    s_add_u32 s44, s4, 10485760
    s_addc_u32 s45, s5, 0
    s_mov_b32 s46, 16384
    s_mov_b32 s47, 0x00020000
    s_add_u32 s48, s4, 11534336
    s_addc_u32 s49, s5, 0
    s_mov_b32 s50, 2211840
    s_mov_b32 s51, 0x00020000
    s_mul_i32 s26, s3, 40960
    s_lshl_b32 s27, s16, 12
    s_add_u32 s26, s26, s27
    s_mul_i32 s27, s3, 112640
    s_mul_i32 s29, s17, 5120
    s_add_u32 s27, s27, s29
    s_mul_i32 s28, s3, 20480
    v_and_b32 v7, 31, v1
    v_lshlrev_b32 v7, 3, v7
    v_lshrrev_b32 v8, 5, v1
    v_lshl_add_u32 v7, v8, 11, v7
    s_lshl_b32 s29, s3, 8
    buffer_load_dwordx2 v[236:237], v7, s[44:47], s29 offen
    s_add_u32 s29, s29, 4096
    buffer_load_dwordx2 v[238:239], v7, s[44:47], s29 offen
    s_add_u32 s29, s29, 4096
    buffer_load_dwordx2 v[240:241], v7, s[44:47], s29 offen
    s_add_u32 s29, s29, 4096
    buffer_load_dwordx2 v[242:243], v7, s[44:47], s29 offen
    buffer_load_dwordx4 v[116:119], v5, s[32:35], s26 offen offset:0
    buffer_load_dwordx4 v[120:123], v5, s[32:35], s26 offen offset:1024
    buffer_load_dwordx4 v[124:127], v5, s[32:35], s26 offen offset:2048
    buffer_load_dwordx4 v[128:131], v5, s[32:35], s26 offen offset:3072
    s_add_u32 s26, s26, 327680
    buffer_load_dwordx4 v[96:99], v5, s[36:39], s27 offen offset:0
    buffer_load_dwordx4 v[100:103], v5, s[36:39], s27 offen offset:1024
    buffer_load_dwordx4 v[104:107], v5, s[36:39], s27 offen offset:2048
    buffer_load_dwordx4 v[108:111], v5, s[36:39], s27 offen offset:3072
    buffer_load_dwordx4 v[112:115], v6, s[36:39], s27 offen
    s_add_u32 s27, s27, 901120
    v_lshlrev_b32 v8, 2, v1
    v_add_u32 v8, s28, v8
    v_lshlrev_b32 v9, 4, v2
    v_add_u32 v9, s28, v9
    v_mov_b32 v16, 0
    v_mov_b32 v17, 0
    v_mov_b32 v18, 0
    v_mov_b32 v19, 0
    v_mov_b32 v20, 0
    v_mov_b32 v21, 0
    v_mov_b32 v22, 0
    v_mov_b32 v23, 0
    v_mov_b32 v24, 0
    v_mov_b32 v25, 0
    v_mov_b32 v26, 0
    v_mov_b32 v27, 0
    v_mov_b32 v28, 0
    v_mov_b32 v29, 0
    v_mov_b32 v30, 0
    v_mov_b32 v31, 0
    v_mov_b32 v32, 0
    v_mov_b32 v33, 0
    v_mov_b32 v34, 0
    v_mov_b32 v35, 0
    v_mov_b32 v36, 0
    v_mov_b32 v37, 0
    v_mov_b32 v38, 0
    v_mov_b32 v39, 0
    v_mov_b32 v40, 0
    v_mov_b32 v41, 0
    v_mov_b32 v42, 0
    v_mov_b32 v43, 0
    v_mov_b32 v44, 0
    v_mov_b32 v45, 0
    v_mov_b32 v46, 0
    v_mov_b32 v47, 0
    v_mov_b32 v48, 0
    v_mov_b32 v49, 0
    v_mov_b32 v50, 0
    v_mov_b32 v51, 0
    v_mov_b32 v52, 0
    v_mov_b32 v53, 0
    v_mov_b32 v54, 0
    v_mov_b32 v55, 0
    v_mov_b32 v56, 0
    v_mov_b32 v57, 0
    v_mov_b32 v58, 0
    v_mov_b32 v59, 0
    v_mov_b32 v60, 0
    v_mov_b32 v61, 0
    v_mov_b32 v62, 0
    v_mov_b32 v63, 0
    v_mov_b32 v64, 0
    v_mov_b32 v65, 0
    v_mov_b32 v66, 0
    v_mov_b32 v67, 0
    v_mov_b32 v68, 0
    v_mov_b32 v69, 0
    v_mov_b32 v70, 0
    v_mov_b32 v71, 0
    v_mov_b32 v72, 0
    v_mov_b32 v73, 0
    v_mov_b32 v74, 0
    v_mov_b32 v75, 0
    v_mov_b32 v76, 0
    v_mov_b32 v77, 0
    v_mov_b32 v78, 0
    v_mov_b32 v79, 0
    v_mov_b32 v80, 0
    v_mov_b32 v81, 0
    v_mov_b32 v82, 0
    v_mov_b32 v83, 0
    v_mov_b32 v84, 0
    v_mov_b32 v85, 0
    v_mov_b32 v86, 0
    v_mov_b32 v87, 0
    v_mov_b32 v88, 0
    v_mov_b32 v89, 0
    v_mov_b32 v90, 0
    v_mov_b32 v91, 0
    v_mov_b32 v92, 0
    v_mov_b32 v93, 0
    v_mov_b32 v94, 0
    v_mov_b32 v95, 0
    s_waitcnt vmcnt(9)
    v_mul_f32 v236, 0x3acccccd, v236
    v_mul_f32 v237, 0x3acccccd, v237
    v_fma_f32 v237, -v236, v236, v237
    v_max_f32 v237, 0, v237
    v_add_f32 v13, 0x3727c5ac, v237
    v_rcp_f32 v14, v13
    v_rsq_f32 v13, v13
    v_mul_f32 v14, v14, v237
    v_add_f32 v14, 0x3727c5ac, v14
    v_rsq_f32 v14, v14
    s_nop 0
    v_mul_f32 v13, v13, v14
    v_mul_f32 v237, v236, v13
    v_sub_f32 v237, 0, v237
    ds_write_b32 v8, v13 offset:0
    ds_write_b32 v8, v237 offset:1024
    v_mul_f32 v238, 0x3acccccd, v238
    v_mul_f32 v239, 0x3acccccd, v239
    v_fma_f32 v239, -v238, v238, v239
    v_max_f32 v239, 0, v239
    v_add_f32 v13, 0x3727c5ac, v239
    v_rcp_f32 v14, v13
    v_rsq_f32 v13, v13
    v_mul_f32 v14, v14, v239
    v_add_f32 v14, 0x3727c5ac, v14
    v_rsq_f32 v14, v14
    s_nop 0
    v_mul_f32 v13, v13, v14
    v_mul_f32 v239, v238, v13
    v_sub_f32 v239, 0, v239
    ds_write_b32 v8, v13 offset:256
    ds_write_b32 v8, v239 offset:1280
    v_mul_f32 v240, 0x3acccccd, v240
    v_mul_f32 v241, 0x3acccccd, v241
    v_fma_f32 v241, -v240, v240, v241
    v_max_f32 v241, 0, v241
    v_add_f32 v13, 0x3727c5ac, v241
    v_rcp_f32 v14, v13
    v_rsq_f32 v13, v13
    v_mul_f32 v14, v14, v241
    v_add_f32 v14, 0x3727c5ac, v14
    v_rsq_f32 v14, v14
    s_nop 0
    v_mul_f32 v13, v13, v14
    v_mul_f32 v241, v240, v13
    v_sub_f32 v241, 0, v241
    ds_write_b32 v8, v13 offset:512
    ds_write_b32 v8, v241 offset:1536
    v_mul_f32 v242, 0x3acccccd, v242
    v_mul_f32 v243, 0x3acccccd, v243
    v_fma_f32 v243, -v242, v242, v243
    v_max_f32 v243, 0, v243
    v_add_f32 v13, 0x3727c5ac, v243
    v_rcp_f32 v14, v13
    v_rsq_f32 v13, v13
    v_mul_f32 v14, v14, v243
    v_add_f32 v14, 0x3727c5ac, v14
    v_rsq_f32 v14, v14
    s_nop 0
    v_mul_f32 v13, v13, v14
    v_mul_f32 v243, v242, v13
    v_sub_f32 v243, 0, v243
    ds_write_b32 v8, v13 offset:768
    ds_write_b32 v8, v243 offset:1792
    buffer_load_dwordx4 v[152:155], v5, s[32:35], s26 offen offset:0
    buffer_load_dwordx4 v[156:159], v5, s[32:35], s26 offen offset:1024
    buffer_load_dwordx4 v[160:163], v5, s[32:35], s26 offen offset:2048
    buffer_load_dwordx4 v[164:167], v5, s[32:35], s26 offen offset:3072
    s_add_u32 s26, s26, 327680
    buffer_load_dwordx4 v[132:135], v5, s[36:39], s27 offen offset:0
    buffer_load_dwordx4 v[136:139], v5, s[36:39], s27 offen offset:1024
    buffer_load_dwordx4 v[140:143], v5, s[36:39], s27 offen offset:2048
    buffer_load_dwordx4 v[144:147], v5, s[36:39], s27 offen offset:3072
    buffer_load_dwordx4 v[148:151], v6, s[36:39], s27 offen
    s_add_u32 s27, s27, 901120
    ds_read_b128 v[204:207], v9 offset:0
    ds_read_b128 v[208:211], v9 offset:64
    ds_read_b128 v[212:215], v9 offset:1024
    ds_read_b128 v[216:219], v9 offset:1088
    s_waitcnt vmcnt(14)
    s_waitcnt lgkmcnt(0)
    ds_read_b128 v[220:223], v9 offset:128
    ds_read_b128 v[224:227], v9 offset:192
    ds_read_b128 v[228:231], v9 offset:1152
    ds_read_b128 v[232:235], v9 offset:1216
    v_lshlrev_b32 v236, 16, v116
    v_and_b32 v237, 0xffff0000, v116
    v_pk_fma_f32 v[236:237], v[236:237], v[204:205], v[212:213]
    v_cvt_pk_bf16_f32 v116, v236, v237
    buffer_load_dwordx4 v[188:191], v5, s[32:35], s26 offen offset:0
    v_lshlrev_b32 v238, 16, v117
    v_and_b32 v239, 0xffff0000, v117
    v_pk_fma_f32 v[238:239], v[238:239], v[206:207], v[214:215]
    v_cvt_pk_bf16_f32 v117, v238, v239
    v_lshlrev_b32 v240, 16, v118
    v_and_b32 v241, 0xffff0000, v118
    v_pk_fma_f32 v[240:241], v[240:241], v[208:209], v[216:217]
    v_cvt_pk_bf16_f32 v118, v240, v241
    buffer_load_dwordx4 v[192:195], v5, s[32:35], s26 offen offset:1024
    v_lshlrev_b32 v242, 16, v119
    v_and_b32 v243, 0xffff0000, v119
    v_pk_fma_f32 v[242:243], v[242:243], v[210:211], v[218:219]
    v_cvt_pk_bf16_f32 v119, v242, v243
    v_lshlrev_b32 v236, 16, v120
    v_and_b32 v237, 0xffff0000, v120
    v_pk_fma_f32 v[236:237], v[236:237], v[204:205], v[212:213]
    v_cvt_pk_bf16_f32 v120, v236, v237
    buffer_load_dwordx4 v[196:199], v5, s[32:35], s26 offen offset:2048
    v_lshlrev_b32 v238, 16, v121
    v_and_b32 v239, 0xffff0000, v121
    v_pk_fma_f32 v[238:239], v[238:239], v[206:207], v[214:215]
    v_cvt_pk_bf16_f32 v121, v238, v239
    v_lshlrev_b32 v240, 16, v122
    v_and_b32 v241, 0xffff0000, v122
    v_pk_fma_f32 v[240:241], v[240:241], v[208:209], v[216:217]
    v_cvt_pk_bf16_f32 v122, v240, v241
    buffer_load_dwordx4 v[200:203], v5, s[32:35], s26 offen offset:3072
    s_add_u32 s26, s26, 327680
    v_lshlrev_b32 v242, 16, v123
    v_and_b32 v243, 0xffff0000, v123
    v_pk_fma_f32 v[242:243], v[242:243], v[210:211], v[218:219]
    v_cvt_pk_bf16_f32 v123, v242, v243
    v_lshlrev_b32 v236, 16, v124
    v_and_b32 v237, 0xffff0000, v124
    v_pk_fma_f32 v[236:237], v[236:237], v[204:205], v[212:213]
    v_cvt_pk_bf16_f32 v124, v236, v237
    buffer_load_dwordx4 v[168:171], v5, s[36:39], s27 offen offset:0
    v_lshlrev_b32 v238, 16, v125
    v_and_b32 v239, 0xffff0000, v125
    v_pk_fma_f32 v[238:239], v[238:239], v[206:207], v[214:215]
    v_cvt_pk_bf16_f32 v125, v238, v239
    v_lshlrev_b32 v240, 16, v126
    v_and_b32 v241, 0xffff0000, v126
    v_pk_fma_f32 v[240:241], v[240:241], v[208:209], v[216:217]
    v_cvt_pk_bf16_f32 v126, v240, v241
    buffer_load_dwordx4 v[172:175], v5, s[36:39], s27 offen offset:1024
    v_lshlrev_b32 v242, 16, v127
    v_and_b32 v243, 0xffff0000, v127
    v_pk_fma_f32 v[242:243], v[242:243], v[210:211], v[218:219]
    v_cvt_pk_bf16_f32 v127, v242, v243
    v_lshlrev_b32 v236, 16, v128
    v_and_b32 v237, 0xffff0000, v128
    v_pk_fma_f32 v[236:237], v[236:237], v[204:205], v[212:213]
    v_cvt_pk_bf16_f32 v128, v236, v237
    buffer_load_dwordx4 v[176:179], v5, s[36:39], s27 offen offset:2048
    v_lshlrev_b32 v238, 16, v129
    v_and_b32 v239, 0xffff0000, v129
    v_pk_fma_f32 v[238:239], v[238:239], v[206:207], v[214:215]
    v_cvt_pk_bf16_f32 v129, v238, v239
    v_lshlrev_b32 v240, 16, v130
    v_and_b32 v241, 0xffff0000, v130
    v_pk_fma_f32 v[240:241], v[240:241], v[208:209], v[216:217]
    v_cvt_pk_bf16_f32 v130, v240, v241
    buffer_load_dwordx4 v[180:183], v5, s[36:39], s27 offen offset:3072
    v_lshlrev_b32 v242, 16, v131
    v_and_b32 v243, 0xffff0000, v131
    v_pk_fma_f32 v[242:243], v[242:243], v[210:211], v[218:219]
    v_cvt_pk_bf16_f32 v131, v242, v243
    buffer_load_dwordx4 v[184:187], v6, s[36:39], s27 offen
    s_add_u32 s27, s27, 901120
    s_waitcnt vmcnt(18)
    v_mfma_f32_16x16x32_bf16 v[16:19], v[96:99], v[116:119], v[16:19]
    v_mfma_f32_16x16x32_bf16 v[20:23], v[96:99], v[120:123], v[20:23]
    v_mfma_f32_16x16x32_bf16 v[24:27], v[96:99], v[124:127], v[24:27]
    v_mfma_f32_16x16x32_bf16 v[28:31], v[96:99], v[128:131], v[28:31]
    v_mfma_f32_16x16x32_bf16 v[32:35], v[100:103], v[116:119], v[32:35]
    v_mfma_f32_16x16x32_bf16 v[36:39], v[100:103], v[120:123], v[36:39]
    v_mfma_f32_16x16x32_bf16 v[40:43], v[100:103], v[124:127], v[40:43]
    v_mfma_f32_16x16x32_bf16 v[44:47], v[100:103], v[128:131], v[44:47]
    v_mfma_f32_16x16x32_bf16 v[48:51], v[104:107], v[116:119], v[48:51]
    v_mfma_f32_16x16x32_bf16 v[52:55], v[104:107], v[120:123], v[52:55]
    v_mfma_f32_16x16x32_bf16 v[56:59], v[104:107], v[124:127], v[56:59]
    v_mfma_f32_16x16x32_bf16 v[60:63], v[104:107], v[128:131], v[60:63]
    v_mfma_f32_16x16x32_bf16 v[64:67], v[108:111], v[116:119], v[64:67]
    v_mfma_f32_16x16x32_bf16 v[68:71], v[108:111], v[120:123], v[68:71]
    v_mfma_f32_16x16x32_bf16 v[72:75], v[108:111], v[124:127], v[72:75]
    v_mfma_f32_16x16x32_bf16 v[76:79], v[108:111], v[128:131], v[76:79]
    v_mfma_f32_16x16x32_bf16 v[80:83], v[112:115], v[116:119], v[80:83]
    v_mfma_f32_16x16x32_bf16 v[84:87], v[112:115], v[120:123], v[84:87]
    v_mfma_f32_16x16x32_bf16 v[88:91], v[112:115], v[124:127], v[88:91]
    v_mfma_f32_16x16x32_bf16 v[92:95], v[112:115], v[128:131], v[92:95]
    s_waitcnt vmcnt(14)
    s_waitcnt lgkmcnt(0)
    ds_read_b128 v[204:207], v9 offset:256
    ds_read_b128 v[208:211], v9 offset:320
    ds_read_b128 v[212:215], v9 offset:1280
    ds_read_b128 v[216:219], v9 offset:1344
    v_lshlrev_b32 v236, 16, v152
    v_and_b32 v237, 0xffff0000, v152
    v_pk_fma_f32 v[236:237], v[236:237], v[220:221], v[228:229]
    v_cvt_pk_bf16_f32 v152, v236, v237
    buffer_load_dwordx4 v[116:119], v5, s[32:35], s26 offen offset:0
    v_lshlrev_b32 v238, 16, v153
    v_and_b32 v239, 0xffff0000, v153
    v_pk_fma_f32 v[238:239], v[238:239], v[222:223], v[230:231]
    v_cvt_pk_bf16_f32 v153, v238, v239
    v_lshlrev_b32 v240, 16, v154
    v_and_b32 v241, 0xffff0000, v154
    v_pk_fma_f32 v[240:241], v[240:241], v[224:225], v[232:233]
    v_cvt_pk_bf16_f32 v154, v240, v241
    buffer_load_dwordx4 v[120:123], v5, s[32:35], s26 offen offset:1024
    v_lshlrev_b32 v242, 16, v155
    v_and_b32 v243, 0xffff0000, v155
    v_pk_fma_f32 v[242:243], v[242:243], v[226:227], v[234:235]
    v_cvt_pk_bf16_f32 v155, v242, v243
    v_lshlrev_b32 v236, 16, v156
    v_and_b32 v237, 0xffff0000, v156
    v_pk_fma_f32 v[236:237], v[236:237], v[220:221], v[228:229]
    v_cvt_pk_bf16_f32 v156, v236, v237
    buffer_load_dwordx4 v[124:127], v5, s[32:35], s26 offen offset:2048
    v_lshlrev_b32 v238, 16, v157
    v_and_b32 v239, 0xffff0000, v157
    v_pk_fma_f32 v[238:239], v[238:239], v[222:223], v[230:231]
    v_cvt_pk_bf16_f32 v157, v238, v239
    v_lshlrev_b32 v240, 16, v158
    v_and_b32 v241, 0xffff0000, v158
    v_pk_fma_f32 v[240:241], v[240:241], v[224:225], v[232:233]
    v_cvt_pk_bf16_f32 v158, v240, v241
    buffer_load_dwordx4 v[128:131], v5, s[32:35], s26 offen offset:3072
    s_add_u32 s26, s26, 327680
    v_lshlrev_b32 v242, 16, v159
    v_and_b32 v243, 0xffff0000, v159
    v_pk_fma_f32 v[242:243], v[242:243], v[226:227], v[234:235]
    v_cvt_pk_bf16_f32 v159, v242, v243
    v_lshlrev_b32 v236, 16, v160
    v_and_b32 v237, 0xffff0000, v160
    v_pk_fma_f32 v[236:237], v[236:237], v[220:221], v[228:229]
    v_cvt_pk_bf16_f32 v160, v236, v237
    buffer_load_dwordx4 v[96:99], v5, s[36:39], s27 offen offset:0
    v_lshlrev_b32 v238, 16, v161
    v_and_b32 v239, 0xffff0000, v161
    v_pk_fma_f32 v[238:239], v[238:239], v[222:223], v[230:231]
    v_cvt_pk_bf16_f32 v161, v238, v239
    v_lshlrev_b32 v240, 16, v162
    v_and_b32 v241, 0xffff0000, v162
    v_pk_fma_f32 v[240:241], v[240:241], v[224:225], v[232:233]
    v_cvt_pk_bf16_f32 v162, v240, v241
    buffer_load_dwordx4 v[100:103], v5, s[36:39], s27 offen offset:1024
    v_lshlrev_b32 v242, 16, v163
    v_and_b32 v243, 0xffff0000, v163
    v_pk_fma_f32 v[242:243], v[242:243], v[226:227], v[234:235]
    v_cvt_pk_bf16_f32 v163, v242, v243
    v_lshlrev_b32 v236, 16, v164
    v_and_b32 v237, 0xffff0000, v164
    v_pk_fma_f32 v[236:237], v[236:237], v[220:221], v[228:229]
    v_cvt_pk_bf16_f32 v164, v236, v237
    buffer_load_dwordx4 v[104:107], v5, s[36:39], s27 offen offset:2048
    v_lshlrev_b32 v238, 16, v165
    v_and_b32 v239, 0xffff0000, v165
    v_pk_fma_f32 v[238:239], v[238:239], v[222:223], v[230:231]
    v_cvt_pk_bf16_f32 v165, v238, v239
    v_lshlrev_b32 v240, 16, v166
    v_and_b32 v241, 0xffff0000, v166
    v_pk_fma_f32 v[240:241], v[240:241], v[224:225], v[232:233]
    v_cvt_pk_bf16_f32 v166, v240, v241
    buffer_load_dwordx4 v[108:111], v5, s[36:39], s27 offen offset:3072
    v_lshlrev_b32 v242, 16, v167
    v_and_b32 v243, 0xffff0000, v167
    v_pk_fma_f32 v[242:243], v[242:243], v[226:227], v[234:235]
    v_cvt_pk_bf16_f32 v167, v242, v243
    buffer_load_dwordx4 v[112:115], v6, s[36:39], s27 offen
    s_add_u32 s27, s27, 901120
    s_waitcnt vmcnt(18)
    v_mfma_f32_16x16x32_bf16 v[16:19], v[132:135], v[152:155], v[16:19]
    v_mfma_f32_16x16x32_bf16 v[20:23], v[132:135], v[156:159], v[20:23]
    v_mfma_f32_16x16x32_bf16 v[24:27], v[132:135], v[160:163], v[24:27]
    v_mfma_f32_16x16x32_bf16 v[28:31], v[132:135], v[164:167], v[28:31]
    v_mfma_f32_16x16x32_bf16 v[32:35], v[136:139], v[152:155], v[32:35]
    v_mfma_f32_16x16x32_bf16 v[36:39], v[136:139], v[156:159], v[36:39]
    v_mfma_f32_16x16x32_bf16 v[40:43], v[136:139], v[160:163], v[40:43]
    v_mfma_f32_16x16x32_bf16 v[44:47], v[136:139], v[164:167], v[44:47]
    v_mfma_f32_16x16x32_bf16 v[48:51], v[140:143], v[152:155], v[48:51]
    v_mfma_f32_16x16x32_bf16 v[52:55], v[140:143], v[156:159], v[52:55]
    v_mfma_f32_16x16x32_bf16 v[56:59], v[140:143], v[160:163], v[56:59]
    v_mfma_f32_16x16x32_bf16 v[60:63], v[140:143], v[164:167], v[60:63]
    v_mfma_f32_16x16x32_bf16 v[64:67], v[144:147], v[152:155], v[64:67]
    v_mfma_f32_16x16x32_bf16 v[68:71], v[144:147], v[156:159], v[68:71]
    v_mfma_f32_16x16x32_bf16 v[72:75], v[144:147], v[160:163], v[72:75]
    v_mfma_f32_16x16x32_bf16 v[76:79], v[144:147], v[164:167], v[76:79]
    v_mfma_f32_16x16x32_bf16 v[80:83], v[148:151], v[152:155], v[80:83]
    v_mfma_f32_16x16x32_bf16 v[84:87], v[148:151], v[156:159], v[84:87]
    v_mfma_f32_16x16x32_bf16 v[88:91], v[148:151], v[160:163], v[88:91]
    v_mfma_f32_16x16x32_bf16 v[92:95], v[148:151], v[164:167], v[92:95]
    s_setprio 2
    s_waitcnt vmcnt(14)
    s_waitcnt lgkmcnt(0)
    ds_read_b128 v[220:223], v9 offset:384
    ds_read_b128 v[224:227], v9 offset:448
    ds_read_b128 v[228:231], v9 offset:1408
    ds_read_b128 v[232:235], v9 offset:1472
    v_lshlrev_b32 v236, 16, v188
    v_and_b32 v237, 0xffff0000, v188
    v_pk_fma_f32 v[236:237], v[236:237], v[204:205], v[212:213]
    v_cvt_pk_bf16_f32 v188, v236, v237
    buffer_load_dwordx4 v[152:155], v5, s[32:35], s26 offen offset:0
    v_lshlrev_b32 v238, 16, v189
    v_and_b32 v239, 0xffff0000, v189
    v_pk_fma_f32 v[238:239], v[238:239], v[206:207], v[214:215]
    v_cvt_pk_bf16_f32 v189, v238, v239
    v_lshlrev_b32 v240, 16, v190
    v_and_b32 v241, 0xffff0000, v190
    v_pk_fma_f32 v[240:241], v[240:241], v[208:209], v[216:217]
    v_cvt_pk_bf16_f32 v190, v240, v241
    buffer_load_dwordx4 v[156:159], v5, s[32:35], s26 offen offset:1024
    v_lshlrev_b32 v242, 16, v191
    v_and_b32 v243, 0xffff0000, v191
    v_pk_fma_f32 v[242:243], v[242:243], v[210:211], v[218:219]
    v_cvt_pk_bf16_f32 v191, v242, v243
    v_lshlrev_b32 v236, 16, v192
    v_and_b32 v237, 0xffff0000, v192
    v_pk_fma_f32 v[236:237], v[236:237], v[204:205], v[212:213]
    v_cvt_pk_bf16_f32 v192, v236, v237
    buffer_load_dwordx4 v[160:163], v5, s[32:35], s26 offen offset:2048
    v_lshlrev_b32 v238, 16, v193
    v_and_b32 v239, 0xffff0000, v193
    v_pk_fma_f32 v[238:239], v[238:239], v[206:207], v[214:215]
    v_cvt_pk_bf16_f32 v193, v238, v239
    v_lshlrev_b32 v240, 16, v194
    v_and_b32 v241, 0xffff0000, v194
    v_pk_fma_f32 v[240:241], v[240:241], v[208:209], v[216:217]
    v_cvt_pk_bf16_f32 v194, v240, v241
    buffer_load_dwordx4 v[164:167], v5, s[32:35], s26 offen offset:3072
    s_add_u32 s26, s26, 327680
    v_lshlrev_b32 v242, 16, v195
    v_and_b32 v243, 0xffff0000, v195
    v_pk_fma_f32 v[242:243], v[242:243], v[210:211], v[218:219]
    v_cvt_pk_bf16_f32 v195, v242, v243
    v_lshlrev_b32 v236, 16, v196
    v_and_b32 v237, 0xffff0000, v196
    v_pk_fma_f32 v[236:237], v[236:237], v[204:205], v[212:213]
    v_cvt_pk_bf16_f32 v196, v236, v237
    buffer_load_dwordx4 v[132:135], v5, s[36:39], s27 offen offset:0
    v_lshlrev_b32 v238, 16, v197
    v_and_b32 v239, 0xffff0000, v197
    v_pk_fma_f32 v[238:239], v[238:239], v[206:207], v[214:215]
    v_cvt_pk_bf16_f32 v197, v238, v239
    v_lshlrev_b32 v240, 16, v198
    v_and_b32 v241, 0xffff0000, v198
    v_pk_fma_f32 v[240:241], v[240:241], v[208:209], v[216:217]
    v_cvt_pk_bf16_f32 v198, v240, v241
    buffer_load_dwordx4 v[136:139], v5, s[36:39], s27 offen offset:1024
    v_lshlrev_b32 v242, 16, v199
    v_and_b32 v243, 0xffff0000, v199
    v_pk_fma_f32 v[242:243], v[242:243], v[210:211], v[218:219]
    v_cvt_pk_bf16_f32 v199, v242, v243
    v_lshlrev_b32 v236, 16, v200
    v_and_b32 v237, 0xffff0000, v200
    v_pk_fma_f32 v[236:237], v[236:237], v[204:205], v[212:213]
    v_cvt_pk_bf16_f32 v200, v236, v237
    buffer_load_dwordx4 v[140:143], v5, s[36:39], s27 offen offset:2048
    v_lshlrev_b32 v238, 16, v201
    v_and_b32 v239, 0xffff0000, v201
    v_pk_fma_f32 v[238:239], v[238:239], v[206:207], v[214:215]
    v_cvt_pk_bf16_f32 v201, v238, v239
    v_lshlrev_b32 v240, 16, v202
    v_and_b32 v241, 0xffff0000, v202
    v_pk_fma_f32 v[240:241], v[240:241], v[208:209], v[216:217]
    v_cvt_pk_bf16_f32 v202, v240, v241
    buffer_load_dwordx4 v[144:147], v5, s[36:39], s27 offen offset:3072
    v_lshlrev_b32 v242, 16, v203
    v_and_b32 v243, 0xffff0000, v203
    v_pk_fma_f32 v[242:243], v[242:243], v[210:211], v[218:219]
    v_cvt_pk_bf16_f32 v203, v242, v243
    buffer_load_dwordx4 v[148:151], v6, s[36:39], s27 offen
    s_add_u32 s27, s27, 901120
    s_waitcnt vmcnt(18)
    v_mfma_f32_16x16x32_bf16 v[16:19], v[168:171], v[188:191], v[16:19]
    v_mfma_f32_16x16x32_bf16 v[20:23], v[168:171], v[192:195], v[20:23]
    v_mfma_f32_16x16x32_bf16 v[24:27], v[168:171], v[196:199], v[24:27]
    v_mfma_f32_16x16x32_bf16 v[28:31], v[168:171], v[200:203], v[28:31]
    v_mfma_f32_16x16x32_bf16 v[32:35], v[172:175], v[188:191], v[32:35]
    v_mfma_f32_16x16x32_bf16 v[36:39], v[172:175], v[192:195], v[36:39]
    v_mfma_f32_16x16x32_bf16 v[40:43], v[172:175], v[196:199], v[40:43]
    v_mfma_f32_16x16x32_bf16 v[44:47], v[172:175], v[200:203], v[44:47]
    v_mfma_f32_16x16x32_bf16 v[48:51], v[176:179], v[188:191], v[48:51]
    v_mfma_f32_16x16x32_bf16 v[52:55], v[176:179], v[192:195], v[52:55]
    v_mfma_f32_16x16x32_bf16 v[56:59], v[176:179], v[196:199], v[56:59]
    v_mfma_f32_16x16x32_bf16 v[60:63], v[176:179], v[200:203], v[60:63]
    v_mfma_f32_16x16x32_bf16 v[64:67], v[180:183], v[188:191], v[64:67]
    v_mfma_f32_16x16x32_bf16 v[68:71], v[180:183], v[192:195], v[68:71]
    v_mfma_f32_16x16x32_bf16 v[72:75], v[180:183], v[196:199], v[72:75]
    v_mfma_f32_16x16x32_bf16 v[76:79], v[180:183], v[200:203], v[76:79]
    v_mfma_f32_16x16x32_bf16 v[80:83], v[184:187], v[188:191], v[80:83]
    v_mfma_f32_16x16x32_bf16 v[84:87], v[184:187], v[192:195], v[84:87]
    v_mfma_f32_16x16x32_bf16 v[88:91], v[184:187], v[196:199], v[88:91]
    v_mfma_f32_16x16x32_bf16 v[92:95], v[184:187], v[200:203], v[92:95]
    s_waitcnt vmcnt(14)
    s_waitcnt lgkmcnt(0)
    ds_read_b128 v[204:207], v9 offset:512
    ds_read_b128 v[208:211], v9 offset:576
    ds_read_b128 v[212:215], v9 offset:1536
    ds_read_b128 v[216:219], v9 offset:1600
    v_lshlrev_b32 v236, 16, v116
    v_and_b32 v237, 0xffff0000, v116
    v_pk_fma_f32 v[236:237], v[236:237], v[220:221], v[228:229]
    v_cvt_pk_bf16_f32 v116, v236, v237
    buffer_load_dwordx4 v[188:191], v5, s[32:35], s26 offen offset:0
    v_lshlrev_b32 v238, 16, v117
    v_and_b32 v239, 0xffff0000, v117
    v_pk_fma_f32 v[238:239], v[238:239], v[222:223], v[230:231]
    v_cvt_pk_bf16_f32 v117, v238, v239
    v_lshlrev_b32 v240, 16, v118
    v_and_b32 v241, 0xffff0000, v118
    v_pk_fma_f32 v[240:241], v[240:241], v[224:225], v[232:233]
    v_cvt_pk_bf16_f32 v118, v240, v241
    buffer_load_dwordx4 v[192:195], v5, s[32:35], s26 offen offset:1024
    v_lshlrev_b32 v242, 16, v119
    v_and_b32 v243, 0xffff0000, v119
    v_pk_fma_f32 v[242:243], v[242:243], v[226:227], v[234:235]
    v_cvt_pk_bf16_f32 v119, v242, v243
    v_lshlrev_b32 v236, 16, v120
    v_and_b32 v237, 0xffff0000, v120
    v_pk_fma_f32 v[236:237], v[236:237], v[220:221], v[228:229]
    v_cvt_pk_bf16_f32 v120, v236, v237
    buffer_load_dwordx4 v[196:199], v5, s[32:35], s26 offen offset:2048
    v_lshlrev_b32 v238, 16, v121
    v_and_b32 v239, 0xffff0000, v121
    v_pk_fma_f32 v[238:239], v[238:239], v[222:223], v[230:231]
    v_cvt_pk_bf16_f32 v121, v238, v239
    v_lshlrev_b32 v240, 16, v122
    v_and_b32 v241, 0xffff0000, v122
    v_pk_fma_f32 v[240:241], v[240:241], v[224:225], v[232:233]
    v_cvt_pk_bf16_f32 v122, v240, v241
    buffer_load_dwordx4 v[200:203], v5, s[32:35], s26 offen offset:3072
    s_add_u32 s26, s26, 327680
    v_lshlrev_b32 v242, 16, v123
    v_and_b32 v243, 0xffff0000, v123
    v_pk_fma_f32 v[242:243], v[242:243], v[226:227], v[234:235]
    v_cvt_pk_bf16_f32 v123, v242, v243
    v_lshlrev_b32 v236, 16, v124
    v_and_b32 v237, 0xffff0000, v124
    v_pk_fma_f32 v[236:237], v[236:237], v[220:221], v[228:229]
    v_cvt_pk_bf16_f32 v124, v236, v237
    buffer_load_dwordx4 v[168:171], v5, s[36:39], s27 offen offset:0
    v_lshlrev_b32 v238, 16, v125
    v_and_b32 v239, 0xffff0000, v125
    v_pk_fma_f32 v[238:239], v[238:239], v[222:223], v[230:231]
    v_cvt_pk_bf16_f32 v125, v238, v239
    v_lshlrev_b32 v240, 16, v126
    v_and_b32 v241, 0xffff0000, v126
    v_pk_fma_f32 v[240:241], v[240:241], v[224:225], v[232:233]
    v_cvt_pk_bf16_f32 v126, v240, v241
    buffer_load_dwordx4 v[172:175], v5, s[36:39], s27 offen offset:1024
    v_lshlrev_b32 v242, 16, v127
    v_and_b32 v243, 0xffff0000, v127
    v_pk_fma_f32 v[242:243], v[242:243], v[226:227], v[234:235]
    v_cvt_pk_bf16_f32 v127, v242, v243
    v_lshlrev_b32 v236, 16, v128
    v_and_b32 v237, 0xffff0000, v128
    v_pk_fma_f32 v[236:237], v[236:237], v[220:221], v[228:229]
    v_cvt_pk_bf16_f32 v128, v236, v237
    buffer_load_dwordx4 v[176:179], v5, s[36:39], s27 offen offset:2048
    v_lshlrev_b32 v238, 16, v129
    v_and_b32 v239, 0xffff0000, v129
    v_pk_fma_f32 v[238:239], v[238:239], v[222:223], v[230:231]
    v_cvt_pk_bf16_f32 v129, v238, v239
    v_lshlrev_b32 v240, 16, v130
    v_and_b32 v241, 0xffff0000, v130
    v_pk_fma_f32 v[240:241], v[240:241], v[224:225], v[232:233]
    v_cvt_pk_bf16_f32 v130, v240, v241
    buffer_load_dwordx4 v[180:183], v5, s[36:39], s27 offen offset:3072
    v_lshlrev_b32 v242, 16, v131
    v_and_b32 v243, 0xffff0000, v131
    v_pk_fma_f32 v[242:243], v[242:243], v[226:227], v[234:235]
    v_cvt_pk_bf16_f32 v131, v242, v243
    buffer_load_dwordx4 v[184:187], v6, s[36:39], s27 offen
    s_add_u32 s27, s27, 901120
    s_waitcnt vmcnt(18)
    v_mfma_f32_16x16x32_bf16 v[16:19], v[96:99], v[116:119], v[16:19]
    v_mfma_f32_16x16x32_bf16 v[20:23], v[96:99], v[120:123], v[20:23]
    v_mfma_f32_16x16x32_bf16 v[24:27], v[96:99], v[124:127], v[24:27]
    v_mfma_f32_16x16x32_bf16 v[28:31], v[96:99], v[128:131], v[28:31]
    v_mfma_f32_16x16x32_bf16 v[32:35], v[100:103], v[116:119], v[32:35]
    v_mfma_f32_16x16x32_bf16 v[36:39], v[100:103], v[120:123], v[36:39]
    v_mfma_f32_16x16x32_bf16 v[40:43], v[100:103], v[124:127], v[40:43]
    v_mfma_f32_16x16x32_bf16 v[44:47], v[100:103], v[128:131], v[44:47]
    v_mfma_f32_16x16x32_bf16 v[48:51], v[104:107], v[116:119], v[48:51]
    v_mfma_f32_16x16x32_bf16 v[52:55], v[104:107], v[120:123], v[52:55]
    v_mfma_f32_16x16x32_bf16 v[56:59], v[104:107], v[124:127], v[56:59]
    v_mfma_f32_16x16x32_bf16 v[60:63], v[104:107], v[128:131], v[60:63]
    v_mfma_f32_16x16x32_bf16 v[64:67], v[108:111], v[116:119], v[64:67]
    v_mfma_f32_16x16x32_bf16 v[68:71], v[108:111], v[120:123], v[68:71]
    v_mfma_f32_16x16x32_bf16 v[72:75], v[108:111], v[124:127], v[72:75]
    v_mfma_f32_16x16x32_bf16 v[76:79], v[108:111], v[128:131], v[76:79]
    v_mfma_f32_16x16x32_bf16 v[80:83], v[112:115], v[116:119], v[80:83]
    v_mfma_f32_16x16x32_bf16 v[84:87], v[112:115], v[120:123], v[84:87]
    v_mfma_f32_16x16x32_bf16 v[88:91], v[112:115], v[124:127], v[88:91]
    v_mfma_f32_16x16x32_bf16 v[92:95], v[112:115], v[128:131], v[92:95]
    s_setprio 1
    s_waitcnt vmcnt(14)
    s_waitcnt lgkmcnt(0)
    ds_read_b128 v[220:223], v9 offset:640
    ds_read_b128 v[224:227], v9 offset:704
    ds_read_b128 v[228:231], v9 offset:1664
    ds_read_b128 v[232:235], v9 offset:1728
    v_lshlrev_b32 v236, 16, v152
    v_and_b32 v237, 0xffff0000, v152
    v_pk_fma_f32 v[236:237], v[236:237], v[204:205], v[212:213]
    v_cvt_pk_bf16_f32 v152, v236, v237
    buffer_load_dwordx4 v[116:119], v5, s[32:35], s26 offen offset:0
    v_lshlrev_b32 v238, 16, v153
    v_and_b32 v239, 0xffff0000, v153
    v_pk_fma_f32 v[238:239], v[238:239], v[206:207], v[214:215]
    v_cvt_pk_bf16_f32 v153, v238, v239
    v_lshlrev_b32 v240, 16, v154
    v_and_b32 v241, 0xffff0000, v154
    v_pk_fma_f32 v[240:241], v[240:241], v[208:209], v[216:217]
    v_cvt_pk_bf16_f32 v154, v240, v241
    buffer_load_dwordx4 v[120:123], v5, s[32:35], s26 offen offset:1024
    v_lshlrev_b32 v242, 16, v155
    v_and_b32 v243, 0xffff0000, v155
    v_pk_fma_f32 v[242:243], v[242:243], v[210:211], v[218:219]
    v_cvt_pk_bf16_f32 v155, v242, v243
    v_lshlrev_b32 v236, 16, v156
    v_and_b32 v237, 0xffff0000, v156
    v_pk_fma_f32 v[236:237], v[236:237], v[204:205], v[212:213]
    v_cvt_pk_bf16_f32 v156, v236, v237
    buffer_load_dwordx4 v[124:127], v5, s[32:35], s26 offen offset:2048
    v_lshlrev_b32 v238, 16, v157
    v_and_b32 v239, 0xffff0000, v157
    v_pk_fma_f32 v[238:239], v[238:239], v[206:207], v[214:215]
    v_cvt_pk_bf16_f32 v157, v238, v239
    v_lshlrev_b32 v240, 16, v158
    v_and_b32 v241, 0xffff0000, v158
    v_pk_fma_f32 v[240:241], v[240:241], v[208:209], v[216:217]
    v_cvt_pk_bf16_f32 v158, v240, v241
    buffer_load_dwordx4 v[128:131], v5, s[32:35], s26 offen offset:3072
    s_add_u32 s26, s26, 327680
    v_lshlrev_b32 v242, 16, v159
    v_and_b32 v243, 0xffff0000, v159
    v_pk_fma_f32 v[242:243], v[242:243], v[210:211], v[218:219]
    v_cvt_pk_bf16_f32 v159, v242, v243
    v_lshlrev_b32 v236, 16, v160
    v_and_b32 v237, 0xffff0000, v160
    v_pk_fma_f32 v[236:237], v[236:237], v[204:205], v[212:213]
    v_cvt_pk_bf16_f32 v160, v236, v237
    buffer_load_dwordx4 v[96:99], v5, s[36:39], s27 offen offset:0
    v_lshlrev_b32 v238, 16, v161
    v_and_b32 v239, 0xffff0000, v161
    v_pk_fma_f32 v[238:239], v[238:239], v[206:207], v[214:215]
    v_cvt_pk_bf16_f32 v161, v238, v239
    v_lshlrev_b32 v240, 16, v162
    v_and_b32 v241, 0xffff0000, v162
    v_pk_fma_f32 v[240:241], v[240:241], v[208:209], v[216:217]
    v_cvt_pk_bf16_f32 v162, v240, v241
    buffer_load_dwordx4 v[100:103], v5, s[36:39], s27 offen offset:1024
    v_lshlrev_b32 v242, 16, v163
    v_and_b32 v243, 0xffff0000, v163
    v_pk_fma_f32 v[242:243], v[242:243], v[210:211], v[218:219]
    v_cvt_pk_bf16_f32 v163, v242, v243
    v_lshlrev_b32 v236, 16, v164
    v_and_b32 v237, 0xffff0000, v164
    v_pk_fma_f32 v[236:237], v[236:237], v[204:205], v[212:213]
    v_cvt_pk_bf16_f32 v164, v236, v237
    buffer_load_dwordx4 v[104:107], v5, s[36:39], s27 offen offset:2048
    v_lshlrev_b32 v238, 16, v165
    v_and_b32 v239, 0xffff0000, v165
    v_pk_fma_f32 v[238:239], v[238:239], v[206:207], v[214:215]
    v_cvt_pk_bf16_f32 v165, v238, v239
    v_lshlrev_b32 v240, 16, v166
    v_and_b32 v241, 0xffff0000, v166
    v_pk_fma_f32 v[240:241], v[240:241], v[208:209], v[216:217]
    v_cvt_pk_bf16_f32 v166, v240, v241
    buffer_load_dwordx4 v[108:111], v5, s[36:39], s27 offen offset:3072
    v_lshlrev_b32 v242, 16, v167
    v_and_b32 v243, 0xffff0000, v167
    v_pk_fma_f32 v[242:243], v[242:243], v[210:211], v[218:219]
    v_cvt_pk_bf16_f32 v167, v242, v243
    buffer_load_dwordx4 v[112:115], v6, s[36:39], s27 offen
    s_add_u32 s27, s27, 901120
    s_waitcnt vmcnt(18)
    v_mfma_f32_16x16x32_bf16 v[16:19], v[132:135], v[152:155], v[16:19]
    v_mfma_f32_16x16x32_bf16 v[20:23], v[132:135], v[156:159], v[20:23]
    v_mfma_f32_16x16x32_bf16 v[24:27], v[132:135], v[160:163], v[24:27]
    v_mfma_f32_16x16x32_bf16 v[28:31], v[132:135], v[164:167], v[28:31]
    v_mfma_f32_16x16x32_bf16 v[32:35], v[136:139], v[152:155], v[32:35]
    v_mfma_f32_16x16x32_bf16 v[36:39], v[136:139], v[156:159], v[36:39]
    v_mfma_f32_16x16x32_bf16 v[40:43], v[136:139], v[160:163], v[40:43]
    v_mfma_f32_16x16x32_bf16 v[44:47], v[136:139], v[164:167], v[44:47]
    v_mfma_f32_16x16x32_bf16 v[48:51], v[140:143], v[152:155], v[48:51]
    v_mfma_f32_16x16x32_bf16 v[52:55], v[140:143], v[156:159], v[52:55]
    v_mfma_f32_16x16x32_bf16 v[56:59], v[140:143], v[160:163], v[56:59]
    v_mfma_f32_16x16x32_bf16 v[60:63], v[140:143], v[164:167], v[60:63]
    v_mfma_f32_16x16x32_bf16 v[64:67], v[144:147], v[152:155], v[64:67]
    v_mfma_f32_16x16x32_bf16 v[68:71], v[144:147], v[156:159], v[68:71]
    v_mfma_f32_16x16x32_bf16 v[72:75], v[144:147], v[160:163], v[72:75]
    v_mfma_f32_16x16x32_bf16 v[76:79], v[144:147], v[164:167], v[76:79]
    v_mfma_f32_16x16x32_bf16 v[80:83], v[148:151], v[152:155], v[80:83]
    v_mfma_f32_16x16x32_bf16 v[84:87], v[148:151], v[156:159], v[84:87]
    v_mfma_f32_16x16x32_bf16 v[88:91], v[148:151], v[160:163], v[88:91]
    v_mfma_f32_16x16x32_bf16 v[92:95], v[148:151], v[164:167], v[92:95]
    s_waitcnt vmcnt(14)
    s_waitcnt lgkmcnt(0)
    ds_read_b128 v[204:207], v9 offset:768
    ds_read_b128 v[208:211], v9 offset:832
    ds_read_b128 v[212:215], v9 offset:1792
    ds_read_b128 v[216:219], v9 offset:1856
    v_lshlrev_b32 v236, 16, v188
    v_and_b32 v237, 0xffff0000, v188
    v_pk_fma_f32 v[236:237], v[236:237], v[220:221], v[228:229]
    v_cvt_pk_bf16_f32 v188, v236, v237
    buffer_load_dwordx4 v[152:155], v5, s[32:35], s26 offen offset:0
    v_lshlrev_b32 v238, 16, v189
    v_and_b32 v239, 0xffff0000, v189
    v_pk_fma_f32 v[238:239], v[238:239], v[222:223], v[230:231]
    v_cvt_pk_bf16_f32 v189, v238, v239
    v_lshlrev_b32 v240, 16, v190
    v_and_b32 v241, 0xffff0000, v190
    v_pk_fma_f32 v[240:241], v[240:241], v[224:225], v[232:233]
    v_cvt_pk_bf16_f32 v190, v240, v241
    buffer_load_dwordx4 v[156:159], v5, s[32:35], s26 offen offset:1024
    v_lshlrev_b32 v242, 16, v191
    v_and_b32 v243, 0xffff0000, v191
    v_pk_fma_f32 v[242:243], v[242:243], v[226:227], v[234:235]
    v_cvt_pk_bf16_f32 v191, v242, v243
    v_lshlrev_b32 v236, 16, v192
    v_and_b32 v237, 0xffff0000, v192
    v_pk_fma_f32 v[236:237], v[236:237], v[220:221], v[228:229]
    v_cvt_pk_bf16_f32 v192, v236, v237
    buffer_load_dwordx4 v[160:163], v5, s[32:35], s26 offen offset:2048
    v_lshlrev_b32 v238, 16, v193
    v_and_b32 v239, 0xffff0000, v193
    v_pk_fma_f32 v[238:239], v[238:239], v[222:223], v[230:231]
    v_cvt_pk_bf16_f32 v193, v238, v239
    v_lshlrev_b32 v240, 16, v194
    v_and_b32 v241, 0xffff0000, v194
    v_pk_fma_f32 v[240:241], v[240:241], v[224:225], v[232:233]
    v_cvt_pk_bf16_f32 v194, v240, v241
    buffer_load_dwordx4 v[164:167], v5, s[32:35], s26 offen offset:3072
    s_add_u32 s26, s26, 327680
    v_lshlrev_b32 v242, 16, v195
    v_and_b32 v243, 0xffff0000, v195
    v_pk_fma_f32 v[242:243], v[242:243], v[226:227], v[234:235]
    v_cvt_pk_bf16_f32 v195, v242, v243
    v_lshlrev_b32 v236, 16, v196
    v_and_b32 v237, 0xffff0000, v196
    v_pk_fma_f32 v[236:237], v[236:237], v[220:221], v[228:229]
    v_cvt_pk_bf16_f32 v196, v236, v237
    buffer_load_dwordx4 v[132:135], v5, s[36:39], s27 offen offset:0
    v_lshlrev_b32 v238, 16, v197
    v_and_b32 v239, 0xffff0000, v197
    v_pk_fma_f32 v[238:239], v[238:239], v[222:223], v[230:231]
    v_cvt_pk_bf16_f32 v197, v238, v239
    v_lshlrev_b32 v240, 16, v198
    v_and_b32 v241, 0xffff0000, v198
    v_pk_fma_f32 v[240:241], v[240:241], v[224:225], v[232:233]
    v_cvt_pk_bf16_f32 v198, v240, v241
    buffer_load_dwordx4 v[136:139], v5, s[36:39], s27 offen offset:1024
    v_lshlrev_b32 v242, 16, v199
    v_and_b32 v243, 0xffff0000, v199
    v_pk_fma_f32 v[242:243], v[242:243], v[226:227], v[234:235]
    v_cvt_pk_bf16_f32 v199, v242, v243
    v_lshlrev_b32 v236, 16, v200
    v_and_b32 v237, 0xffff0000, v200
    v_pk_fma_f32 v[236:237], v[236:237], v[220:221], v[228:229]
    v_cvt_pk_bf16_f32 v200, v236, v237
    buffer_load_dwordx4 v[140:143], v5, s[36:39], s27 offen offset:2048
    v_lshlrev_b32 v238, 16, v201
    v_and_b32 v239, 0xffff0000, v201
    v_pk_fma_f32 v[238:239], v[238:239], v[222:223], v[230:231]
    v_cvt_pk_bf16_f32 v201, v238, v239
    v_lshlrev_b32 v240, 16, v202
    v_and_b32 v241, 0xffff0000, v202
    v_pk_fma_f32 v[240:241], v[240:241], v[224:225], v[232:233]
    v_cvt_pk_bf16_f32 v202, v240, v241
    buffer_load_dwordx4 v[144:147], v5, s[36:39], s27 offen offset:3072
    v_lshlrev_b32 v242, 16, v203
    v_and_b32 v243, 0xffff0000, v203
    v_pk_fma_f32 v[242:243], v[242:243], v[226:227], v[234:235]
    v_cvt_pk_bf16_f32 v203, v242, v243
    buffer_load_dwordx4 v[148:151], v6, s[36:39], s27 offen
    s_add_u32 s27, s27, 901120
    s_waitcnt vmcnt(18)
    v_mfma_f32_16x16x32_bf16 v[16:19], v[168:171], v[188:191], v[16:19]
    v_mfma_f32_16x16x32_bf16 v[20:23], v[168:171], v[192:195], v[20:23]
    v_mfma_f32_16x16x32_bf16 v[24:27], v[168:171], v[196:199], v[24:27]
    v_mfma_f32_16x16x32_bf16 v[28:31], v[168:171], v[200:203], v[28:31]
    v_mfma_f32_16x16x32_bf16 v[32:35], v[172:175], v[188:191], v[32:35]
    v_mfma_f32_16x16x32_bf16 v[36:39], v[172:175], v[192:195], v[36:39]
    v_mfma_f32_16x16x32_bf16 v[40:43], v[172:175], v[196:199], v[40:43]
    v_mfma_f32_16x16x32_bf16 v[44:47], v[172:175], v[200:203], v[44:47]
    v_mfma_f32_16x16x32_bf16 v[48:51], v[176:179], v[188:191], v[48:51]
    v_mfma_f32_16x16x32_bf16 v[52:55], v[176:179], v[192:195], v[52:55]
    v_mfma_f32_16x16x32_bf16 v[56:59], v[176:179], v[196:199], v[56:59]
    v_mfma_f32_16x16x32_bf16 v[60:63], v[176:179], v[200:203], v[60:63]
    v_mfma_f32_16x16x32_bf16 v[64:67], v[180:183], v[188:191], v[64:67]
    v_mfma_f32_16x16x32_bf16 v[68:71], v[180:183], v[192:195], v[68:71]
    v_mfma_f32_16x16x32_bf16 v[72:75], v[180:183], v[196:199], v[72:75]
    v_mfma_f32_16x16x32_bf16 v[76:79], v[180:183], v[200:203], v[76:79]
    v_mfma_f32_16x16x32_bf16 v[80:83], v[184:187], v[188:191], v[80:83]
    v_mfma_f32_16x16x32_bf16 v[84:87], v[184:187], v[192:195], v[84:87]
    v_mfma_f32_16x16x32_bf16 v[88:91], v[184:187], v[196:199], v[88:91]
    v_mfma_f32_16x16x32_bf16 v[92:95], v[184:187], v[200:203], v[92:95]
    s_setprio 0
    s_waitcnt vmcnt(14)
    s_waitcnt lgkmcnt(0)
    ds_read_b128 v[220:223], v9 offset:896
    ds_read_b128 v[224:227], v9 offset:960
    ds_read_b128 v[228:231], v9 offset:1920
    ds_read_b128 v[232:235], v9 offset:1984
    v_lshlrev_b32 v236, 16, v116
    v_and_b32 v237, 0xffff0000, v116
    v_pk_fma_f32 v[236:237], v[236:237], v[204:205], v[212:213]
    v_cvt_pk_bf16_f32 v116, v236, v237
    v_lshlrev_b32 v238, 16, v117
    v_and_b32 v239, 0xffff0000, v117
    v_pk_fma_f32 v[238:239], v[238:239], v[206:207], v[214:215]
    v_cvt_pk_bf16_f32 v117, v238, v239
    v_lshlrev_b32 v240, 16, v118
    v_and_b32 v241, 0xffff0000, v118
    v_pk_fma_f32 v[240:241], v[240:241], v[208:209], v[216:217]
    v_cvt_pk_bf16_f32 v118, v240, v241
    v_lshlrev_b32 v242, 16, v119
    v_and_b32 v243, 0xffff0000, v119
    v_pk_fma_f32 v[242:243], v[242:243], v[210:211], v[218:219]
    v_cvt_pk_bf16_f32 v119, v242, v243
    v_lshlrev_b32 v236, 16, v120
    v_and_b32 v237, 0xffff0000, v120
    v_pk_fma_f32 v[236:237], v[236:237], v[204:205], v[212:213]
    v_cvt_pk_bf16_f32 v120, v236, v237
    v_lshlrev_b32 v238, 16, v121
    v_and_b32 v239, 0xffff0000, v121
    v_pk_fma_f32 v[238:239], v[238:239], v[206:207], v[214:215]
    v_cvt_pk_bf16_f32 v121, v238, v239
    v_lshlrev_b32 v240, 16, v122
    v_and_b32 v241, 0xffff0000, v122
    v_pk_fma_f32 v[240:241], v[240:241], v[208:209], v[216:217]
    v_cvt_pk_bf16_f32 v122, v240, v241
    v_lshlrev_b32 v242, 16, v123
    v_and_b32 v243, 0xffff0000, v123
    v_pk_fma_f32 v[242:243], v[242:243], v[210:211], v[218:219]
    v_cvt_pk_bf16_f32 v123, v242, v243
    v_lshlrev_b32 v236, 16, v124
    v_and_b32 v237, 0xffff0000, v124
    v_pk_fma_f32 v[236:237], v[236:237], v[204:205], v[212:213]
    v_cvt_pk_bf16_f32 v124, v236, v237
    v_lshlrev_b32 v238, 16, v125
    v_and_b32 v239, 0xffff0000, v125
    v_pk_fma_f32 v[238:239], v[238:239], v[206:207], v[214:215]
    v_cvt_pk_bf16_f32 v125, v238, v239
    v_lshlrev_b32 v240, 16, v126
    v_and_b32 v241, 0xffff0000, v126
    v_pk_fma_f32 v[240:241], v[240:241], v[208:209], v[216:217]
    v_cvt_pk_bf16_f32 v126, v240, v241
    v_lshlrev_b32 v242, 16, v127
    v_and_b32 v243, 0xffff0000, v127
    v_pk_fma_f32 v[242:243], v[242:243], v[210:211], v[218:219]
    v_cvt_pk_bf16_f32 v127, v242, v243
    v_lshlrev_b32 v236, 16, v128
    v_and_b32 v237, 0xffff0000, v128
    v_pk_fma_f32 v[236:237], v[236:237], v[204:205], v[212:213]
    v_cvt_pk_bf16_f32 v128, v236, v237
    v_lshlrev_b32 v238, 16, v129
    v_and_b32 v239, 0xffff0000, v129
    v_pk_fma_f32 v[238:239], v[238:239], v[206:207], v[214:215]
    v_cvt_pk_bf16_f32 v129, v238, v239
    v_lshlrev_b32 v240, 16, v130
    v_and_b32 v241, 0xffff0000, v130
    v_pk_fma_f32 v[240:241], v[240:241], v[208:209], v[216:217]
    v_cvt_pk_bf16_f32 v130, v240, v241
    v_lshlrev_b32 v242, 16, v131
    v_and_b32 v243, 0xffff0000, v131
    v_pk_fma_f32 v[242:243], v[242:243], v[210:211], v[218:219]
    v_cvt_pk_bf16_f32 v131, v242, v243
    s_waitcnt vmcnt(9)
    v_mfma_f32_16x16x32_bf16 v[16:19], v[96:99], v[116:119], v[16:19]
    v_mfma_f32_16x16x32_bf16 v[20:23], v[96:99], v[120:123], v[20:23]
    v_mfma_f32_16x16x32_bf16 v[24:27], v[96:99], v[124:127], v[24:27]
    v_mfma_f32_16x16x32_bf16 v[28:31], v[96:99], v[128:131], v[28:31]
    v_mfma_f32_16x16x32_bf16 v[32:35], v[100:103], v[116:119], v[32:35]
    v_mfma_f32_16x16x32_bf16 v[36:39], v[100:103], v[120:123], v[36:39]
    v_mfma_f32_16x16x32_bf16 v[40:43], v[100:103], v[124:127], v[40:43]
    v_mfma_f32_16x16x32_bf16 v[44:47], v[100:103], v[128:131], v[44:47]
    v_mfma_f32_16x16x32_bf16 v[48:51], v[104:107], v[116:119], v[48:51]
    v_mfma_f32_16x16x32_bf16 v[52:55], v[104:107], v[120:123], v[52:55]
    v_mfma_f32_16x16x32_bf16 v[56:59], v[104:107], v[124:127], v[56:59]
    v_mfma_f32_16x16x32_bf16 v[60:63], v[104:107], v[128:131], v[60:63]
    v_mfma_f32_16x16x32_bf16 v[64:67], v[108:111], v[116:119], v[64:67]
    v_mfma_f32_16x16x32_bf16 v[68:71], v[108:111], v[120:123], v[68:71]
    v_mfma_f32_16x16x32_bf16 v[72:75], v[108:111], v[124:127], v[72:75]
    v_mfma_f32_16x16x32_bf16 v[76:79], v[108:111], v[128:131], v[76:79]
    v_mfma_f32_16x16x32_bf16 v[80:83], v[112:115], v[116:119], v[80:83]
    v_mfma_f32_16x16x32_bf16 v[84:87], v[112:115], v[120:123], v[84:87]
    v_mfma_f32_16x16x32_bf16 v[88:91], v[112:115], v[124:127], v[88:91]
    v_mfma_f32_16x16x32_bf16 v[92:95], v[112:115], v[128:131], v[92:95]
    s_waitcnt vmcnt(5)
    s_waitcnt lgkmcnt(0)
    v_lshlrev_b32 v236, 16, v152
    v_and_b32 v237, 0xffff0000, v152
    v_pk_fma_f32 v[236:237], v[236:237], v[220:221], v[228:229]
    v_cvt_pk_bf16_f32 v152, v236, v237
    v_lshlrev_b32 v238, 16, v153
    v_and_b32 v239, 0xffff0000, v153
    v_pk_fma_f32 v[238:239], v[238:239], v[222:223], v[230:231]
    v_cvt_pk_bf16_f32 v153, v238, v239
    v_lshlrev_b32 v240, 16, v154
    v_and_b32 v241, 0xffff0000, v154
    v_pk_fma_f32 v[240:241], v[240:241], v[224:225], v[232:233]
    v_cvt_pk_bf16_f32 v154, v240, v241
    v_lshlrev_b32 v242, 16, v155
    v_and_b32 v243, 0xffff0000, v155
    v_pk_fma_f32 v[242:243], v[242:243], v[226:227], v[234:235]
    v_cvt_pk_bf16_f32 v155, v242, v243
    v_lshlrev_b32 v236, 16, v156
    v_and_b32 v237, 0xffff0000, v156
    v_pk_fma_f32 v[236:237], v[236:237], v[220:221], v[228:229]
    v_cvt_pk_bf16_f32 v156, v236, v237
    v_lshlrev_b32 v238, 16, v157
    v_and_b32 v239, 0xffff0000, v157
    v_pk_fma_f32 v[238:239], v[238:239], v[222:223], v[230:231]
    v_cvt_pk_bf16_f32 v157, v238, v239
    v_lshlrev_b32 v240, 16, v158
    v_and_b32 v241, 0xffff0000, v158
    v_pk_fma_f32 v[240:241], v[240:241], v[224:225], v[232:233]
    v_cvt_pk_bf16_f32 v158, v240, v241
    v_lshlrev_b32 v242, 16, v159
    v_and_b32 v243, 0xffff0000, v159
    v_pk_fma_f32 v[242:243], v[242:243], v[226:227], v[234:235]
    v_cvt_pk_bf16_f32 v159, v242, v243
    v_lshlrev_b32 v236, 16, v160
    v_and_b32 v237, 0xffff0000, v160
    v_pk_fma_f32 v[236:237], v[236:237], v[220:221], v[228:229]
    v_cvt_pk_bf16_f32 v160, v236, v237
    v_lshlrev_b32 v238, 16, v161
    v_and_b32 v239, 0xffff0000, v161
    v_pk_fma_f32 v[238:239], v[238:239], v[222:223], v[230:231]
    v_cvt_pk_bf16_f32 v161, v238, v239
    v_lshlrev_b32 v240, 16, v162
    v_and_b32 v241, 0xffff0000, v162
    v_pk_fma_f32 v[240:241], v[240:241], v[224:225], v[232:233]
    v_cvt_pk_bf16_f32 v162, v240, v241
    v_lshlrev_b32 v242, 16, v163
    v_and_b32 v243, 0xffff0000, v163
    v_pk_fma_f32 v[242:243], v[242:243], v[226:227], v[234:235]
    v_cvt_pk_bf16_f32 v163, v242, v243
    v_lshlrev_b32 v236, 16, v164
    v_and_b32 v237, 0xffff0000, v164
    v_pk_fma_f32 v[236:237], v[236:237], v[220:221], v[228:229]
    v_cvt_pk_bf16_f32 v164, v236, v237
    v_lshlrev_b32 v238, 16, v165
    v_and_b32 v239, 0xffff0000, v165
    v_pk_fma_f32 v[238:239], v[238:239], v[222:223], v[230:231]
    v_cvt_pk_bf16_f32 v165, v238, v239
    v_lshlrev_b32 v240, 16, v166
    v_and_b32 v241, 0xffff0000, v166
    v_pk_fma_f32 v[240:241], v[240:241], v[224:225], v[232:233]
    v_cvt_pk_bf16_f32 v166, v240, v241
    v_lshlrev_b32 v242, 16, v167
    v_and_b32 v243, 0xffff0000, v167
    v_pk_fma_f32 v[242:243], v[242:243], v[226:227], v[234:235]
    v_cvt_pk_bf16_f32 v167, v242, v243
    s_waitcnt vmcnt(0)
    v_mfma_f32_16x16x32_bf16 v[16:19], v[132:135], v[152:155], v[16:19]
    v_mfma_f32_16x16x32_bf16 v[20:23], v[132:135], v[156:159], v[20:23]
    v_mfma_f32_16x16x32_bf16 v[24:27], v[132:135], v[160:163], v[24:27]
    v_mfma_f32_16x16x32_bf16 v[28:31], v[132:135], v[164:167], v[28:31]
    v_mfma_f32_16x16x32_bf16 v[32:35], v[136:139], v[152:155], v[32:35]
    v_mfma_f32_16x16x32_bf16 v[36:39], v[136:139], v[156:159], v[36:39]
    v_mfma_f32_16x16x32_bf16 v[40:43], v[136:139], v[160:163], v[40:43]
    v_mfma_f32_16x16x32_bf16 v[44:47], v[136:139], v[164:167], v[44:47]
    v_mfma_f32_16x16x32_bf16 v[48:51], v[140:143], v[152:155], v[48:51]
    v_mfma_f32_16x16x32_bf16 v[52:55], v[140:143], v[156:159], v[52:55]
    v_mfma_f32_16x16x32_bf16 v[56:59], v[140:143], v[160:163], v[56:59]
    v_mfma_f32_16x16x32_bf16 v[60:63], v[140:143], v[164:167], v[60:63]
    v_mfma_f32_16x16x32_bf16 v[64:67], v[144:147], v[152:155], v[64:67]
    v_mfma_f32_16x16x32_bf16 v[68:71], v[144:147], v[156:159], v[68:71]
    v_mfma_f32_16x16x32_bf16 v[72:75], v[144:147], v[160:163], v[72:75]
    v_mfma_f32_16x16x32_bf16 v[76:79], v[144:147], v[164:167], v[76:79]
    v_mfma_f32_16x16x32_bf16 v[80:83], v[148:151], v[152:155], v[80:83]
    v_mfma_f32_16x16x32_bf16 v[84:87], v[148:151], v[156:159], v[84:87]
    v_mfma_f32_16x16x32_bf16 v[88:91], v[148:151], v[160:163], v[88:91]
    v_mfma_f32_16x16x32_bf16 v[92:95], v[148:151], v[164:167], v[92:95]
    s_lshr_b32 s30, s3, 2
    s_mul_i32 s30, s30, 3
    s_mul_i32 s29, s17, 160
    s_lshl_b32 s31, s30, 5
    s_add_u32 s29, s29, s31
    v_lshlrev_b32 v13, 3, v2
    buffer_load_dwordx2 v[96:97], v13, s[40:43], s29 offen offset:0
    buffer_load_dwordx2 v[98:99], v13, s[40:43], s29 offen offset:32
    buffer_load_dwordx2 v[100:101], v13, s[40:43], s29 offen offset:64
    s_mul_i32 s28, s3, 20480
    v_add_u32 v14, s28, v5
    s_nop 7
    ds_write_b128 v14, v[16:19] offset:0
    ds_write_b128 v14, v[32:35] offset:1024
    ds_write_b128 v14, v[48:51] offset:2048
    ds_write_b128 v14, v[64:67] offset:3072
    ds_write_b128 v14, v[80:83] offset:4096
    ds_write_b128 v14, v[20:23] offset:5120
    ds_write_b128 v14, v[36:39] offset:6144
    ds_write_b128 v14, v[52:55] offset:7168
    ds_write_b128 v14, v[68:71] offset:8192
    ds_write_b128 v14, v[84:87] offset:9216
    ds_write_b128 v14, v[24:27] offset:10240
    ds_write_b128 v14, v[40:43] offset:11264
    ds_write_b128 v14, v[56:59] offset:12288
    ds_write_b128 v14, v[72:75] offset:13312
    ds_write_b128 v14, v[88:91] offset:14336
    ds_write_b128 v14, v[28:31] offset:15360
    ds_write_b128 v14, v[44:47] offset:16384
    ds_write_b128 v14, v[60:63] offset:17408
    ds_write_b128 v14, v[76:79] offset:18432
    ds_write_b128 v14, v[92:95] offset:19456
    s_and_b32 s28, s3, 3
    s_mul_i32 s28, s28, 5120
    s_lshr_b32 s29, s3, 2
    s_mul_i32 s29, s29, 3072
    s_add_u32 s28, s28, s29
    v_add_u32 v14, s28, v5
    v_add_u32 v15, 61440, v14
    v_add_u32 v13, 122880, v14
    s_waitcnt lgkmcnt(0)
    s_barrier
    ds_read_b128 v[16:19], v14 offset:0
    ds_read_b128 v[20:23], v14 offset:1024
    ds_read_b128 v[24:27], v14 offset:2048
    ds_read_b128 v[28:31], v14 offset:20480
    ds_read_b128 v[32:35], v14 offset:21504
    ds_read_b128 v[36:39], v14 offset:22528
    ds_read_b128 v[40:43], v14 offset:40960
    ds_read_b128 v[44:47], v14 offset:41984
    ds_read_b128 v[48:51], v14 offset:43008
    ds_read_b128 v[52:55], v15 offset:0
    ds_read_b128 v[56:59], v15 offset:1024
    ds_read_b128 v[60:63], v15 offset:2048
    ds_read_b128 v[64:67], v15 offset:20480
    ds_read_b128 v[68:71], v15 offset:21504
    ds_read_b128 v[72:75], v15 offset:22528
    ds_read_b128 v[76:79], v15 offset:40960
    ds_read_b128 v[80:83], v15 offset:41984
    ds_read_b128 v[84:87], v15 offset:43008
    ds_read_b128 v[88:91], v13 offset:0
    ds_read_b128 v[92:95], v13 offset:1024
    ds_read_b128 v[116:119], v13 offset:2048
    ds_read_b128 v[120:123], v13 offset:20480
    ds_read_b128 v[124:127], v13 offset:21504
    ds_read_b128 v[128:131], v13 offset:22528
    s_waitcnt lgkmcnt(0)
    v_add_f32 v16, v16, v28
    v_add_f32 v40, v40, v52
    v_add_f32 v64, v64, v76
    v_add_f32 v88, v88, v120
    v_add_f32 v16, v16, v40
    v_add_f32 v64, v64, v88
    v_add_f32 v104, v16, v64
    v_add_f32 v17, v17, v29
    v_add_f32 v41, v41, v53
    v_add_f32 v65, v65, v77
    v_add_f32 v89, v89, v121
    v_add_f32 v17, v17, v41
    v_add_f32 v65, v65, v89
    v_add_f32 v105, v17, v65
    v_add_f32 v18, v18, v30
    v_add_f32 v42, v42, v54
    v_add_f32 v66, v66, v78
    v_add_f32 v90, v90, v122
    v_add_f32 v18, v18, v42
    v_add_f32 v66, v66, v90
    v_add_f32 v106, v18, v66
    v_add_f32 v19, v19, v31
    v_add_f32 v43, v43, v55
    v_add_f32 v67, v67, v79
    v_add_f32 v91, v91, v123
    v_add_f32 v19, v19, v43
    v_add_f32 v67, v67, v91
    v_add_f32 v107, v19, v67
    v_add_f32 v20, v20, v32
    v_add_f32 v44, v44, v56
    v_add_f32 v68, v68, v80
    v_add_f32 v92, v92, v124
    v_add_f32 v20, v20, v44
    v_add_f32 v68, v68, v92
    v_add_f32 v108, v20, v68
    v_add_f32 v21, v21, v33
    v_add_f32 v45, v45, v57
    v_add_f32 v69, v69, v81
    v_add_f32 v93, v93, v125
    v_add_f32 v21, v21, v45
    v_add_f32 v69, v69, v93
    v_add_f32 v109, v21, v69
    v_add_f32 v22, v22, v34
    v_add_f32 v46, v46, v58
    v_add_f32 v70, v70, v82
    v_add_f32 v94, v94, v126
    v_add_f32 v22, v22, v46
    v_add_f32 v70, v70, v94
    v_add_f32 v110, v22, v70
    v_add_f32 v23, v23, v35
    v_add_f32 v47, v47, v59
    v_add_f32 v71, v71, v83
    v_add_f32 v95, v95, v127
    v_add_f32 v23, v23, v47
    v_add_f32 v71, v71, v95
    v_add_f32 v111, v23, v71
    v_add_f32 v24, v24, v36
    v_add_f32 v48, v48, v60
    v_add_f32 v72, v72, v84
    v_add_f32 v116, v116, v128
    v_add_f32 v24, v24, v48
    v_add_f32 v72, v72, v116
    v_add_f32 v112, v24, v72
    v_add_f32 v25, v25, v37
    v_add_f32 v49, v49, v61
    v_add_f32 v73, v73, v85
    v_add_f32 v117, v117, v129
    v_add_f32 v25, v25, v49
    v_add_f32 v73, v73, v117
    v_add_f32 v113, v25, v73
    v_add_f32 v26, v26, v38
    v_add_f32 v50, v50, v62
    v_add_f32 v74, v74, v86
    v_add_f32 v118, v118, v130
    v_add_f32 v26, v26, v50
    v_add_f32 v74, v74, v118
    v_add_f32 v114, v26, v74
    v_add_f32 v27, v27, v39
    v_add_f32 v51, v51, v63
    v_add_f32 v75, v75, v87
    v_add_f32 v119, v119, v131
    v_add_f32 v27, v27, v51
    v_add_f32 v75, v75, v119
    v_add_f32 v115, v27, v75
    s_waitcnt vmcnt(0)
    v_mov_b32 v13, 0xc0135761
    v_mov_b32 v14, 0xbdd2d3e8
    v_lshlrev_b32 v16, 16, v96
    v_and_b32 v17, 0xffff0000, v96
    v_lshlrev_b32 v18, 16, v97
    v_and_b32 v19, 0xffff0000, v97
    v_lshlrev_b32 v20, 16, v98
    v_and_b32 v21, 0xffff0000, v98
    v_lshlrev_b32 v22, 16, v99
    v_and_b32 v23, 0xffff0000, v99
    v_lshlrev_b32 v24, 16, v100
    v_and_b32 v25, 0xffff0000, v100
    v_lshlrev_b32 v26, 16, v101
    v_and_b32 v27, 0xffff0000, v101
    v_add_f32 v104, v104, v16
    v_add_f32 v105, v105, v17
    v_add_f32 v106, v106, v18
    v_add_f32 v107, v107, v19
    v_add_f32 v108, v108, v20
    v_add_f32 v109, v109, v21
    v_add_f32 v110, v110, v22
    v_add_f32 v111, v111, v23
    v_add_f32 v112, v112, v24
    v_add_f32 v113, v113, v25
    v_add_f32 v114, v114, v26
    v_add_f32 v115, v115, v27
    v_mul_f32 v16, v104, v104
    v_mul_f32 v17, v105, v105
    v_mul_f32 v18, v106, v106
    v_mul_f32 v19, v107, v107
    v_mul_f32 v20, v108, v108
    v_mul_f32 v21, v109, v109
    v_mul_f32 v22, v110, v110
    v_mul_f32 v23, v111, v111
    v_mul_f32 v24, v112, v112
    v_mul_f32 v25, v113, v113
    v_mul_f32 v26, v114, v114
    v_mul_f32 v27, v115, v115
    v_fma_f32 v16, v16, v14, v13
    v_fma_f32 v17, v17, v14, v13
    v_fma_f32 v18, v18, v14, v13
    v_fma_f32 v19, v19, v14, v13
    v_fma_f32 v20, v20, v14, v13
    v_fma_f32 v21, v21, v14, v13
    v_fma_f32 v22, v22, v14, v13
    v_fma_f32 v23, v23, v14, v13
    v_fma_f32 v24, v24, v14, v13
    v_fma_f32 v25, v25, v14, v13
    v_fma_f32 v26, v26, v14, v13
    v_fma_f32 v27, v27, v14, v13
    v_mul_f32 v16, v16, v104
    v_mul_f32 v17, v17, v105
    v_mul_f32 v18, v18, v106
    v_mul_f32 v19, v19, v107
    v_mul_f32 v20, v20, v108
    v_mul_f32 v21, v21, v109
    v_mul_f32 v22, v22, v110
    v_mul_f32 v23, v23, v111
    v_mul_f32 v24, v24, v112
    v_mul_f32 v25, v25, v113
    v_mul_f32 v26, v26, v114
    v_mul_f32 v27, v27, v115
    v_exp_f32 v16, v16
    v_exp_f32 v17, v17
    v_exp_f32 v18, v18
    v_exp_f32 v19, v19
    v_exp_f32 v20, v20
    v_exp_f32 v21, v21
    v_exp_f32 v22, v22
    v_exp_f32 v23, v23
    v_exp_f32 v24, v24
    v_exp_f32 v25, v25
    v_exp_f32 v26, v26
    v_exp_f32 v27, v27
    v_add_f32 v16, 1.0, v16
    v_add_f32 v17, 1.0, v17
    v_add_f32 v18, 1.0, v18
    v_add_f32 v19, 1.0, v19
    v_add_f32 v20, 1.0, v20
    v_add_f32 v21, 1.0, v21
    v_add_f32 v22, 1.0, v22
    v_add_f32 v23, 1.0, v23
    v_add_f32 v24, 1.0, v24
    v_add_f32 v25, 1.0, v25
    v_add_f32 v26, 1.0, v26
    v_add_f32 v27, 1.0, v27
    v_rcp_f32 v16, v16
    v_rcp_f32 v17, v17
    v_rcp_f32 v18, v18
    v_rcp_f32 v19, v19
    v_rcp_f32 v20, v20
    v_rcp_f32 v21, v21
    v_rcp_f32 v22, v22
    v_rcp_f32 v23, v23
    v_rcp_f32 v24, v24
    v_rcp_f32 v25, v25
    v_rcp_f32 v26, v26
    v_rcp_f32 v27, v27
    v_mul_f32 v104, v104, v16
    v_mul_f32 v105, v105, v17
    v_mul_f32 v106, v106, v18
    v_mul_f32 v107, v107, v19
    v_mul_f32 v108, v108, v20
    v_mul_f32 v109, v109, v21
    v_mul_f32 v110, v110, v22
    v_mul_f32 v111, v111, v23
    v_mul_f32 v112, v112, v24
    v_mul_f32 v113, v113, v25
    v_mul_f32 v114, v114, v26
    v_mul_f32 v115, v115, v27
    v_cvt_pk_bf16_f32 v136, v104, v105
    v_cvt_pk_bf16_f32 v137, v106, v107
    v_cvt_pk_bf16_f32 v138, v108, v109
    v_cvt_pk_bf16_f32 v139, v110, v111
    v_cvt_pk_bf16_f32 v140, v112, v113
    v_cvt_pk_bf16_f32 v141, v114, v115
    s_mul_i32 s24, s17, 5
    s_add_u32 s24, s24, s30
    s_and_b32 s25, s3, 3
    s_lshl_b32 s26, s16, 2
    s_add_u32 s25, s25, s26
    s_lshl_b32 s25, s25, 10
    s_add_u32 s26, s24, 0
    s_lshr_b32 s27, s26, 1
    s_mul_i32 s27, s27, 40960
    s_and_b32 s26, s26, 1
    s_lshl_b32 s26, s26, 3
    s_add_u32 s27, s27, s26
    s_add_u32 s27, s27, s25
    buffer_store_dwordx2 v[136:137], v5, s[48:51], s27 offen
    s_add_u32 s26, s24, 1
    s_lshr_b32 s27, s26, 1
    s_mul_i32 s27, s27, 40960
    s_and_b32 s26, s26, 1
    s_lshl_b32 s26, s26, 3
    s_add_u32 s27, s27, s26
    s_add_u32 s27, s27, s25
    buffer_store_dwordx2 v[138:139], v5, s[48:51], s27 offen
    s_cmp_ge_u32 s3, 4
    s_cbranch_scc1 mlpa0_kernel_sk1
    s_add_u32 s26, s24, 2
    s_lshr_b32 s27, s26, 1
    s_mul_i32 s27, s27, 40960
    s_and_b32 s26, s26, 1
    s_lshl_b32 s26, s26, 3
    s_add_u32 s27, s27, s26
    s_add_u32 s27, s27, s25
    buffer_store_dwordx2 v[140:141], v5, s[48:51], s27 offen
mlpa0_kernel_sk1:
mlpa0_kernel_end:
    s_endpgm

.globl mlpb0_kernel
.p2align 8
.type mlpb0_kernel,@function
mlpb0_kernel:
    s_cmp_ge_u32 s2, 256
    s_cbranch_scc1 mlpb0_kernel_end
    s_load_dwordx2 s[4:5], s[0:1], 96
    s_load_dwordx2 s[10:11], s[0:1], 72
    s_bfe_u32 s16, s2, 0x20001
    s_lshl_b32 s16, s16, 3
    s_lshr_b32 s17, s2, 3
    s_and_b32 s18, s17, 7
    s_add_u32 s16, s16, s18
    s_lshr_b32 s17, s17, 3
    s_and_b32 s18, s2, 1
    s_lshl_b32 s18, s18, 2
    s_add_u32 s17, s17, s18
    v_lshrrev_b32 v2, 6, v0
    v_and_b32 v1, 63, v0
    v_readfirstlane_b32 s3, v2
    v_lshrrev_b32 v2, 4, v1
    v_and_b32 v3, 15, v1
    v_lshlrev_b32 v5, 4, v1
    v_add_u32 v6, 4096, v5
    s_lshl_b32 s20, s16, 6
    s_lshl_b32 s21, s3, 4
    s_add_u32 s20, s20, s21
    s_lshr_b32 s21, s20, 4
    s_mul_i32 s21, s21, 20480
    s_mul_i32 s24, s17, 5
    s_lshr_b32 s24, s24, 1
    s_lshl_b32 s24, s24, 10
    s_add_u32 s24, s24, s21
    s_and_b32 s25, s17, 1
    s_waitcnt lgkmcnt(0)
    s_add_u32 s32, s4, 11534336
    s_addc_u32 s33, s5, 0
    s_mov_b32 s34, 2211840
    s_mov_b32 s35, 0x00020000
    s_add_u32 s36, s4, 41943040
    s_addc_u32 s37, s5, 0
    s_mov_b32 s38, 7077888
    s_mov_b32 s39, 0x00020000
    s_mov_b32 s40, s10
    s_mov_b32 s41, s11
    s_mov_b32 s42, 4096
    s_mov_b32 s43, 0x00020000
    s_add_u32 s44, s4, 7340032
    s_addc_u32 s45, s5, 0
    s_mov_b32 s46, 2621440
    s_mov_b32 s47, 0x00020000
    s_add_u32 s48, s4, 14680064
    s_addc_u32 s49, s5, 0
    s_mov_b32 s50, 2621440
    s_mov_b32 s51, 0x00020000
    s_mul_i32 s26, s3, 40960
    s_mul_i32 s27, s17, 5120
    s_add_u32 s26, s26, s27
    s_lshl_b32 s27, s3, 17
    s_lshl_b32 s28, s16, 12
    s_add_u32 s27, s27, s28
    s_mul_i32 s29, s16, 81920
    s_mul_i32 s28, s17, 5120
    s_add_u32 s29, s29, s28
    s_and_b32 s28, s3, 1
    s_mul_i32 s28, s28, 40960
    s_add_u32 s29, s29, s28
    s_cmp_ge_u32 s3, 2
    s_cselect_b32 s52, s44, s32
    s_cselect_b32 s53, s45, s33
    s_cselect_b32 s54, s46, s34
    s_mov_b32 s55, 0x00020000
    buffer_load_dwordx4 v[96:99], v5, s[32:35], s26 offen offset:0
    buffer_load_dwordx4 v[100:103], v5, s[32:35], s26 offen offset:1024
    buffer_load_dwordx4 v[104:107], v5, s[32:35], s26 offen offset:2048
    buffer_load_dwordx4 v[108:111], v5, s[32:35], s26 offen offset:3072
    buffer_load_dwordx4 v[112:115], v6, s[32:35], s26 offen
    s_add_u32 s26, s26, 163840
    buffer_load_dwordx4 v[116:119], v5, s[36:39], s27 offen offset:0
    buffer_load_dwordx4 v[120:123], v5, s[36:39], s27 offen offset:1024
    buffer_load_dwordx4 v[124:127], v5, s[36:39], s27 offen offset:2048
    buffer_load_dwordx4 v[128:131], v5, s[36:39], s27 offen offset:3072
    s_add_u32 s27, s27, 524288
    buffer_load_dwordx4 v[132:135], v5, s[32:35], s26 offen offset:0
    buffer_load_dwordx4 v[136:139], v5, s[32:35], s26 offen offset:1024
    buffer_load_dwordx4 v[140:143], v5, s[32:35], s26 offen offset:2048
    buffer_load_dwordx4 v[144:147], v5, s[32:35], s26 offen offset:3072
    buffer_load_dwordx4 v[148:151], v6, s[32:35], s26 offen
    s_add_u32 s26, s26, 163840
    buffer_load_dwordx4 v[152:155], v5, s[36:39], s27 offen offset:0
    buffer_load_dwordx4 v[156:159], v5, s[36:39], s27 offen offset:1024
    buffer_load_dwordx4 v[160:163], v5, s[36:39], s27 offen offset:2048
    buffer_load_dwordx4 v[164:167], v5, s[36:39], s27 offen offset:3072
    s_add_u32 s27, s27, 524288
    buffer_load_dwordx4 v[168:171], v5, s[32:35], s26 offen offset:0
    buffer_load_dwordx4 v[172:175], v5, s[32:35], s26 offen offset:1024
    buffer_load_dwordx4 v[176:179], v5, s[32:35], s26 offen offset:2048
    buffer_load_dwordx4 v[180:183], v5, s[32:35], s26 offen offset:3072
    buffer_load_dwordx4 v[184:187], v6, s[32:35], s26 offen
    s_add_u32 s26, s26, 163840
    buffer_load_dwordx4 v[188:191], v5, s[36:39], s27 offen offset:0
    buffer_load_dwordx4 v[192:195], v5, s[36:39], s27 offen offset:1024
    buffer_load_dwordx4 v[196:199], v5, s[36:39], s27 offen offset:2048
    buffer_load_dwordx4 v[200:203], v5, s[36:39], s27 offen offset:3072
    s_add_u32 s27, s27, 524288
    v_mov_b32 v16, 0
    v_mov_b32 v17, 0
    v_mov_b32 v18, 0
    v_mov_b32 v19, 0
    v_mov_b32 v20, 0
    v_mov_b32 v21, 0
    v_mov_b32 v22, 0
    v_mov_b32 v23, 0
    v_mov_b32 v24, 0
    v_mov_b32 v25, 0
    v_mov_b32 v26, 0
    v_mov_b32 v27, 0
    v_mov_b32 v28, 0
    v_mov_b32 v29, 0
    v_mov_b32 v30, 0
    v_mov_b32 v31, 0
    v_mov_b32 v32, 0
    v_mov_b32 v33, 0
    v_mov_b32 v34, 0
    v_mov_b32 v35, 0
    v_mov_b32 v36, 0
    v_mov_b32 v37, 0
    v_mov_b32 v38, 0
    v_mov_b32 v39, 0
    v_mov_b32 v40, 0
    v_mov_b32 v41, 0
    v_mov_b32 v42, 0
    v_mov_b32 v43, 0
    v_mov_b32 v44, 0
    v_mov_b32 v45, 0
    v_mov_b32 v46, 0
    v_mov_b32 v47, 0
    v_mov_b32 v48, 0
    v_mov_b32 v49, 0
    v_mov_b32 v50, 0
    v_mov_b32 v51, 0
    v_mov_b32 v52, 0
    v_mov_b32 v53, 0
    v_mov_b32 v54, 0
    v_mov_b32 v55, 0
    v_mov_b32 v56, 0
    v_mov_b32 v57, 0
    v_mov_b32 v58, 0
    v_mov_b32 v59, 0
    v_mov_b32 v60, 0
    v_mov_b32 v61, 0
    v_mov_b32 v62, 0
    v_mov_b32 v63, 0
    v_mov_b32 v64, 0
    v_mov_b32 v65, 0
    v_mov_b32 v66, 0
    v_mov_b32 v67, 0
    v_mov_b32 v68, 0
    v_mov_b32 v69, 0
    v_mov_b32 v70, 0
    v_mov_b32 v71, 0
    v_mov_b32 v72, 0
    v_mov_b32 v73, 0
    v_mov_b32 v74, 0
    v_mov_b32 v75, 0
    v_mov_b32 v76, 0
    v_mov_b32 v77, 0
    v_mov_b32 v78, 0
    v_mov_b32 v79, 0
    v_mov_b32 v80, 0
    v_mov_b32 v81, 0
    v_mov_b32 v82, 0
    v_mov_b32 v83, 0
    v_mov_b32 v84, 0
    v_mov_b32 v85, 0
    v_mov_b32 v86, 0
    v_mov_b32 v87, 0
    v_mov_b32 v88, 0
    v_mov_b32 v89, 0
    v_mov_b32 v90, 0
    v_mov_b32 v91, 0
    v_mov_b32 v92, 0
    v_mov_b32 v93, 0
    v_mov_b32 v94, 0
    v_mov_b32 v95, 0
    v_lshrrev_b32 v248, 2, v3
    v_cmp_eq_u32 vcc, v248, v2
    v_and_b32 v248, 1, v3
    v_lshlrev_b32 v248, 4, v248
    v_mov_b32 v249, 0x3f80
    v_lshlrev_b32 v249, v248, v249
    v_cndmask_b32 v249, 0, v249, vcc
    v_and_b32 v248, 2, v3
    v_cmp_eq_u32 vcc, 0, v248
    v_mov_b32 v242, 0
    v_mov_b32 v243, 0
    v_cndmask_b32 v240, 0, v249, vcc
    v_cndmask_b32 v241, v249, 0, vcc
    v_mov_b32 v244, 0
    v_mov_b32 v245, 0
    v_mov_b32 v246, v240
    v_mov_b32 v247, v241
    s_waitcnt vmcnt(18)
    v_mfma_f32_16x16x32_bf16 v[16:19], v[96:99], v[116:119], v[16:19]
    buffer_load_dwordx4 v[204:207], v5, s[32:35], s26 offen offset:0
    v_mfma_f32_16x16x32_bf16 v[20:23], v[96:99], v[120:123], v[20:23]
    buffer_load_dwordx4 v[208:211], v5, s[32:35], s26 offen offset:1024
    v_mfma_f32_16x16x32_bf16 v[24:27], v[96:99], v[124:127], v[24:27]
    buffer_load_dwordx4 v[212:215], v5, s[32:35], s26 offen offset:2048
    v_mfma_f32_16x16x32_bf16 v[28:31], v[96:99], v[128:131], v[28:31]
    buffer_load_dwordx4 v[216:219], v5, s[32:35], s26 offen offset:3072
    v_mfma_f32_16x16x32_bf16 v[32:35], v[100:103], v[116:119], v[32:35]
    buffer_load_dwordx4 v[220:223], v6, s[32:35], s26 offen
    s_add_u32 s26, s26, 163840
    v_mfma_f32_16x16x32_bf16 v[36:39], v[100:103], v[120:123], v[36:39]
    buffer_load_dwordx4 v[224:227], v5, s[36:39], s27 offen offset:0
    v_mfma_f32_16x16x32_bf16 v[40:43], v[100:103], v[124:127], v[40:43]
    buffer_load_dwordx4 v[228:231], v5, s[36:39], s27 offen offset:1024
    v_mfma_f32_16x16x32_bf16 v[44:47], v[100:103], v[128:131], v[44:47]
    buffer_load_dwordx4 v[232:235], v5, s[36:39], s27 offen offset:2048
    v_mfma_f32_16x16x32_bf16 v[48:51], v[104:107], v[116:119], v[48:51]
    buffer_load_dwordx4 v[236:239], v5, s[36:39], s27 offen offset:3072
    s_add_u32 s27, s27, 524288
    v_mfma_f32_16x16x32_bf16 v[52:55], v[104:107], v[120:123], v[52:55]
    v_mfma_f32_16x16x32_bf16 v[56:59], v[104:107], v[124:127], v[56:59]
    v_mfma_f32_16x16x32_bf16 v[60:63], v[104:107], v[128:131], v[60:63]
    v_mfma_f32_16x16x32_bf16 v[64:67], v[108:111], v[116:119], v[64:67]
    v_mfma_f32_16x16x32_bf16 v[68:71], v[108:111], v[120:123], v[68:71]
    v_mfma_f32_16x16x32_bf16 v[72:75], v[108:111], v[124:127], v[72:75]
    v_mfma_f32_16x16x32_bf16 v[76:79], v[108:111], v[128:131], v[76:79]
    v_mfma_f32_16x16x32_bf16 v[80:83], v[112:115], v[116:119], v[80:83]
    v_mfma_f32_16x16x32_bf16 v[84:87], v[112:115], v[120:123], v[84:87]
    v_mfma_f32_16x16x32_bf16 v[88:91], v[112:115], v[124:127], v[88:91]
    v_mfma_f32_16x16x32_bf16 v[92:95], v[112:115], v[128:131], v[92:95]
    s_waitcnt vmcnt(18)
    v_mfma_f32_16x16x32_bf16 v[16:19], v[132:135], v[152:155], v[16:19]
    buffer_load_dwordx4 v[96:99], v5, s[32:35], s26 offen offset:0
    v_mfma_f32_16x16x32_bf16 v[20:23], v[132:135], v[156:159], v[20:23]
    buffer_load_dwordx4 v[100:103], v5, s[32:35], s26 offen offset:1024
    v_mfma_f32_16x16x32_bf16 v[24:27], v[132:135], v[160:163], v[24:27]
    buffer_load_dwordx4 v[104:107], v5, s[32:35], s26 offen offset:2048
    v_mfma_f32_16x16x32_bf16 v[28:31], v[132:135], v[164:167], v[28:31]
    buffer_load_dwordx4 v[108:111], v5, s[32:35], s26 offen offset:3072
    v_mfma_f32_16x16x32_bf16 v[32:35], v[136:139], v[152:155], v[32:35]
    buffer_load_dwordx4 v[112:115], v6, s[32:35], s26 offen
    s_add_u32 s26, s26, 163840
    v_mfma_f32_16x16x32_bf16 v[36:39], v[136:139], v[156:159], v[36:39]
    buffer_load_dwordx4 v[116:119], v5, s[36:39], s27 offen offset:0
    v_mfma_f32_16x16x32_bf16 v[40:43], v[136:139], v[160:163], v[40:43]
    buffer_load_dwordx4 v[120:123], v5, s[36:39], s27 offen offset:1024
    v_mfma_f32_16x16x32_bf16 v[44:47], v[136:139], v[164:167], v[44:47]
    buffer_load_dwordx4 v[124:127], v5, s[36:39], s27 offen offset:2048
    v_mfma_f32_16x16x32_bf16 v[48:51], v[140:143], v[152:155], v[48:51]
    buffer_load_dwordx4 v[128:131], v5, s[36:39], s27 offen offset:3072
    s_add_u32 s27, s27, 524288
    v_mfma_f32_16x16x32_bf16 v[52:55], v[140:143], v[156:159], v[52:55]
    v_mfma_f32_16x16x32_bf16 v[56:59], v[140:143], v[160:163], v[56:59]
    v_mfma_f32_16x16x32_bf16 v[60:63], v[140:143], v[164:167], v[60:63]
    v_mfma_f32_16x16x32_bf16 v[64:67], v[144:147], v[152:155], v[64:67]
    v_mfma_f32_16x16x32_bf16 v[68:71], v[144:147], v[156:159], v[68:71]
    v_mfma_f32_16x16x32_bf16 v[72:75], v[144:147], v[160:163], v[72:75]
    v_mfma_f32_16x16x32_bf16 v[76:79], v[144:147], v[164:167], v[76:79]
    v_mfma_f32_16x16x32_bf16 v[80:83], v[148:151], v[152:155], v[80:83]
    v_mfma_f32_16x16x32_bf16 v[84:87], v[148:151], v[156:159], v[84:87]
    v_mfma_f32_16x16x32_bf16 v[88:91], v[148:151], v[160:163], v[88:91]
    v_mfma_f32_16x16x32_bf16 v[92:95], v[148:151], v[164:167], v[92:95]
    s_waitcnt vmcnt(18)
    v_mfma_f32_16x16x32_bf16 v[16:19], v[168:171], v[188:191], v[16:19]
    buffer_load_dwordx4 v[132:135], v5, s[32:35], s26 offen offset:0
    v_mfma_f32_16x16x32_bf16 v[20:23], v[168:171], v[192:195], v[20:23]
    buffer_load_dwordx4 v[136:139], v5, s[32:35], s26 offen offset:1024
    v_mfma_f32_16x16x32_bf16 v[24:27], v[168:171], v[196:199], v[24:27]
    buffer_load_dwordx4 v[140:143], v5, s[32:35], s26 offen offset:2048
    v_mfma_f32_16x16x32_bf16 v[28:31], v[168:171], v[200:203], v[28:31]
    buffer_load_dwordx4 v[144:147], v5, s[32:35], s26 offen offset:3072
    v_mfma_f32_16x16x32_bf16 v[32:35], v[172:175], v[188:191], v[32:35]
    buffer_load_dwordx4 v[148:151], v6, s[32:35], s26 offen
    s_add_u32 s26, s26, 163840
    v_mfma_f32_16x16x32_bf16 v[36:39], v[172:175], v[192:195], v[36:39]
    buffer_load_dwordx4 v[152:155], v5, s[36:39], s27 offen offset:0
    v_mfma_f32_16x16x32_bf16 v[40:43], v[172:175], v[196:199], v[40:43]
    buffer_load_dwordx4 v[156:159], v5, s[36:39], s27 offen offset:1024
    v_mfma_f32_16x16x32_bf16 v[44:47], v[172:175], v[200:203], v[44:47]
    buffer_load_dwordx4 v[160:163], v5, s[36:39], s27 offen offset:2048
    v_mfma_f32_16x16x32_bf16 v[48:51], v[176:179], v[188:191], v[48:51]
    buffer_load_dwordx4 v[164:167], v5, s[36:39], s27 offen offset:3072
    s_add_u32 s27, s27, 524288
    v_mfma_f32_16x16x32_bf16 v[52:55], v[176:179], v[192:195], v[52:55]
    v_mfma_f32_16x16x32_bf16 v[56:59], v[176:179], v[196:199], v[56:59]
    v_mfma_f32_16x16x32_bf16 v[60:63], v[176:179], v[200:203], v[60:63]
    v_mfma_f32_16x16x32_bf16 v[64:67], v[180:183], v[188:191], v[64:67]
    v_mfma_f32_16x16x32_bf16 v[68:71], v[180:183], v[192:195], v[68:71]
    v_mfma_f32_16x16x32_bf16 v[72:75], v[180:183], v[196:199], v[72:75]
    v_mfma_f32_16x16x32_bf16 v[76:79], v[180:183], v[200:203], v[76:79]
    v_mfma_f32_16x16x32_bf16 v[80:83], v[184:187], v[188:191], v[80:83]
    v_mfma_f32_16x16x32_bf16 v[84:87], v[184:187], v[192:195], v[84:87]
    v_mfma_f32_16x16x32_bf16 v[88:91], v[184:187], v[196:199], v[88:91]
    v_mfma_f32_16x16x32_bf16 v[92:95], v[184:187], v[200:203], v[92:95]
    s_waitcnt vmcnt(18)
    v_mfma_f32_16x16x32_bf16 v[16:19], v[204:207], v[224:227], v[16:19]
    buffer_load_dwordx4 v[168:171], v5, s[32:35], s26 offen offset:0
    v_mfma_f32_16x16x32_bf16 v[20:23], v[204:207], v[228:231], v[20:23]
    buffer_load_dwordx4 v[172:175], v5, s[32:35], s26 offen offset:1024
    v_mfma_f32_16x16x32_bf16 v[24:27], v[204:207], v[232:235], v[24:27]
    buffer_load_dwordx4 v[176:179], v5, s[32:35], s26 offen offset:2048
    v_mfma_f32_16x16x32_bf16 v[28:31], v[204:207], v[236:239], v[28:31]
    buffer_load_dwordx4 v[180:183], v5, s[32:35], s26 offen offset:3072
    v_mfma_f32_16x16x32_bf16 v[32:35], v[208:211], v[224:227], v[32:35]
    buffer_load_dwordx4 v[184:187], v6, s[32:35], s26 offen
    s_add_u32 s26, s26, 163840
    v_mfma_f32_16x16x32_bf16 v[36:39], v[208:211], v[228:231], v[36:39]
    buffer_load_dwordx4 v[188:191], v5, s[36:39], s27 offen offset:0
    v_mfma_f32_16x16x32_bf16 v[40:43], v[208:211], v[232:235], v[40:43]
    buffer_load_dwordx4 v[192:195], v5, s[36:39], s27 offen offset:1024
    v_mfma_f32_16x16x32_bf16 v[44:47], v[208:211], v[236:239], v[44:47]
    buffer_load_dwordx4 v[196:199], v5, s[36:39], s27 offen offset:2048
    v_mfma_f32_16x16x32_bf16 v[48:51], v[212:215], v[224:227], v[48:51]
    buffer_load_dwordx4 v[200:203], v5, s[36:39], s27 offen offset:3072
    s_add_u32 s27, s27, 524288
    v_mfma_f32_16x16x32_bf16 v[52:55], v[212:215], v[228:231], v[52:55]
    v_mfma_f32_16x16x32_bf16 v[56:59], v[212:215], v[232:235], v[56:59]
    v_mfma_f32_16x16x32_bf16 v[60:63], v[212:215], v[236:239], v[60:63]
    v_mfma_f32_16x16x32_bf16 v[64:67], v[216:219], v[224:227], v[64:67]
    v_mfma_f32_16x16x32_bf16 v[68:71], v[216:219], v[228:231], v[68:71]
    v_mfma_f32_16x16x32_bf16 v[72:75], v[216:219], v[232:235], v[72:75]
    v_mfma_f32_16x16x32_bf16 v[76:79], v[216:219], v[236:239], v[76:79]
    v_mfma_f32_16x16x32_bf16 v[80:83], v[220:223], v[224:227], v[80:83]
    v_mfma_f32_16x16x32_bf16 v[84:87], v[220:223], v[228:231], v[84:87]
    v_mfma_f32_16x16x32_bf16 v[88:91], v[220:223], v[232:235], v[88:91]
    v_mfma_f32_16x16x32_bf16 v[92:95], v[220:223], v[236:239], v[92:95]
    s_waitcnt vmcnt(18)
    v_mfma_f32_16x16x32_bf16 v[16:19], v[96:99], v[116:119], v[16:19]
    buffer_load_dwordx4 v[204:207], v5, s[32:35], s26 offen offset:0
    v_mfma_f32_16x16x32_bf16 v[20:23], v[96:99], v[120:123], v[20:23]
    buffer_load_dwordx4 v[208:211], v5, s[32:35], s26 offen offset:1024
    v_mfma_f32_16x16x32_bf16 v[24:27], v[96:99], v[124:127], v[24:27]
    buffer_load_dwordx4 v[212:215], v5, s[32:35], s26 offen offset:2048
    v_mfma_f32_16x16x32_bf16 v[28:31], v[96:99], v[128:131], v[28:31]
    buffer_load_dwordx4 v[216:219], v5, s[32:35], s26 offen offset:3072
    v_mfma_f32_16x16x32_bf16 v[32:35], v[100:103], v[116:119], v[32:35]
    buffer_load_dwordx4 v[220:223], v6, s[32:35], s26 offen
    s_add_u32 s26, s26, 163840
    v_mfma_f32_16x16x32_bf16 v[36:39], v[100:103], v[120:123], v[36:39]
    buffer_load_dwordx4 v[224:227], v5, s[36:39], s27 offen offset:0
    v_mfma_f32_16x16x32_bf16 v[40:43], v[100:103], v[124:127], v[40:43]
    buffer_load_dwordx4 v[228:231], v5, s[36:39], s27 offen offset:1024
    v_mfma_f32_16x16x32_bf16 v[44:47], v[100:103], v[128:131], v[44:47]
    buffer_load_dwordx4 v[232:235], v5, s[36:39], s27 offen offset:2048
    v_mfma_f32_16x16x32_bf16 v[48:51], v[104:107], v[116:119], v[48:51]
    buffer_load_dwordx4 v[236:239], v5, s[36:39], s27 offen offset:3072
    s_add_u32 s27, s27, 524288
    v_mfma_f32_16x16x32_bf16 v[52:55], v[104:107], v[120:123], v[52:55]
    v_mfma_f32_16x16x32_bf16 v[56:59], v[104:107], v[124:127], v[56:59]
    v_mfma_f32_16x16x32_bf16 v[60:63], v[104:107], v[128:131], v[60:63]
    v_mfma_f32_16x16x32_bf16 v[64:67], v[108:111], v[116:119], v[64:67]
    v_mfma_f32_16x16x32_bf16 v[68:71], v[108:111], v[120:123], v[68:71]
    v_mfma_f32_16x16x32_bf16 v[72:75], v[108:111], v[124:127], v[72:75]
    v_mfma_f32_16x16x32_bf16 v[76:79], v[108:111], v[128:131], v[76:79]
    v_mfma_f32_16x16x32_bf16 v[80:83], v[112:115], v[116:119], v[80:83]
    v_mfma_f32_16x16x32_bf16 v[84:87], v[112:115], v[120:123], v[84:87]
    v_mfma_f32_16x16x32_bf16 v[88:91], v[112:115], v[124:127], v[88:91]
    v_mfma_f32_16x16x32_bf16 v[92:95], v[112:115], v[128:131], v[92:95]
    s_waitcnt vmcnt(18)
    v_mfma_f32_16x16x32_bf16 v[16:19], v[132:135], v[152:155], v[16:19]
    buffer_load_dwordx4 v[96:99], v5, s[32:35], s26 offen offset:0
    v_mfma_f32_16x16x32_bf16 v[20:23], v[132:135], v[156:159], v[20:23]
    buffer_load_dwordx4 v[100:103], v5, s[32:35], s26 offen offset:1024
    v_mfma_f32_16x16x32_bf16 v[24:27], v[132:135], v[160:163], v[24:27]
    buffer_load_dwordx4 v[104:107], v5, s[32:35], s26 offen offset:2048
    v_mfma_f32_16x16x32_bf16 v[28:31], v[132:135], v[164:167], v[28:31]
    buffer_load_dwordx4 v[108:111], v5, s[32:35], s26 offen offset:3072
    v_mfma_f32_16x16x32_bf16 v[32:35], v[136:139], v[152:155], v[32:35]
    buffer_load_dwordx4 v[112:115], v6, s[32:35], s26 offen
    s_add_u32 s26, s26, 163840
    v_mfma_f32_16x16x32_bf16 v[36:39], v[136:139], v[156:159], v[36:39]
    buffer_load_dwordx4 v[116:119], v5, s[36:39], s27 offen offset:0
    v_mfma_f32_16x16x32_bf16 v[40:43], v[136:139], v[160:163], v[40:43]
    buffer_load_dwordx4 v[120:123], v5, s[36:39], s27 offen offset:1024
    v_mfma_f32_16x16x32_bf16 v[44:47], v[136:139], v[164:167], v[44:47]
    buffer_load_dwordx4 v[124:127], v5, s[36:39], s27 offen offset:2048
    v_mfma_f32_16x16x32_bf16 v[48:51], v[140:143], v[152:155], v[48:51]
    buffer_load_dwordx4 v[128:131], v5, s[36:39], s27 offen offset:3072
    s_add_u32 s27, s27, 524288
    v_mfma_f32_16x16x32_bf16 v[52:55], v[140:143], v[156:159], v[52:55]
    v_mfma_f32_16x16x32_bf16 v[56:59], v[140:143], v[160:163], v[56:59]
    v_mfma_f32_16x16x32_bf16 v[60:63], v[140:143], v[164:167], v[60:63]
    v_mfma_f32_16x16x32_bf16 v[64:67], v[144:147], v[152:155], v[64:67]
    v_mfma_f32_16x16x32_bf16 v[68:71], v[144:147], v[156:159], v[68:71]
    v_mfma_f32_16x16x32_bf16 v[72:75], v[144:147], v[160:163], v[72:75]
    v_mfma_f32_16x16x32_bf16 v[76:79], v[144:147], v[164:167], v[76:79]
    v_mfma_f32_16x16x32_bf16 v[80:83], v[148:151], v[152:155], v[80:83]
    v_mfma_f32_16x16x32_bf16 v[84:87], v[148:151], v[156:159], v[84:87]
    v_mfma_f32_16x16x32_bf16 v[88:91], v[148:151], v[160:163], v[88:91]
    v_mfma_f32_16x16x32_bf16 v[92:95], v[148:151], v[164:167], v[92:95]
    s_waitcnt vmcnt(18)
    v_mfma_f32_16x16x32_bf16 v[16:19], v[168:171], v[188:191], v[16:19]
    buffer_load_dwordx4 v[132:135], v5, s[32:35], s26 offen offset:0
    v_mfma_f32_16x16x32_bf16 v[20:23], v[168:171], v[192:195], v[20:23]
    buffer_load_dwordx4 v[136:139], v5, s[32:35], s26 offen offset:1024
    v_mfma_f32_16x16x32_bf16 v[24:27], v[168:171], v[196:199], v[24:27]
    buffer_load_dwordx4 v[140:143], v5, s[32:35], s26 offen offset:2048
    v_mfma_f32_16x16x32_bf16 v[28:31], v[168:171], v[200:203], v[28:31]
    buffer_load_dwordx4 v[144:147], v5, s[32:35], s26 offen offset:3072
    v_mfma_f32_16x16x32_bf16 v[32:35], v[172:175], v[188:191], v[32:35]
    buffer_load_dwordx4 v[148:151], v6, s[32:35], s26 offen
    s_add_u32 s26, s26, 163840
    v_mfma_f32_16x16x32_bf16 v[36:39], v[172:175], v[192:195], v[36:39]
    buffer_load_dwordx4 v[152:155], v5, s[36:39], s27 offen offset:0
    v_mfma_f32_16x16x32_bf16 v[40:43], v[172:175], v[196:199], v[40:43]
    buffer_load_dwordx4 v[156:159], v5, s[36:39], s27 offen offset:1024
    v_mfma_f32_16x16x32_bf16 v[44:47], v[172:175], v[200:203], v[44:47]
    buffer_load_dwordx4 v[160:163], v5, s[36:39], s27 offen offset:2048
    v_mfma_f32_16x16x32_bf16 v[48:51], v[176:179], v[188:191], v[48:51]
    buffer_load_dwordx4 v[164:167], v5, s[36:39], s27 offen offset:3072
    s_add_u32 s27, s27, 524288
    v_mfma_f32_16x16x32_bf16 v[52:55], v[176:179], v[192:195], v[52:55]
    v_mfma_f32_16x16x32_bf16 v[56:59], v[176:179], v[196:199], v[56:59]
    v_mfma_f32_16x16x32_bf16 v[60:63], v[176:179], v[200:203], v[60:63]
    v_mfma_f32_16x16x32_bf16 v[64:67], v[180:183], v[188:191], v[64:67]
    v_mfma_f32_16x16x32_bf16 v[68:71], v[180:183], v[192:195], v[68:71]
    v_mfma_f32_16x16x32_bf16 v[72:75], v[180:183], v[196:199], v[72:75]
    v_mfma_f32_16x16x32_bf16 v[76:79], v[180:183], v[200:203], v[76:79]
    v_mfma_f32_16x16x32_bf16 v[80:83], v[184:187], v[188:191], v[80:83]
    v_mfma_f32_16x16x32_bf16 v[84:87], v[184:187], v[192:195], v[84:87]
    v_mfma_f32_16x16x32_bf16 v[88:91], v[184:187], v[196:199], v[88:91]
    v_mfma_f32_16x16x32_bf16 v[92:95], v[184:187], v[200:203], v[92:95]
    s_waitcnt vmcnt(18)
    v_mfma_f32_16x16x32_bf16 v[16:19], v[204:207], v[224:227], v[16:19]
    buffer_load_dwordx4 v[168:171], v5, s[32:35], s26 offen offset:0
    v_mfma_f32_16x16x32_bf16 v[20:23], v[204:207], v[228:231], v[20:23]
    buffer_load_dwordx4 v[172:175], v5, s[32:35], s26 offen offset:1024
    v_mfma_f32_16x16x32_bf16 v[24:27], v[204:207], v[232:235], v[24:27]
    buffer_load_dwordx4 v[176:179], v5, s[32:35], s26 offen offset:2048
    v_mfma_f32_16x16x32_bf16 v[28:31], v[204:207], v[236:239], v[28:31]
    buffer_load_dwordx4 v[180:183], v5, s[32:35], s26 offen offset:3072
    v_mfma_f32_16x16x32_bf16 v[32:35], v[208:211], v[224:227], v[32:35]
    buffer_load_dwordx4 v[184:187], v6, s[32:35], s26 offen
    s_add_u32 s26, s26, 163840
    v_mfma_f32_16x16x32_bf16 v[36:39], v[208:211], v[228:231], v[36:39]
    buffer_load_dwordx4 v[188:191], v5, s[36:39], s27 offen offset:0
    v_mfma_f32_16x16x32_bf16 v[40:43], v[208:211], v[232:235], v[40:43]
    buffer_load_dwordx4 v[192:195], v5, s[36:39], s27 offen offset:1024
    v_mfma_f32_16x16x32_bf16 v[44:47], v[208:211], v[236:239], v[44:47]
    buffer_load_dwordx4 v[196:199], v5, s[36:39], s27 offen offset:2048
    v_mfma_f32_16x16x32_bf16 v[48:51], v[212:215], v[224:227], v[48:51]
    buffer_load_dwordx4 v[200:203], v5, s[36:39], s27 offen offset:3072
    s_add_u32 s27, s27, 524288
    v_mfma_f32_16x16x32_bf16 v[52:55], v[212:215], v[228:231], v[52:55]
    v_mfma_f32_16x16x32_bf16 v[56:59], v[212:215], v[232:235], v[56:59]
    v_mfma_f32_16x16x32_bf16 v[60:63], v[212:215], v[236:239], v[60:63]
    v_mfma_f32_16x16x32_bf16 v[64:67], v[216:219], v[224:227], v[64:67]
    v_mfma_f32_16x16x32_bf16 v[68:71], v[216:219], v[228:231], v[68:71]
    v_mfma_f32_16x16x32_bf16 v[72:75], v[216:219], v[232:235], v[72:75]
    v_mfma_f32_16x16x32_bf16 v[76:79], v[216:219], v[236:239], v[76:79]
    v_mfma_f32_16x16x32_bf16 v[80:83], v[220:223], v[224:227], v[80:83]
    v_mfma_f32_16x16x32_bf16 v[84:87], v[220:223], v[228:231], v[84:87]
    v_mfma_f32_16x16x32_bf16 v[88:91], v[220:223], v[232:235], v[88:91]
    v_mfma_f32_16x16x32_bf16 v[92:95], v[220:223], v[236:239], v[92:95]
    s_waitcnt vmcnt(18)
    v_mfma_f32_16x16x32_bf16 v[16:19], v[96:99], v[116:119], v[16:19]
    buffer_load_dwordx4 v[204:207], v5, s[32:35], s26 offen offset:0
    v_mfma_f32_16x16x32_bf16 v[20:23], v[96:99], v[120:123], v[20:23]
    buffer_load_dwordx4 v[208:211], v5, s[32:35], s26 offen offset:1024
    v_mfma_f32_16x16x32_bf16 v[24:27], v[96:99], v[124:127], v[24:27]
    buffer_load_dwordx4 v[212:215], v5, s[32:35], s26 offen offset:2048
    v_mfma_f32_16x16x32_bf16 v[28:31], v[96:99], v[128:131], v[28:31]
    buffer_load_dwordx4 v[216:219], v5, s[32:35], s26 offen offset:3072
    v_mfma_f32_16x16x32_bf16 v[32:35], v[100:103], v[116:119], v[32:35]
    buffer_load_dwordx4 v[220:223], v6, s[32:35], s26 offen
    s_add_u32 s26, s26, 163840
    v_mfma_f32_16x16x32_bf16 v[36:39], v[100:103], v[120:123], v[36:39]
    buffer_load_dwordx4 v[224:227], v5, s[36:39], s27 offen offset:0
    v_mfma_f32_16x16x32_bf16 v[40:43], v[100:103], v[124:127], v[40:43]
    buffer_load_dwordx4 v[228:231], v5, s[36:39], s27 offen offset:1024
    v_mfma_f32_16x16x32_bf16 v[44:47], v[100:103], v[128:131], v[44:47]
    buffer_load_dwordx4 v[232:235], v5, s[36:39], s27 offen offset:2048
    v_mfma_f32_16x16x32_bf16 v[48:51], v[104:107], v[116:119], v[48:51]
    buffer_load_dwordx4 v[236:239], v5, s[36:39], s27 offen offset:3072
    s_add_u32 s27, s27, 524288
    v_mfma_f32_16x16x32_bf16 v[52:55], v[104:107], v[120:123], v[52:55]
    v_mfma_f32_16x16x32_bf16 v[56:59], v[104:107], v[124:127], v[56:59]
    v_mfma_f32_16x16x32_bf16 v[60:63], v[104:107], v[128:131], v[60:63]
    v_mfma_f32_16x16x32_bf16 v[64:67], v[108:111], v[116:119], v[64:67]
    v_mfma_f32_16x16x32_bf16 v[68:71], v[108:111], v[120:123], v[68:71]
    v_mfma_f32_16x16x32_bf16 v[72:75], v[108:111], v[124:127], v[72:75]
    v_mfma_f32_16x16x32_bf16 v[76:79], v[108:111], v[128:131], v[76:79]
    v_mfma_f32_16x16x32_bf16 v[80:83], v[112:115], v[116:119], v[80:83]
    v_mfma_f32_16x16x32_bf16 v[84:87], v[112:115], v[120:123], v[84:87]
    v_mfma_f32_16x16x32_bf16 v[88:91], v[112:115], v[124:127], v[88:91]
    v_mfma_f32_16x16x32_bf16 v[92:95], v[112:115], v[128:131], v[92:95]
    s_waitcnt vmcnt(18)
    v_mfma_f32_16x16x32_bf16 v[16:19], v[132:135], v[152:155], v[16:19]
    buffer_load_dwordx4 v[96:99], v5, s[32:35], s26 offen offset:0
    v_mfma_f32_16x16x32_bf16 v[20:23], v[132:135], v[156:159], v[20:23]
    buffer_load_dwordx4 v[100:103], v5, s[32:35], s26 offen offset:1024
    v_mfma_f32_16x16x32_bf16 v[24:27], v[132:135], v[160:163], v[24:27]
    buffer_load_dwordx4 v[104:107], v5, s[32:35], s26 offen offset:2048
    v_mfma_f32_16x16x32_bf16 v[28:31], v[132:135], v[164:167], v[28:31]
    buffer_load_dwordx4 v[108:111], v5, s[32:35], s26 offen offset:3072
    v_mfma_f32_16x16x32_bf16 v[32:35], v[136:139], v[152:155], v[32:35]
    buffer_load_dwordx4 v[112:115], v6, s[32:35], s26 offen
    s_add_u32 s26, s26, 163840
    v_mfma_f32_16x16x32_bf16 v[36:39], v[136:139], v[156:159], v[36:39]
    buffer_load_dwordx4 v[116:119], v5, s[36:39], s27 offen offset:0
    v_mfma_f32_16x16x32_bf16 v[40:43], v[136:139], v[160:163], v[40:43]
    buffer_load_dwordx4 v[120:123], v5, s[36:39], s27 offen offset:1024
    v_mfma_f32_16x16x32_bf16 v[44:47], v[136:139], v[164:167], v[44:47]
    buffer_load_dwordx4 v[124:127], v5, s[36:39], s27 offen offset:2048
    v_mfma_f32_16x16x32_bf16 v[48:51], v[140:143], v[152:155], v[48:51]
    buffer_load_dwordx4 v[128:131], v5, s[36:39], s27 offen offset:3072
    s_add_u32 s27, s27, 524288
    v_mfma_f32_16x16x32_bf16 v[52:55], v[140:143], v[156:159], v[52:55]
    v_mfma_f32_16x16x32_bf16 v[56:59], v[140:143], v[160:163], v[56:59]
    v_mfma_f32_16x16x32_bf16 v[60:63], v[140:143], v[164:167], v[60:63]
    v_mfma_f32_16x16x32_bf16 v[64:67], v[144:147], v[152:155], v[64:67]
    v_mfma_f32_16x16x32_bf16 v[68:71], v[144:147], v[156:159], v[68:71]
    v_mfma_f32_16x16x32_bf16 v[72:75], v[144:147], v[160:163], v[72:75]
    v_mfma_f32_16x16x32_bf16 v[76:79], v[144:147], v[164:167], v[76:79]
    v_mfma_f32_16x16x32_bf16 v[80:83], v[148:151], v[152:155], v[80:83]
    v_mfma_f32_16x16x32_bf16 v[84:87], v[148:151], v[156:159], v[84:87]
    v_mfma_f32_16x16x32_bf16 v[88:91], v[148:151], v[160:163], v[88:91]
    v_mfma_f32_16x16x32_bf16 v[92:95], v[148:151], v[164:167], v[92:95]
    s_waitcnt vmcnt(18)
    v_mfma_f32_16x16x32_bf16 v[16:19], v[168:171], v[188:191], v[16:19]
    s_cmp_ge_u32 s3, 2
    s_cselect_b32 s26, s29, s26
    buffer_load_dwordx4 v[132:135], v5, s[52:55], s26 offen offset:0
    v_mfma_f32_16x16x32_bf16 v[20:23], v[168:171], v[192:195], v[20:23]
    buffer_load_dwordx4 v[136:139], v5, s[52:55], s26 offen offset:1024
    v_mfma_f32_16x16x32_bf16 v[24:27], v[168:171], v[196:199], v[24:27]
    buffer_load_dwordx4 v[140:143], v5, s[52:55], s26 offen offset:2048
    v_mfma_f32_16x16x32_bf16 v[28:31], v[168:171], v[200:203], v[28:31]
    buffer_load_dwordx4 v[144:147], v5, s[52:55], s26 offen offset:3072
    v_mfma_f32_16x16x32_bf16 v[32:35], v[172:175], v[188:191], v[32:35]
    buffer_load_dwordx4 v[148:151], v6, s[52:55], s26 offen
    s_add_u32 s26, s26, 163840
    v_mfma_f32_16x16x32_bf16 v[36:39], v[172:175], v[192:195], v[36:39]
    buffer_load_dwordx4 v[152:155], v5, s[36:39], s27 offen offset:0
    v_mfma_f32_16x16x32_bf16 v[40:43], v[172:175], v[196:199], v[40:43]
    buffer_load_dwordx4 v[156:159], v5, s[36:39], s27 offen offset:1024
    v_mfma_f32_16x16x32_bf16 v[44:47], v[172:175], v[200:203], v[44:47]
    buffer_load_dwordx4 v[160:163], v5, s[36:39], s27 offen offset:2048
    v_mfma_f32_16x16x32_bf16 v[48:51], v[176:179], v[188:191], v[48:51]
    buffer_load_dwordx4 v[164:167], v5, s[36:39], s27 offen offset:3072
    s_add_u32 s27, s27, 524288
    v_mfma_f32_16x16x32_bf16 v[52:55], v[176:179], v[192:195], v[52:55]
    v_mfma_f32_16x16x32_bf16 v[56:59], v[176:179], v[196:199], v[56:59]
    v_mfma_f32_16x16x32_bf16 v[60:63], v[176:179], v[200:203], v[60:63]
    v_mfma_f32_16x16x32_bf16 v[64:67], v[180:183], v[188:191], v[64:67]
    v_mfma_f32_16x16x32_bf16 v[68:71], v[180:183], v[192:195], v[68:71]
    v_mfma_f32_16x16x32_bf16 v[72:75], v[180:183], v[196:199], v[72:75]
    v_mfma_f32_16x16x32_bf16 v[76:79], v[180:183], v[200:203], v[76:79]
    v_mfma_f32_16x16x32_bf16 v[80:83], v[184:187], v[188:191], v[80:83]
    v_mfma_f32_16x16x32_bf16 v[84:87], v[184:187], v[192:195], v[84:87]
    v_mfma_f32_16x16x32_bf16 v[88:91], v[184:187], v[196:199], v[88:91]
    v_mfma_f32_16x16x32_bf16 v[92:95], v[184:187], v[200:203], v[92:95]
    s_waitcnt vmcnt(18)
    v_mfma_f32_16x16x32_bf16 v[16:19], v[204:207], v[224:227], v[16:19]
    v_mfma_f32_16x16x32_bf16 v[20:23], v[204:207], v[228:231], v[20:23]
    v_mfma_f32_16x16x32_bf16 v[24:27], v[204:207], v[232:235], v[24:27]
    v_mfma_f32_16x16x32_bf16 v[28:31], v[204:207], v[236:239], v[28:31]
    v_mfma_f32_16x16x32_bf16 v[32:35], v[208:211], v[224:227], v[32:35]
    v_mfma_f32_16x16x32_bf16 v[36:39], v[208:211], v[228:231], v[36:39]
    v_mfma_f32_16x16x32_bf16 v[40:43], v[208:211], v[232:235], v[40:43]
    v_mfma_f32_16x16x32_bf16 v[44:47], v[208:211], v[236:239], v[44:47]
    v_mfma_f32_16x16x32_bf16 v[48:51], v[212:215], v[224:227], v[48:51]
    v_mfma_f32_16x16x32_bf16 v[52:55], v[212:215], v[228:231], v[52:55]
    v_mfma_f32_16x16x32_bf16 v[56:59], v[212:215], v[232:235], v[56:59]
    v_mfma_f32_16x16x32_bf16 v[60:63], v[212:215], v[236:239], v[60:63]
    v_mfma_f32_16x16x32_bf16 v[64:67], v[216:219], v[224:227], v[64:67]
    v_mfma_f32_16x16x32_bf16 v[68:71], v[216:219], v[228:231], v[68:71]
    v_mfma_f32_16x16x32_bf16 v[72:75], v[216:219], v[232:235], v[72:75]
    v_mfma_f32_16x16x32_bf16 v[76:79], v[216:219], v[236:239], v[76:79]
    v_mfma_f32_16x16x32_bf16 v[80:83], v[220:223], v[224:227], v[80:83]
    v_mfma_f32_16x16x32_bf16 v[84:87], v[220:223], v[228:231], v[84:87]
    v_mfma_f32_16x16x32_bf16 v[88:91], v[220:223], v[232:235], v[88:91]
    v_mfma_f32_16x16x32_bf16 v[92:95], v[220:223], v[236:239], v[92:95]
    s_waitcnt vmcnt(9)
    v_mfma_f32_16x16x32_bf16 v[16:19], v[96:99], v[116:119], v[16:19]
    v_mfma_f32_16x16x32_bf16 v[20:23], v[96:99], v[120:123], v[20:23]
    v_mfma_f32_16x16x32_bf16 v[24:27], v[96:99], v[124:127], v[24:27]
    v_mfma_f32_16x16x32_bf16 v[28:31], v[96:99], v[128:131], v[28:31]
    v_mfma_f32_16x16x32_bf16 v[32:35], v[100:103], v[116:119], v[32:35]
    v_mfma_f32_16x16x32_bf16 v[36:39], v[100:103], v[120:123], v[36:39]
    v_mfma_f32_16x16x32_bf16 v[40:43], v[100:103], v[124:127], v[40:43]
    v_mfma_f32_16x16x32_bf16 v[44:47], v[100:103], v[128:131], v[44:47]
    v_mfma_f32_16x16x32_bf16 v[48:51], v[104:107], v[116:119], v[48:51]
    v_mfma_f32_16x16x32_bf16 v[52:55], v[104:107], v[120:123], v[52:55]
    v_mfma_f32_16x16x32_bf16 v[56:59], v[104:107], v[124:127], v[56:59]
    v_mfma_f32_16x16x32_bf16 v[60:63], v[104:107], v[128:131], v[60:63]
    v_mfma_f32_16x16x32_bf16 v[64:67], v[108:111], v[116:119], v[64:67]
    v_mfma_f32_16x16x32_bf16 v[68:71], v[108:111], v[120:123], v[68:71]
    v_mfma_f32_16x16x32_bf16 v[72:75], v[108:111], v[124:127], v[72:75]
    v_mfma_f32_16x16x32_bf16 v[76:79], v[108:111], v[128:131], v[76:79]
    v_mfma_f32_16x16x32_bf16 v[80:83], v[112:115], v[116:119], v[80:83]
    v_mfma_f32_16x16x32_bf16 v[84:87], v[112:115], v[120:123], v[84:87]
    v_mfma_f32_16x16x32_bf16 v[88:91], v[112:115], v[124:127], v[88:91]
    v_mfma_f32_16x16x32_bf16 v[92:95], v[112:115], v[128:131], v[92:95]
    s_waitcnt vmcnt(0)
    s_cmp_lg_u32 s3, 2
    s_cbranch_scc1 mlpb0_kernel_sk1
    v_mov_b32 v152, v240
    v_mov_b32 v153, v241
    v_mov_b32 v154, v242
    v_mov_b32 v155, v243
    v_mov_b32 v156, v244
    v_mov_b32 v157, v245
    v_mov_b32 v158, v246
    v_mov_b32 v159, v247
    s_nop 1
mlpb0_kernel_sk1:
    s_cmp_lg_u32 s3, 3
    s_cbranch_scc1 mlpb0_kernel_sk2
    v_mov_b32 v160, v240
    v_mov_b32 v161, v241
    v_mov_b32 v162, v242
    v_mov_b32 v163, v243
    v_mov_b32 v164, v244
    v_mov_b32 v165, v245
    v_mov_b32 v166, v246
    v_mov_b32 v167, v247
    s_nop 1
mlpb0_kernel_sk2:
    v_mfma_f32_16x16x32_bf16 v[16:19], v[132:135], v[152:155], v[16:19]
    v_mfma_f32_16x16x32_bf16 v[20:23], v[132:135], v[156:159], v[20:23]
    v_mfma_f32_16x16x32_bf16 v[24:27], v[132:135], v[160:163], v[24:27]
    v_mfma_f32_16x16x32_bf16 v[28:31], v[132:135], v[164:167], v[28:31]
    v_mfma_f32_16x16x32_bf16 v[32:35], v[136:139], v[152:155], v[32:35]
    v_mfma_f32_16x16x32_bf16 v[36:39], v[136:139], v[156:159], v[36:39]
    v_mfma_f32_16x16x32_bf16 v[40:43], v[136:139], v[160:163], v[40:43]
    v_mfma_f32_16x16x32_bf16 v[44:47], v[136:139], v[164:167], v[44:47]
    v_mfma_f32_16x16x32_bf16 v[48:51], v[140:143], v[152:155], v[48:51]
    v_mfma_f32_16x16x32_bf16 v[52:55], v[140:143], v[156:159], v[52:55]
    v_mfma_f32_16x16x32_bf16 v[56:59], v[140:143], v[160:163], v[56:59]
    v_mfma_f32_16x16x32_bf16 v[60:63], v[140:143], v[164:167], v[60:63]
    v_mfma_f32_16x16x32_bf16 v[64:67], v[144:147], v[152:155], v[64:67]
    v_mfma_f32_16x16x32_bf16 v[68:71], v[144:147], v[156:159], v[68:71]
    v_mfma_f32_16x16x32_bf16 v[72:75], v[144:147], v[160:163], v[72:75]
    v_mfma_f32_16x16x32_bf16 v[76:79], v[144:147], v[164:167], v[76:79]
    v_mfma_f32_16x16x32_bf16 v[80:83], v[148:151], v[152:155], v[80:83]
    v_mfma_f32_16x16x32_bf16 v[84:87], v[148:151], v[156:159], v[84:87]
    v_mfma_f32_16x16x32_bf16 v[88:91], v[148:151], v[160:163], v[88:91]
    v_mfma_f32_16x16x32_bf16 v[92:95], v[148:151], v[164:167], v[92:95]
    v_add_u32 v9, s20, v3
    v_lshlrev_b32 v9, 1, v9
    buffer_load_ushort v96, v9, s[40:43], 0 offen
    s_mul_i32 s28, s3, 20480
    v_add_u32 v14, s28, v5
    s_nop 7
    s_cmp_eq_u32 s3, 0
    s_cbranch_scc1 mlpb0_kernel_own3
    ds_write_b128 v14, v[16:19] offset:0
    ds_write_b128 v14, v[32:35] offset:1024
    ds_write_b128 v14, v[48:51] offset:2048
    ds_write_b128 v14, v[64:67] offset:3072
    ds_write_b128 v14, v[80:83] offset:4096
    s_branch mlpb0_kernel_own3_d
mlpb0_kernel_own3:
    v_mov_b32 v104, v16
    v_mov_b32 v105, v17
    v_mov_b32 v106, v18
    v_mov_b32 v107, v19
    v_mov_b32 v108, v32
    v_mov_b32 v109, v33
    v_mov_b32 v110, v34
    v_mov_b32 v111, v35
    v_mov_b32 v112, v48
    v_mov_b32 v113, v49
    v_mov_b32 v114, v50
    v_mov_b32 v115, v51
    v_mov_b32 v116, v64
    v_mov_b32 v117, v65
    v_mov_b32 v118, v66
    v_mov_b32 v119, v67
    v_mov_b32 v120, v80
    v_mov_b32 v121, v81
    v_mov_b32 v122, v82
    v_mov_b32 v123, v83
mlpb0_kernel_own3_d:
    s_cmp_eq_u32 s3, 1
    s_cbranch_scc1 mlpb0_kernel_own4
    ds_write_b128 v14, v[20:23] offset:5120
    ds_write_b128 v14, v[36:39] offset:6144
    ds_write_b128 v14, v[52:55] offset:7168
    ds_write_b128 v14, v[68:71] offset:8192
    ds_write_b128 v14, v[84:87] offset:9216
    s_branch mlpb0_kernel_own4_d
mlpb0_kernel_own4:
    v_mov_b32 v104, v20
    v_mov_b32 v105, v21
    v_mov_b32 v106, v22
    v_mov_b32 v107, v23
    v_mov_b32 v108, v36
    v_mov_b32 v109, v37
    v_mov_b32 v110, v38
    v_mov_b32 v111, v39
    v_mov_b32 v112, v52
    v_mov_b32 v113, v53
    v_mov_b32 v114, v54
    v_mov_b32 v115, v55
    v_mov_b32 v116, v68
    v_mov_b32 v117, v69
    v_mov_b32 v118, v70
    v_mov_b32 v119, v71
    v_mov_b32 v120, v84
    v_mov_b32 v121, v85
    v_mov_b32 v122, v86
    v_mov_b32 v123, v87
mlpb0_kernel_own4_d:
    s_cmp_eq_u32 s3, 2
    s_cbranch_scc1 mlpb0_kernel_own5
    ds_write_b128 v14, v[24:27] offset:10240
    ds_write_b128 v14, v[40:43] offset:11264
    ds_write_b128 v14, v[56:59] offset:12288
    ds_write_b128 v14, v[72:75] offset:13312
    ds_write_b128 v14, v[88:91] offset:14336
    s_branch mlpb0_kernel_own5_d
mlpb0_kernel_own5:
    v_mov_b32 v104, v24
    v_mov_b32 v105, v25
    v_mov_b32 v106, v26
    v_mov_b32 v107, v27
    v_mov_b32 v108, v40
    v_mov_b32 v109, v41
    v_mov_b32 v110, v42
    v_mov_b32 v111, v43
    v_mov_b32 v112, v56
    v_mov_b32 v113, v57
    v_mov_b32 v114, v58
    v_mov_b32 v115, v59
    v_mov_b32 v116, v72
    v_mov_b32 v117, v73
    v_mov_b32 v118, v74
    v_mov_b32 v119, v75
    v_mov_b32 v120, v88
    v_mov_b32 v121, v89
    v_mov_b32 v122, v90
    v_mov_b32 v123, v91
mlpb0_kernel_own5_d:
    s_cmp_eq_u32 s3, 3
    s_cbranch_scc1 mlpb0_kernel_own6
    ds_write_b128 v14, v[28:31] offset:15360
    ds_write_b128 v14, v[44:47] offset:16384
    ds_write_b128 v14, v[60:63] offset:17408
    ds_write_b128 v14, v[76:79] offset:18432
    ds_write_b128 v14, v[92:95] offset:19456
    s_branch mlpb0_kernel_own6_d
mlpb0_kernel_own6:
    v_mov_b32 v104, v28
    v_mov_b32 v105, v29
    v_mov_b32 v106, v30
    v_mov_b32 v107, v31
    v_mov_b32 v108, v44
    v_mov_b32 v109, v45
    v_mov_b32 v110, v46
    v_mov_b32 v111, v47
    v_mov_b32 v112, v60
    v_mov_b32 v113, v61
    v_mov_b32 v114, v62
    v_mov_b32 v115, v63
    v_mov_b32 v116, v76
    v_mov_b32 v117, v77
    v_mov_b32 v118, v78
    v_mov_b32 v119, v79
    v_mov_b32 v120, v92
    v_mov_b32 v121, v93
    v_mov_b32 v122, v94
    v_mov_b32 v123, v95
mlpb0_kernel_own6_d:
    s_mul_i32 s29, s3, 5120
    s_add_u32 s28, s3, 1
    s_and_b32 s28, s28, 3
    s_mul_i32 s28, s28, 20480
    s_add_u32 s28, s28, s29
    v_add_u32 v13, s28, v5
    s_add_u32 s28, s3, 2
    s_and_b32 s28, s28, 3
    s_mul_i32 s28, s28, 20480
    s_add_u32 s28, s28, s29
    v_add_u32 v14, s28, v5
    s_add_u32 s28, s3, 3
    s_and_b32 s28, s28, 3
    s_mul_i32 s28, s28, 20480
    s_add_u32 s28, s28, s29
    v_add_u32 v15, s28, v5
    s_waitcnt lgkmcnt(0)
    s_barrier
    ds_read_b128 v[16:19], v13 offset:0
    ds_read_b128 v[20:23], v13 offset:1024
    ds_read_b128 v[24:27], v13 offset:2048
    ds_read_b128 v[28:31], v13 offset:3072
    ds_read_b128 v[32:35], v13 offset:4096
    ds_read_b128 v[36:39], v14 offset:0
    ds_read_b128 v[40:43], v14 offset:1024
    ds_read_b128 v[44:47], v14 offset:2048
    ds_read_b128 v[48:51], v14 offset:3072
    ds_read_b128 v[52:55], v14 offset:4096
    ds_read_b128 v[56:59], v15 offset:0
    ds_read_b128 v[60:63], v15 offset:1024
    ds_read_b128 v[64:67], v15 offset:2048
    ds_read_b128 v[68:71], v15 offset:3072
    ds_read_b128 v[72:75], v15 offset:4096
    s_waitcnt lgkmcnt(5)
    v_add_f32 v16, v16, v36
    v_add_f32 v17, v17, v37
    v_add_f32 v18, v18, v38
    v_add_f32 v19, v19, v39
    v_add_f32 v20, v20, v40
    v_add_f32 v21, v21, v41
    v_add_f32 v22, v22, v42
    v_add_f32 v23, v23, v43
    v_add_f32 v24, v24, v44
    v_add_f32 v25, v25, v45
    v_add_f32 v26, v26, v46
    v_add_f32 v27, v27, v47
    v_add_f32 v28, v28, v48
    v_add_f32 v29, v29, v49
    v_add_f32 v30, v30, v50
    v_add_f32 v31, v31, v51
    v_add_f32 v32, v32, v52
    v_add_f32 v33, v33, v53
    v_add_f32 v34, v34, v54
    v_add_f32 v35, v35, v55
    s_waitcnt lgkmcnt(0)
    v_add_f32 v104, v104, v56
    v_add_f32 v105, v105, v57
    v_add_f32 v106, v106, v58
    v_add_f32 v107, v107, v59
    v_add_f32 v108, v108, v60
    v_add_f32 v109, v109, v61
    v_add_f32 v110, v110, v62
    v_add_f32 v111, v111, v63
    v_add_f32 v112, v112, v64
    v_add_f32 v113, v113, v65
    v_add_f32 v114, v114, v66
    v_add_f32 v115, v115, v67
    v_add_f32 v116, v116, v68
    v_add_f32 v117, v117, v69
    v_add_f32 v118, v118, v70
    v_add_f32 v119, v119, v71
    v_add_f32 v120, v120, v72
    v_add_f32 v121, v121, v73
    v_add_f32 v122, v122, v74
    v_add_f32 v123, v123, v75
    v_add_f32 v104, v104, v16
    v_add_f32 v105, v105, v17
    v_add_f32 v106, v106, v18
    v_add_f32 v107, v107, v19
    v_add_f32 v108, v108, v20
    v_add_f32 v109, v109, v21
    v_add_f32 v110, v110, v22
    v_add_f32 v111, v111, v23
    v_add_f32 v112, v112, v24
    v_add_f32 v113, v113, v25
    v_add_f32 v114, v114, v26
    v_add_f32 v115, v115, v27
    v_add_f32 v116, v116, v28
    v_add_f32 v117, v117, v29
    v_add_f32 v118, v118, v30
    v_add_f32 v119, v119, v31
    v_add_f32 v120, v120, v32
    v_add_f32 v121, v121, v33
    v_add_f32 v122, v122, v34
    v_add_f32 v123, v123, v35
    s_waitcnt vmcnt(0)
    v_lshlrev_b32 v96, 16, v96
    v_add_f32 v104, v104, v96
    v_add_f32 v105, v105, v96
    v_add_f32 v106, v106, v96
    v_add_f32 v107, v107, v96
    v_cvt_pk_bf16_f32 v136, v104, v105
    v_cvt_pk_bf16_f32 v137, v106, v107
    v_add_f32 v108, v108, v96
    v_add_f32 v109, v109, v96
    v_add_f32 v110, v110, v96
    v_add_f32 v111, v111, v96
    v_cvt_pk_bf16_f32 v138, v108, v109
    v_cvt_pk_bf16_f32 v139, v110, v111
    v_add_f32 v112, v112, v96
    v_add_f32 v113, v113, v96
    v_add_f32 v114, v114, v96
    v_add_f32 v115, v115, v96
    v_cvt_pk_bf16_f32 v140, v112, v113
    v_cvt_pk_bf16_f32 v141, v114, v115
    v_add_f32 v116, v116, v96
    v_add_f32 v117, v117, v96
    v_add_f32 v118, v118, v96
    v_add_f32 v119, v119, v96
    v_cvt_pk_bf16_f32 v142, v116, v117
    v_cvt_pk_bf16_f32 v143, v118, v119
    v_add_f32 v120, v120, v96
    v_add_f32 v121, v121, v96
    v_add_f32 v122, v122, v96
    v_add_f32 v123, v123, v96
    v_cvt_pk_bf16_f32 v144, v120, v121
    v_cvt_pk_bf16_f32 v145, v122, v123
    s_cmp_eq_u32 s25, 1
    s_cbranch_scc1 mlpb0_kernel_odd7
    buffer_store_dwordx4 v[136:139], v5, s[48:51], s24 offen
    buffer_store_dwordx4 v[140:143], v5, s[48:51], s24 offen offset:1024
    buffer_store_dwordx2 v[144:145], v5, s[48:51], s24 offen offset:2048
    s_branch mlpb0_kernel_done8
mlpb0_kernel_odd7:
    buffer_store_dwordx2 v[136:137], v5, s[48:51], s24 offen offset:8
    buffer_store_dwordx4 v[138:141], v5, s[48:51], s24 offen offset:1024
    buffer_store_dwordx4 v[142:145], v5, s[48:51], s24 offen offset:2048
mlpb0_kernel_done8:
mlpb0_kernel_end:
    s_endpgm

.globl qkv1_kernel
.p2align 8
.type qkv1_kernel,@function
qkv1_kernel:
    s_cmp_ge_u32 s2, 256
    s_cbranch_scc1 qkv1_kernel_end
    s_load_dwordx2 s[4:5], s[0:1], 96
    s_load_dwordx2 s[6:7], s[0:1], 0
    s_load_dwordx2 s[8:9], s[0:1], 8
    s_load_dwordx4 s[12:15], s[0:1], 16
    s_and_b32 s16, s2, 7
    s_lshr_b32 s17, s2, 3
    s_and_b32 s18, s17, 3
    s_lshl_b32 s16, s16, 2
    s_add_u32 s16, s16, s18
    s_lshr_b32 s17, s17, 2
    v_lshrrev_b32 v2, 6, v0
    v_and_b32 v1, 63, v0
    v_readfirstlane_b32 s3, v2
    v_lshrrev_b32 v2, 4, v1
    v_and_b32 v3, 15, v1
    s_lshl_b32 s20, s16, 6
    s_lshl_b32 s21, s3, 4
    s_add_u32 s20, s20, s21
    s_lshr_b32 s21, s20, 4
    s_mul_i32 s21, s21, 20480
    s_mul_i32 s24, s17, 5
    s_lshr_b32 s24, s24, 1
    s_lshl_b32 s24, s24, 10
    s_add_u32 s24, s24, s21
    s_and_b32 s25, s17, 1
    v_lshlrev_b32 v5, 4, v1
    s_waitcnt lgkmcnt(0)
    s_add_u32 s32, s4, 14680064
    s_addc_u32 s33, s5, 0
    s_mov_b32 s34, 2621440
    s_mov_b32 s35, 0x00020000
    s_add_u32 s36, s4, 51380224
    s_addc_u32 s37, s5, 0
    s_mov_b32 s38, 819200
    s_mov_b32 s39, 0x00020000
    s_cmp_lt_u32 s17, 2
    s_cselect_b32 s40, s12, s14
    s_cselect_b32 s41, s13, s15
    s_cmp_lt_u32 s17, 4
    s_cselect_b32 s42, 25600, 0
    s_mov_b32 s43, 0x00020000
    s_add_u32 s44, s4, 0
    s_addc_u32 s45, s5, 0
    s_mov_b32 s46, 2621440
    s_mov_b32 s47, 0x00020000
    s_add_u32 s48, s4, 3145728
    s_addc_u32 s49, s5, 0
    s_mov_b32 s50, 196608
    s_mov_b32 s51, 0x00020000
    s_add_u32 s52, s4, 3407872
    s_addc_u32 s53, s5, 0
    s_mov_b32 s54, 1024
    s_mov_b32 s55, 0x00020000
    v_add_u32 v6, 4096, v5
    s_mul_i32 s26, s17, 5120
    s_mul_i32 s27, s3, 40960
    s_add_u32 s26, s26, s27
    s_mul_i32 s27, s3, 5120
    s_lshl_b32 s31, s3, 10
    s_add_u32 s22, s21, 0
    buffer_load_dwordx4 v[16:19], v5, s[32:35], s22 offen offset:0
    buffer_load_dwordx4 v[20:23], v5, s[32:35], s22 offen offset:1024
    buffer_load_dwordx4 v[24:27], v5, s[32:35], s22 offen offset:2048
    buffer_load_dwordx4 v[28:31], v5, s[32:35], s22 offen offset:3072
    s_mov_b32 m0, s27
    s_nop 0
    buffer_load_dwordx4 v5, s[36:39], s26 offen offset:0 lds
    s_mov_b32 m0, s27
    s_nop 0
    buffer_load_dwordx4 v5, s[36:39], s26 offen offset:1024 lds
    s_mov_b32 m0, s27
    s_nop 0
    buffer_load_dwordx4 v5, s[36:39], s26 offen offset:2048 lds
    s_mov_b32 m0, s27
    s_nop 0
    buffer_load_dwordx4 v5, s[36:39], s26 offen offset:3072 lds
    s_add_u32 m0, s27, 4096
    s_nop 0
    buffer_load_dwordx4 v6, s[36:39], s26 offen lds
    s_add_u32 s26, s26, 163840
    s_add_u32 s27, s27, 20480
    s_add_u32 m0, s31, 102400
    s_add_u32 s30, s31, 4096
    buffer_load_dwordx4 v5, s[40:43], s31 offen lds
    s_add_u32 m0, s30, 102400
    s_nop 0
    buffer_load_dwordx4 v5, s[40:43], s30 offen lds
    s_add_u32 s31, s31, 5120
    s_add_u32 s22, s21, 4096
    buffer_load_dwordx4 v[32:35], v5, s[32:35], s22 offen offset:0
    buffer_load_dwordx4 v[36:39], v5, s[32:35], s22 offen offset:1024
    buffer_load_dwordx4 v[40:43], v5, s[32:35], s22 offen offset:2048
    buffer_load_dwordx4 v[44:47], v5, s[32:35], s22 offen offset:3072
    s_mov_b32 m0, s27
    s_nop 0
    buffer_load_dwordx4 v5, s[36:39], s26 offen offset:0 lds
    s_mov_b32 m0, s27
    s_nop 0
    buffer_load_dwordx4 v5, s[36:39], s26 offen offset:1024 lds
    s_mov_b32 m0, s27
    s_nop 0
    buffer_load_dwordx4 v5, s[36:39], s26 offen offset:2048 lds
    s_mov_b32 m0, s27
    s_nop 0
    buffer_load_dwordx4 v5, s[36:39], s26 offen offset:3072 lds
    s_add_u32 m0, s27, 4096
    s_nop 0
    buffer_load_dwordx4 v6, s[36:39], s26 offen lds
    s_add_u32 s26, s26, 163840
    s_add_u32 s27, s27, 20480
    s_add_u32 m0, s31, 102400
    s_add_u32 s30, s31, 4096
    buffer_load_dwordx4 v5, s[40:43], s31 offen lds
    s_add_u32 m0, s30, 102400
    s_nop 0
    buffer_load_dwordx4 v5, s[40:43], s30 offen lds
    s_add_u32 s31, s31, 5120
    v_mov_b32 v12, v5
    v_add_u32 v13, 51200, v5
    v_lshrrev_b32 v11, 2, v1
    v_mul_u32_u24 v11, 40, v11
    v_and_b32 v14, 3, v1
    v_lshl_add_u32 v11, v14, 3, v11
    s_lshl_b32 s29, s25, 5
    s_add_u32 s29, s29, 102400
    v_add_u32 v11, s29, v11
    v_mov_b32 v96, 0
    v_mov_b32 v97, 0
    v_mov_b32 v98, 0
    v_mov_b32 v99, 0
    v_mov_b32 v100, 0
    v_mov_b32 v101, 0
    v_mov_b32 v102, 0
    v_mov_b32 v103, 0
    v_mov_b32 v104, 0
    v_mov_b32 v105, 0
    v_mov_b32 v106, 0
    v_mov_b32 v107, 0
    v_mov_b32 v108, 0
    v_mov_b32 v109, 0
    v_mov_b32 v110, 0
    v_mov_b32 v111, 0
    v_mov_b32 v112, 0
    v_mov_b32 v113, 0
    v_mov_b32 v114, 0
    v_mov_b32 v115, 0
    v_mov_b32 v116, 0
    v_mov_b32 v117, 0
    v_mov_b32 v118, 0
    v_mov_b32 v119, 0
    v_mov_b32 v120, 0
    v_mov_b32 v121, 0
    v_mov_b32 v122, 0
    v_mov_b32 v123, 0
    v_mov_b32 v124, 0
    v_mov_b32 v125, 0
    v_mov_b32 v126, 0
    v_mov_b32 v127, 0
    v_mov_b32 v128, 0
    v_mov_b32 v129, 0
    v_mov_b32 v130, 0
    v_mov_b32 v131, 0
    v_mov_b32 v132, 0
    v_mov_b32 v133, 0
    v_mov_b32 v134, 0
    v_mov_b32 v135, 0
    v_mov_b32 v136, 0
    v_mov_b32 v137, 0
    v_mov_b32 v138, 0
    v_mov_b32 v139, 0
    v_mov_b32 v140, 0
    v_mov_b32 v141, 0
    v_mov_b32 v142, 0
    v_mov_b32 v143, 0
    v_mov_b32 v236, 0x3f803f80
    v_mov_b32 v237, 0x3f803f80
    v_mov_b32 v238, 0x3f803f80
    v_mov_b32 v239, 0x3f803f80
    v_mov_b32 v240, 0
    v_mov_b32 v241, 0
    v_mov_b32 v242, 0
    v_mov_b32 v243, 0
    v_mov_b32 v244, 0
    v_mov_b32 v245, 0
    v_mov_b32 v246, 0
    v_mov_b32 v247, 0
    s_waitcnt vmcnt(11)
    s_barrier
    ds_read_b128 v[144:147], v12 offset:0
    ds_read_b128 v[148:151], v12 offset:1024
    ds_read_b128 v[152:155], v12 offset:2048
    ds_read_b128 v[156:159], v12 offset:3072
    ds_read_b128 v[160:163], v12 offset:4096
    ds_read_b64_tr_b16 v[164:165], v11 offset:0
    ds_read_b64_tr_b16 v[166:167], v11 offset:640
    ds_read_b128 v[168:171], v12 offset:5120
    ds_read_b128 v[172:175], v12 offset:6144
    ds_read_b128 v[176:179], v12 offset:7168
    ds_read_b128 v[180:183], v12 offset:8192
    ds_read_b128 v[184:187], v12 offset:9216
    ds_read_b64_tr_b16 v[188:189], v11 offset:1280
    ds_read_b64_tr_b16 v[190:191], v11 offset:1920
    s_waitcnt lgkmcnt(7)
    v_mfma_f32_16x16x32_bf16 v[96:99], v[144:147], v[16:19], v[96:99]
    ds_read_b128 v[192:195], v12 offset:10240
    v_mfma_f32_16x16x32_bf16 v[100:103], v[148:151], v[16:19], v[100:103]
    ds_read_b128 v[196:199], v12 offset:11264
    s_add_u32 s22, s21, 8192
    buffer_load_dwordx4 v[48:51], v5, s[32:35], s22 offen offset:0
    v_mfma_f32_16x16x32_bf16 v[104:107], v[152:155], v[16:19], v[104:107]
    ds_read_b128 v[200:203], v12 offset:12288
    v_mfma_f32_16x16x32_bf16 v[108:111], v[156:159], v[16:19], v[108:111]
    ds_read_b128 v[204:207], v12 offset:13312
    buffer_load_dwordx4 v[52:55], v5, s[32:35], s22 offen offset:1024
    v_mfma_f32_16x16x32_bf16 v[112:115], v[160:163], v[16:19], v[112:115]
    ds_read_b128 v[208:211], v12 offset:14336
    v_mfma_f32_16x16x32_bf16 v[116:119], v[164:167], v[16:19], v[116:119]
    ds_read_b64_tr_b16 v[212:213], v11 offset:2560
    ds_read_b64_tr_b16 v[214:215], v11 offset:3200
    buffer_load_dwordx4 v[56:59], v5, s[32:35], s22 offen offset:2048
    v_mfma_f32_16x16x32_bf16 v[240:243], v[236:239], v[16:19], v[240:243]
    v_mfma_f32_16x16x32_bf16 v[244:247], v[16:19], v[16:19], v[244:247]
    s_cmp_lg_u32 s3, 0
    s_cbranch_scc1 qkv1_kernel_cs1
    v_mfma_f32_16x16x32_bf16 v[120:123], v[144:147], v[236:239], v[120:123]
    v_mfma_f32_16x16x32_bf16 v[124:127], v[148:151], v[236:239], v[124:127]
    v_mfma_f32_16x16x32_bf16 v[128:131], v[152:155], v[236:239], v[128:131]
    v_mfma_f32_16x16x32_bf16 v[132:135], v[156:159], v[236:239], v[132:135]
    v_mfma_f32_16x16x32_bf16 v[136:139], v[160:163], v[236:239], v[136:139]
    v_mfma_f32_16x16x32_bf16 v[140:143], v[164:167], v[236:239], v[140:143]
qkv1_kernel_cs1:
    s_waitcnt lgkmcnt(7)
    v_mfma_f32_16x16x32_bf16 v[96:99], v[168:171], v[20:23], v[96:99]
    ds_read_b128 v[144:147], v12 offset:15360
    v_mfma_f32_16x16x32_bf16 v[100:103], v[172:175], v[20:23], v[100:103]
    ds_read_b128 v[148:151], v12 offset:16384
    buffer_load_dwordx4 v[60:63], v5, s[32:35], s22 offen offset:3072
    v_mfma_f32_16x16x32_bf16 v[104:107], v[176:179], v[20:23], v[104:107]
    ds_read_b128 v[152:155], v12 offset:17408
    v_mfma_f32_16x16x32_bf16 v[108:111], v[180:183], v[20:23], v[108:111]
    ds_read_b128 v[156:159], v12 offset:18432
    s_mov_b32 m0, s27
    s_nop 0
    buffer_load_dwordx4 v5, s[36:39], s26 offen offset:0 lds
    v_mfma_f32_16x16x32_bf16 v[112:115], v[184:187], v[20:23], v[112:115]
    ds_read_b128 v[160:163], v12 offset:19456
    v_mfma_f32_16x16x32_bf16 v[116:119], v[188:191], v[20:23], v[116:119]
    ds_read_b64_tr_b16 v[164:165], v11 offset:3840
    ds_read_b64_tr_b16 v[166:167], v11 offset:4480
    s_mov_b32 m0, s27
    s_nop 0
    buffer_load_dwordx4 v5, s[36:39], s26 offen offset:1024 lds
    v_mfma_f32_16x16x32_bf16 v[240:243], v[236:239], v[20:23], v[240:243]
    v_mfma_f32_16x16x32_bf16 v[244:247], v[20:23], v[20:23], v[244:247]
    s_cmp_lg_u32 s3, 1
    s_cbranch_scc1 qkv1_kernel_cs2
    v_mfma_f32_16x16x32_bf16 v[120:123], v[168:171], v[236:239], v[120:123]
    v_mfma_f32_16x16x32_bf16 v[124:127], v[172:175], v[236:239], v[124:127]
    v_mfma_f32_16x16x32_bf16 v[128:131], v[176:179], v[236:239], v[128:131]
    v_mfma_f32_16x16x32_bf16 v[132:135], v[180:183], v[236:239], v[132:135]
    v_mfma_f32_16x16x32_bf16 v[136:139], v[184:187], v[236:239], v[136:139]
    v_mfma_f32_16x16x32_bf16 v[140:143], v[188:191], v[236:239], v[140:143]
qkv1_kernel_cs2:
    s_waitcnt vmcnt(6)
    s_barrier
    s_waitcnt lgkmcnt(7)
    v_mfma_f32_16x16x32_bf16 v[96:99], v[192:195], v[24:27], v[96:99]
    ds_read_b128 v[168:171], v12 offset:20480
    v_mfma_f32_16x16x32_bf16 v[100:103], v[196:199], v[24:27], v[100:103]
    ds_read_b128 v[172:175], v12 offset:21504
    s_mov_b32 m0, s27
    s_nop 0
    buffer_load_dwordx4 v5, s[36:39], s26 offen offset:2048 lds
    v_mfma_f32_16x16x32_bf16 v[104:107], v[200:203], v[24:27], v[104:107]
    ds_read_b128 v[176:179], v12 offset:22528
    v_mfma_f32_16x16x32_bf16 v[108:111], v[204:207], v[24:27], v[108:111]
    ds_read_b128 v[180:183], v12 offset:23552
    s_mov_b32 m0, s27
    s_nop 0
    buffer_load_dwordx4 v5, s[36:39], s26 offen offset:3072 lds
    v_mfma_f32_16x16x32_bf16 v[112:115], v[208:211], v[24:27], v[112:115]
    ds_read_b128 v[184:187], v12 offset:24576
    v_mfma_f32_16x16x32_bf16 v[116:119], v[212:215], v[24:27], v[116:119]
    ds_read_b64_tr_b16 v[188:189], v11 offset:5120
    ds_read_b64_tr_b16 v[190:191], v11 offset:5760
    s_add_u32 m0, s27, 4096
    s_nop 0
    buffer_load_dwordx4 v6, s[36:39], s26 offen lds
    s_add_u32 s26, s26, 163840
    s_add_u32 s27, s27, 20480
    v_mfma_f32_16x16x32_bf16 v[240:243], v[236:239], v[24:27], v[240:243]
    v_mfma_f32_16x16x32_bf16 v[244:247], v[24:27], v[24:27], v[244:247]
    s_cmp_lg_u32 s3, 2
    s_cbranch_scc1 qkv1_kernel_cs3
    v_mfma_f32_16x16x32_bf16 v[120:123], v[192:195], v[236:239], v[120:123]
    v_mfma_f32_16x16x32_bf16 v[124:127], v[196:199], v[236:239], v[124:127]
    v_mfma_f32_16x16x32_bf16 v[128:131], v[200:203], v[236:239], v[128:131]
    v_mfma_f32_16x16x32_bf16 v[132:135], v[204:207], v[236:239], v[132:135]
    v_mfma_f32_16x16x32_bf16 v[136:139], v[208:211], v[236:239], v[136:139]
    v_mfma_f32_16x16x32_bf16 v[140:143], v[212:215], v[236:239], v[140:143]
qkv1_kernel_cs3:
    s_waitcnt lgkmcnt(7)
    v_mfma_f32_16x16x32_bf16 v[96:99], v[144:147], v[28:31], v[96:99]
    ds_read_b128 v[192:195], v12 offset:25600
    v_mfma_f32_16x16x32_bf16 v[100:103], v[148:151], v[28:31], v[100:103]
    ds_read_b128 v[196:199], v12 offset:26624
    s_add_u32 m0, s31, 102400
    s_add_u32 s30, s31, 4096
    buffer_load_dwordx4 v5, s[40:43], s31 offen lds
    v_mfma_f32_16x16x32_bf16 v[104:107], v[152:155], v[28:31], v[104:107]
    ds_read_b128 v[200:203], v12 offset:27648
    v_mfma_f32_16x16x32_bf16 v[108:111], v[156:159], v[28:31], v[108:111]
    ds_read_b128 v[204:207], v12 offset:28672
    s_add_u32 m0, s30, 102400
    s_nop 0
    buffer_load_dwordx4 v5, s[40:43], s30 offen lds
    s_add_u32 s31, s31, 5120
    v_mfma_f32_16x16x32_bf16 v[112:115], v[160:163], v[28:31], v[112:115]
    ds_read_b128 v[208:211], v12 offset:29696
    v_mfma_f32_16x16x32_bf16 v[116:119], v[164:167], v[28:31], v[116:119]
    ds_read_b64_tr_b16 v[212:213], v11 offset:6400
    ds_read_b64_tr_b16 v[214:215], v11 offset:7040
    s_add_u32 s22, s21, 12288
    buffer_load_dwordx4 v[64:67], v5, s[32:35], s22 offen offset:0
    v_mfma_f32_16x16x32_bf16 v[240:243], v[236:239], v[28:31], v[240:243]
    v_mfma_f32_16x16x32_bf16 v[244:247], v[28:31], v[28:31], v[244:247]
    s_cmp_lg_u32 s3, 3
    s_cbranch_scc1 qkv1_kernel_cs4
    v_mfma_f32_16x16x32_bf16 v[120:123], v[144:147], v[236:239], v[120:123]
    v_mfma_f32_16x16x32_bf16 v[124:127], v[148:151], v[236:239], v[124:127]
    v_mfma_f32_16x16x32_bf16 v[128:131], v[152:155], v[236:239], v[128:131]
    v_mfma_f32_16x16x32_bf16 v[132:135], v[156:159], v[236:239], v[132:135]
    v_mfma_f32_16x16x32_bf16 v[136:139], v[160:163], v[236:239], v[136:139]
    v_mfma_f32_16x16x32_bf16 v[140:143], v[164:167], v[236:239], v[140:143]
qkv1_kernel_cs4:
    s_waitcnt lgkmcnt(7)
    v_mfma_f32_16x16x32_bf16 v[96:99], v[168:171], v[32:35], v[96:99]
    ds_read_b128 v[144:147], v12 offset:30720
    v_mfma_f32_16x16x32_bf16 v[100:103], v[172:175], v[32:35], v[100:103]
    ds_read_b128 v[148:151], v12 offset:31744
    buffer_load_dwordx4 v[68:71], v5, s[32:35], s22 offen offset:1024
    v_mfma_f32_16x16x32_bf16 v[104:107], v[176:179], v[32:35], v[104:107]
    ds_read_b128 v[152:155], v12 offset:32768
    v_mfma_f32_16x16x32_bf16 v[108:111], v[180:183], v[32:35], v[108:111]
    ds_read_b128 v[156:159], v12 offset:33792
    buffer_load_dwordx4 v[72:75], v5, s[32:35], s22 offen offset:2048
    v_mfma_f32_16x16x32_bf16 v[112:115], v[184:187], v[32:35], v[112:115]
    ds_read_b128 v[160:163], v12 offset:34816
    v_mfma_f32_16x16x32_bf16 v[116:119], v[188:191], v[32:35], v[116:119]
    ds_read_b64_tr_b16 v[164:165], v11 offset:7680
    ds_read_b64_tr_b16 v[166:167], v11 offset:8320
    buffer_load_dwordx4 v[76:79], v5, s[32:35], s22 offen offset:3072
    v_mfma_f32_16x16x32_bf16 v[240:243], v[236:239], v[32:35], v[240:243]
    v_mfma_f32_16x16x32_bf16 v[244:247], v[32:35], v[32:35], v[244:247]
    s_cmp_lg_u32 s3, 0
    s_cbranch_scc1 qkv1_kernel_cs5
    v_mfma_f32_16x16x32_bf16 v[120:123], v[168:171], v[236:239], v[120:123]
    v_mfma_f32_16x16x32_bf16 v[124:127], v[172:175], v[236:239], v[124:127]
    v_mfma_f32_16x16x32_bf16 v[128:131], v[176:179], v[236:239], v[128:131]
    v_mfma_f32_16x16x32_bf16 v[132:135], v[180:183], v[236:239], v[132:135]
    v_mfma_f32_16x16x32_bf16 v[136:139], v[184:187], v[236:239], v[136:139]
    v_mfma_f32_16x16x32_bf16 v[140:143], v[188:191], v[236:239], v[140:143]
qkv1_kernel_cs5:
    s_waitcnt lgkmcnt(7)
    v_mfma_f32_16x16x32_bf16 v[96:99], v[192:195], v[36:39], v[96:99]
    ds_read_b128 v[168:171], v12 offset:35840
    v_mfma_f32_16x16x32_bf16 v[100:103], v[196:199], v[36:39], v[100:103]
    ds_read_b128 v[172:175], v12 offset:36864
    s_mov_b32 m0, s27
    s_nop 0
    buffer_load_dwordx4 v5, s[36:39], s26 offen offset:0 lds
    v_mfma_f32_16x16x32_bf16 v[104:107], v[200:203], v[36:39], v[104:107]
    ds_read_b128 v[176:179], v12 offset:37888
    v_mfma_f32_16x16x32_bf16 v[108:111], v[204:207], v[36:39], v[108:111]
    ds_read_b128 v[180:183], v12 offset:38912
    s_mov_b32 m0, s27
    s_nop 0
    buffer_load_dwordx4 v5, s[36:39], s26 offen offset:1024 lds
    v_mfma_f32_16x16x32_bf16 v[112:115], v[208:211], v[36:39], v[112:115]
    ds_read_b128 v[184:187], v12 offset:39936
    v_mfma_f32_16x16x32_bf16 v[116:119], v[212:215], v[36:39], v[116:119]
    ds_read_b64_tr_b16 v[188:189], v11 offset:8960
    ds_read_b64_tr_b16 v[190:191], v11 offset:9600
    s_mov_b32 m0, s27
    s_nop 0
    buffer_load_dwordx4 v5, s[36:39], s26 offen offset:2048 lds
    v_mfma_f32_16x16x32_bf16 v[240:243], v[236:239], v[36:39], v[240:243]
    v_mfma_f32_16x16x32_bf16 v[244:247], v[36:39], v[36:39], v[244:247]
    s_cmp_lg_u32 s3, 1
    s_cbranch_scc1 qkv1_kernel_cs6
    v_mfma_f32_16x16x32_bf16 v[120:123], v[192:195], v[236:239], v[120:123]
    v_mfma_f32_16x16x32_bf16 v[124:127], v[196:199], v[236:239], v[124:127]
    v_mfma_f32_16x16x32_bf16 v[128:131], v[200:203], v[236:239], v[128:131]
    v_mfma_f32_16x16x32_bf16 v[132:135], v[204:207], v[236:239], v[132:135]
    v_mfma_f32_16x16x32_bf16 v[136:139], v[208:211], v[236:239], v[136:139]
    v_mfma_f32_16x16x32_bf16 v[140:143], v[212:215], v[236:239], v[140:143]
qkv1_kernel_cs6:
    s_waitcnt vmcnt(7)
    s_barrier
    s_waitcnt lgkmcnt(7)
    v_mfma_f32_16x16x32_bf16 v[96:99], v[144:147], v[40:43], v[96:99]
    ds_read_b128 v[192:195], v12 offset:40960
    v_mfma_f32_16x16x32_bf16 v[100:103], v[148:151], v[40:43], v[100:103]
    ds_read_b128 v[196:199], v12 offset:41984
    s_mov_b32 m0, s27
    s_nop 0
    buffer_load_dwordx4 v5, s[36:39], s26 offen offset:3072 lds
    v_mfma_f32_16x16x32_bf16 v[104:107], v[152:155], v[40:43], v[104:107]
    ds_read_b128 v[200:203], v12 offset:43008
    v_mfma_f32_16x16x32_bf16 v[108:111], v[156:159], v[40:43], v[108:111]
    ds_read_b128 v[204:207], v12 offset:44032
    s_add_u32 m0, s27, 4096
    s_nop 0
    buffer_load_dwordx4 v6, s[36:39], s26 offen lds
    s_add_u32 s26, s26, 163840
    s_add_u32 s27, s27, 20480
    v_mfma_f32_16x16x32_bf16 v[112:115], v[160:163], v[40:43], v[112:115]
    ds_read_b128 v[208:211], v12 offset:45056
    v_mfma_f32_16x16x32_bf16 v[116:119], v[164:167], v[40:43], v[116:119]
    ds_read_b64_tr_b16 v[212:213], v11 offset:10240
    ds_read_b64_tr_b16 v[214:215], v11 offset:10880
    s_add_u32 m0, s31, 102400
    s_add_u32 s30, s31, 4096
    buffer_load_dwordx4 v5, s[40:43], s31 offen lds
    v_mfma_f32_16x16x32_bf16 v[240:243], v[236:239], v[40:43], v[240:243]
    v_mfma_f32_16x16x32_bf16 v[244:247], v[40:43], v[40:43], v[244:247]
    s_cmp_lg_u32 s3, 2
    s_cbranch_scc1 qkv1_kernel_cs7
    v_mfma_f32_16x16x32_bf16 v[120:123], v[144:147], v[236:239], v[120:123]
    v_mfma_f32_16x16x32_bf16 v[124:127], v[148:151], v[236:239], v[124:127]
    v_mfma_f32_16x16x32_bf16 v[128:131], v[152:155], v[236:239], v[128:131]
    v_mfma_f32_16x16x32_bf16 v[132:135], v[156:159], v[236:239], v[132:135]
    v_mfma_f32_16x16x32_bf16 v[136:139], v[160:163], v[236:239], v[136:139]
    v_mfma_f32_16x16x32_bf16 v[140:143], v[164:167], v[236:239], v[140:143]
qkv1_kernel_cs7:
    s_waitcnt lgkmcnt(7)
    v_mfma_f32_16x16x32_bf16 v[96:99], v[168:171], v[44:47], v[96:99]
    ds_read_b128 v[144:147], v12 offset:46080
    v_mfma_f32_16x16x32_bf16 v[100:103], v[172:175], v[44:47], v[100:103]
    ds_read_b128 v[148:151], v12 offset:47104
    s_add_u32 m0, s30, 102400
    s_nop 0
    buffer_load_dwordx4 v5, s[40:43], s30 offen lds
    s_add_u32 s31, s31, 5120
    v_mfma_f32_16x16x32_bf16 v[104:107], v[176:179], v[44:47], v[104:107]
    ds_read_b128 v[152:155], v12 offset:48128
    v_mfma_f32_16x16x32_bf16 v[108:111], v[180:183], v[44:47], v[108:111]
    ds_read_b128 v[156:159], v12 offset:49152
    s_add_u32 s22, s21, 16384
    buffer_load_dwordx4 v[80:83], v5, s[32:35], s22 offen offset:0
    v_mfma_f32_16x16x32_bf16 v[112:115], v[184:187], v[44:47], v[112:115]
    ds_read_b128 v[160:163], v12 offset:50176
    v_mfma_f32_16x16x32_bf16 v[116:119], v[188:191], v[44:47], v[116:119]
    ds_read_b64_tr_b16 v[164:165], v11 offset:11520
    ds_read_b64_tr_b16 v[166:167], v11 offset:12160
    buffer_load_dwordx4 v[84:87], v5, s[32:35], s22 offen offset:1024
    v_mfma_f32_16x16x32_bf16 v[240:243], v[236:239], v[44:47], v[240:243]
    v_mfma_f32_16x16x32_bf16 v[244:247], v[44:47], v[44:47], v[244:247]
    s_cmp_lg_u32 s3, 3
    s_cbranch_scc1 qkv1_kernel_cs8
    v_mfma_f32_16x16x32_bf16 v[120:123], v[168:171], v[236:239], v[120:123]
    v_mfma_f32_16x16x32_bf16 v[124:127], v[172:175], v[236:239], v[124:127]
    v_mfma_f32_16x16x32_bf16 v[128:131], v[176:179], v[236:239], v[128:131]
    v_mfma_f32_16x16x32_bf16 v[132:135], v[180:183], v[236:239], v[132:135]
    v_mfma_f32_16x16x32_bf16 v[136:139], v[184:187], v[236:239], v[136:139]
    v_mfma_f32_16x16x32_bf16 v[140:143], v[188:191], v[236:239], v[140:143]
qkv1_kernel_cs8:
    s_waitcnt lgkmcnt(7)
    v_mfma_f32_16x16x32_bf16 v[96:99], v[192:195], v[48:51], v[96:99]
    ds_read_b128 v[168:171], v13 offset:0
    v_mfma_f32_16x16x32_bf16 v[100:103], v[196:199], v[48:51], v[100:103]
    ds_read_b128 v[172:175], v13 offset:1024
    buffer_load_dwordx4 v[88:91], v5, s[32:35], s22 offen offset:2048
    v_mfma_f32_16x16x32_bf16 v[104:107], v[200:203], v[48:51], v[104:107]
    ds_read_b128 v[176:179], v13 offset:2048
    v_mfma_f32_16x16x32_bf16 v[108:111], v[204:207], v[48:51], v[108:111]
    ds_read_b128 v[180:183], v13 offset:3072
    buffer_load_dwordx4 v[92:95], v5, s[32:35], s22 offen offset:3072
    v_mfma_f32_16x16x32_bf16 v[112:115], v[208:211], v[48:51], v[112:115]
    ds_read_b128 v[184:187], v13 offset:4096
    v_mfma_f32_16x16x32_bf16 v[116:119], v[212:215], v[48:51], v[116:119]
    ds_read_b64_tr_b16 v[188:189], v11 offset:12800
    ds_read_b64_tr_b16 v[190:191], v11 offset:13440
    s_mov_b32 m0, s27
    s_nop 0
    buffer_load_dwordx4 v5, s[36:39], s26 offen offset:0 lds
    v_mfma_f32_16x16x32_bf16 v[240:243], v[236:239], v[48:51], v[240:243]
    v_mfma_f32_16x16x32_bf16 v[244:247], v[48:51], v[48:51], v[244:247]
    s_cmp_lg_u32 s3, 0
    s_cbranch_scc1 qkv1_kernel_cs9
    v_mfma_f32_16x16x32_bf16 v[120:123], v[192:195], v[236:239], v[120:123]
    v_mfma_f32_16x16x32_bf16 v[124:127], v[196:199], v[236:239], v[124:127]
    v_mfma_f32_16x16x32_bf16 v[128:131], v[200:203], v[236:239], v[128:131]
    v_mfma_f32_16x16x32_bf16 v[132:135], v[204:207], v[236:239], v[132:135]
    v_mfma_f32_16x16x32_bf16 v[136:139], v[208:211], v[236:239], v[136:139]
    v_mfma_f32_16x16x32_bf16 v[140:143], v[212:215], v[236:239], v[140:143]
qkv1_kernel_cs9:
    s_waitcnt lgkmcnt(7)
    v_mfma_f32_16x16x32_bf16 v[96:99], v[144:147], v[52:55], v[96:99]
    ds_read_b128 v[192:195], v13 offset:5120
    v_mfma_f32_16x16x32_bf16 v[100:103], v[148:151], v[52:55], v[100:103]
    ds_read_b128 v[196:199], v13 offset:6144
    s_mov_b32 m0, s27
    s_nop 0
    buffer_load_dwordx4 v5, s[36:39], s26 offen offset:1024 lds
    v_mfma_f32_16x16x32_bf16 v[104:107], v[152:155], v[52:55], v[104:107]
    ds_read_b128 v[200:203], v13 offset:7168
    v_mfma_f32_16x16x32_bf16 v[108:111], v[156:159], v[52:55], v[108:111]
    ds_read_b128 v[204:207], v13 offset:8192
    s_mov_b32 m0, s27
    s_nop 0
    buffer_load_dwordx4 v5, s[36:39], s26 offen offset:2048 lds
    v_mfma_f32_16x16x32_bf16 v[112:115], v[160:163], v[52:55], v[112:115]
    ds_read_b128 v[208:211], v13 offset:9216
    v_mfma_f32_16x16x32_bf16 v[116:119], v[164:167], v[52:55], v[116:119]
    ds_read_b64_tr_b16 v[212:213], v11 offset:14080
    ds_read_b64_tr_b16 v[214:215], v11 offset:14720
    s_mov_b32 m0, s27
    s_nop 0
    buffer_load_dwordx4 v5, s[36:39], s26 offen offset:3072 lds
    v_mfma_f32_16x16x32_bf16 v[240:243], v[236:239], v[52:55], v[240:243]
    v_mfma_f32_16x16x32_bf16 v[244:247], v[52:55], v[52:55], v[244:247]
    s_cmp_lg_u32 s3, 1
    s_cbranch_scc1 qkv1_kernel_cs10
    v_mfma_f32_16x16x32_bf16 v[120:123], v[144:147], v[236:239], v[120:123]
    v_mfma_f32_16x16x32_bf16 v[124:127], v[148:151], v[236:239], v[124:127]
    v_mfma_f32_16x16x32_bf16 v[128:131], v[152:155], v[236:239], v[128:131]
    v_mfma_f32_16x16x32_bf16 v[132:135], v[156:159], v[236:239], v[132:135]
    v_mfma_f32_16x16x32_bf16 v[136:139], v[160:163], v[236:239], v[136:139]
    v_mfma_f32_16x16x32_bf16 v[140:143], v[164:167], v[236:239], v[140:143]
qkv1_kernel_cs10:
    s_waitcnt vmcnt(8)
    s_barrier
    s_waitcnt lgkmcnt(7)
    v_mfma_f32_16x16x32_bf16 v[96:99], v[168:171], v[56:59], v[96:99]
    ds_read_b128 v[144:147], v13 offset:10240
    v_mfma_f32_16x16x32_bf16 v[100:103], v[172:175], v[56:59], v[100:103]
    ds_read_b128 v[148:151], v13 offset:11264
    s_add_u32 m0, s27, 4096
    s_nop 0
    buffer_load_dwordx4 v6, s[36:39], s26 offen lds
    v_mfma_f32_16x16x32_bf16 v[104:107], v[176:179], v[56:59], v[104:107]
    ds_read_b128 v[152:155], v13 offset:12288
    v_mfma_f32_16x16x32_bf16 v[108:111], v[180:183], v[56:59], v[108:111]
    ds_read_b128 v[156:159], v13 offset:13312
    s_add_u32 m0, s31, 102400
    s_add_u32 s30, s31, 4096
    buffer_load_dwordx4 v5, s[40:43], s31 offen lds
    v_mfma_f32_16x16x32_bf16 v[112:115], v[184:187], v[56:59], v[112:115]
    ds_read_b128 v[160:163], v13 offset:14336
    v_mfma_f32_16x16x32_bf16 v[116:119], v[188:191], v[56:59], v[116:119]
    ds_read_b64_tr_b16 v[164:165], v11 offset:15360
    ds_read_b64_tr_b16 v[166:167], v11 offset:16000
    s_add_u32 m0, s30, 102400
    s_nop 0
    buffer_load_dwordx4 v5, s[40:43], s30 offen lds
    s_add_u32 s31, s31, 5120
    v_mfma_f32_16x16x32_bf16 v[240:243], v[236:239], v[56:59], v[240:243]
    v_mfma_f32_16x16x32_bf16 v[244:247], v[56:59], v[56:59], v[244:247]
    s_cmp_lg_u32 s3, 2
    s_cbranch_scc1 qkv1_kernel_cs11
    v_mfma_f32_16x16x32_bf16 v[120:123], v[168:171], v[236:239], v[120:123]
    v_mfma_f32_16x16x32_bf16 v[124:127], v[172:175], v[236:239], v[124:127]
    v_mfma_f32_16x16x32_bf16 v[128:131], v[176:179], v[236:239], v[128:131]
    v_mfma_f32_16x16x32_bf16 v[132:135], v[180:183], v[236:239], v[132:135]
    v_mfma_f32_16x16x32_bf16 v[136:139], v[184:187], v[236:239], v[136:139]
    v_mfma_f32_16x16x32_bf16 v[140:143], v[188:191], v[236:239], v[140:143]
qkv1_kernel_cs11:
    s_waitcnt lgkmcnt(7)
    v_mfma_f32_16x16x32_bf16 v[96:99], v[192:195], v[60:63], v[96:99]
    ds_read_b128 v[168:171], v13 offset:15360
    v_mfma_f32_16x16x32_bf16 v[100:103], v[196:199], v[60:63], v[100:103]
    ds_read_b128 v[172:175], v13 offset:16384
    v_mfma_f32_16x16x32_bf16 v[104:107], v[200:203], v[60:63], v[104:107]
    ds_read_b128 v[176:179], v13 offset:17408
    v_mfma_f32_16x16x32_bf16 v[108:111], v[204:207], v[60:63], v[108:111]
    ds_read_b128 v[180:183], v13 offset:18432
    v_mfma_f32_16x16x32_bf16 v[112:115], v[208:211], v[60:63], v[112:115]
    ds_read_b128 v[184:187], v13 offset:19456
    v_mfma_f32_16x16x32_bf16 v[116:119], v[212:215], v[60:63], v[116:119]
    ds_read_b64_tr_b16 v[188:189], v11 offset:16640
    ds_read_b64_tr_b16 v[190:191], v11 offset:17280
    v_mfma_f32_16x16x32_bf16 v[240:243], v[236:239], v[60:63], v[240:243]
    v_mfma_f32_16x16x32_bf16 v[244:247], v[60:63], v[60:63], v[244:247]
    s_cmp_lg_u32 s3, 3
    s_cbranch_scc1 qkv1_kernel_cs12
    v_mfma_f32_16x16x32_bf16 v[120:123], v[192:195], v[236:239], v[120:123]
    v_mfma_f32_16x16x32_bf16 v[124:127], v[196:199], v[236:239], v[124:127]
    v_mfma_f32_16x16x32_bf16 v[128:131], v[200:203], v[236:239], v[128:131]
    v_mfma_f32_16x16x32_bf16 v[132:135], v[204:207], v[236:239], v[132:135]
    v_mfma_f32_16x16x32_bf16 v[136:139], v[208:211], v[236:239], v[136:139]
    v_mfma_f32_16x16x32_bf16 v[140:143], v[212:215], v[236:239], v[140:143]
qkv1_kernel_cs12:
    s_waitcnt lgkmcnt(7)
    v_mfma_f32_16x16x32_bf16 v[96:99], v[144:147], v[64:67], v[96:99]
    ds_read_b128 v[192:195], v13 offset:20480
    v_mfma_f32_16x16x32_bf16 v[100:103], v[148:151], v[64:67], v[100:103]
    ds_read_b128 v[196:199], v13 offset:21504
    v_mfma_f32_16x16x32_bf16 v[104:107], v[152:155], v[64:67], v[104:107]
    ds_read_b128 v[200:203], v13 offset:22528
    v_mfma_f32_16x16x32_bf16 v[108:111], v[156:159], v[64:67], v[108:111]
    ds_read_b128 v[204:207], v13 offset:23552
    v_mfma_f32_16x16x32_bf16 v[112:115], v[160:163], v[64:67], v[112:115]
    ds_read_b128 v[208:211], v13 offset:24576
    v_mfma_f32_16x16x32_bf16 v[116:119], v[164:167], v[64:67], v[116:119]
    ds_read_b64_tr_b16 v[212:213], v11 offset:17920
    ds_read_b64_tr_b16 v[214:215], v11 offset:18560
    v_mfma_f32_16x16x32_bf16 v[240:243], v[236:239], v[64:67], v[240:243]
    v_mfma_f32_16x16x32_bf16 v[244:247], v[64:67], v[64:67], v[244:247]
    s_cmp_lg_u32 s3, 0
    s_cbranch_scc1 qkv1_kernel_cs13
    v_mfma_f32_16x16x32_bf16 v[120:123], v[144:147], v[236:239], v[120:123]
    v_mfma_f32_16x16x32_bf16 v[124:127], v[148:151], v[236:239], v[124:127]
    v_mfma_f32_16x16x32_bf16 v[128:131], v[152:155], v[236:239], v[128:131]
    v_mfma_f32_16x16x32_bf16 v[132:135], v[156:159], v[236:239], v[132:135]
    v_mfma_f32_16x16x32_bf16 v[136:139], v[160:163], v[236:239], v[136:139]
    v_mfma_f32_16x16x32_bf16 v[140:143], v[164:167], v[236:239], v[140:143]
qkv1_kernel_cs13:
    s_waitcnt lgkmcnt(7)
    v_mfma_f32_16x16x32_bf16 v[96:99], v[168:171], v[68:71], v[96:99]
    ds_read_b128 v[144:147], v13 offset:25600
    v_mfma_f32_16x16x32_bf16 v[100:103], v[172:175], v[68:71], v[100:103]
    ds_read_b128 v[148:151], v13 offset:26624
    v_mfma_f32_16x16x32_bf16 v[104:107], v[176:179], v[68:71], v[104:107]
    ds_read_b128 v[152:155], v13 offset:27648
    v_mfma_f32_16x16x32_bf16 v[108:111], v[180:183], v[68:71], v[108:111]
    ds_read_b128 v[156:159], v13 offset:28672
    v_mfma_f32_16x16x32_bf16 v[112:115], v[184:187], v[68:71], v[112:115]
    ds_read_b128 v[160:163], v13 offset:29696
    v_mfma_f32_16x16x32_bf16 v[116:119], v[188:191], v[68:71], v[116:119]
    ds_read_b64_tr_b16 v[164:165], v11 offset:19200
    ds_read_b64_tr_b16 v[166:167], v11 offset:19840
    v_mfma_f32_16x16x32_bf16 v[240:243], v[236:239], v[68:71], v[240:243]
    v_mfma_f32_16x16x32_bf16 v[244:247], v[68:71], v[68:71], v[244:247]
    s_cmp_lg_u32 s3, 1
    s_cbranch_scc1 qkv1_kernel_cs14
    v_mfma_f32_16x16x32_bf16 v[120:123], v[168:171], v[236:239], v[120:123]
    v_mfma_f32_16x16x32_bf16 v[124:127], v[172:175], v[236:239], v[124:127]
    v_mfma_f32_16x16x32_bf16 v[128:131], v[176:179], v[236:239], v[128:131]
    v_mfma_f32_16x16x32_bf16 v[132:135], v[180:183], v[236:239], v[132:135]
    v_mfma_f32_16x16x32_bf16 v[136:139], v[184:187], v[236:239], v[136:139]
    v_mfma_f32_16x16x32_bf16 v[140:143], v[188:191], v[236:239], v[140:143]
qkv1_kernel_cs14:
    s_waitcnt vmcnt(0)
    s_barrier
    s_waitcnt lgkmcnt(7)
    v_mfma_f32_16x16x32_bf16 v[96:99], v[192:195], v[72:75], v[96:99]
    ds_read_b128 v[168:171], v13 offset:30720
    v_mfma_f32_16x16x32_bf16 v[100:103], v[196:199], v[72:75], v[100:103]
    ds_read_b128 v[172:175], v13 offset:31744
    v_mfma_f32_16x16x32_bf16 v[104:107], v[200:203], v[72:75], v[104:107]
    ds_read_b128 v[176:179], v13 offset:32768
    v_mfma_f32_16x16x32_bf16 v[108:111], v[204:207], v[72:75], v[108:111]
    ds_read_b128 v[180:183], v13 offset:33792
    v_mfma_f32_16x16x32_bf16 v[112:115], v[208:211], v[72:75], v[112:115]
    ds_read_b128 v[184:187], v13 offset:34816
    v_mfma_f32_16x16x32_bf16 v[116:119], v[212:215], v[72:75], v[116:119]
    ds_read_b64_tr_b16 v[188:189], v11 offset:20480
    ds_read_b64_tr_b16 v[190:191], v11 offset:21120
    v_mfma_f32_16x16x32_bf16 v[240:243], v[236:239], v[72:75], v[240:243]
    v_mfma_f32_16x16x32_bf16 v[244:247], v[72:75], v[72:75], v[244:247]
    s_cmp_lg_u32 s3, 2
    s_cbranch_scc1 qkv1_kernel_cs15
    v_mfma_f32_16x16x32_bf16 v[120:123], v[192:195], v[236:239], v[120:123]
    v_mfma_f32_16x16x32_bf16 v[124:127], v[196:199], v[236:239], v[124:127]
    v_mfma_f32_16x16x32_bf16 v[128:131], v[200:203], v[236:239], v[128:131]
    v_mfma_f32_16x16x32_bf16 v[132:135], v[204:207], v[236:239], v[132:135]
    v_mfma_f32_16x16x32_bf16 v[136:139], v[208:211], v[236:239], v[136:139]
    v_mfma_f32_16x16x32_bf16 v[140:143], v[212:215], v[236:239], v[140:143]
qkv1_kernel_cs15:
    s_waitcnt lgkmcnt(7)
    v_mfma_f32_16x16x32_bf16 v[96:99], v[144:147], v[76:79], v[96:99]
    ds_read_b128 v[192:195], v13 offset:35840
    v_mfma_f32_16x16x32_bf16 v[100:103], v[148:151], v[76:79], v[100:103]
    ds_read_b128 v[196:199], v13 offset:36864
    v_mfma_f32_16x16x32_bf16 v[104:107], v[152:155], v[76:79], v[104:107]
    ds_read_b128 v[200:203], v13 offset:37888
    v_mfma_f32_16x16x32_bf16 v[108:111], v[156:159], v[76:79], v[108:111]
    ds_read_b128 v[204:207], v13 offset:38912
    v_mfma_f32_16x16x32_bf16 v[112:115], v[160:163], v[76:79], v[112:115]
    ds_read_b128 v[208:211], v13 offset:39936
    v_mfma_f32_16x16x32_bf16 v[116:119], v[164:167], v[76:79], v[116:119]
    ds_read_b64_tr_b16 v[212:213], v11 offset:21760
    ds_read_b64_tr_b16 v[214:215], v11 offset:22400
    v_mfma_f32_16x16x32_bf16 v[240:243], v[236:239], v[76:79], v[240:243]
    v_mfma_f32_16x16x32_bf16 v[244:247], v[76:79], v[76:79], v[244:247]
    s_cmp_lg_u32 s3, 3
    s_cbranch_scc1 qkv1_kernel_cs16
    v_mfma_f32_16x16x32_bf16 v[120:123], v[144:147], v[236:239], v[120:123]
    v_mfma_f32_16x16x32_bf16 v[124:127], v[148:151], v[236:239], v[124:127]
    v_mfma_f32_16x16x32_bf16 v[128:131], v[152:155], v[236:239], v[128:131]
    v_mfma_f32_16x16x32_bf16 v[132:135], v[156:159], v[236:239], v[132:135]
    v_mfma_f32_16x16x32_bf16 v[136:139], v[160:163], v[236:239], v[136:139]
    v_mfma_f32_16x16x32_bf16 v[140:143], v[164:167], v[236:239], v[140:143]
qkv1_kernel_cs16:
    s_waitcnt lgkmcnt(7)
    v_mfma_f32_16x16x32_bf16 v[96:99], v[168:171], v[80:83], v[96:99]
    ds_read_b128 v[144:147], v13 offset:40960
    v_mfma_f32_16x16x32_bf16 v[100:103], v[172:175], v[80:83], v[100:103]
    ds_read_b128 v[148:151], v13 offset:41984
    v_mfma_f32_16x16x32_bf16 v[104:107], v[176:179], v[80:83], v[104:107]
    ds_read_b128 v[152:155], v13 offset:43008
    v_mfma_f32_16x16x32_bf16 v[108:111], v[180:183], v[80:83], v[108:111]
    ds_read_b128 v[156:159], v13 offset:44032
    v_mfma_f32_16x16x32_bf16 v[112:115], v[184:187], v[80:83], v[112:115]
    ds_read_b128 v[160:163], v13 offset:45056
    v_mfma_f32_16x16x32_bf16 v[116:119], v[188:191], v[80:83], v[116:119]
    ds_read_b64_tr_b16 v[164:165], v11 offset:23040
    ds_read_b64_tr_b16 v[166:167], v11 offset:23680
    v_mfma_f32_16x16x32_bf16 v[240:243], v[236:239], v[80:83], v[240:243]
    v_mfma_f32_16x16x32_bf16 v[244:247], v[80:83], v[80:83], v[244:247]
    s_cmp_lg_u32 s3, 0
    s_cbranch_scc1 qkv1_kernel_cs17
    v_mfma_f32_16x16x32_bf16 v[120:123], v[168:171], v[236:239], v[120:123]
    v_mfma_f32_16x16x32_bf16 v[124:127], v[172:175], v[236:239], v[124:127]
    v_mfma_f32_16x16x32_bf16 v[128:131], v[176:179], v[236:239], v[128:131]
    v_mfma_f32_16x16x32_bf16 v[132:135], v[180:183], v[236:239], v[132:135]
    v_mfma_f32_16x16x32_bf16 v[136:139], v[184:187], v[236:239], v[136:139]
    v_mfma_f32_16x16x32_bf16 v[140:143], v[188:191], v[236:239], v[140:143]
qkv1_kernel_cs17:
    s_waitcnt lgkmcnt(7)
    v_mfma_f32_16x16x32_bf16 v[96:99], v[192:195], v[84:87], v[96:99]
    ds_read_b128 v[168:171], v13 offset:46080
    v_mfma_f32_16x16x32_bf16 v[100:103], v[196:199], v[84:87], v[100:103]
    ds_read_b128 v[172:175], v13 offset:47104
    v_mfma_f32_16x16x32_bf16 v[104:107], v[200:203], v[84:87], v[104:107]
    ds_read_b128 v[176:179], v13 offset:48128
    v_mfma_f32_16x16x32_bf16 v[108:111], v[204:207], v[84:87], v[108:111]
    ds_read_b128 v[180:183], v13 offset:49152
    v_mfma_f32_16x16x32_bf16 v[112:115], v[208:211], v[84:87], v[112:115]
    ds_read_b128 v[184:187], v13 offset:50176
    v_mfma_f32_16x16x32_bf16 v[116:119], v[212:215], v[84:87], v[116:119]
    ds_read_b64_tr_b16 v[188:189], v11 offset:24320
    ds_read_b64_tr_b16 v[190:191], v11 offset:24960
    v_mfma_f32_16x16x32_bf16 v[240:243], v[236:239], v[84:87], v[240:243]
    v_mfma_f32_16x16x32_bf16 v[244:247], v[84:87], v[84:87], v[244:247]
    s_cmp_lg_u32 s3, 1
    s_cbranch_scc1 qkv1_kernel_cs18
    v_mfma_f32_16x16x32_bf16 v[120:123], v[192:195], v[236:239], v[120:123]
    v_mfma_f32_16x16x32_bf16 v[124:127], v[196:199], v[236:239], v[124:127]
    v_mfma_f32_16x16x32_bf16 v[128:131], v[200:203], v[236:239], v[128:131]
    v_mfma_f32_16x16x32_bf16 v[132:135], v[204:207], v[236:239], v[132:135]
    v_mfma_f32_16x16x32_bf16 v[136:139], v[208:211], v[236:239], v[136:139]
    v_mfma_f32_16x16x32_bf16 v[140:143], v[212:215], v[236:239], v[140:143]
qkv1_kernel_cs18:
    s_waitcnt lgkmcnt(7)
    v_mfma_f32_16x16x32_bf16 v[96:99], v[144:147], v[88:91], v[96:99]
    v_mfma_f32_16x16x32_bf16 v[100:103], v[148:151], v[88:91], v[100:103]
    v_mfma_f32_16x16x32_bf16 v[104:107], v[152:155], v[88:91], v[104:107]
    v_mfma_f32_16x16x32_bf16 v[108:111], v[156:159], v[88:91], v[108:111]
    v_mfma_f32_16x16x32_bf16 v[112:115], v[160:163], v[88:91], v[112:115]
    v_mfma_f32_16x16x32_bf16 v[116:119], v[164:167], v[88:91], v[116:119]
    v_mfma_f32_16x16x32_bf16 v[240:243], v[236:239], v[88:91], v[240:243]
    v_mfma_f32_16x16x32_bf16 v[244:247], v[88:91], v[88:91], v[244:247]
    s_cmp_lg_u32 s3, 2
    s_cbranch_scc1 qkv1_kernel_cs19
    v_mfma_f32_16x16x32_bf16 v[120:123], v[144:147], v[236:239], v[120:123]
    v_mfma_f32_16x16x32_bf16 v[124:127], v[148:151], v[236:239], v[124:127]
    v_mfma_f32_16x16x32_bf16 v[128:131], v[152:155], v[236:239], v[128:131]
    v_mfma_f32_16x16x32_bf16 v[132:135], v[156:159], v[236:239], v[132:135]
    v_mfma_f32_16x16x32_bf16 v[136:139], v[160:163], v[236:239], v[136:139]
    v_mfma_f32_16x16x32_bf16 v[140:143], v[164:167], v[236:239], v[140:143]
qkv1_kernel_cs19:
    s_waitcnt lgkmcnt(0)
    v_mfma_f32_16x16x32_bf16 v[96:99], v[168:171], v[92:95], v[96:99]
    v_mfma_f32_16x16x32_bf16 v[100:103], v[172:175], v[92:95], v[100:103]
    v_mfma_f32_16x16x32_bf16 v[104:107], v[176:179], v[92:95], v[104:107]
    v_mfma_f32_16x16x32_bf16 v[108:111], v[180:183], v[92:95], v[108:111]
    v_mfma_f32_16x16x32_bf16 v[112:115], v[184:187], v[92:95], v[112:115]
    v_mfma_f32_16x16x32_bf16 v[116:119], v[188:191], v[92:95], v[116:119]
    v_mfma_f32_16x16x32_bf16 v[240:243], v[236:239], v[92:95], v[240:243]
    v_mfma_f32_16x16x32_bf16 v[244:247], v[92:95], v[92:95], v[244:247]
    s_cmp_lg_u32 s3, 3
    s_cbranch_scc1 qkv1_kernel_cs20
    v_mfma_f32_16x16x32_bf16 v[120:123], v[168:171], v[236:239], v[120:123]
    v_mfma_f32_16x16x32_bf16 v[124:127], v[172:175], v[236:239], v[124:127]
    v_mfma_f32_16x16x32_bf16 v[128:131], v[176:179], v[236:239], v[128:131]
    v_mfma_f32_16x16x32_bf16 v[132:135], v[180:183], v[236:239], v[132:135]
    v_mfma_f32_16x16x32_bf16 v[136:139], v[184:187], v[236:239], v[136:139]
    v_mfma_f32_16x16x32_bf16 v[140:143], v[188:191], v[236:239], v[140:143]
qkv1_kernel_cs20:
    s_mul_i32 s28, s3, 384
    s_add_u32 s28, s28, 131072
    v_lshlrev_b32 v12, 4, v2
    v_add_u32 v13, s28, v12
    v_add_u32 v12, 131072, v12
    v_lshrrev_b32 v14, 2, v3
    v_and_b32 v15, 3, v3
    s_nop 2
    ds_write_b128 v13, v[120:123] offset:0
    ds_write_b128 v13, v[124:127] offset:64
    ds_write_b128 v13, v[128:131] offset:128
    ds_write_b128 v13, v[132:135] offset:192
    ds_write_b128 v13, v[136:139] offset:256
    ds_write_b128 v13, v[140:143] offset:320
    v_mov_b32 v216, v240
    v_mov_b32 v218, v244
    v_cmp_eq_u32 vcc, 1, v15
    s_nop 1
    v_cndmask_b32 v218, v218, v245, vcc
    v_cmp_eq_u32 vcc, 2, v15
    s_nop 1
    v_cndmask_b32 v218, v218, v246, vcc
    v_cmp_eq_u32 vcc, 3, v15
    s_nop 1
    v_cndmask_b32 v218, v218, v247, vcc
    v_cmp_eq_u32 vcc, v14, v2
    s_nop 1
    v_cndmask_b32 v218, 0, v218, vcc
    v_mov_b32 v221, v218
    s_nop 1
    v_permlane16_swap_b32 v218, v221
    v_add_f32 v218, v218, v221
    v_mov_b32 v221, v218
    s_nop 1
    v_permlane32_swap_b32 v218, v221
    v_add_f32 v218, v218, v221
    s_waitcnt lgkmcnt(0)
    s_barrier
    ds_read_b128 v[16:19], v12 offset:0
    ds_read_b128 v[20:23], v12 offset:64
    ds_read_b128 v[24:27], v12 offset:128
    ds_read_b128 v[28:31], v12 offset:192
    ds_read_b128 v[32:35], v12 offset:256
    ds_read_b128 v[36:39], v12 offset:320
    ds_read_b128 v[40:43], v12 offset:384
    ds_read_b128 v[44:47], v12 offset:448
    ds_read_b128 v[48:51], v12 offset:512
    ds_read_b128 v[52:55], v12 offset:576
    ds_read_b128 v[56:59], v12 offset:640
    ds_read_b128 v[60:63], v12 offset:704
    ds_read_b128 v[64:67], v12 offset:768
    ds_read_b128 v[68:71], v12 offset:832
    ds_read_b128 v[72:75], v12 offset:896
    ds_read_b128 v[76:79], v12 offset:960
    ds_read_b128 v[80:83], v12 offset:1024
    ds_read_b128 v[84:87], v12 offset:1088
    ds_read_b128 v[144:147], v12 offset:1152
    ds_read_b128 v[148:151], v12 offset:1216
    ds_read_b128 v[152:155], v12 offset:1280
    ds_read_b128 v[156:159], v12 offset:1344
    ds_read_b128 v[160:163], v12 offset:1408
    ds_read_b128 v[164:167], v12 offset:1472
    v_mul_f32 v216, 0x3acccccd, v216
    v_mul_f32 v218, 0x3acccccd, v218
    v_fma_f32 v218, -v216, v216, v218
    v_max_f32 v218, 0, v218
    v_add_f32 v218, 0x3727c5ac, v218
    v_rsq_f32 v217, v218
    v_sub_f32 v216, 0, v216
    v_mul_f32 v219, 0x3ea52b5c, v217
    s_waitcnt lgkmcnt(0)
    v_add_f32 v16, v16, v40
    v_add_f32 v64, v64, v144
    v_add_f32 v17, v17, v41
    v_add_f32 v65, v65, v145
    v_add_f32 v18, v18, v42
    v_add_f32 v66, v66, v146
    v_add_f32 v19, v19, v43
    v_add_f32 v67, v67, v147
    v_add_f32 v20, v20, v44
    v_add_f32 v68, v68, v148
    v_add_f32 v21, v21, v45
    v_add_f32 v69, v69, v149
    v_add_f32 v22, v22, v46
    v_add_f32 v70, v70, v150
    v_add_f32 v23, v23, v47
    v_add_f32 v71, v71, v151
    v_add_f32 v24, v24, v48
    v_add_f32 v72, v72, v152
    v_add_f32 v25, v25, v49
    v_add_f32 v73, v73, v153
    v_add_f32 v26, v26, v50
    v_add_f32 v74, v74, v154
    v_add_f32 v27, v27, v51
    v_add_f32 v75, v75, v155
    v_add_f32 v28, v28, v52
    v_add_f32 v76, v76, v156
    v_add_f32 v29, v29, v53
    v_add_f32 v77, v77, v157
    v_add_f32 v30, v30, v54
    v_add_f32 v78, v78, v158
    v_add_f32 v31, v31, v55
    v_add_f32 v79, v79, v159
    v_add_f32 v32, v32, v56
    v_add_f32 v80, v80, v160
    v_add_f32 v33, v33, v57
    v_add_f32 v81, v81, v161
    v_add_f32 v34, v34, v58
    v_add_f32 v82, v82, v162
    v_add_f32 v35, v35, v59
    v_add_f32 v83, v83, v163
    v_add_f32 v36, v36, v60
    v_add_f32 v84, v84, v164
    v_add_f32 v37, v37, v61
    v_add_f32 v85, v85, v165
    v_add_f32 v38, v38, v62
    v_add_f32 v86, v86, v166
    v_add_f32 v39, v39, v63
    v_add_f32 v87, v87, v167
    v_add_f32 v16, v16, v64
    v_fma_f32 v96, v16, v216, v96
    v_mul_f32 v96, v96, v219
    v_add_f32 v17, v17, v65
    v_fma_f32 v97, v17, v216, v97
    v_mul_f32 v97, v97, v219
    v_add_f32 v18, v18, v66
    v_fma_f32 v98, v18, v216, v98
    v_mul_f32 v98, v98, v219
    v_add_f32 v19, v19, v67
    v_fma_f32 v99, v19, v216, v99
    v_mul_f32 v99, v99, v219
    v_add_f32 v20, v20, v68
    v_fma_f32 v100, v20, v216, v100
    v_mul_f32 v100, v100, v219
    v_add_f32 v21, v21, v69
    v_fma_f32 v101, v21, v216, v101
    v_mul_f32 v101, v101, v219
    v_add_f32 v22, v22, v70
    v_fma_f32 v102, v22, v216, v102
    v_mul_f32 v102, v102, v219
    v_add_f32 v23, v23, v71
    v_fma_f32 v103, v23, v216, v103
    v_mul_f32 v103, v103, v219
    v_add_f32 v24, v24, v72
    v_fma_f32 v104, v24, v216, v104
    v_mul_f32 v104, v104, v219
    v_add_f32 v25, v25, v73
    v_fma_f32 v105, v25, v216, v105
    v_mul_f32 v105, v105, v219
    v_add_f32 v26, v26, v74
    v_fma_f32 v106, v26, v216, v106
    v_mul_f32 v106, v106, v219
    v_add_f32 v27, v27, v75
    v_fma_f32 v107, v27, v216, v107
    v_mul_f32 v107, v107, v219
    v_add_f32 v28, v28, v76
    v_fma_f32 v108, v28, v216, v108
    v_mul_f32 v108, v108, v219
    v_add_f32 v29, v29, v77
    v_fma_f32 v109, v29, v216, v109
    v_mul_f32 v109, v109, v219
    v_add_f32 v30, v30, v78
    v_fma_f32 v110, v30, v216, v110
    v_mul_f32 v110, v110, v219
    v_add_f32 v31, v31, v79
    v_fma_f32 v111, v31, v216, v111
    v_mul_f32 v111, v111, v219
    v_add_f32 v32, v32, v80
    v_fma_f32 v112, v32, v216, v112
    v_mul_f32 v112, v112, v219
    v_add_f32 v33, v33, v81
    v_fma_f32 v113, v33, v216, v113
    v_mul_f32 v113, v113, v219
    v_add_f32 v34, v34, v82
    v_fma_f32 v114, v34, v216, v114
    v_mul_f32 v114, v114, v219
    v_add_f32 v35, v35, v83
    v_fma_f32 v115, v35, v216, v115
    v_mul_f32 v115, v115, v219
    v_add_f32 v36, v36, v84
    v_fma_f32 v116, v36, v216, v116
    v_mul_f32 v116, v116, v217
    v_add_f32 v37, v37, v85
    v_fma_f32 v117, v37, v216, v117
    v_mul_f32 v117, v117, v217
    v_add_f32 v38, v38, v86
    v_fma_f32 v118, v38, v216, v118
    v_mul_f32 v118, v118, v217
    v_add_f32 v39, v39, v87
    v_fma_f32 v119, v39, v216, v119
    v_mul_f32 v119, v119, v217
    v_cvt_pk_bf16_f32 v222, v96, v97
    v_cvt_pk_bf16_f32 v223, v98, v99
    v_cvt_pk_bf16_f32 v224, v100, v101
    v_cvt_pk_bf16_f32 v225, v102, v103
    v_cvt_pk_bf16_f32 v226, v104, v105
    v_cvt_pk_bf16_f32 v227, v106, v107
    v_cvt_pk_bf16_f32 v228, v108, v109
    v_cvt_pk_bf16_f32 v229, v110, v111
    v_cvt_pk_bf16_f32 v230, v112, v113
    v_cvt_pk_bf16_f32 v231, v114, v115
    v_cvt_pk_bf16_f32 v232, v116, v117
    v_cvt_pk_bf16_f32 v233, v118, v119
    s_cmp_eq_u32 s25, 1
    s_cbranch_scc1 qkv1_kernel_odd21
    buffer_store_dwordx4 v[222:225], v5, s[44:47], s24 offen
    buffer_store_dwordx4 v[226:229], v5, s[44:47], s24 offen offset:1024
    buffer_store_dwordx2 v[230:231], v5, s[44:47], s24 offen offset:2048
    s_branch qkv1_kernel_done22
qkv1_kernel_odd21:
    buffer_store_dwordx2 v[222:223], v5, s[44:47], s24 offen offset:8
    buffer_store_dwordx4 v[224:227], v5, s[44:47], s24 offen offset:1024
    buffer_store_dwordx4 v[228:231], v5, s[44:47], s24 offen offset:2048
qkv1_kernel_done22:
    s_cmp_ge_u32 s17, 4
    s_cbranch_scc1 qkv1_kernel_kvdone23
    s_lshr_b32 s26, s20, 5
    s_mul_i32 s26, s26, 3072
    s_and_b32 s27, s3, 1
    s_lshl_b32 s29, s27, 4
    v_add_u32 v13, s29, v3
    v_mov_b32 v18, 0x7ffffff0
    s_cmp_ge_u32 s17, 2
    s_cbranch_scc1 qkv1_kernel_isV24
    v_lshrrev_b32 v14, 1, v2
    v_lshl_add_u32 v14, v14, 5, v13
    v_lshlrev_b32 v14, 4, v14
    v_and_b32 v15, 1, v2
    v_lshl_add_u32 v14, v15, 3, v14
    v_lshlrev_b32 v15, 3, v13
    v_lshl_add_u32 v15, v2, 8, v15
    v_add_u32 v15, 1024, v15
    v_mov_b32 v22, 0x3f80
    v_cmp_gt_u32 vcc, 2, v2
    s_nop 1
    v_cndmask_b32 v15, v18, v15, vcc
    v_cmp_eq_u32 vcc, 0, v2
    s_nop 1
    v_cndmask_b32 v19, 0, v232, vcc
    v_cndmask_b32 v20, 0, v233, vcc
    v_cndmask_b32 v22, v22, v232, vcc
    v_cndmask_b32 v23, 0, v233, vcc
    s_cmp_eq_u32 s25, 0
    s_cselect_b64 vcc, -1, 0
    s_nop 1
    v_cndmask_b32 v14, v15, v14, vcc
    v_cndmask_b32 v19, v19, v232, vcc
    v_cndmask_b32 v20, v20, v233, vcc
    v_cndmask_b32 v232, v22, v232, vcc
    v_cndmask_b32 v233, v23, v233, vcc
    buffer_store_dwordx2 v[232:233], v14, s[48:51], s26 offen
    v_mov_b32 v21, 0
    v_dot2_f32_bf16 v21, v19, v19, v21
    v_dot2_f32_bf16 v21, v20, v20, v21
    s_nop 2
    v_mov_b32 v24, v21
    s_nop 1
    v_permlane16_swap_b32 v21, v24
    v_add_f32 v21, v21, v24
    v_mov_b32 v24, v21
    s_nop 1
    v_permlane32_swap_b32 v21, v24
    v_add_f32 v21, v21, v24
    s_nop 1
    v_max_f32_dpp v21, v21, v21 row_ror:8 row_mask:0xf bank_mask:0xf
    s_nop 1
    v_max_f32_dpp v21, v21, v21 row_ror:4 row_mask:0xf bank_mask:0xf
    s_nop 1
    v_max_f32_dpp v21, v21, v21 row_ror:2 row_mask:0xf bank_mask:0xf
    s_nop 1
    v_max_f32_dpp v21, v21, v21 row_ror:1 row_mask:0xf bank_mask:0xf
    s_lshl_b32 s29, s25, 7
    s_lshl_b32 s30, s16, 2
    s_add_u32 s29, s29, s30
    s_add_u32 s29, s29, s3
    s_lshl_b32 s29, s29, 2
    v_mov_b32 v13, 0
    v_cmp_eq_u32 vcc, 0, v1
    s_nop 1
    v_cndmask_b32 v13, v18, v13, vcc
    buffer_store_dword v21, v13, s[52:55], s29 offen
    s_branch qkv1_kernel_kvdone23
qkv1_kernel_isV24:
    s_mul_i32 s29, s27, 768
    s_lshl_b32 s30, s25, 8
    s_add_u32 s29, s29, s30
    s_add_u32 s29, s29, 1536
    v_bfe_u32 v14, v3, 2, 1
    v_mul_u32_u24 v14, 384, v14
    v_lshl_add_u32 v14, v2, 6, v14
    v_and_b32 v15, 3, v3
    v_lshl_add_u32 v14, v15, 1, v14
    v_lshrrev_b32 v15, 3, v3
    v_lshl_add_u32 v14, v15, 3, v14
    v_add_u32 v14, s29, v14
    v_mov_b32 v19, v14
    v_mov_b32 v20, v14
    s_cmp_eq_u32 s25, 0
    s_cbranch_scc1 qkv1_kernel_isV24_st
    v_cmp_eq_u32 vcc, 1, v2
    v_mov_b32 v21, 0x3f80
    s_nop 0
    v_cndmask_b32 v232, v232, v21, vcc
    v_cmp_gt_u32 vcc, 2, v2
    s_nop 1
    v_cndmask_b32 v19, v18, v14, vcc
    v_cmp_gt_u32 vcc, 1, v2
    s_nop 1
    v_cndmask_b32 v20, v18, v14, vcc
qkv1_kernel_isV24_st:
    buffer_store_short v232, v19, s[48:51], s26 offen
    buffer_store_short_d16_hi v232, v19, s[48:51], s26 offen offset:16
    buffer_store_short v233, v20, s[48:51], s26 offen offset:32
    buffer_store_short_d16_hi v233, v20, s[48:51], s26 offen offset:48
qkv1_kernel_kvdone23:
qkv1_kernel_end:
    s_endpgm

.globl attn1_kernel
.p2align 8
.type attn1_kernel,@function
attn1_kernel:
    s_cmp_ge_u32 s2, 256
    s_cbranch_scc1 attn1_kernel_end
    s_load_dwordx2 s[4:5], s[0:1], 96
    v_lshrrev_b32 v2, 6, v0
    v_and_b32 v1, 63, v0
    v_readfirstlane_b32 s3, v2
    v_lshrrev_b32 v2, 5, v1
    v_and_b32 v3, 31, v1
    v_lshlrev_b32 v4, 4, v1
    s_lshr_b32 s20, s2, 1
    s_mul_i32 s20, s20, 20480
    s_and_b32 s21, s2, 1
    s_lshl_b32 s21, s21, 7
    s_add_u32 s20, s20, s21
    s_mov_b32 s15, 0
    s_waitcnt lgkmcnt(0)
    s_cmp_eq_u32 s3, 4
    s_cbranch_scc1 attn1_kernel_loader1
    s_add_u32 s32, s4, 0
    s_addc_u32 s33, s5, 0
    s_mov_b32 s34, 2621440
    s_mov_b32 s35, 0x00020000
    s_add_u32 s40, s4, 3407872
    s_addc_u32 s41, s5, 0
    s_mov_b32 s42, 1024
    s_mov_b32 s43, 0x00020000
    v_lshrrev_b32 v5, 3, v0
    v_lshlrev_b32 v5, 8, v5
    v_and_b32 v6, 7, v0
    v_lshl_add_u32 v5, v6, 4, v5
    v_lshrrev_b32 v7, 1, v1
    v_lshlrev_b32 v7, 8, v7
    v_and_b32 v8, 1, v1
    v_lshl_add_u32 v7, v8, 4, v7
    s_lshl_b32 s21, s3, 5
    s_add_u32 s21, s21, s20
    s_mul_i32 s22, s3, 3072
    s_add_u32 m0, s22, 98304
    v_lshlrev_b32 v6, 2, v1
    buffer_load_dwordx4 v7, s[32:35], s21 offen lds
    s_add_u32 m0, s22, 99328
    s_add_u32 s21, s21, 8192
    buffer_load_dwordx4 v7, s[32:35], s21 offen lds
    s_add_u32 m0, s22, 100352
    s_add_u32 s21, s21, 8192
    buffer_load_dwordx4 v7, s[32:35], s21 offen lds
    buffer_load_dword v16, v6, s[40:43], 0 offen
    buffer_load_dword v17, v6, s[40:43], 0 offen offset:256
    buffer_load_dword v18, v6, s[40:43], 0 offen offset:512
    buffer_load_dword v19, v6, s[40:43], 0 offen offset:768
    s_add_u32 s44, s4, 4194304
    s_addc_u32 s45, s5, 0
    s_mov_b32 s46, 2621440
    s_mov_b32 s47, 0x00020000
    s_add_u32 s21, s22, 98304
    s_lshl_b32 s22, s3, 5
    s_add_u32 s22, s22, 98304
    v_mul_u32_u24 v21, 5, v3
    v_lshl_add_u32 v21, v2, 1, v21
    v_add_u32 v7, 0, v21
    v_lshrrev_b32 v8, 3, v7
    v_lshlrev_b32 v8, 2, v8
    v_and_b32 v9, 3, v7
    v_add_u32 v8, v8, v9
    v_lshlrev_b32 v8, 5, v8
    v_bfe_u32 v9, v7, 2, 1
    v_lshl_add_u32 v8, v9, 3, v8
    v_add_u32 v22, s21, v8
    v_add_u32 v7, 1, v21
    v_lshrrev_b32 v8, 3, v7
    v_lshlrev_b32 v8, 2, v8
    v_and_b32 v9, 3, v7
    v_add_u32 v8, v8, v9
    v_lshlrev_b32 v8, 5, v8
    v_bfe_u32 v9, v7, 2, 1
    v_lshl_add_u32 v8, v9, 3, v8
    v_add_u32 v23, s21, v8
    v_mul_u32_u24 v21, 5, v3
    v_add_u32 v7, 4, v21
    v_lshrrev_b32 v8, 3, v7
    v_lshlrev_b32 v8, 2, v8
    v_and_b32 v9, 3, v7
    v_add_u32 v8, v8, v9
    v_lshlrev_b32 v8, 5, v8
    v_bfe_u32 v9, v7, 2, 1
    v_lshl_add_u32 v8, v9, 3, v8
    v_add_u32 v24, s21, v8
    v_add_u32 v7, 4, v21
    v_lshrrev_b32 v8, 3, v7
    v_lshlrev_b32 v8, 2, v8
    v_and_b32 v9, 3, v7
    v_add_u32 v8, v8, v9
    v_lshlrev_b32 v8, 7, v8
    v_bfe_u32 v9, v7, 2, 1
    v_lshl_add_u32 v8, v9, 3, v8
    v_add_u32 v13, s22, v8
    v_add_u32 v21, v21, v2
    v_add_u32 v7, 0, v21
    v_lshrrev_b32 v8, 3, v7
    v_lshlrev_b32 v8, 2, v8
    v_and_b32 v9, 3, v7
    v_add_u32 v8, v8, v9
    v_lshlrev_b32 v8, 7, v8
    v_bfe_u32 v9, v7, 2, 1
    v_lshl_add_u32 v8, v9, 3, v8
    v_add_u32 v10, s22, v8
    v_add_u32 v7, 2, v21
    v_lshrrev_b32 v8, 3, v7
    v_lshlrev_b32 v8, 2, v8
    v_and_b32 v9, 3, v7
    v_add_u32 v8, v8, v9
    v_lshlrev_b32 v8, 7, v8
    v_bfe_u32 v9, v7, 2, 1
    v_lshl_add_u32 v8, v9, 3, v8
    v_add_u32 v11, s22, v8
    v_lshlrev_b32 v25, 3, v1
    v_add_u32 v25, 1024, v25
    v_min_u32 v26, 21, v3
    v_lshlrev_b32 v26, 4, v26
    v_mul_u32_u24 v27, 384, v2
    v_add_u32 v26, v26, v27
    v_add_u32 v26, 1536, v26
    v_mov_b32 v7, 110624
    v_cmp_gt_u32 vcc, 32, v1
    s_nop 1
    v_cndmask_b32 v12, v7, v13, vcc
    s_waitcnt vmcnt(0)
    v_max_f32 v16, v16, v17
    v_max_f32 v18, v18, v19
    s_nop 1
    v_max_f32_dpp v16, v16, v16 row_ror:8 row_mask:0xf bank_mask:0xf
    s_nop 1
    v_max_f32_dpp v16, v16, v16 row_ror:4 row_mask:0xf bank_mask:0xf
    s_nop 1
    v_max_f32_dpp v16, v16, v16 row_ror:2 row_mask:0xf bank_mask:0xf
    s_nop 1
    v_max_f32_dpp v16, v16, v16 row_ror:1 row_mask:0xf bank_mask:0xf
    v_mov_b32 v17, v16
    s_nop 1
    v_permlane16_swap_b32 v16, v17
    v_max_f32 v16, v16, v17
    v_mov_b32 v17, v16
    s_nop 1
    v_permlane32_swap_b32 v16, v17
    v_max_f32 v16, v16, v17
    s_nop 1
    v_max_f32_dpp v18, v18, v18 row_ror:8 row_mask:0xf bank_mask:0xf
    s_nop 1
    v_max_f32_dpp v18, v18, v18 row_ror:4 row_mask:0xf bank_mask:0xf
    s_nop 1
    v_max_f32_dpp v18, v18, v18 row_ror:2 row_mask:0xf bank_mask:0xf
    s_nop 1
    v_max_f32_dpp v18, v18, v18 row_ror:1 row_mask:0xf bank_mask:0xf
    v_mov_b32 v17, v18
    s_nop 1
    v_permlane16_swap_b32 v18, v17
    v_max_f32 v18, v18, v17
    v_mov_b32 v17, v18
    s_nop 1
    v_permlane32_swap_b32 v18, v17
    v_max_f32 v18, v18, v17
    v_add_f32 v16, v16, v18
    ds_read_b64 v[32:33], v22 offset:0
    ds_read_b64 v[34:35], v23 offset:0
    ds_read_b64 v[36:37], v24 offset:0
    ds_read_b64 v[40:41], v22 offset:16
    ds_read_b64 v[42:43], v23 offset:16
    ds_read_b64 v[44:45], v24 offset:16
    s_waitcnt lgkmcnt(0)
    v_cndmask_b32 v36, 0, v36, vcc
    v_cndmask_b32 v37, 0, v37, vcc
    v_mov_b32 v17, 0
    v_dot2_f32_bf16 v17, v32, v32, v17
    v_dot2_f32_bf16 v17, v33, v33, v17
    v_dot2_f32_bf16 v17, v34, v34, v17
    v_dot2_f32_bf16 v17, v35, v35, v17
    v_dot2_f32_bf16 v17, v36, v36, v17
    v_dot2_f32_bf16 v17, v37, v37, v17
    s_nop 2
    v_mov_b32 v18, v17
    s_nop 1
    v_permlane32_swap_b32 v17, v18
    v_add_f32 v17, v17, v18
    v_mul_f32 v17, v17, v16
    v_sqrt_f32 v17, v17
    s_nop 0
    v_mul_f32 v17, 0xbf8147ae, v17
    v_cvt_pk_bf16_f32 v17, v17, 0
    v_cndmask_b32 v36, v17, v36, vcc
    v_cndmask_b32 v44, 0, v44, vcc
    v_cndmask_b32 v45, 0, v45, vcc
    v_mov_b32 v17, 0
    v_dot2_f32_bf16 v17, v40, v40, v17
    v_dot2_f32_bf16 v17, v41, v41, v17
    v_dot2_f32_bf16 v17, v42, v42, v17
    v_dot2_f32_bf16 v17, v43, v43, v17
    v_dot2_f32_bf16 v17, v44, v44, v17
    v_dot2_f32_bf16 v17, v45, v45, v17
    s_nop 2
    v_mov_b32 v18, v17
    s_nop 1
    v_permlane32_swap_b32 v17, v18
    v_add_f32 v17, v17, v18
    v_mul_f32 v17, v17, v16
    v_sqrt_f32 v17, v17
    s_nop 0
    v_mul_f32 v17, 0xbf8147ae, v17
    v_cvt_pk_bf16_f32 v17, v17, 0
    v_cndmask_b32 v44, v17, v44, vcc
attn1_kernel_mainpass2:
    v_mov_b32 v128, 0
    v_mov_b32 v129, 0
    v_mov_b32 v130, 0
    v_mov_b32 v131, 0
    v_mov_b32 v132, 0
    v_mov_b32 v133, 0
    v_mov_b32 v134, 0
    v_mov_b32 v135, 0
    v_mov_b32 v136, 0
    v_mov_b32 v137, 0
    v_mov_b32 v138, 0
    v_mov_b32 v139, 0
    v_mov_b32 v140, 0
    v_mov_b32 v141, 0
    v_mov_b32 v142, 0
    v_mov_b32 v143, 0
    v_mov_b32 v144, 0
    v_mov_b32 v145, 0
    v_mov_b32 v146, 0
    v_mov_b32 v147, 0
    v_mov_b32 v148, 0
    v_mov_b32 v149, 0
    v_mov_b32 v150, 0
    v_mov_b32 v151, 0
    v_mov_b32 v152, 0
    v_mov_b32 v153, 0
    v_mov_b32 v154, 0
    v_mov_b32 v155, 0
    v_mov_b32 v156, 0
    v_mov_b32 v157, 0
    v_mov_b32 v158, 0
    v_mov_b32 v159, 0
    v_mov_b32 v124, 0
    v_mov_b32 v125, 0
    v_mov_b32 v126, 0
    v_mov_b32 v127, 0
    v_mov_b32 v108, 0
    v_mov_b32 v109, 0
    v_mov_b32 v110, 0
    v_mov_b32 v111, 0
    v_mov_b32 v188, 0
    v_mov_b32 v189, 0
    v_mov_b32 v190, 0
    v_mov_b32 v191, 0
    v_mov_b32 v28, v4
    v_add_u32 v192, 24576, v4
    v_mov_b32 v29, v25
    v_add_u32 v193, 24576, v25
    v_mov_b32 v30, v26
    v_add_u32 v194, 24576, v26
    s_mov_b32 s23, 49152
    s_barrier
    ds_read_b128 v[160:163], v28 offset:0
    ds_read_b64 v[168:169], v29 offset:0
    s_waitcnt lgkmcnt(0)
    v_mfma_f32_32x32x16_bf16 v[48:63], v[160:163], v[32:35], 0
    v_mfma_f32_32x32x8_bf16 v[48:63], v[168:169], v[36:37], v[48:63]
    v_mfma_f32_32x32x16_bf16 v[80:95], v[160:163], v[40:43], 0
    v_mfma_f32_32x32x8_bf16 v[80:95], v[168:169], v[44:45], v[80:95]
    ds_read_b128 v[164:167], v28 offset:3072
    ds_read_b64 v[172:173], v29 offset:3072
    ds_read_b128 v[176:179], v30 offset:0
    ds_read_b128 v[180:183], v30 offset:768
    s_nop 7
    s_nop 3
    s_mov_b32 s24, 8
attn1_kernel_loop3:
    s_waitcnt lgkmcnt(0)
    v_mfma_f32_32x32x16_bf16 v[64:79], v[164:167], v[32:35], 0
    v_cvt_pk_bf16_f32 v126, v108, v109
    v_cvt_pk_bf16_f32 v127, v110, v111
    v_exp_f32 v48, v48
    v_exp_f32 v49, v49
    v_exp_f32 v50, v50
    v_exp_f32 v51, v51
    v_mfma_f32_32x32x16_bf16 v[144:159], v[188:191], v[124:127], v[144:159]
    ds_read_b128 v[160:163], v28 offset:6144
    ds_read_b64 v[168:169], v29 offset:6144
    ds_read_b128 v[184:187], v30 offset:3072
    ds_read_b128 v[188:191], v30 offset:3840
    v_cvt_pk_bf16_f32 v112, v48, v49
    v_cvt_pk_bf16_f32 v113, v50, v51
    v_exp_f32 v52, v52
    v_exp_f32 v53, v53
    v_exp_f32 v54, v54
    v_exp_f32 v55, v55
    v_mfma_f32_32x32x8_bf16 v[64:79], v[172:173], v[36:37], v[64:79]
    v_cvt_pk_bf16_f32 v114, v52, v53
    v_cvt_pk_bf16_f32 v115, v54, v55
    v_exp_f32 v56, v56
    v_exp_f32 v57, v57
    v_exp_f32 v58, v58
    v_exp_f32 v59, v59
    v_mfma_f32_32x32x16_bf16 v[128:143], v[176:179], v[112:115], v[128:143]
    v_cvt_pk_bf16_f32 v116, v56, v57
    v_cvt_pk_bf16_f32 v117, v58, v59
    v_exp_f32 v60, v60
    v_exp_f32 v61, v61
    v_exp_f32 v62, v62
    v_exp_f32 v63, v63
    v_mfma_f32_32x32x16_bf16 v[96:111], v[164:167], v[40:43], 0
    v_cvt_pk_bf16_f32 v118, v60, v61
    v_cvt_pk_bf16_f32 v119, v62, v63
    v_exp_f32 v80, v80
    v_exp_f32 v81, v81
    v_exp_f32 v82, v82
    v_exp_f32 v83, v83
    v_mfma_f32_32x32x16_bf16 v[128:143], v[180:183], v[116:119], v[128:143]
    v_cvt_pk_bf16_f32 v120, v80, v81
    v_cvt_pk_bf16_f32 v121, v82, v83
    v_exp_f32 v84, v84
    v_exp_f32 v85, v85
    v_exp_f32 v86, v86
    v_exp_f32 v87, v87
    v_mfma_f32_32x32x8_bf16 v[96:111], v[172:173], v[44:45], v[96:111]
    v_cvt_pk_bf16_f32 v122, v84, v85
    v_cvt_pk_bf16_f32 v123, v86, v87
    v_exp_f32 v88, v88
    v_exp_f32 v89, v89
    v_exp_f32 v90, v90
    v_exp_f32 v91, v91
    v_mfma_f32_32x32x16_bf16 v[144:159], v[176:179], v[120:123], v[144:159]
    v_cvt_pk_bf16_f32 v124, v88, v89
    v_cvt_pk_bf16_f32 v125, v90, v91
    v_exp_f32 v92, v92
    v_exp_f32 v93, v93
    v_exp_f32 v94, v94
    v_exp_f32 v95, v95
    s_waitcnt lgkmcnt(0)
    v_mfma_f32_32x32x16_bf16 v[48:63], v[160:163], v[32:35], 0
    v_cvt_pk_bf16_f32 v126, v92, v93
    v_cvt_pk_bf16_f32 v127, v94, v95
    v_exp_f32 v64, v64
    v_exp_f32 v65, v65
    v_exp_f32 v66, v66
    v_exp_f32 v67, v67
    v_mfma_f32_32x32x16_bf16 v[144:159], v[180:183], v[124:127], v[144:159]
    ds_read_b128 v[164:167], v28 offset:9216
    ds_read_b64 v[172:173], v29 offset:9216
    ds_read_b128 v[176:179], v30 offset:6144
    ds_read_b128 v[180:183], v30 offset:6912
    v_cvt_pk_bf16_f32 v112, v64, v65
    v_cvt_pk_bf16_f32 v113, v66, v67
    v_exp_f32 v68, v68
    v_exp_f32 v69, v69
    v_exp_f32 v70, v70
    v_exp_f32 v71, v71
    v_mfma_f32_32x32x8_bf16 v[48:63], v[168:169], v[36:37], v[48:63]
    v_cvt_pk_bf16_f32 v114, v68, v69
    v_cvt_pk_bf16_f32 v115, v70, v71
    v_exp_f32 v72, v72
    v_exp_f32 v73, v73
    v_exp_f32 v74, v74
    v_exp_f32 v75, v75
    v_mfma_f32_32x32x16_bf16 v[128:143], v[184:187], v[112:115], v[128:143]
    v_cvt_pk_bf16_f32 v116, v72, v73
    v_cvt_pk_bf16_f32 v117, v74, v75
    v_exp_f32 v76, v76
    v_exp_f32 v77, v77
    v_exp_f32 v78, v78
    v_exp_f32 v79, v79
    v_mfma_f32_32x32x16_bf16 v[80:95], v[160:163], v[40:43], 0
    v_cvt_pk_bf16_f32 v118, v76, v77
    v_cvt_pk_bf16_f32 v119, v78, v79
    v_exp_f32 v96, v96
    v_exp_f32 v97, v97
    v_exp_f32 v98, v98
    v_exp_f32 v99, v99
    v_mfma_f32_32x32x16_bf16 v[128:143], v[188:191], v[116:119], v[128:143]
    v_cvt_pk_bf16_f32 v120, v96, v97
    v_cvt_pk_bf16_f32 v121, v98, v99
    v_exp_f32 v100, v100
    v_exp_f32 v101, v101
    v_exp_f32 v102, v102
    v_exp_f32 v103, v103
    v_mfma_f32_32x32x8_bf16 v[80:95], v[168:169], v[44:45], v[80:95]
    v_cvt_pk_bf16_f32 v122, v100, v101
    v_cvt_pk_bf16_f32 v123, v102, v103
    v_exp_f32 v104, v104
    v_exp_f32 v105, v105
    v_exp_f32 v106, v106
    v_exp_f32 v107, v107
    v_mfma_f32_32x32x16_bf16 v[144:159], v[184:187], v[120:123], v[144:159]
    v_cvt_pk_bf16_f32 v124, v104, v105
    v_cvt_pk_bf16_f32 v125, v106, v107
    v_exp_f32 v108, v108
    v_exp_f32 v109, v109
    v_exp_f32 v110, v110
    v_exp_f32 v111, v111
    s_waitcnt lgkmcnt(0)
    v_mfma_f32_32x32x16_bf16 v[64:79], v[164:167], v[32:35], 0
    v_cvt_pk_bf16_f32 v126, v108, v109
    v_cvt_pk_bf16_f32 v127, v110, v111
    v_exp_f32 v48, v48
    v_exp_f32 v49, v49
    v_exp_f32 v50, v50
    v_exp_f32 v51, v51
    v_mfma_f32_32x32x16_bf16 v[144:159], v[188:191], v[124:127], v[144:159]
    ds_read_b128 v[160:163], v28 offset:12288
    ds_read_b64 v[168:169], v29 offset:12288
    ds_read_b128 v[184:187], v30 offset:9216
    ds_read_b128 v[188:191], v30 offset:9984
    v_cvt_pk_bf16_f32 v112, v48, v49
    v_cvt_pk_bf16_f32 v113, v50, v51
    v_exp_f32 v52, v52
    v_exp_f32 v53, v53
    v_exp_f32 v54, v54
    v_exp_f32 v55, v55
    v_mfma_f32_32x32x8_bf16 v[64:79], v[172:173], v[36:37], v[64:79]
    v_cvt_pk_bf16_f32 v114, v52, v53
    v_cvt_pk_bf16_f32 v115, v54, v55
    v_exp_f32 v56, v56
    v_exp_f32 v57, v57
    v_exp_f32 v58, v58
    v_exp_f32 v59, v59
    v_mfma_f32_32x32x16_bf16 v[128:143], v[176:179], v[112:115], v[128:143]
    v_cvt_pk_bf16_f32 v116, v56, v57
    v_cvt_pk_bf16_f32 v117, v58, v59
    v_exp_f32 v60, v60
    v_exp_f32 v61, v61
    v_exp_f32 v62, v62
    v_exp_f32 v63, v63
    v_mfma_f32_32x32x16_bf16 v[96:111], v[164:167], v[40:43], 0
    v_cvt_pk_bf16_f32 v118, v60, v61
    v_cvt_pk_bf16_f32 v119, v62, v63
    v_exp_f32 v80, v80
    v_exp_f32 v81, v81
    v_exp_f32 v82, v82
    v_exp_f32 v83, v83
    v_mfma_f32_32x32x16_bf16 v[128:143], v[180:183], v[116:119], v[128:143]
    v_cvt_pk_bf16_f32 v120, v80, v81
    v_cvt_pk_bf16_f32 v121, v82, v83
    v_exp_f32 v84, v84
    v_exp_f32 v85, v85
    v_exp_f32 v86, v86
    v_exp_f32 v87, v87
    v_mfma_f32_32x32x8_bf16 v[96:111], v[172:173], v[44:45], v[96:111]
    v_cvt_pk_bf16_f32 v122, v84, v85
    v_cvt_pk_bf16_f32 v123, v86, v87
    v_exp_f32 v88, v88
    v_exp_f32 v89, v89
    v_exp_f32 v90, v90
    v_exp_f32 v91, v91
    v_mfma_f32_32x32x16_bf16 v[144:159], v[176:179], v[120:123], v[144:159]
    v_cvt_pk_bf16_f32 v124, v88, v89
    v_cvt_pk_bf16_f32 v125, v90, v91
    v_exp_f32 v92, v92
    v_exp_f32 v93, v93
    v_exp_f32 v94, v94
    v_exp_f32 v95, v95
    s_waitcnt lgkmcnt(0)
    v_mfma_f32_32x32x16_bf16 v[48:63], v[160:163], v[32:35], 0
    v_cvt_pk_bf16_f32 v126, v92, v93
    v_cvt_pk_bf16_f32 v127, v94, v95
    v_exp_f32 v64, v64
    v_exp_f32 v65, v65
    v_exp_f32 v66, v66
    v_exp_f32 v67, v67
    v_mfma_f32_32x32x16_bf16 v[144:159], v[180:183], v[124:127], v[144:159]
    ds_read_b128 v[164:167], v28 offset:15360
    ds_read_b64 v[172:173], v29 offset:15360
    ds_read_b128 v[176:179], v30 offset:12288
    ds_read_b128 v[180:183], v30 offset:13056
    v_cvt_pk_bf16_f32 v112, v64, v65
    v_cvt_pk_bf16_f32 v113, v66, v67
    v_exp_f32 v68, v68
    v_exp_f32 v69, v69
    v_exp_f32 v70, v70
    v_exp_f32 v71, v71
    v_mfma_f32_32x32x8_bf16 v[48:63], v[168:169], v[36:37], v[48:63]
    v_cvt_pk_bf16_f32 v114, v68, v69
    v_cvt_pk_bf16_f32 v115, v70, v71
    v_exp_f32 v72, v72
    v_exp_f32 v73, v73
    v_exp_f32 v74, v74
    v_exp_f32 v75, v75
    v_mfma_f32_32x32x16_bf16 v[128:143], v[184:187], v[112:115], v[128:143]
    v_cvt_pk_bf16_f32 v116, v72, v73
    v_cvt_pk_bf16_f32 v117, v74, v75
    v_exp_f32 v76, v76
    v_exp_f32 v77, v77
    v_exp_f32 v78, v78
    v_exp_f32 v79, v79
    v_mfma_f32_32x32x16_bf16 v[80:95], v[160:163], v[40:43], 0
    v_cvt_pk_bf16_f32 v118, v76, v77
    v_cvt_pk_bf16_f32 v119, v78, v79
    v_exp_f32 v96, v96
    v_exp_f32 v97, v97
    v_exp_f32 v98, v98
    v_exp_f32 v99, v99
    v_mfma_f32_32x32x16_bf16 v[128:143], v[188:191], v[116:119], v[128:143]
    v_cvt_pk_bf16_f32 v120, v96, v97
    v_cvt_pk_bf16_f32 v121, v98, v99
    v_exp_f32 v100, v100
    v_exp_f32 v101, v101
    v_exp_f32 v102, v102
    v_exp_f32 v103, v103
    v_mfma_f32_32x32x8_bf16 v[80:95], v[168:169], v[44:45], v[80:95]
    v_cvt_pk_bf16_f32 v122, v100, v101
    v_cvt_pk_bf16_f32 v123, v102, v103
    v_exp_f32 v104, v104
    v_exp_f32 v105, v105
    v_exp_f32 v106, v106
    v_exp_f32 v107, v107
    v_mfma_f32_32x32x16_bf16 v[144:159], v[184:187], v[120:123], v[144:159]
    v_cvt_pk_bf16_f32 v124, v104, v105
    v_cvt_pk_bf16_f32 v125, v106, v107
    v_exp_f32 v108, v108
    v_exp_f32 v109, v109
    v_exp_f32 v110, v110
    v_exp_f32 v111, v111
    s_waitcnt lgkmcnt(0)
    v_mfma_f32_32x32x16_bf16 v[64:79], v[164:167], v[32:35], 0
    v_cvt_pk_bf16_f32 v126, v108, v109
    v_cvt_pk_bf16_f32 v127, v110, v111
    v_exp_f32 v48, v48
    v_exp_f32 v49, v49
    v_exp_f32 v50, v50
    v_exp_f32 v51, v51
    v_mfma_f32_32x32x16_bf16 v[144:159], v[188:191], v[124:127], v[144:159]
    ds_read_b128 v[160:163], v28 offset:18432
    ds_read_b64 v[168:169], v29 offset:18432
    ds_read_b128 v[184:187], v30 offset:15360
    ds_read_b128 v[188:191], v30 offset:16128
    v_cvt_pk_bf16_f32 v112, v48, v49
    v_cvt_pk_bf16_f32 v113, v50, v51
    v_exp_f32 v52, v52
    v_exp_f32 v53, v53
    v_exp_f32 v54, v54
    v_exp_f32 v55, v55
    v_mfma_f32_32x32x8_bf16 v[64:79], v[172:173], v[36:37], v[64:79]
    v_cvt_pk_bf16_f32 v114, v52, v53
    v_cvt_pk_bf16_f32 v115, v54, v55
    v_exp_f32 v56, v56
    v_exp_f32 v57, v57
    v_exp_f32 v58, v58
    v_exp_f32 v59, v59
    v_mfma_f32_32x32x16_bf16 v[128:143], v[176:179], v[112:115], v[128:143]
    v_cvt_pk_bf16_f32 v116, v56, v57
    v_cvt_pk_bf16_f32 v117, v58, v59
    v_exp_f32 v60, v60
    v_exp_f32 v61, v61
    v_exp_f32 v62, v62
    v_exp_f32 v63, v63
    v_mfma_f32_32x32x16_bf16 v[96:111], v[164:167], v[40:43], 0
    v_cvt_pk_bf16_f32 v118, v60, v61
    v_cvt_pk_bf16_f32 v119, v62, v63
    v_exp_f32 v80, v80
    v_exp_f32 v81, v81
    v_exp_f32 v82, v82
    v_exp_f32 v83, v83
    v_mfma_f32_32x32x16_bf16 v[128:143], v[180:183], v[116:119], v[128:143]
    v_cvt_pk_bf16_f32 v120, v80, v81
    v_cvt_pk_bf16_f32 v121, v82, v83
    v_exp_f32 v84, v84
    v_exp_f32 v85, v85
    v_exp_f32 v86, v86
    v_exp_f32 v87, v87
    v_mfma_f32_32x32x8_bf16 v[96:111], v[172:173], v[44:45], v[96:111]
    v_cvt_pk_bf16_f32 v122, v84, v85
    v_cvt_pk_bf16_f32 v123, v86, v87
    v_exp_f32 v88, v88
    v_exp_f32 v89, v89
    v_exp_f32 v90, v90
    v_exp_f32 v91, v91
    v_mfma_f32_32x32x16_bf16 v[144:159], v[176:179], v[120:123], v[144:159]
    v_cvt_pk_bf16_f32 v124, v88, v89
    v_cvt_pk_bf16_f32 v125, v90, v91
    v_exp_f32 v92, v92
    v_exp_f32 v93, v93
    v_exp_f32 v94, v94
    v_exp_f32 v95, v95
    s_waitcnt lgkmcnt(0)
    v_mfma_f32_32x32x16_bf16 v[48:63], v[160:163], v[32:35], 0
    v_cvt_pk_bf16_f32 v126, v92, v93
    v_cvt_pk_bf16_f32 v127, v94, v95
    v_exp_f32 v64, v64
    v_exp_f32 v65, v65
    v_exp_f32 v66, v66
    v_exp_f32 v67, v67
    v_mfma_f32_32x32x16_bf16 v[144:159], v[180:183], v[124:127], v[144:159]
    ds_read_b128 v[164:167], v28 offset:21504
    ds_read_b64 v[172:173], v29 offset:21504
    ds_read_b128 v[176:179], v30 offset:18432
    ds_read_b128 v[180:183], v30 offset:19200
    v_cvt_pk_bf16_f32 v112, v64, v65
    v_cvt_pk_bf16_f32 v113, v66, v67
    v_exp_f32 v68, v68
    v_exp_f32 v69, v69
    v_exp_f32 v70, v70
    v_exp_f32 v71, v71
    v_mfma_f32_32x32x8_bf16 v[48:63], v[168:169], v[36:37], v[48:63]
    v_cvt_pk_bf16_f32 v114, v68, v69
    v_cvt_pk_bf16_f32 v115, v70, v71
    v_exp_f32 v72, v72
    v_exp_f32 v73, v73
    v_exp_f32 v74, v74
    v_exp_f32 v75, v75
    v_mfma_f32_32x32x16_bf16 v[128:143], v[184:187], v[112:115], v[128:143]
    v_cvt_pk_bf16_f32 v116, v72, v73
    v_cvt_pk_bf16_f32 v117, v74, v75
    v_exp_f32 v76, v76
    v_exp_f32 v77, v77
    v_exp_f32 v78, v78
    v_exp_f32 v79, v79
    v_mfma_f32_32x32x16_bf16 v[80:95], v[160:163], v[40:43], 0
    v_cvt_pk_bf16_f32 v118, v76, v77
    v_cvt_pk_bf16_f32 v119, v78, v79
    v_exp_f32 v96, v96
    v_exp_f32 v97, v97
    v_exp_f32 v98, v98
    v_exp_f32 v99, v99
    v_mfma_f32_32x32x16_bf16 v[128:143], v[188:191], v[116:119], v[128:143]
    v_cvt_pk_bf16_f32 v120, v96, v97
    v_cvt_pk_bf16_f32 v121, v98, v99
    v_exp_f32 v100, v100
    v_exp_f32 v101, v101
    v_exp_f32 v102, v102
    v_exp_f32 v103, v103
    v_mfma_f32_32x32x8_bf16 v[80:95], v[168:169], v[44:45], v[80:95]
    v_cvt_pk_bf16_f32 v122, v100, v101
    v_cvt_pk_bf16_f32 v123, v102, v103
    v_exp_f32 v104, v104
    v_exp_f32 v105, v105
    v_exp_f32 v106, v106
    v_exp_f32 v107, v107
    v_mfma_f32_32x32x16_bf16 v[144:159], v[184:187], v[120:123], v[144:159]
    v_cvt_pk_bf16_f32 v124, v104, v105
    v_cvt_pk_bf16_f32 v125, v106, v107
    v_exp_f32 v108, v108
    v_exp_f32 v109, v109
    v_exp_f32 v110, v110
    v_exp_f32 v111, v111
    s_waitcnt lgkmcnt(0)
    v_mfma_f32_32x32x16_bf16 v[64:79], v[164:167], v[32:35], 0
    v_cvt_pk_bf16_f32 v126, v108, v109
    v_cvt_pk_bf16_f32 v127, v110, v111
    v_exp_f32 v48, v48
    v_exp_f32 v49, v49
    v_exp_f32 v50, v50
    v_exp_f32 v51, v51
    v_mfma_f32_32x32x16_bf16 v[144:159], v[188:191], v[124:127], v[144:159]
    s_barrier
    ds_read_b128 v[160:163], v192 offset:0
    ds_read_b64 v[168:169], v193 offset:0
    ds_read_b128 v[184:187], v30 offset:21504
    ds_read_b128 v[188:191], v30 offset:22272
    v_cvt_pk_bf16_f32 v112, v48, v49
    v_cvt_pk_bf16_f32 v113, v50, v51
    v_exp_f32 v52, v52
    v_exp_f32 v53, v53
    v_exp_f32 v54, v54
    v_exp_f32 v55, v55
    v_mfma_f32_32x32x8_bf16 v[64:79], v[172:173], v[36:37], v[64:79]
    v_cvt_pk_bf16_f32 v114, v52, v53
    v_cvt_pk_bf16_f32 v115, v54, v55
    v_exp_f32 v56, v56
    v_exp_f32 v57, v57
    v_exp_f32 v58, v58
    v_exp_f32 v59, v59
    v_mfma_f32_32x32x16_bf16 v[128:143], v[176:179], v[112:115], v[128:143]
    v_cvt_pk_bf16_f32 v116, v56, v57
    v_cvt_pk_bf16_f32 v117, v58, v59
    v_exp_f32 v60, v60
    v_exp_f32 v61, v61
    v_exp_f32 v62, v62
    v_exp_f32 v63, v63
    v_mfma_f32_32x32x16_bf16 v[96:111], v[164:167], v[40:43], 0
    v_cvt_pk_bf16_f32 v118, v60, v61
    v_cvt_pk_bf16_f32 v119, v62, v63
    v_exp_f32 v80, v80
    v_exp_f32 v81, v81
    v_exp_f32 v82, v82
    v_exp_f32 v83, v83
    v_mfma_f32_32x32x16_bf16 v[128:143], v[180:183], v[116:119], v[128:143]
    v_cvt_pk_bf16_f32 v120, v80, v81
    v_cvt_pk_bf16_f32 v121, v82, v83
    v_exp_f32 v84, v84
    v_exp_f32 v85, v85
    v_exp_f32 v86, v86
    v_exp_f32 v87, v87
    v_mfma_f32_32x32x8_bf16 v[96:111], v[172:173], v[44:45], v[96:111]
    v_cvt_pk_bf16_f32 v122, v84, v85
    v_cvt_pk_bf16_f32 v123, v86, v87
    v_exp_f32 v88, v88
    v_exp_f32 v89, v89
    v_exp_f32 v90, v90
    v_exp_f32 v91, v91
    v_mfma_f32_32x32x16_bf16 v[144:159], v[176:179], v[120:123], v[144:159]
    v_cvt_pk_bf16_f32 v124, v88, v89
    v_cvt_pk_bf16_f32 v125, v90, v91
    v_exp_f32 v92, v92
    v_exp_f32 v93, v93
    v_exp_f32 v94, v94
    v_exp_f32 v95, v95
    s_waitcnt lgkmcnt(0)
    v_mfma_f32_32x32x16_bf16 v[48:63], v[160:163], v[32:35], 0
    v_cvt_pk_bf16_f32 v126, v92, v93
    v_cvt_pk_bf16_f32 v127, v94, v95
    v_exp_f32 v64, v64
    v_exp_f32 v65, v65
    v_exp_f32 v66, v66
    v_exp_f32 v67, v67
    v_mfma_f32_32x32x16_bf16 v[144:159], v[180:183], v[124:127], v[144:159]
    ds_read_b128 v[164:167], v192 offset:3072
    ds_read_b64 v[172:173], v193 offset:3072
    ds_read_b128 v[176:179], v194 offset:0
    ds_read_b128 v[180:183], v194 offset:768
    v_cvt_pk_bf16_f32 v112, v64, v65
    v_cvt_pk_bf16_f32 v113, v66, v67
    v_exp_f32 v68, v68
    v_exp_f32 v69, v69
    v_exp_f32 v70, v70
    v_exp_f32 v71, v71
    v_mfma_f32_32x32x8_bf16 v[48:63], v[168:169], v[36:37], v[48:63]
    v_cvt_pk_bf16_f32 v114, v68, v69
    v_cvt_pk_bf16_f32 v115, v70, v71
    v_exp_f32 v72, v72
    v_exp_f32 v73, v73
    v_exp_f32 v74, v74
    v_exp_f32 v75, v75
    v_mfma_f32_32x32x16_bf16 v[128:143], v[184:187], v[112:115], v[128:143]
    v_cvt_pk_bf16_f32 v116, v72, v73
    v_cvt_pk_bf16_f32 v117, v74, v75
    v_exp_f32 v76, v76
    v_exp_f32 v77, v77
    v_exp_f32 v78, v78
    v_exp_f32 v79, v79
    v_mfma_f32_32x32x16_bf16 v[80:95], v[160:163], v[40:43], 0
    v_cvt_pk_bf16_f32 v118, v76, v77
    v_cvt_pk_bf16_f32 v119, v78, v79
    v_exp_f32 v96, v96
    v_exp_f32 v97, v97
    v_exp_f32 v98, v98
    v_exp_f32 v99, v99
    v_mfma_f32_32x32x16_bf16 v[128:143], v[188:191], v[116:119], v[128:143]
    v_cvt_pk_bf16_f32 v120, v96, v97
    v_cvt_pk_bf16_f32 v121, v98, v99
    v_exp_f32 v100, v100
    v_exp_f32 v101, v101
    v_exp_f32 v102, v102
    v_exp_f32 v103, v103
    v_mfma_f32_32x32x8_bf16 v[80:95], v[168:169], v[44:45], v[80:95]
    v_cvt_pk_bf16_f32 v122, v100, v101
    v_cvt_pk_bf16_f32 v123, v102, v103
    v_exp_f32 v104, v104
    v_exp_f32 v105, v105
    v_exp_f32 v106, v106
    v_exp_f32 v107, v107
    v_mfma_f32_32x32x16_bf16 v[144:159], v[184:187], v[120:123], v[144:159]
    v_cvt_pk_bf16_f32 v124, v104, v105
    v_cvt_pk_bf16_f32 v125, v106, v107
    v_exp_f32 v108, v108
    v_exp_f32 v109, v109
    v_exp_f32 v110, v110
    v_exp_f32 v111, v111
    v_mov_b32 v28, v192
    v_add_u32 v192, s23, v4
    v_mov_b32 v29, v193
    v_add_u32 v193, s23, v25
    v_mov_b32 v30, v194
    v_add_u32 v194, s23, v26
    s_add_u32 s23, s23, 24576
    s_cmp_ge_u32 s23, 98304
    s_cselect_b32 s19, 98304, 0
    s_sub_u32 s23, s23, s19
    s_sub_u32 s24, s24, 1
    s_cmp_lg_u32 s24, 0
    s_cbranch_scc1 attn1_kernel_loop3
    v_cvt_pk_bf16_f32 v126, v108, v109
    v_cvt_pk_bf16_f32 v127, v110, v111
    s_waitcnt lgkmcnt(0)
    s_nop 0
    v_mfma_f32_32x32x16_bf16 v[144:159], v[188:191], v[124:127], v[144:159]
    s_nop 7
    s_nop 7
    v_mov_b32 v18, v136
    v_mov_b32 v16, v136
    v_mov_b32 v19, v152
    v_mov_b32 v17, v152
    s_nop 1
    v_permlane32_swap_b32 v18, v16
    v_permlane32_swap_b32 v19, v17
    v_mov_b32 v18, 0x2b800000
    v_min_f32 v19, v16, v17
    v_cmp_nge_f32 vcc, v19, v18
    v_cmp_u_f32 s[28:29], v16, v17
    s_or_b64 vcc, vcc, s[28:29]
    s_cmp_lg_u64 vcc, 0
    s_cselect_b32 s25, 1, 0
    v_mov_b32 v18, s25
    s_lshl_b32 s26, s3, 2
    s_add_u32 s26, s26, 110592
    v_mov_b32 v19, s26
    ds_write_b32 v19, v18
    v_rcp_f32 v16, v16
    v_rcp_f32 v17, v17
    s_nop 0
    v_mul_f32 v128, v128, v16
    v_mul_f32 v129, v129, v16
    v_mul_f32 v130, v130, v16
    v_mul_f32 v131, v131, v16
    v_mul_f32 v132, v132, v16
    v_mul_f32 v133, v133, v16
    v_mul_f32 v134, v134, v16
    v_mul_f32 v135, v135, v16
    v_mul_f32 v136, v136, v16
    v_mul_f32 v137, v137, v16
    v_mul_f32 v138, v138, v16
    v_mul_f32 v139, v139, v16
    v_cvt_pk_bf16_f32 v48, v128, v129
    v_cvt_pk_bf16_f32 v49, v130, v131
    v_cvt_pk_bf16_f32 v50, v132, v133
    v_cvt_pk_bf16_f32 v51, v134, v135
    v_cvt_pk_bf16_f32 v52, v136, v137
    v_cvt_pk_bf16_f32 v53, v138, v139
    ds_write_b64 v10, v[48:49] offset:0
    ds_write_b64 v11, v[50:51] offset:0
    ds_write_b64 v12, v[52:53] offset:0
    v_mul_f32 v144, v144, v17
    v_mul_f32 v145, v145, v17
    v_mul_f32 v146, v146, v17
    v_mul_f32 v147, v147, v17
    v_mul_f32 v148, v148, v17
    v_mul_f32 v149, v149, v17
    v_mul_f32 v150, v150, v17
    v_mul_f32 v151, v151, v17
    v_mul_f32 v152, v152, v17
    v_mul_f32 v153, v153, v17
    v_mul_f32 v154, v154, v17
    v_mul_f32 v155, v155, v17
    v_cvt_pk_bf16_f32 v80, v144, v145
    v_cvt_pk_bf16_f32 v81, v146, v147
    v_cvt_pk_bf16_f32 v82, v148, v149
    v_cvt_pk_bf16_f32 v83, v150, v151
    v_cvt_pk_bf16_f32 v84, v152, v153
    v_cvt_pk_bf16_f32 v85, v154, v155
    ds_write_b64 v10, v[80:81] offset:16
    ds_write_b64 v11, v[82:83] offset:16
    ds_write_b64 v12, v[84:85] offset:16
    v_lshlrev_b32 v6, 4, v0
    v_add_u32 v6, 98304, v6
    v_mov_b32 v19, 110592
    s_waitcnt lgkmcnt(0)
    s_barrier
    ds_read_b128 v[16:19], v19
    ds_read_b128 v[48:51], v6
    ds_read_b128 v[52:55], v6 offset:4096
    ds_read_b128 v[56:59], v6 offset:8192
    s_waitcnt lgkmcnt(3)
    v_or_b32 v16, v16, v17
    v_or3_b32 v16, v16, v18, v19
    s_nop 0
    v_readfirstlane_b32 s25, v16
    s_cmp_lg_u32 s15, 0
    s_cbranch_scc1 attn1_kernel_fin4
    s_cmp_eq_u32 s25, 0
    s_cbranch_scc1 attn1_kernel_fin4
    s_waitcnt lgkmcnt(0)
    v_cmp_gt_u32 vcc, 32, v1
    s_nop 1
    v_cndmask_b32 v36, 0, v36, vcc
    v_cndmask_b32 v44, 0, v44, vcc
    v_mov_b32 v16, 0xff7fffff
    v_mov_b32 v17, 0xff7fffff
    s_mov_b32 s24, 0
attn1_kernel_mloop5:
    s_barrier
    s_barrier
    ds_read_b128 v[160:163], v4 offset:0
    ds_read_b64 v[168:169], v25 offset:0
    s_waitcnt lgkmcnt(0)
    v_mfma_f32_32x32x16_bf16 v[48:63], v[160:163], v[32:35], 0
    v_mfma_f32_32x32x8_bf16 v[48:63], v[168:169], v[36:37], v[48:63]
    v_mfma_f32_32x32x16_bf16 v[80:95], v[160:163], v[40:43], 0
    v_mfma_f32_32x32x8_bf16 v[80:95], v[168:169], v[44:45], v[80:95]
    s_nop 7
    s_nop 7
    v_max3_f32 v16, v16, v48, v49
    v_max3_f32 v16, v16, v50, v51
    v_max3_f32 v16, v16, v52, v53
    v_max3_f32 v16, v16, v54, v55
    v_max3_f32 v16, v16, v56, v57
    v_max3_f32 v16, v16, v58, v59
    v_max3_f32 v16, v16, v60, v61
    v_max3_f32 v16, v16, v62, v63
    v_max3_f32 v17, v17, v80, v81
    v_max3_f32 v17, v17, v82, v83
    v_max3_f32 v17, v17, v84, v85
    v_max3_f32 v17, v17, v86, v87
    v_max3_f32 v17, v17, v88, v89
    v_max3_f32 v17, v17, v90, v91
    v_max3_f32 v17, v17, v92, v93
    v_max3_f32 v17, v17, v94, v95
    ds_read_b128 v[160:163], v4 offset:3072
    ds_read_b64 v[168:169], v25 offset:3072
    s_waitcnt lgkmcnt(0)
    v_mfma_f32_32x32x16_bf16 v[48:63], v[160:163], v[32:35], 0
    v_mfma_f32_32x32x8_bf16 v[48:63], v[168:169], v[36:37], v[48:63]
    v_mfma_f32_32x32x16_bf16 v[80:95], v[160:163], v[40:43], 0
    v_mfma_f32_32x32x8_bf16 v[80:95], v[168:169], v[44:45], v[80:95]
    s_nop 7
    s_nop 7
    v_max3_f32 v16, v16, v48, v49
    v_max3_f32 v16, v16, v50, v51
    v_max3_f32 v16, v16, v52, v53
    v_max3_f32 v16, v16, v54, v55
    v_max3_f32 v16, v16, v56, v57
    v_max3_f32 v16, v16, v58, v59
    v_max3_f32 v16, v16, v60, v61
    v_max3_f32 v16, v16, v62, v63
    v_max3_f32 v17, v17, v80, v81
    v_max3_f32 v17, v17, v82, v83
    v_max3_f32 v17, v17, v84, v85
    v_max3_f32 v17, v17, v86, v87
    v_max3_f32 v17, v17, v88, v89
    v_max3_f32 v17, v17, v90, v91
    v_max3_f32 v17, v17, v92, v93
    v_max3_f32 v17, v17, v94, v95
    ds_read_b128 v[160:163], v4 offset:6144
    ds_read_b64 v[168:169], v25 offset:6144
    s_waitcnt lgkmcnt(0)
    v_mfma_f32_32x32x16_bf16 v[48:63], v[160:163], v[32:35], 0
    v_mfma_f32_32x32x8_bf16 v[48:63], v[168:169], v[36:37], v[48:63]
    v_mfma_f32_32x32x16_bf16 v[80:95], v[160:163], v[40:43], 0
    v_mfma_f32_32x32x8_bf16 v[80:95], v[168:169], v[44:45], v[80:95]
    s_nop 7
    s_nop 7
    v_max3_f32 v16, v16, v48, v49
    v_max3_f32 v16, v16, v50, v51
    v_max3_f32 v16, v16, v52, v53
    v_max3_f32 v16, v16, v54, v55
    v_max3_f32 v16, v16, v56, v57
    v_max3_f32 v16, v16, v58, v59
    v_max3_f32 v16, v16, v60, v61
    v_max3_f32 v16, v16, v62, v63
    v_max3_f32 v17, v17, v80, v81
    v_max3_f32 v17, v17, v82, v83
    v_max3_f32 v17, v17, v84, v85
    v_max3_f32 v17, v17, v86, v87
    v_max3_f32 v17, v17, v88, v89
    v_max3_f32 v17, v17, v90, v91
    v_max3_f32 v17, v17, v92, v93
    v_max3_f32 v17, v17, v94, v95
    ds_read_b128 v[160:163], v4 offset:9216
    ds_read_b64 v[168:169], v25 offset:9216
    s_waitcnt lgkmcnt(0)
    v_mfma_f32_32x32x16_bf16 v[48:63], v[160:163], v[32:35], 0
    v_mfma_f32_32x32x8_bf16 v[48:63], v[168:169], v[36:37], v[48:63]
    v_mfma_f32_32x32x16_bf16 v[80:95], v[160:163], v[40:43], 0
    v_mfma_f32_32x32x8_bf16 v[80:95], v[168:169], v[44:45], v[80:95]
    s_nop 7
    s_nop 7
    v_max3_f32 v16, v16, v48, v49
    v_max3_f32 v16, v16, v50, v51
    v_max3_f32 v16, v16, v52, v53
    v_max3_f32 v16, v16, v54, v55
    v_max3_f32 v16, v16, v56, v57
    v_max3_f32 v16, v16, v58, v59
    v_max3_f32 v16, v16, v60, v61
    v_max3_f32 v16, v16, v62, v63
    v_max3_f32 v17, v17, v80, v81
    v_max3_f32 v17, v17, v82, v83
    v_max3_f32 v17, v17, v84, v85
    v_max3_f32 v17, v17, v86, v87
    v_max3_f32 v17, v17, v88, v89
    v_max3_f32 v17, v17, v90, v91
    v_max3_f32 v17, v17, v92, v93
    v_max3_f32 v17, v17, v94, v95
    ds_read_b128 v[160:163], v4 offset:12288
    ds_read_b64 v[168:169], v25 offset:12288
    s_waitcnt lgkmcnt(0)
    v_mfma_f32_32x32x16_bf16 v[48:63], v[160:163], v[32:35], 0
    v_mfma_f32_32x32x8_bf16 v[48:63], v[168:169], v[36:37], v[48:63]
    v_mfma_f32_32x32x16_bf16 v[80:95], v[160:163], v[40:43], 0
    v_mfma_f32_32x32x8_bf16 v[80:95], v[168:169], v[44:45], v[80:95]
    s_nop 7
    s_nop 7
    v_max3_f32 v16, v16, v48, v49
    v_max3_f32 v16, v16, v50, v51
    v_max3_f32 v16, v16, v52, v53
    v_max3_f32 v16, v16, v54, v55
    v_max3_f32 v16, v16, v56, v57
    v_max3_f32 v16, v16, v58, v59
    v_max3_f32 v16, v16, v60, v61
    v_max3_f32 v16, v16, v62, v63
    v_max3_f32 v17, v17, v80, v81
    v_max3_f32 v17, v17, v82, v83
    v_max3_f32 v17, v17, v84, v85
    v_max3_f32 v17, v17, v86, v87
    v_max3_f32 v17, v17, v88, v89
    v_max3_f32 v17, v17, v90, v91
    v_max3_f32 v17, v17, v92, v93
    v_max3_f32 v17, v17, v94, v95
    ds_read_b128 v[160:163], v4 offset:15360
    ds_read_b64 v[168:169], v25 offset:15360
    s_waitcnt lgkmcnt(0)
    v_mfma_f32_32x32x16_bf16 v[48:63], v[160:163], v[32:35], 0
    v_mfma_f32_32x32x8_bf16 v[48:63], v[168:169], v[36:37], v[48:63]
    v_mfma_f32_32x32x16_bf16 v[80:95], v[160:163], v[40:43], 0
    v_mfma_f32_32x32x8_bf16 v[80:95], v[168:169], v[44:45], v[80:95]
    s_nop 7
    s_nop 7
    v_max3_f32 v16, v16, v48, v49
    v_max3_f32 v16, v16, v50, v51
    v_max3_f32 v16, v16, v52, v53
    v_max3_f32 v16, v16, v54, v55
    v_max3_f32 v16, v16, v56, v57
    v_max3_f32 v16, v16, v58, v59
    v_max3_f32 v16, v16, v60, v61
    v_max3_f32 v16, v16, v62, v63
    v_max3_f32 v17, v17, v80, v81
    v_max3_f32 v17, v17, v82, v83
    v_max3_f32 v17, v17, v84, v85
    v_max3_f32 v17, v17, v86, v87
    v_max3_f32 v17, v17, v88, v89
    v_max3_f32 v17, v17, v90, v91
    v_max3_f32 v17, v17, v92, v93
    v_max3_f32 v17, v17, v94, v95
    ds_read_b128 v[160:163], v4 offset:18432
    ds_read_b64 v[168:169], v25 offset:18432
    s_waitcnt lgkmcnt(0)
    v_mfma_f32_32x32x16_bf16 v[48:63], v[160:163], v[32:35], 0
    v_mfma_f32_32x32x8_bf16 v[48:63], v[168:169], v[36:37], v[48:63]
    v_mfma_f32_32x32x16_bf16 v[80:95], v[160:163], v[40:43], 0
    v_mfma_f32_32x32x8_bf16 v[80:95], v[168:169], v[44:45], v[80:95]
    s_nop 7
    s_nop 7
    v_max3_f32 v16, v16, v48, v49
    v_max3_f32 v16, v16, v50, v51
    v_max3_f32 v16, v16, v52, v53
    v_max3_f32 v16, v16, v54, v55
    v_max3_f32 v16, v16, v56, v57
    v_max3_f32 v16, v16, v58, v59
    v_max3_f32 v16, v16, v60, v61
    v_max3_f32 v16, v16, v62, v63
    v_max3_f32 v17, v17, v80, v81
    v_max3_f32 v17, v17, v82, v83
    v_max3_f32 v17, v17, v84, v85
    v_max3_f32 v17, v17, v86, v87
    v_max3_f32 v17, v17, v88, v89
    v_max3_f32 v17, v17, v90, v91
    v_max3_f32 v17, v17, v92, v93
    v_max3_f32 v17, v17, v94, v95
    ds_read_b128 v[160:163], v4 offset:21504
    ds_read_b64 v[168:169], v25 offset:21504
    s_waitcnt lgkmcnt(0)
    v_mfma_f32_32x32x16_bf16 v[48:63], v[160:163], v[32:35], 0
    v_mfma_f32_32x32x8_bf16 v[48:63], v[168:169], v[36:37], v[48:63]
    v_mfma_f32_32x32x16_bf16 v[80:95], v[160:163], v[40:43], 0
    v_mfma_f32_32x32x8_bf16 v[80:95], v[168:169], v[44:45], v[80:95]
    s_nop 7
    s_nop 7
    v_max3_f32 v16, v16, v48, v49
    v_max3_f32 v16, v16, v50, v51
    v_max3_f32 v16, v16, v52, v53
    v_max3_f32 v16, v16, v54, v55
    v_max3_f32 v16, v16, v56, v57
    v_max3_f32 v16, v16, v58, v59
    v_max3_f32 v16, v16, v60, v61
    v_max3_f32 v16, v16, v62, v63
    v_max3_f32 v17, v17, v80, v81
    v_max3_f32 v17, v17, v82, v83
    v_max3_f32 v17, v17, v84, v85
    v_max3_f32 v17, v17, v86, v87
    v_max3_f32 v17, v17, v88, v89
    v_max3_f32 v17, v17, v90, v91
    v_max3_f32 v17, v17, v92, v93
    v_max3_f32 v17, v17, v94, v95
    s_add_u32 s24, s24, 1
    s_cmp_lt_u32 s24, 8
    s_cbranch_scc1 attn1_kernel_mloop5
    v_cmp_gt_u32 vcc, 32, v1
    v_mov_b32 v18, v16
    s_nop 1
    v_permlane32_swap_b32 v16, v18
    v_max_f32 v16, v16, v18
    v_sub_f32 v16, 0, v16
    v_cvt_pk_bf16_f32 v16, v16, 0
    v_cndmask_b32 v36, v16, v36, vcc
    v_mov_b32 v18, v17
    s_nop 1
    v_permlane32_swap_b32 v17, v18
    v_max_f32 v17, v17, v18
    v_sub_f32 v17, 0, v17
    v_cvt_pk_bf16_f32 v17, v17, 0
    v_cndmask_b32 v44, v17, v44, vcc
    s_mov_b32 s15, 1
    s_barrier
    s_branch attn1_kernel_mainpass2
attn1_kernel_fin4:
    s_add_u32 s21, s20, 8192
    s_add_u32 s22, s20, 16384
    s_waitcnt lgkmcnt(0)
    buffer_store_dwordx4 v[48:51], v5, s[44:47], s20 offen
    buffer_store_dwordx4 v[52:55], v5, s[44:47], s21 offen
    s_cmp_ge_u32 s3, 2
    s_cbranch_scc1 attn1_kernel_o26
    buffer_store_dwordx4 v[56:59], v5, s[44:47], s22 offen
attn1_kernel_o26:
    s_endpgm
attn1_kernel_loader1:
    s_add_u32 s36, s4, 3145728
    s_addc_u32 s37, s5, 0
    s_mov_b32 s38, 196608
    s_mov_b32 s39, 0x00020000
    s_add_u32 s48, s4, 10485760
    s_addc_u32 s49, s5, 0
    s_mov_b32 s50, 16384
    s_mov_b32 s51, 0x00020000
    s_mov_b32 s17, 0
    s_mov_b32 s18, 0
    s_add_u32 m0, s18, 0
    s_add_u32 s19, s17, 0
    buffer_load_dwordx4 v4, s[36:39], s19 offen offset:0 lds
    buffer_load_dwordx4 v4, s[36:39], s19 offen offset:1024 lds
    buffer_load_dwordx4 v4, s[36:39], s19 offen offset:2048 lds
    buffer_load_dwordx4 v4, s[36:39], s19 offen offset:3072 lds
    s_add_u32 m0, s18, 4096
    s_add_u32 s19, s17, 4096
    buffer_load_dwordx4 v4, s[36:39], s19 offen offset:0 lds
    buffer_load_dwordx4 v4, s[36:39], s19 offen offset:1024 lds
    buffer_load_dwordx4 v4, s[36:39], s19 offen offset:2048 lds
    buffer_load_dwordx4 v4, s[36:39], s19 offen offset:3072 lds
    s_add_u32 m0, s18, 8192
    s_add_u32 s19, s17, 8192
    buffer_load_dwordx4 v4, s[36:39], s19 offen offset:0 lds
    buffer_load_dwordx4 v4, s[36:39], s19 offen offset:1024 lds
    buffer_load_dwordx4 v4, s[36:39], s19 offen offset:2048 lds
    buffer_load_dwordx4 v4, s[36:39], s19 offen offset:3072 lds
    s_add_u32 m0, s18, 12288
    s_add_u32 s19, s17, 12288
    buffer_load_dwordx4 v4, s[36:39], s19 offen offset:0 lds
    buffer_load_dwordx4 v4, s[36:39], s19 offen offset:1024 lds
    buffer_load_dwordx4 v4, s[36:39], s19 offen offset:2048 lds
    buffer_load_dwordx4 v4, s[36:39], s19 offen offset:3072 lds
    s_add_u32 m0, s18, 16384
    s_add_u32 s19, s17, 16384
    buffer_load_dwordx4 v4, s[36:39], s19 offen offset:0 lds
    buffer_load_dwordx4 v4, s[36:39], s19 offen offset:1024 lds
    buffer_load_dwordx4 v4, s[36:39], s19 offen offset:2048 lds
    buffer_load_dwordx4 v4, s[36:39], s19 offen offset:3072 lds
    s_add_u32 m0, s18, 20480
    s_add_u32 s19, s17, 20480
    buffer_load_dwordx4 v4, s[36:39], s19 offen offset:0 lds
    buffer_load_dwordx4 v4, s[36:39], s19 offen offset:1024 lds
    buffer_load_dwordx4 v4, s[36:39], s19 offen offset:2048 lds
    buffer_load_dwordx4 v4, s[36:39], s19 offen offset:3072 lds
    s_add_u32 s17, s17, 24576
    s_add_u32 s18, s18, 24576
    s_cmp_ge_u32 s18, 98304
    s_cselect_b32 s19, 98304, 0
    s_sub_u32 s18, s18, s19
    s_add_u32 m0, s18, 0
    s_add_u32 s19, s17, 0
    buffer_load_dwordx4 v4, s[36:39], s19 offen offset:0 lds
    buffer_load_dwordx4 v4, s[36:39], s19 offen offset:1024 lds
    buffer_load_dwordx4 v4, s[36:39], s19 offen offset:2048 lds
    buffer_load_dwordx4 v4, s[36:39], s19 offen offset:3072 lds
    s_add_u32 m0, s18, 4096
    s_add_u32 s19, s17, 4096
    buffer_load_dwordx4 v4, s[36:39], s19 offen offset:0 lds
    buffer_load_dwordx4 v4, s[36:39], s19 offen offset:1024 lds
    buffer_load_dwordx4 v4, s[36:39], s19 offen offset:2048 lds
    buffer_load_dwordx4 v4, s[36:39], s19 offen offset:3072 lds
    s_add_u32 m0, s18, 8192
    s_add_u32 s19, s17, 8192
    buffer_load_dwordx4 v4, s[36:39], s19 offen offset:0 lds
    buffer_load_dwordx4 v4, s[36:39], s19 offen offset:1024 lds
    buffer_load_dwordx4 v4, s[36:39], s19 offen offset:2048 lds
    buffer_load_dwordx4 v4, s[36:39], s19 offen offset:3072 lds
    s_add_u32 m0, s18, 12288
    s_add_u32 s19, s17, 12288
    buffer_load_dwordx4 v4, s[36:39], s19 offen offset:0 lds
    buffer_load_dwordx4 v4, s[36:39], s19 offen offset:1024 lds
    buffer_load_dwordx4 v4, s[36:39], s19 offen offset:2048 lds
    buffer_load_dwordx4 v4, s[36:39], s19 offen offset:3072 lds
    s_add_u32 m0, s18, 16384
    s_add_u32 s19, s17, 16384
    buffer_load_dwordx4 v4, s[36:39], s19 offen offset:0 lds
    buffer_load_dwordx4 v4, s[36:39], s19 offen offset:1024 lds
    buffer_load_dwordx4 v4, s[36:39], s19 offen offset:2048 lds
    buffer_load_dwordx4 v4, s[36:39], s19 offen offset:3072 lds
    s_add_u32 m0, s18, 20480
    s_add_u32 s19, s17, 20480
    buffer_load_dwordx4 v4, s[36:39], s19 offen offset:0 lds
    buffer_load_dwordx4 v4, s[36:39], s19 offen offset:1024 lds
    buffer_load_dwordx4 v4, s[36:39], s19 offen offset:2048 lds
    buffer_load_dwordx4 v4, s[36:39], s19 offen offset:3072 lds
    s_add_u32 s17, s17, 24576
    s_add_u32 s18, s18, 24576
    s_cmp_ge_u32 s18, 98304
    s_cselect_b32 s19, 98304, 0
    s_sub_u32 s18, s18, s19
    s_lshl_b32 s21, s2, 6
    v_lshlrev_b32 v6, 2, v1
    v_mov_b32 v7, 0x7ffffff0
    v_cmp_gt_u32 vcc, 16, v1
    v_mov_b32 v20, 0
    s_nop 0
    v_cndmask_b32 v7, v7, v6, vcc
    buffer_store_dword v20, v7, s[48:51], s21 offen
    s_waitcnt vmcnt(25)
attn1_kernel_lmain7:
    s_barrier
    s_add_u32 m0, s18, 0
    s_add_u32 s19, s17, 0
    buffer_load_dwordx4 v4, s[36:39], s19 offen offset:0 lds
    buffer_load_dwordx4 v4, s[36:39], s19 offen offset:1024 lds
    buffer_load_dwordx4 v4, s[36:39], s19 offen offset:2048 lds
    buffer_load_dwordx4 v4, s[36:39], s19 offen offset:3072 lds
    s_add_u32 m0, s18, 4096
    s_add_u32 s19, s17, 4096
    buffer_load_dwordx4 v4, s[36:39], s19 offen offset:0 lds
    buffer_load_dwordx4 v4, s[36:39], s19 offen offset:1024 lds
    buffer_load_dwordx4 v4, s[36:39], s19 offen offset:2048 lds
    buffer_load_dwordx4 v4, s[36:39], s19 offen offset:3072 lds
    s_add_u32 m0, s18, 8192
    s_add_u32 s19, s17, 8192
    buffer_load_dwordx4 v4, s[36:39], s19 offen offset:0 lds
    buffer_load_dwordx4 v4, s[36:39], s19 offen offset:1024 lds
    buffer_load_dwordx4 v4, s[36:39], s19 offen offset:2048 lds
    buffer_load_dwordx4 v4, s[36:39], s19 offen offset:3072 lds
    s_add_u32 m0, s18, 12288
    s_add_u32 s19, s17, 12288
    buffer_load_dwordx4 v4, s[36:39], s19 offen offset:0 lds
    buffer_load_dwordx4 v4, s[36:39], s19 offen offset:1024 lds
    buffer_load_dwordx4 v4, s[36:39], s19 offen offset:2048 lds
    buffer_load_dwordx4 v4, s[36:39], s19 offen offset:3072 lds
    s_add_u32 m0, s18, 16384
    s_add_u32 s19, s17, 16384
    buffer_load_dwordx4 v4, s[36:39], s19 offen offset:0 lds
    buffer_load_dwordx4 v4, s[36:39], s19 offen offset:1024 lds
    buffer_load_dwordx4 v4, s[36:39], s19 offen offset:2048 lds
    buffer_load_dwordx4 v4, s[36:39], s19 offen offset:3072 lds
    s_add_u32 m0, s18, 20480
    s_add_u32 s19, s17, 20480
    buffer_load_dwordx4 v4, s[36:39], s19 offen offset:0 lds
    buffer_load_dwordx4 v4, s[36:39], s19 offen offset:1024 lds
    buffer_load_dwordx4 v4, s[36:39], s19 offen offset:2048 lds
    buffer_load_dwordx4 v4, s[36:39], s19 offen offset:3072 lds
    s_add_u32 s17, s17, 24576
    s_add_u32 s18, s18, 24576
    s_cmp_ge_u32 s18, 98304
    s_cselect_b32 s19, 98304, 0
    s_sub_u32 s18, s18, s19
    s_mov_b32 s24, 8
attn1_kernel_lloop8:
    s_waitcnt vmcnt(24)
    s_barrier
    s_add_u32 m0, s18, 0
    s_add_u32 s19, s17, 0
    buffer_load_dwordx4 v4, s[36:39], s19 offen offset:0 lds
    buffer_load_dwordx4 v4, s[36:39], s19 offen offset:1024 lds
    buffer_load_dwordx4 v4, s[36:39], s19 offen offset:2048 lds
    buffer_load_dwordx4 v4, s[36:39], s19 offen offset:3072 lds
    s_add_u32 m0, s18, 4096
    s_add_u32 s19, s17, 4096
    buffer_load_dwordx4 v4, s[36:39], s19 offen offset:0 lds
    buffer_load_dwordx4 v4, s[36:39], s19 offen offset:1024 lds
    buffer_load_dwordx4 v4, s[36:39], s19 offen offset:2048 lds
    buffer_load_dwordx4 v4, s[36:39], s19 offen offset:3072 lds
    s_add_u32 m0, s18, 8192
    s_add_u32 s19, s17, 8192
    buffer_load_dwordx4 v4, s[36:39], s19 offen offset:0 lds
    buffer_load_dwordx4 v4, s[36:39], s19 offen offset:1024 lds
    buffer_load_dwordx4 v4, s[36:39], s19 offen offset:2048 lds
    buffer_load_dwordx4 v4, s[36:39], s19 offen offset:3072 lds
    s_add_u32 m0, s18, 12288
    s_add_u32 s19, s17, 12288
    buffer_load_dwordx4 v4, s[36:39], s19 offen offset:0 lds
    buffer_load_dwordx4 v4, s[36:39], s19 offen offset:1024 lds
    buffer_load_dwordx4 v4, s[36:39], s19 offen offset:2048 lds
    buffer_load_dwordx4 v4, s[36:39], s19 offen offset:3072 lds
    s_add_u32 m0, s18, 16384
    s_add_u32 s19, s17, 16384
    buffer_load_dwordx4 v4, s[36:39], s19 offen offset:0 lds
    buffer_load_dwordx4 v4, s[36:39], s19 offen offset:1024 lds
    buffer_load_dwordx4 v4, s[36:39], s19 offen offset:2048 lds
    buffer_load_dwordx4 v4, s[36:39], s19 offen offset:3072 lds
    s_add_u32 m0, s18, 20480
    s_add_u32 s19, s17, 20480
    buffer_load_dwordx4 v4, s[36:39], s19 offen offset:0 lds
    buffer_load_dwordx4 v4, s[36:39], s19 offen offset:1024 lds
    buffer_load_dwordx4 v4, s[36:39], s19 offen offset:2048 lds
    buffer_load_dwordx4 v4, s[36:39], s19 offen offset:3072 lds
    s_add_u32 s17, s17, 24576
    s_add_u32 s18, s18, 24576
    s_cmp_ge_u32 s18, 98304
    s_cselect_b32 s19, 98304, 0
    s_sub_u32 s18, s18, s19
    s_sub_u32 s24, s24, 1
    s_cmp_lg_u32 s24, 0
    s_cbranch_scc1 attn1_kernel_lloop8
    v_mov_b32 v19, 110592
    s_waitcnt vmcnt(0)
    s_barrier
    ds_read_b128 v[24:27], v19
    s_waitcnt lgkmcnt(0)
    v_or_b32 v24, v24, v25
    v_or3_b32 v24, v24, v26, v27
    s_nop 0
    v_readfirstlane_b32 s25, v24
    s_cmp_lg_u32 s15, 0
    s_cbranch_scc1 attn1_kernel_end
    s_cmp_eq_u32 s25, 0
    s_cbranch_scc1 attn1_kernel_end
    s_mov_b32 s24, 0
attn1_kernel_lmloop9:
    s_barrier
    s_mul_i32 s17, s24, 24576
    s_mov_b32 s18, 0
    s_add_u32 m0, s18, 0
    s_add_u32 s19, s17, 0
    buffer_load_dwordx4 v4, s[36:39], s19 offen offset:0 lds
    buffer_load_dwordx4 v4, s[36:39], s19 offen offset:1024 lds
    buffer_load_dwordx4 v4, s[36:39], s19 offen offset:2048 lds
    buffer_load_dwordx4 v4, s[36:39], s19 offen offset:3072 lds
    s_add_u32 m0, s18, 4096
    s_add_u32 s19, s17, 4096
    buffer_load_dwordx4 v4, s[36:39], s19 offen offset:0 lds
    buffer_load_dwordx4 v4, s[36:39], s19 offen offset:1024 lds
    buffer_load_dwordx4 v4, s[36:39], s19 offen offset:2048 lds
    buffer_load_dwordx4 v4, s[36:39], s19 offen offset:3072 lds
    s_add_u32 m0, s18, 8192
    s_add_u32 s19, s17, 8192
    buffer_load_dwordx4 v4, s[36:39], s19 offen offset:0 lds
    buffer_load_dwordx4 v4, s[36:39], s19 offen offset:1024 lds
    buffer_load_dwordx4 v4, s[36:39], s19 offen offset:2048 lds
    buffer_load_dwordx4 v4, s[36:39], s19 offen offset:3072 lds
    s_add_u32 m0, s18, 12288
    s_add_u32 s19, s17, 12288
    buffer_load_dwordx4 v4, s[36:39], s19 offen offset:0 lds
    buffer_load_dwordx4 v4, s[36:39], s19 offen offset:1024 lds
    buffer_load_dwordx4 v4, s[36:39], s19 offen offset:2048 lds
    buffer_load_dwordx4 v4, s[36:39], s19 offen offset:3072 lds
    s_add_u32 m0, s18, 16384
    s_add_u32 s19, s17, 16384
    buffer_load_dwordx4 v4, s[36:39], s19 offen offset:0 lds
    buffer_load_dwordx4 v4, s[36:39], s19 offen offset:1024 lds
    buffer_load_dwordx4 v4, s[36:39], s19 offen offset:2048 lds
    buffer_load_dwordx4 v4, s[36:39], s19 offen offset:3072 lds
    s_add_u32 m0, s18, 20480
    s_add_u32 s19, s17, 20480
    buffer_load_dwordx4 v4, s[36:39], s19 offen offset:0 lds
    buffer_load_dwordx4 v4, s[36:39], s19 offen offset:1024 lds
    buffer_load_dwordx4 v4, s[36:39], s19 offen offset:2048 lds
    buffer_load_dwordx4 v4, s[36:39], s19 offen offset:3072 lds
    s_add_u32 s17, s17, 24576
    s_add_u32 s18, s18, 24576
    s_cmp_ge_u32 s18, 98304
    s_cselect_b32 s19, 98304, 0
    s_sub_u32 s18, s18, s19
    s_waitcnt vmcnt(0)
    s_barrier
    s_add_u32 s24, s24, 1
    s_cmp_lt_u32 s24, 8
    s_cbranch_scc1 attn1_kernel_lmloop9
    s_mov_b32 s15, 1
    s_barrier
    s_mov_b32 s17, 0
    s_mov_b32 s18, 0
    s_add_u32 m0, s18, 0
    s_add_u32 s19, s17, 0
    buffer_load_dwordx4 v4, s[36:39], s19 offen offset:0 lds
    buffer_load_dwordx4 v4, s[36:39], s19 offen offset:1024 lds
    buffer_load_dwordx4 v4, s[36:39], s19 offen offset:2048 lds
    buffer_load_dwordx4 v4, s[36:39], s19 offen offset:3072 lds
    s_add_u32 m0, s18, 4096
    s_add_u32 s19, s17, 4096
    buffer_load_dwordx4 v4, s[36:39], s19 offen offset:0 lds
    buffer_load_dwordx4 v4, s[36:39], s19 offen offset:1024 lds
    buffer_load_dwordx4 v4, s[36:39], s19 offen offset:2048 lds
    buffer_load_dwordx4 v4, s[36:39], s19 offen offset:3072 lds
    s_add_u32 m0, s18, 8192
    s_add_u32 s19, s17, 8192
    buffer_load_dwordx4 v4, s[36:39], s19 offen offset:0 lds
    buffer_load_dwordx4 v4, s[36:39], s19 offen offset:1024 lds
    buffer_load_dwordx4 v4, s[36:39], s19 offen offset:2048 lds
    buffer_load_dwordx4 v4, s[36:39], s19 offen offset:3072 lds
    s_add_u32 m0, s18, 12288
    s_add_u32 s19, s17, 12288
    buffer_load_dwordx4 v4, s[36:39], s19 offen offset:0 lds
    buffer_load_dwordx4 v4, s[36:39], s19 offen offset:1024 lds
    buffer_load_dwordx4 v4, s[36:39], s19 offen offset:2048 lds
    buffer_load_dwordx4 v4, s[36:39], s19 offen offset:3072 lds
    s_add_u32 m0, s18, 16384
    s_add_u32 s19, s17, 16384
    buffer_load_dwordx4 v4, s[36:39], s19 offen offset:0 lds
    buffer_load_dwordx4 v4, s[36:39], s19 offen offset:1024 lds
    buffer_load_dwordx4 v4, s[36:39], s19 offen offset:2048 lds
    buffer_load_dwordx4 v4, s[36:39], s19 offen offset:3072 lds
    s_add_u32 m0, s18, 20480
    s_add_u32 s19, s17, 20480
    buffer_load_dwordx4 v4, s[36:39], s19 offen offset:0 lds
    buffer_load_dwordx4 v4, s[36:39], s19 offen offset:1024 lds
    buffer_load_dwordx4 v4, s[36:39], s19 offen offset:2048 lds
    buffer_load_dwordx4 v4, s[36:39], s19 offen offset:3072 lds
    s_add_u32 s17, s17, 24576
    s_add_u32 s18, s18, 24576
    s_cmp_ge_u32 s18, 98304
    s_cselect_b32 s19, 98304, 0
    s_sub_u32 s18, s18, s19
    s_add_u32 m0, s18, 0
    s_add_u32 s19, s17, 0
    buffer_load_dwordx4 v4, s[36:39], s19 offen offset:0 lds
    buffer_load_dwordx4 v4, s[36:39], s19 offen offset:1024 lds
    buffer_load_dwordx4 v4, s[36:39], s19 offen offset:2048 lds
    buffer_load_dwordx4 v4, s[36:39], s19 offen offset:3072 lds
    s_add_u32 m0, s18, 4096
    s_add_u32 s19, s17, 4096
    buffer_load_dwordx4 v4, s[36:39], s19 offen offset:0 lds
    buffer_load_dwordx4 v4, s[36:39], s19 offen offset:1024 lds
    buffer_load_dwordx4 v4, s[36:39], s19 offen offset:2048 lds
    buffer_load_dwordx4 v4, s[36:39], s19 offen offset:3072 lds
    s_add_u32 m0, s18, 8192
    s_add_u32 s19, s17, 8192
    buffer_load_dwordx4 v4, s[36:39], s19 offen offset:0 lds
    buffer_load_dwordx4 v4, s[36:39], s19 offen offset:1024 lds
    buffer_load_dwordx4 v4, s[36:39], s19 offen offset:2048 lds
    buffer_load_dwordx4 v4, s[36:39], s19 offen offset:3072 lds
    s_add_u32 m0, s18, 12288
    s_add_u32 s19, s17, 12288
    buffer_load_dwordx4 v4, s[36:39], s19 offen offset:0 lds
    buffer_load_dwordx4 v4, s[36:39], s19 offen offset:1024 lds
    buffer_load_dwordx4 v4, s[36:39], s19 offen offset:2048 lds
    buffer_load_dwordx4 v4, s[36:39], s19 offen offset:3072 lds
    s_add_u32 m0, s18, 16384
    s_add_u32 s19, s17, 16384
    buffer_load_dwordx4 v4, s[36:39], s19 offen offset:0 lds
    buffer_load_dwordx4 v4, s[36:39], s19 offen offset:1024 lds
    buffer_load_dwordx4 v4, s[36:39], s19 offen offset:2048 lds
    buffer_load_dwordx4 v4, s[36:39], s19 offen offset:3072 lds
    s_add_u32 m0, s18, 20480
    s_add_u32 s19, s17, 20480
    buffer_load_dwordx4 v4, s[36:39], s19 offen offset:0 lds
    buffer_load_dwordx4 v4, s[36:39], s19 offen offset:1024 lds
    buffer_load_dwordx4 v4, s[36:39], s19 offen offset:2048 lds
    buffer_load_dwordx4 v4, s[36:39], s19 offen offset:3072 lds
    s_add_u32 s17, s17, 24576
    s_add_u32 s18, s18, 24576
    s_cmp_ge_u32 s18, 98304
    s_cselect_b32 s19, 98304, 0
    s_sub_u32 s18, s18, s19
    s_waitcnt vmcnt(24)
    s_branch attn1_kernel_lmain7
attn1_kernel_end:
    s_endpgm

.globl oproj1_kernel
.p2align 8
.type oproj1_kernel,@function
oproj1_kernel:
    s_cmp_ge_u32 s2, 256
    s_cbranch_scc1 oproj1_kernel_end
    s_load_dwordx2 s[4:5], s[0:1], 96
    s_load_dwordx2 s[8:9], s[0:1], 32
    s_and_b32 s16, s2, 7
    s_lshr_b32 s17, s2, 3
    s_and_b32 s18, s17, 3
    s_lshl_b32 s16, s16, 2
    s_add_u32 s16, s16, s18
    s_lshr_b32 s17, s17, 2
    v_lshrrev_b32 v2, 6, v0
    v_and_b32 v1, 63, v0
    v_readfirstlane_b32 s3, v2
    v_lshrrev_b32 v2, 4, v1
    v_and_b32 v3, 15, v1
    s_lshl_b32 s20, s16, 6
    s_lshl_b32 s21, s3, 4
    s_add_u32 s20, s20, s21
    s_lshr_b32 s21, s20, 4
    s_mul_i32 s21, s21, 20480
    s_mul_i32 s24, s17, 5
    s_lshr_b32 s24, s24, 1
    s_lshl_b32 s24, s24, 10
    s_add_u32 s24, s24, s21
    s_and_b32 s25, s17, 1
    v_lshlrev_b32 v5, 4, v1
    s_waitcnt lgkmcnt(0)
    s_add_u32 s32, s4, 4194304
    s_addc_u32 s33, s5, 0
    s_mov_b32 s34, 2621440
    s_mov_b32 s35, 0x00020000
    s_add_u32 s36, s4, 50331648
    s_addc_u32 s37, s5, 0
    s_mov_b32 s38, 819200
    s_mov_b32 s39, 0x00020000
    s_add_u32 s40, s4, 14680064
    s_addc_u32 s41, s5, 0
    s_mov_b32 s42, 2621440
    s_mov_b32 s43, 0x00020000
    s_add_u32 s44, s4, 17825792
    s_addc_u32 s45, s5, 0
    s_mov_b32 s46, 2621440
    s_mov_b32 s47, 0x00020000
    s_add_u32 s48, s4, 10485760
    s_addc_u32 s49, s5, 0
    s_mov_b32 s50, 16384
    s_mov_b32 s51, 0x00020000
    s_mul_i32 s26, s17, 5120
    s_mul_i32 s27, s3, 40960
    s_add_u32 s26, s26, s27
    s_mul_i32 s27, s3, 5120
    s_lshl_b32 s31, s3, 10
    v_add_u32 v6, 4096, v5
    s_add_u32 s22, s21, 0
    buffer_load_dwordx4 v[16:19], v5, s[32:35], s22 offen offset:0
    buffer_load_dwordx4 v[20:23], v5, s[32:35], s22 offen offset:1024
    buffer_load_dwordx4 v[24:27], v5, s[32:35], s22 offen offset:2048
    buffer_load_dwordx4 v[28:31], v5, s[32:35], s22 offen offset:3072
    s_mov_b32 m0, s27
    s_nop 0
    buffer_load_dwordx4 v5, s[36:39], s26 offen lds
    s_mov_b32 m0, s27
    s_nop 0
    buffer_load_dwordx4 v5, s[36:39], s26 offen offset:1024 lds
    s_mov_b32 m0, s27
    s_nop 0
    buffer_load_dwordx4 v5, s[36:39], s26 offen offset:2048 lds
    s_mov_b32 m0, s27
    s_nop 0
    buffer_load_dwordx4 v5, s[36:39], s26 offen offset:3072 lds
    s_add_u32 m0, s27, 4096
    s_nop 0
    buffer_load_dwordx4 v6, s[36:39], s26 offen lds
    s_add_u32 s26, s26, 163840
    s_add_u32 s27, s27, 20480
    s_add_u32 s22, s21, 4096
    buffer_load_dwordx4 v[32:35], v5, s[32:35], s22 offen offset:0
    buffer_load_dwordx4 v[36:39], v5, s[32:35], s22 offen offset:1024
    buffer_load_dwordx4 v[40:43], v5, s[32:35], s22 offen offset:2048
    buffer_load_dwordx4 v[44:47], v5, s[32:35], s22 offen offset:3072
    s_mov_b32 m0, s27
    s_nop 0
    buffer_load_dwordx4 v5, s[36:39], s26 offen lds
    s_mov_b32 m0, s27
    s_nop 0
    buffer_load_dwordx4 v5, s[36:39], s26 offen offset:1024 lds
    s_mov_b32 m0, s27
    s_nop 0
    buffer_load_dwordx4 v5, s[36:39], s26 offen offset:2048 lds
    s_mov_b32 m0, s27
    s_nop 0
    buffer_load_dwordx4 v5, s[36:39], s26 offen offset:3072 lds
    s_add_u32 m0, s27, 4096
    s_nop 0
    buffer_load_dwordx4 v6, s[36:39], s26 offen lds
    s_add_u32 s26, s26, 163840
    s_add_u32 s27, s27, 20480
    s_add_u32 s22, s21, 8192
    buffer_load_dwordx4 v[48:51], v5, s[32:35], s22 offen offset:0
    buffer_load_dwordx4 v[52:55], v5, s[32:35], s22 offen offset:1024
    buffer_load_dwordx4 v[56:59], v5, s[32:35], s22 offen offset:2048
    buffer_load_dwordx4 v[60:63], v5, s[32:35], s22 offen offset:3072
    s_mov_b32 m0, s27
    s_nop 0
    buffer_load_dwordx4 v5, s[36:39], s26 offen lds
    s_mov_b32 m0, s27
    s_nop 0
    buffer_load_dwordx4 v5, s[36:39], s26 offen offset:1024 lds
    s_mov_b32 m0, s27
    s_nop 0
    buffer_load_dwordx4 v5, s[36:39], s26 offen offset:2048 lds
    s_mov_b32 m0, s27
    s_nop 0
    buffer_load_dwordx4 v5, s[36:39], s26 offen offset:3072 lds
    s_add_u32 m0, s27, 4096
    s_nop 0
    buffer_load_dwordx4 v6, s[36:39], s26 offen lds
    s_add_u32 s26, s26, 163840
    s_add_u32 s27, s27, 20480
    v_mov_b32 v12, v5
    v_add_u32 v13, 51200, v5
    v_mov_b32 v96, 0
    v_mov_b32 v97, 0
    v_mov_b32 v98, 0
    v_mov_b32 v99, 0
    v_mov_b32 v100, 0
    v_mov_b32 v101, 0
    v_mov_b32 v102, 0
    v_mov_b32 v103, 0
    v_mov_b32 v104, 0
    v_mov_b32 v105, 0
    v_mov_b32 v106, 0
    v_mov_b32 v107, 0
    v_mov_b32 v108, 0
    v_mov_b32 v109, 0
    v_mov_b32 v110, 0
    v_mov_b32 v111, 0
    v_mov_b32 v112, 0
    v_mov_b32 v113, 0
    v_mov_b32 v114, 0
    v_mov_b32 v115, 0
    v_mov_b32 v116, 0
    v_mov_b32 v117, 0
    v_mov_b32 v118, 0
    v_mov_b32 v119, 0
    v_lshrrev_b32 v168, 2, v3
    v_cmp_eq_u32 vcc, v168, v2
    v_and_b32 v168, 1, v3
    v_lshlrev_b32 v168, 4, v168
    v_mov_b32 v169, 0x3f80
    v_lshlrev_b32 v169, v168, v169
    v_cndmask_b32 v169, 0, v169, vcc
    v_and_b32 v168, 2, v3
    v_cmp_eq_u32 vcc, 0, v168
    v_mov_b32 v162, 0
    v_mov_b32 v163, 0
    v_cndmask_b32 v160, 0, v169, vcc
    v_cndmask_b32 v161, v169, 0, vcc
    v_mov_b32 v164, 0
    v_mov_b32 v165, 0
    v_mov_b32 v166, v160
    v_mov_b32 v167, v161
    s_waitcnt vmcnt(18)
    s_barrier
    ds_read_b128 v[120:123], v12 offset:0
    ds_read_b128 v[124:127], v12 offset:1024
    ds_read_b128 v[128:131], v12 offset:2048
    ds_read_b128 v[132:135], v12 offset:3072
    ds_read_b128 v[136:139], v12 offset:4096
    ds_read_b128 v[140:143], v12 offset:5120
    ds_read_b128 v[144:147], v12 offset:6144
    ds_read_b128 v[148:151], v12 offset:7168
    ds_read_b128 v[152:155], v12 offset:8192
    ds_read_b128 v[156:159], v12 offset:9216
    s_waitcnt lgkmcnt(5)
    v_mfma_f32_16x16x32_bf16 v[96:99], v[16:19], v[120:123], v[96:99]
    ds_read_b128 v[192:195], v12 offset:10240
    v_mfma_f32_16x16x32_bf16 v[100:103], v[16:19], v[124:127], v[100:103]
    ds_read_b128 v[196:199], v12 offset:11264
    s_add_u32 s22, s21, 12288
    buffer_load_dwordx4 v[64:67], v5, s[32:35], s22 offen offset:0
    v_mfma_f32_16x16x32_bf16 v[104:107], v[16:19], v[128:131], v[104:107]
    ds_read_b128 v[200:203], v12 offset:12288
    v_mfma_f32_16x16x32_bf16 v[108:111], v[16:19], v[132:135], v[108:111]
    ds_read_b128 v[204:207], v12 offset:13312
    buffer_load_dwordx4 v[68:71], v5, s[32:35], s22 offen offset:1024
    v_mfma_f32_16x16x32_bf16 v[112:115], v[16:19], v[136:139], v[112:115]
    ds_read_b128 v[208:211], v12 offset:14336
    buffer_load_dwordx4 v[72:75], v5, s[32:35], s22 offen offset:2048
    s_waitcnt lgkmcnt(5)
    v_mfma_f32_16x16x32_bf16 v[96:99], v[20:23], v[140:143], v[96:99]
    ds_read_b128 v[120:123], v12 offset:15360
    v_mfma_f32_16x16x32_bf16 v[100:103], v[20:23], v[144:147], v[100:103]
    ds_read_b128 v[124:127], v12 offset:16384
    buffer_load_dwordx4 v[76:79], v5, s[32:35], s22 offen offset:3072
    v_mfma_f32_16x16x32_bf16 v[104:107], v[20:23], v[148:151], v[104:107]
    ds_read_b128 v[128:131], v12 offset:17408
    v_mfma_f32_16x16x32_bf16 v[108:111], v[20:23], v[152:155], v[108:111]
    ds_read_b128 v[132:135], v12 offset:18432
    s_mov_b32 m0, s27
    s_nop 0
    buffer_load_dwordx4 v5, s[36:39], s26 offen lds
    v_mfma_f32_16x16x32_bf16 v[112:115], v[20:23], v[156:159], v[112:115]
    ds_read_b128 v[136:139], v12 offset:19456
    s_waitcnt vmcnt(14)
    s_barrier
    s_waitcnt lgkmcnt(5)
    v_mfma_f32_16x16x32_bf16 v[96:99], v[24:27], v[192:195], v[96:99]
    ds_read_b128 v[140:143], v12 offset:20480
    v_mfma_f32_16x16x32_bf16 v[100:103], v[24:27], v[196:199], v[100:103]
    ds_read_b128 v[144:147], v12 offset:21504
    s_mov_b32 m0, s27
    s_nop 0
    buffer_load_dwordx4 v5, s[36:39], s26 offen offset:1024 lds
    v_mfma_f32_16x16x32_bf16 v[104:107], v[24:27], v[200:203], v[104:107]
    ds_read_b128 v[148:151], v12 offset:22528
    v_mfma_f32_16x16x32_bf16 v[108:111], v[24:27], v[204:207], v[108:111]
    ds_read_b128 v[152:155], v12 offset:23552
    s_mov_b32 m0, s27
    s_nop 0
    buffer_load_dwordx4 v5, s[36:39], s26 offen offset:2048 lds
    v_mfma_f32_16x16x32_bf16 v[112:115], v[24:27], v[208:211], v[112:115]
    ds_read_b128 v[156:159], v12 offset:24576
    s_waitcnt lgkmcnt(5)
    v_mfma_f32_16x16x32_bf16 v[96:99], v[28:31], v[120:123], v[96:99]
    ds_read_b128 v[192:195], v12 offset:25600
    v_mfma_f32_16x16x32_bf16 v[100:103], v[28:31], v[124:127], v[100:103]
    ds_read_b128 v[196:199], v12 offset:26624
    s_mov_b32 m0, s27
    s_nop 0
    buffer_load_dwordx4 v5, s[36:39], s26 offen offset:3072 lds
    v_mfma_f32_16x16x32_bf16 v[104:107], v[28:31], v[128:131], v[104:107]
    ds_read_b128 v[200:203], v12 offset:27648
    v_mfma_f32_16x16x32_bf16 v[108:111], v[28:31], v[132:135], v[108:111]
    ds_read_b128 v[204:207], v12 offset:28672
    s_add_u32 m0, s27, 4096
    s_nop 0
    buffer_load_dwordx4 v6, s[36:39], s26 offen lds
    s_add_u32 s26, s26, 163840
    s_add_u32 s27, s27, 20480
    v_mfma_f32_16x16x32_bf16 v[112:115], v[28:31], v[136:139], v[112:115]
    ds_read_b128 v[208:211], v12 offset:29696
    s_waitcnt lgkmcnt(5)
    v_mfma_f32_16x16x32_bf16 v[96:99], v[32:35], v[140:143], v[96:99]
    ds_read_b128 v[120:123], v12 offset:30720
    v_mfma_f32_16x16x32_bf16 v[100:103], v[32:35], v[144:147], v[100:103]
    ds_read_b128 v[124:127], v12 offset:31744
    s_add_u32 s22, s21, 16384
    buffer_load_dwordx4 v[80:83], v5, s[32:35], s22 offen offset:0
    v_mfma_f32_16x16x32_bf16 v[104:107], v[32:35], v[148:151], v[104:107]
    ds_read_b128 v[128:131], v12 offset:32768
    v_mfma_f32_16x16x32_bf16 v[108:111], v[32:35], v[152:155], v[108:111]
    ds_read_b128 v[132:135], v12 offset:33792
    buffer_load_dwordx4 v[84:87], v5, s[32:35], s22 offen offset:1024
    v_mfma_f32_16x16x32_bf16 v[112:115], v[32:35], v[156:159], v[112:115]
    ds_read_b128 v[136:139], v12 offset:34816
    buffer_load_dwordx4 v[88:91], v5, s[32:35], s22 offen offset:2048
    s_waitcnt lgkmcnt(5)
    v_mfma_f32_16x16x32_bf16 v[96:99], v[36:39], v[192:195], v[96:99]
    ds_read_b128 v[140:143], v12 offset:35840
    v_mfma_f32_16x16x32_bf16 v[100:103], v[36:39], v[196:199], v[100:103]
    ds_read_b128 v[144:147], v12 offset:36864
    buffer_load_dwordx4 v[92:95], v5, s[32:35], s22 offen offset:3072
    v_mfma_f32_16x16x32_bf16 v[104:107], v[36:39], v[200:203], v[104:107]
    ds_read_b128 v[148:151], v12 offset:37888
    v_mfma_f32_16x16x32_bf16 v[108:111], v[36:39], v[204:207], v[108:111]
    ds_read_b128 v[152:155], v12 offset:38912
    s_mov_b32 m0, s27
    s_nop 0
    buffer_load_dwordx4 v5, s[36:39], s26 offen lds
    v_mfma_f32_16x16x32_bf16 v[112:115], v[36:39], v[208:211], v[112:115]
    ds_read_b128 v[156:159], v12 offset:39936
    s_waitcnt vmcnt(14)
    s_barrier
    s_waitcnt lgkmcnt(5)
    v_mfma_f32_16x16x32_bf16 v[96:99], v[40:43], v[120:123], v[96:99]
    ds_read_b128 v[192:195], v12 offset:40960
    v_mfma_f32_16x16x32_bf16 v[100:103], v[40:43], v[124:127], v[100:103]
    ds_read_b128 v[196:199], v12 offset:41984
    s_mov_b32 m0, s27
    s_nop 0
    buffer_load_dwordx4 v5, s[36:39], s26 offen offset:1024 lds
    v_mfma_f32_16x16x32_bf16 v[104:107], v[40:43], v[128:131], v[104:107]
    ds_read_b128 v[200:203], v12 offset:43008
    v_mfma_f32_16x16x32_bf16 v[108:111], v[40:43], v[132:135], v[108:111]
    ds_read_b128 v[204:207], v12 offset:44032
    s_mov_b32 m0, s27
    s_nop 0
    buffer_load_dwordx4 v5, s[36:39], s26 offen offset:2048 lds
    v_mfma_f32_16x16x32_bf16 v[112:115], v[40:43], v[136:139], v[112:115]
    ds_read_b128 v[208:211], v12 offset:45056
    s_waitcnt lgkmcnt(5)
    v_mfma_f32_16x16x32_bf16 v[96:99], v[44:47], v[140:143], v[96:99]
    ds_read_b128 v[120:123], v12 offset:46080
    v_mfma_f32_16x16x32_bf16 v[100:103], v[44:47], v[144:147], v[100:103]
    ds_read_b128 v[124:127], v12 offset:47104
    s_mov_b32 m0, s27
    s_nop 0
    buffer_load_dwordx4 v5, s[36:39], s26 offen offset:3072 lds
    v_mfma_f32_16x16x32_bf16 v[104:107], v[44:47], v[148:151], v[104:107]
    ds_read_b128 v[128:131], v12 offset:48128
    v_mfma_f32_16x16x32_bf16 v[108:111], v[44:47], v[152:155], v[108:111]
    ds_read_b128 v[132:135], v12 offset:49152
    s_add_u32 m0, s27, 4096
    s_nop 0
    buffer_load_dwordx4 v6, s[36:39], s26 offen lds
    v_mfma_f32_16x16x32_bf16 v[112:115], v[44:47], v[156:159], v[112:115]
    ds_read_b128 v[136:139], v12 offset:50176
    s_waitcnt lgkmcnt(5)
    v_mfma_f32_16x16x32_bf16 v[96:99], v[48:51], v[192:195], v[96:99]
    ds_read_b128 v[140:143], v13 offset:0
    v_mfma_f32_16x16x32_bf16 v[100:103], v[48:51], v[196:199], v[100:103]
    ds_read_b128 v[144:147], v13 offset:1024
    buffer_load_dwordx4 v[176:179], v5, s[40:43], s24 offen offset:0
    v_mfma_f32_16x16x32_bf16 v[104:107], v[48:51], v[200:203], v[104:107]
    ds_read_b128 v[148:151], v13 offset:2048
    v_mfma_f32_16x16x32_bf16 v[108:111], v[48:51], v[204:207], v[108:111]
    ds_read_b128 v[152:155], v13 offset:3072
    buffer_load_dwordx4 v[180:183], v5, s[40:43], s24 offen offset:1024
    v_mfma_f32_16x16x32_bf16 v[112:115], v[48:51], v[208:211], v[112:115]
    ds_read_b128 v[156:159], v13 offset:4096
    buffer_load_dwordx4 v[184:187], v5, s[40:43], s24 offen offset:2048
    s_waitcnt lgkmcnt(5)
    v_mfma_f32_16x16x32_bf16 v[96:99], v[52:55], v[120:123], v[96:99]
    ds_read_b128 v[192:195], v13 offset:5120
    v_mfma_f32_16x16x32_bf16 v[100:103], v[52:55], v[124:127], v[100:103]
    ds_read_b128 v[196:199], v13 offset:6144
    v_mfma_f32_16x16x32_bf16 v[104:107], v[52:55], v[128:131], v[104:107]
    ds_read_b128 v[200:203], v13 offset:7168
    v_mfma_f32_16x16x32_bf16 v[108:111], v[52:55], v[132:135], v[108:111]
    ds_read_b128 v[204:207], v13 offset:8192
    v_mfma_f32_16x16x32_bf16 v[112:115], v[52:55], v[136:139], v[112:115]
    ds_read_b128 v[208:211], v13 offset:9216
    s_waitcnt vmcnt(12)
    s_barrier
    s_waitcnt lgkmcnt(5)
    v_mfma_f32_16x16x32_bf16 v[96:99], v[56:59], v[140:143], v[96:99]
    ds_read_b128 v[120:123], v13 offset:10240
    v_mfma_f32_16x16x32_bf16 v[100:103], v[56:59], v[144:147], v[100:103]
    ds_read_b128 v[124:127], v13 offset:11264
    v_mfma_f32_16x16x32_bf16 v[104:107], v[56:59], v[148:151], v[104:107]
    ds_read_b128 v[128:131], v13 offset:12288
    v_mfma_f32_16x16x32_bf16 v[108:111], v[56:59], v[152:155], v[108:111]
    ds_read_b128 v[132:135], v13 offset:13312
    v_mfma_f32_16x16x32_bf16 v[112:115], v[56:59], v[156:159], v[112:115]
    ds_read_b128 v[136:139], v13 offset:14336
    s_waitcnt lgkmcnt(5)
    v_mfma_f32_16x16x32_bf16 v[96:99], v[60:63], v[192:195], v[96:99]
    ds_read_b128 v[140:143], v13 offset:15360
    v_mfma_f32_16x16x32_bf16 v[100:103], v[60:63], v[196:199], v[100:103]
    ds_read_b128 v[144:147], v13 offset:16384
    v_mfma_f32_16x16x32_bf16 v[104:107], v[60:63], v[200:203], v[104:107]
    ds_read_b128 v[148:151], v13 offset:17408
    v_mfma_f32_16x16x32_bf16 v[108:111], v[60:63], v[204:207], v[108:111]
    ds_read_b128 v[152:155], v13 offset:18432
    v_mfma_f32_16x16x32_bf16 v[112:115], v[60:63], v[208:211], v[112:115]
    ds_read_b128 v[156:159], v13 offset:19456
    s_waitcnt lgkmcnt(5)
    v_mfma_f32_16x16x32_bf16 v[96:99], v[64:67], v[120:123], v[96:99]
    ds_read_b128 v[192:195], v13 offset:20480
    v_mfma_f32_16x16x32_bf16 v[100:103], v[64:67], v[124:127], v[100:103]
    ds_read_b128 v[196:199], v13 offset:21504
    v_mfma_f32_16x16x32_bf16 v[104:107], v[64:67], v[128:131], v[104:107]
    ds_read_b128 v[200:203], v13 offset:22528
    v_mfma_f32_16x16x32_bf16 v[108:111], v[64:67], v[132:135], v[108:111]
    ds_read_b128 v[204:207], v13 offset:23552
    v_mfma_f32_16x16x32_bf16 v[112:115], v[64:67], v[136:139], v[112:115]
    ds_read_b128 v[208:211], v13 offset:24576
    s_waitcnt lgkmcnt(5)
    v_mfma_f32_16x16x32_bf16 v[96:99], v[68:71], v[140:143], v[96:99]
    ds_read_b128 v[120:123], v13 offset:25600
    v_mfma_f32_16x16x32_bf16 v[100:103], v[68:71], v[144:147], v[100:103]
    ds_read_b128 v[124:127], v13 offset:26624
    v_mfma_f32_16x16x32_bf16 v[104:107], v[68:71], v[148:151], v[104:107]
    ds_read_b128 v[128:131], v13 offset:27648
    v_mfma_f32_16x16x32_bf16 v[108:111], v[68:71], v[152:155], v[108:111]
    ds_read_b128 v[132:135], v13 offset:28672
    v_mfma_f32_16x16x32_bf16 v[112:115], v[68:71], v[156:159], v[112:115]
    ds_read_b128 v[136:139], v13 offset:29696
    s_waitcnt vmcnt(3)
    s_barrier
    s_waitcnt lgkmcnt(5)
    v_mfma_f32_16x16x32_bf16 v[96:99], v[72:75], v[192:195], v[96:99]
    ds_read_b128 v[140:143], v13 offset:30720
    v_mfma_f32_16x16x32_bf16 v[100:103], v[72:75], v[196:199], v[100:103]
    ds_read_b128 v[144:147], v13 offset:31744
    v_mfma_f32_16x16x32_bf16 v[104:107], v[72:75], v[200:203], v[104:107]
    ds_read_b128 v[148:151], v13 offset:32768
    v_mfma_f32_16x16x32_bf16 v[108:111], v[72:75], v[204:207], v[108:111]
    ds_read_b128 v[152:155], v13 offset:33792
    v_mfma_f32_16x16x32_bf16 v[112:115], v[72:75], v[208:211], v[112:115]
    ds_read_b128 v[156:159], v13 offset:34816
    s_waitcnt lgkmcnt(5)
    v_mfma_f32_16x16x32_bf16 v[96:99], v[76:79], v[120:123], v[96:99]
    ds_read_b128 v[192:195], v13 offset:35840
    v_mfma_f32_16x16x32_bf16 v[100:103], v[76:79], v[124:127], v[100:103]
    ds_read_b128 v[196:199], v13 offset:36864
    v_mfma_f32_16x16x32_bf16 v[104:107], v[76:79], v[128:131], v[104:107]
    ds_read_b128 v[200:203], v13 offset:37888
    v_mfma_f32_16x16x32_bf16 v[108:111], v[76:79], v[132:135], v[108:111]
    ds_read_b128 v[204:207], v13 offset:38912
    v_mfma_f32_16x16x32_bf16 v[112:115], v[76:79], v[136:139], v[112:115]
    ds_read_b128 v[208:211], v13 offset:39936
    s_waitcnt lgkmcnt(5)
    v_mfma_f32_16x16x32_bf16 v[96:99], v[80:83], v[140:143], v[96:99]
    ds_read_b128 v[120:123], v13 offset:40960
    v_mfma_f32_16x16x32_bf16 v[100:103], v[80:83], v[144:147], v[100:103]
    ds_read_b128 v[124:127], v13 offset:41984
    v_mfma_f32_16x16x32_bf16 v[104:107], v[80:83], v[148:151], v[104:107]
    ds_read_b128 v[128:131], v13 offset:43008
    v_mfma_f32_16x16x32_bf16 v[108:111], v[80:83], v[152:155], v[108:111]
    ds_read_b128 v[132:135], v13 offset:44032
    v_mfma_f32_16x16x32_bf16 v[112:115], v[80:83], v[156:159], v[112:115]
    ds_read_b128 v[136:139], v13 offset:45056
    s_waitcnt lgkmcnt(5)
    v_mfma_f32_16x16x32_bf16 v[96:99], v[84:87], v[192:195], v[96:99]
    ds_read_b128 v[140:143], v13 offset:46080
    v_mfma_f32_16x16x32_bf16 v[100:103], v[84:87], v[196:199], v[100:103]
    ds_read_b128 v[144:147], v13 offset:47104
    v_mfma_f32_16x16x32_bf16 v[104:107], v[84:87], v[200:203], v[104:107]
    ds_read_b128 v[148:151], v13 offset:48128
    v_mfma_f32_16x16x32_bf16 v[108:111], v[84:87], v[204:207], v[108:111]
    ds_read_b128 v[152:155], v13 offset:49152
    v_mfma_f32_16x16x32_bf16 v[112:115], v[84:87], v[208:211], v[112:115]
    ds_read_b128 v[156:159], v13 offset:50176
    s_waitcnt lgkmcnt(5)
    v_mfma_f32_16x16x32_bf16 v[96:99], v[88:91], v[120:123], v[96:99]
    v_mfma_f32_16x16x32_bf16 v[100:103], v[88:91], v[124:127], v[100:103]
    v_mfma_f32_16x16x32_bf16 v[104:107], v[88:91], v[128:131], v[104:107]
    v_mfma_f32_16x16x32_bf16 v[108:111], v[88:91], v[132:135], v[108:111]
    v_mfma_f32_16x16x32_bf16 v[112:115], v[88:91], v[136:139], v[112:115]
    s_waitcnt lgkmcnt(0)
    v_mfma_f32_16x16x32_bf16 v[96:99], v[92:95], v[140:143], v[96:99]
    v_mfma_f32_16x16x32_bf16 v[100:103], v[92:95], v[144:147], v[100:103]
    v_mfma_f32_16x16x32_bf16 v[104:107], v[92:95], v[148:151], v[104:107]
    v_mfma_f32_16x16x32_bf16 v[108:111], v[92:95], v[152:155], v[108:111]
    v_mfma_f32_16x16x32_bf16 v[112:115], v[92:95], v[156:159], v[112:115]
    s_waitcnt vmcnt(0)
    s_cmp_eq_u32 s25, 1
    s_cbranch_scc1 oproj1_kernel_odd1
    v_mfma_f32_16x16x32_bf16 v[96:99], v[176:179], v[160:163], v[96:99]
    v_mfma_f32_16x16x32_bf16 v[100:103], v[176:179], v[164:167], v[100:103]
    v_mfma_f32_16x16x32_bf16 v[104:107], v[180:183], v[160:163], v[104:107]
    v_mfma_f32_16x16x32_bf16 v[108:111], v[180:183], v[164:167], v[108:111]
    v_mfma_f32_16x16x32_bf16 v[112:115], v[184:187], v[160:163], v[112:115]
    s_branch oproj1_kernel_done2
oproj1_kernel_odd1:
    v_mfma_f32_16x16x32_bf16 v[96:99], v[176:179], v[164:167], v[96:99]
    v_mfma_f32_16x16x32_bf16 v[100:103], v[180:183], v[160:163], v[100:103]
    v_mfma_f32_16x16x32_bf16 v[104:107], v[180:183], v[164:167], v[104:107]
    v_mfma_f32_16x16x32_bf16 v[108:111], v[184:187], v[160:163], v[108:111]
    v_mfma_f32_16x16x32_bf16 v[112:115], v[184:187], v[164:167], v[112:115]
oproj1_kernel_done2:
    s_lshr_b32 s26, s20, 5
    s_mul_i32 s26, s26, 40960
    s_mul_i32 s27, s17, 5120
    s_add_u32 s26, s26, s27
    s_and_b32 s27, s3, 1
    s_lshl_b32 s27, s27, 3
    s_add_u32 s26, s26, s27
    s_nop 3
    v_cvt_pk_bf16_f32 v16, v96, v97
    v_cvt_pk_bf16_f32 v17, v98, v99
    buffer_store_dwordx2 v[16:17], v5, s[44:47], s26 offen offset:0
    v_cvt_pk_bf16_f32 v18, v100, v101
    v_cvt_pk_bf16_f32 v19, v102, v103
    buffer_store_dwordx2 v[18:19], v5, s[44:47], s26 offen offset:1024
    v_cvt_pk_bf16_f32 v20, v104, v105
    v_cvt_pk_bf16_f32 v21, v106, v107
    buffer_store_dwordx2 v[20:21], v5, s[44:47], s26 offen offset:2048
    v_cvt_pk_bf16_f32 v22, v108, v109
    v_cvt_pk_bf16_f32 v23, v110, v111
    buffer_store_dwordx2 v[22:23], v5, s[44:47], s26 offen offset:3072
    v_cvt_pk_bf16_f32 v24, v112, v113
    v_cvt_pk_bf16_f32 v25, v114, v115
    buffer_store_dwordx2 v[24:25], v6, s[44:47], s26 offen
    v_lshlrev_b32 v40, 16, v16
    v_and_b32 v41, 0xffff0000, v16
    v_lshlrev_b32 v42, 16, v17
    v_and_b32 v43, 0xffff0000, v17
    v_mov_b32 v32, v40
    v_mul_f32 v33, v40, v40
    v_mov_b32 v34, v41
    v_mul_f32 v35, v41, v41
    v_mov_b32 v36, v42
    v_mul_f32 v37, v42, v42
    v_mov_b32 v38, v43
    v_mul_f32 v39, v43, v43
    v_lshlrev_b32 v40, 16, v18
    v_and_b32 v41, 0xffff0000, v18
    v_lshlrev_b32 v42, 16, v19
    v_and_b32 v43, 0xffff0000, v19
    v_add_f32 v32, v32, v40
    v_fmac_f32 v33, v40, v40
    v_add_f32 v34, v34, v41
    v_fmac_f32 v35, v41, v41
    v_add_f32 v36, v36, v42
    v_fmac_f32 v37, v42, v42
    v_add_f32 v38, v38, v43
    v_fmac_f32 v39, v43, v43
    v_lshlrev_b32 v40, 16, v20
    v_and_b32 v41, 0xffff0000, v20
    v_lshlrev_b32 v42, 16, v21
    v_and_b32 v43, 0xffff0000, v21
    v_add_f32 v32, v32, v40
    v_fmac_f32 v33, v40, v40
    v_add_f32 v34, v34, v41
    v_fmac_f32 v35, v41, v41
    v_add_f32 v36, v36, v42
    v_fmac_f32 v37, v42, v42
    v_add_f32 v38, v38, v43
    v_fmac_f32 v39, v43, v43
    v_lshlrev_b32 v40, 16, v22
    v_and_b32 v41, 0xffff0000, v22
    v_lshlrev_b32 v42, 16, v23
    v_and_b32 v43, 0xffff0000, v23
    v_add_f32 v32, v32, v40
    v_fmac_f32 v33, v40, v40
    v_add_f32 v34, v34, v41
    v_fmac_f32 v35, v41, v41
    v_add_f32 v36, v36, v42
    v_fmac_f32 v37, v42, v42
    v_add_f32 v38, v38, v43
    v_fmac_f32 v39, v43, v43
    v_lshlrev_b32 v40, 16, v24
    v_and_b32 v41, 0xffff0000, v24
    v_lshlrev_b32 v42, 16, v25
    v_and_b32 v43, 0xffff0000, v25
    v_add_f32 v32, v32, v40
    v_fmac_f32 v33, v40, v40
    v_add_f32 v34, v34, v41
    v_fmac_f32 v35, v41, v41
    v_add_f32 v36, v36, v42
    v_fmac_f32 v37, v42, v42
    v_add_f32 v38, v38, v43
    v_fmac_f32 v39, v43, v43
    s_nop 1
    v_add_f32_dpp v32, v32, v32 row_ror:8 row_mask:0xf bank_mask:0xf
    v_add_f32_dpp v33, v33, v33 row_ror:8 row_mask:0xf bank_mask:0xf
    v_add_f32_dpp v34, v34, v34 row_ror:8 row_mask:0xf bank_mask:0xf
    v_add_f32_dpp v35, v35, v35 row_ror:8 row_mask:0xf bank_mask:0xf
    v_add_f32_dpp v36, v36, v36 row_ror:8 row_mask:0xf bank_mask:0xf
    v_add_f32_dpp v37, v37, v37 row_ror:8 row_mask:0xf bank_mask:0xf
    v_add_f32_dpp v38, v38, v38 row_ror:8 row_mask:0xf bank_mask:0xf
    v_add_f32_dpp v39, v39, v39 row_ror:8 row_mask:0xf bank_mask:0xf
    s_nop 1
    v_add_f32_dpp v32, v32, v32 row_ror:4 row_mask:0xf bank_mask:0xf
    v_add_f32_dpp v33, v33, v33 row_ror:4 row_mask:0xf bank_mask:0xf
    v_add_f32_dpp v34, v34, v34 row_ror:4 row_mask:0xf bank_mask:0xf
    v_add_f32_dpp v35, v35, v35 row_ror:4 row_mask:0xf bank_mask:0xf
    v_add_f32_dpp v36, v36, v36 row_ror:4 row_mask:0xf bank_mask:0xf
    v_add_f32_dpp v37, v37, v37 row_ror:4 row_mask:0xf bank_mask:0xf
    v_add_f32_dpp v38, v38, v38 row_ror:4 row_mask:0xf bank_mask:0xf
    v_add_f32_dpp v39, v39, v39 row_ror:4 row_mask:0xf bank_mask:0xf
    s_nop 1
    v_add_f32_dpp v32, v32, v32 row_ror:2 row_mask:0xf bank_mask:0xf
    v_add_f32_dpp v33, v33, v33 row_ror:2 row_mask:0xf bank_mask:0xf
    v_add_f32_dpp v34, v34, v34 row_ror:2 row_mask:0xf bank_mask:0xf
    v_add_f32_dpp v35, v35, v35 row_ror:2 row_mask:0xf bank_mask:0xf
    v_add_f32_dpp v36, v36, v36 row_ror:2 row_mask:0xf bank_mask:0xf
    v_add_f32_dpp v37, v37, v37 row_ror:2 row_mask:0xf bank_mask:0xf
    v_add_f32_dpp v38, v38, v38 row_ror:2 row_mask:0xf bank_mask:0xf
    v_add_f32_dpp v39, v39, v39 row_ror:2 row_mask:0xf bank_mask:0xf
    s_nop 1
    v_add_f32_dpp v32, v32, v32 row_ror:1 row_mask:0xf bank_mask:0xf
    v_add_f32_dpp v33, v33, v33 row_ror:1 row_mask:0xf bank_mask:0xf
    v_add_f32_dpp v34, v34, v34 row_ror:1 row_mask:0xf bank_mask:0xf
    v_add_f32_dpp v35, v35, v35 row_ror:1 row_mask:0xf bank_mask:0xf
    v_add_f32_dpp v36, v36, v36 row_ror:1 row_mask:0xf bank_mask:0xf
    v_add_f32_dpp v37, v37, v37 row_ror:1 row_mask:0xf bank_mask:0xf
    v_add_f32_dpp v38, v38, v38 row_ror:1 row_mask:0xf bank_mask:0xf
    v_add_f32_dpp v39, v39, v39 row_ror:1 row_mask:0xf bank_mask:0xf
    v_mov_b32 v40, v32
    v_cmp_eq_u32 vcc, 1, v3
    s_nop 1
    v_cndmask_b32 v40, v40, v33, vcc
    v_cmp_eq_u32 vcc, 2, v3
    s_nop 1
    v_cndmask_b32 v40, v40, v34, vcc
    v_cmp_eq_u32 vcc, 3, v3
    s_nop 1
    v_cndmask_b32 v40, v40, v35, vcc
    v_cmp_eq_u32 vcc, 4, v3
    s_nop 1
    v_cndmask_b32 v40, v40, v36, vcc
    v_cmp_eq_u32 vcc, 5, v3
    s_nop 1
    v_cndmask_b32 v40, v40, v37, vcc
    v_cmp_eq_u32 vcc, 6, v3
    s_nop 1
    v_cndmask_b32 v40, v40, v38, vcc
    v_cmp_eq_u32 vcc, 7, v3
    s_nop 1
    v_cndmask_b32 v40, v40, v39, vcc
    v_lshlrev_b32 v12, 5, v2
    v_lshl_add_u32 v12, v3, 2, v12
    s_lshl_b32 s26, s20, 3
    v_mov_b32 v13, 0x7ffffff0
    v_cmp_gt_u32 vcc, 8, v3
    s_nop 1
    v_cndmask_b32 v12, v13, v12, vcc
    buffer_atomic_add_f32 v40, v12, s[48:51], s26 offen
oproj1_kernel_end:
    s_endpgm

.globl mlpa1_kernel
.p2align 8
.type mlpa1_kernel,@function
mlpa1_kernel:
    s_cmp_ge_u32 s2, 240
    s_cbranch_scc1 mlpa1_kernel_end
    s_lshr_b32 s18, s2, 3
    s_mul_i32 s17, s18, 13108
    s_lshr_b32 s17, s17, 16
    s_mul_i32 s16, s17, 5
    s_sub_u32 s16, s18, s16
    s_and_b32 s18, s2, 1
    s_mul_i32 s18, s18, 5
    s_add_u32 s16, s16, s18
    s_bfe_u32 s18, s2, 0x20001
    s_cmp_ge_u32 s18, 2
    s_cselect_b32 s19, 5, 6
    s_cmp_ge_u32 s17, s19
    s_cbranch_scc1 mlpa1_kernel_end
    s_mul_i32 s19, s18, 6
    s_cmp_eq_u32 s18, 3
    s_cselect_b32 s18, 1, 0
    s_sub_u32 s19, s19, s18
    s_add_u32 s17, s17, s19
    s_setprio 3
    s_load_dwordx2 s[4:5], s[0:1], 96
    s_load_dwordx2 s[10:11], s[0:1], 56
    v_lshrrev_b32 v2, 6, v0
    v_and_b32 v1, 63, v0
    v_readfirstlane_b32 s3, v2
    v_lshrrev_b32 v2, 4, v1
    v_and_b32 v3, 15, v1
    v_lshlrev_b32 v5, 4, v1
    v_add_u32 v6, 4096, v5
    s_waitcnt lgkmcnt(0)
    s_add_u32 s32, s4, 17825792
    s_addc_u32 s33, s5, 0
    s_mov_b32 s34, 2621440
    s_mov_b32 s35, 0x00020000
    s_add_u32 s36, s4, 33554432
    s_addc_u32 s37, s5, 0
    s_mov_b32 s38, 7208960
    s_mov_b32 s39, 0x00020000
    s_mov_b32 s40, s10
    s_mov_b32 s41, s11
    s_mov_b32 s42, 3456
    s_mov_b32 s43, 0x00020000
    s_add_u32 s44, s4, 10485760
    s_addc_u32 s45, s5, 0
    s_mov_b32 s46, 16384
    s_mov_b32 s47, 0x00020000
    s_add_u32 s48, s4, 11534336
    s_addc_u32 s49, s5, 0
    s_mov_b32 s50, 2211840
    s_mov_b32 s51, 0x00020000
    s_mul_i32 s26, s3, 40960
    s_lshl_b32 s27, s16, 12
    s_add_u32 s26, s26, s27
    s_mul_i32 s27, s3, 112640
    s_mul_i32 s29, s17, 5120
    s_add_u32 s27, s27, s29
    s_mul_i32 s28, s3, 20480
    v_and_b32 v7, 31, v1
    v_lshlrev_b32 v7, 3, v7
    v_lshrrev_b32 v8, 5, v1
    v_lshl_add_u32 v7, v8, 11, v7
    s_lshl_b32 s29, s3, 8
    buffer_load_dwordx2 v[236:237], v7, s[44:47], s29 offen
    s_add_u32 s29, s29, 4096
    buffer_load_dwordx2 v[238:239], v7, s[44:47], s29 offen
    s_add_u32 s29, s29, 4096
    buffer_load_dwordx2 v[240:241], v7, s[44:47], s29 offen
    s_add_u32 s29, s29, 4096
    buffer_load_dwordx2 v[242:243], v7, s[44:47], s29 offen
    buffer_load_dwordx4 v[116:119], v5, s[32:35], s26 offen offset:0
    buffer_load_dwordx4 v[120:123], v5, s[32:35], s26 offen offset:1024
    buffer_load_dwordx4 v[124:127], v5, s[32:35], s26 offen offset:2048
    buffer_load_dwordx4 v[128:131], v5, s[32:35], s26 offen offset:3072
    s_add_u32 s26, s26, 327680
    buffer_load_dwordx4 v[96:99], v5, s[36:39], s27 offen offset:0
    buffer_load_dwordx4 v[100:103], v5, s[36:39], s27 offen offset:1024
    buffer_load_dwordx4 v[104:107], v5, s[36:39], s27 offen offset:2048
    buffer_load_dwordx4 v[108:111], v5, s[36:39], s27 offen offset:3072
    buffer_load_dwordx4 v[112:115], v6, s[36:39], s27 offen
    s_add_u32 s27, s27, 901120
    v_lshlrev_b32 v8, 2, v1
    v_add_u32 v8, s28, v8
    v_lshlrev_b32 v9, 4, v2
    v_add_u32 v9, s28, v9
    v_mov_b32 v16, 0
    v_mov_b32 v17, 0
    v_mov_b32 v18, 0
    v_mov_b32 v19, 0
    v_mov_b32 v20, 0
    v_mov_b32 v21, 0
    v_mov_b32 v22, 0
    v_mov_b32 v23, 0
    v_mov_b32 v24, 0
    v_mov_b32 v25, 0
    v_mov_b32 v26, 0
    v_mov_b32 v27, 0
    v_mov_b32 v28, 0
    v_mov_b32 v29, 0
    v_mov_b32 v30, 0
    v_mov_b32 v31, 0
    v_mov_b32 v32, 0
    v_mov_b32 v33, 0
    v_mov_b32 v34, 0
    v_mov_b32 v35, 0
    v_mov_b32 v36, 0
    v_mov_b32 v37, 0
    v_mov_b32 v38, 0
    v_mov_b32 v39, 0
    v_mov_b32 v40, 0
    v_mov_b32 v41, 0
    v_mov_b32 v42, 0
    v_mov_b32 v43, 0
    v_mov_b32 v44, 0
    v_mov_b32 v45, 0
    v_mov_b32 v46, 0
    v_mov_b32 v47, 0
    v_mov_b32 v48, 0
    v_mov_b32 v49, 0
    v_mov_b32 v50, 0
    v_mov_b32 v51, 0
    v_mov_b32 v52, 0
    v_mov_b32 v53, 0
    v_mov_b32 v54, 0
    v_mov_b32 v55, 0
    v_mov_b32 v56, 0
    v_mov_b32 v57, 0
    v_mov_b32 v58, 0
    v_mov_b32 v59, 0
    v_mov_b32 v60, 0
    v_mov_b32 v61, 0
    v_mov_b32 v62, 0
    v_mov_b32 v63, 0
    v_mov_b32 v64, 0
    v_mov_b32 v65, 0
    v_mov_b32 v66, 0
    v_mov_b32 v67, 0
    v_mov_b32 v68, 0
    v_mov_b32 v69, 0
    v_mov_b32 v70, 0
    v_mov_b32 v71, 0
    v_mov_b32 v72, 0
    v_mov_b32 v73, 0
    v_mov_b32 v74, 0
    v_mov_b32 v75, 0
    v_mov_b32 v76, 0
    v_mov_b32 v77, 0
    v_mov_b32 v78, 0
    v_mov_b32 v79, 0
    v_mov_b32 v80, 0
    v_mov_b32 v81, 0
    v_mov_b32 v82, 0
    v_mov_b32 v83, 0
    v_mov_b32 v84, 0
    v_mov_b32 v85, 0
    v_mov_b32 v86, 0
    v_mov_b32 v87, 0
    v_mov_b32 v88, 0
    v_mov_b32 v89, 0
    v_mov_b32 v90, 0
    v_mov_b32 v91, 0
    v_mov_b32 v92, 0
    v_mov_b32 v93, 0
    v_mov_b32 v94, 0
    v_mov_b32 v95, 0
    s_waitcnt vmcnt(9)
    v_mul_f32 v236, 0x3acccccd, v236
    v_mul_f32 v237, 0x3acccccd, v237
    v_fma_f32 v237, -v236, v236, v237
    v_max_f32 v237, 0, v237
    v_add_f32 v13, 0x3727c5ac, v237
    v_rcp_f32 v14, v13
    v_rsq_f32 v13, v13
    v_mul_f32 v14, v14, v237
    v_add_f32 v14, 0x3727c5ac, v14
    v_rsq_f32 v14, v14
    s_nop 0
    v_mul_f32 v13, v13, v14
    v_mul_f32 v237, v236, v13
    v_sub_f32 v237, 0, v237
    ds_write_b32 v8, v13 offset:0
    ds_write_b32 v8, v237 offset:1024
    v_mul_f32 v238, 0x3acccccd, v238
    v_mul_f32 v239, 0x3acccccd, v239
    v_fma_f32 v239, -v238, v238, v239
    v_max_f32 v239, 0, v239
    v_add_f32 v13, 0x3727c5ac, v239
    v_rcp_f32 v14, v13
    v_rsq_f32 v13, v13
    v_mul_f32 v14, v14, v239
    v_add_f32 v14, 0x3727c5ac, v14
    v_rsq_f32 v14, v14
    s_nop 0
    v_mul_f32 v13, v13, v14
    v_mul_f32 v239, v238, v13
    v_sub_f32 v239, 0, v239
    ds_write_b32 v8, v13 offset:256
    ds_write_b32 v8, v239 offset:1280
    v_mul_f32 v240, 0x3acccccd, v240
    v_mul_f32 v241, 0x3acccccd, v241
    v_fma_f32 v241, -v240, v240, v241
    v_max_f32 v241, 0, v241
    v_add_f32 v13, 0x3727c5ac, v241
    v_rcp_f32 v14, v13
    v_rsq_f32 v13, v13
    v_mul_f32 v14, v14, v241
    v_add_f32 v14, 0x3727c5ac, v14
    v_rsq_f32 v14, v14
    s_nop 0
    v_mul_f32 v13, v13, v14
    v_mul_f32 v241, v240, v13
    v_sub_f32 v241, 0, v241
    ds_write_b32 v8, v13 offset:512
    ds_write_b32 v8, v241 offset:1536
    v_mul_f32 v242, 0x3acccccd, v242
    v_mul_f32 v243, 0x3acccccd, v243
    v_fma_f32 v243, -v242, v242, v243
    v_max_f32 v243, 0, v243
    v_add_f32 v13, 0x3727c5ac, v243
    v_rcp_f32 v14, v13
    v_rsq_f32 v13, v13
    v_mul_f32 v14, v14, v243
    v_add_f32 v14, 0x3727c5ac, v14
    v_rsq_f32 v14, v14
    s_nop 0
    v_mul_f32 v13, v13, v14
    v_mul_f32 v243, v242, v13
    v_sub_f32 v243, 0, v243
    ds_write_b32 v8, v13 offset:768
    ds_write_b32 v8, v243 offset:1792
    buffer_load_dwordx4 v[152:155], v5, s[32:35], s26 offen offset:0
    buffer_load_dwordx4 v[156:159], v5, s[32:35], s26 offen offset:1024
    buffer_load_dwordx4 v[160:163], v5, s[32:35], s26 offen offset:2048
    buffer_load_dwordx4 v[164:167], v5, s[32:35], s26 offen offset:3072
    s_add_u32 s26, s26, 327680
    buffer_load_dwordx4 v[132:135], v5, s[36:39], s27 offen offset:0
    buffer_load_dwordx4 v[136:139], v5, s[36:39], s27 offen offset:1024
    buffer_load_dwordx4 v[140:143], v5, s[36:39], s27 offen offset:2048
    buffer_load_dwordx4 v[144:147], v5, s[36:39], s27 offen offset:3072
    buffer_load_dwordx4 v[148:151], v6, s[36:39], s27 offen
    s_add_u32 s27, s27, 901120
    ds_read_b128 v[204:207], v9 offset:0
    ds_read_b128 v[208:211], v9 offset:64
    ds_read_b128 v[212:215], v9 offset:1024
    ds_read_b128 v[216:219], v9 offset:1088
    s_waitcnt vmcnt(14)
    s_waitcnt lgkmcnt(0)
    ds_read_b128 v[220:223], v9 offset:128
    ds_read_b128 v[224:227], v9 offset:192
    ds_read_b128 v[228:231], v9 offset:1152
    ds_read_b128 v[232:235], v9 offset:1216
    v_lshlrev_b32 v236, 16, v116
    v_and_b32 v237, 0xffff0000, v116
    v_pk_fma_f32 v[236:237], v[236:237], v[204:205], v[212:213]
    v_cvt_pk_bf16_f32 v116, v236, v237
    buffer_load_dwordx4 v[188:191], v5, s[32:35], s26 offen offset:0
    v_lshlrev_b32 v238, 16, v117
    v_and_b32 v239, 0xffff0000, v117
    v_pk_fma_f32 v[238:239], v[238:239], v[206:207], v[214:215]
    v_cvt_pk_bf16_f32 v117, v238, v239
    v_lshlrev_b32 v240, 16, v118
    v_and_b32 v241, 0xffff0000, v118
    v_pk_fma_f32 v[240:241], v[240:241], v[208:209], v[216:217]
    v_cvt_pk_bf16_f32 v118, v240, v241
    buffer_load_dwordx4 v[192:195], v5, s[32:35], s26 offen offset:1024
    v_lshlrev_b32 v242, 16, v119
    v_and_b32 v243, 0xffff0000, v119
    v_pk_fma_f32 v[242:243], v[242:243], v[210:211], v[218:219]
    v_cvt_pk_bf16_f32 v119, v242, v243
    v_lshlrev_b32 v236, 16, v120
    v_and_b32 v237, 0xffff0000, v120
    v_pk_fma_f32 v[236:237], v[236:237], v[204:205], v[212:213]
    v_cvt_pk_bf16_f32 v120, v236, v237
    buffer_load_dwordx4 v[196:199], v5, s[32:35], s26 offen offset:2048
    v_lshlrev_b32 v238, 16, v121
    v_and_b32 v239, 0xffff0000, v121
    v_pk_fma_f32 v[238:239], v[238:239], v[206:207], v[214:215]
    v_cvt_pk_bf16_f32 v121, v238, v239
    v_lshlrev_b32 v240, 16, v122
    v_and_b32 v241, 0xffff0000, v122
    v_pk_fma_f32 v[240:241], v[240:241], v[208:209], v[216:217]
    v_cvt_pk_bf16_f32 v122, v240, v241
    buffer_load_dwordx4 v[200:203], v5, s[32:35], s26 offen offset:3072
    s_add_u32 s26, s26, 327680
    v_lshlrev_b32 v242, 16, v123
    v_and_b32 v243, 0xffff0000, v123
    v_pk_fma_f32 v[242:243], v[242:243], v[210:211], v[218:219]
    v_cvt_pk_bf16_f32 v123, v242, v243
    v_lshlrev_b32 v236, 16, v124
    v_and_b32 v237, 0xffff0000, v124
    v_pk_fma_f32 v[236:237], v[236:237], v[204:205], v[212:213]
    v_cvt_pk_bf16_f32 v124, v236, v237
    buffer_load_dwordx4 v[168:171], v5, s[36:39], s27 offen offset:0
    v_lshlrev_b32 v238, 16, v125
    v_and_b32 v239, 0xffff0000, v125
    v_pk_fma_f32 v[238:239], v[238:239], v[206:207], v[214:215]
    v_cvt_pk_bf16_f32 v125, v238, v239
    v_lshlrev_b32 v240, 16, v126
    v_and_b32 v241, 0xffff0000, v126
    v_pk_fma_f32 v[240:241], v[240:241], v[208:209], v[216:217]
    v_cvt_pk_bf16_f32 v126, v240, v241
    buffer_load_dwordx4 v[172:175], v5, s[36:39], s27 offen offset:1024
    v_lshlrev_b32 v242, 16, v127
    v_and_b32 v243, 0xffff0000, v127
    v_pk_fma_f32 v[242:243], v[242:243], v[210:211], v[218:219]
    v_cvt_pk_bf16_f32 v127, v242, v243
    v_lshlrev_b32 v236, 16, v128
    v_and_b32 v237, 0xffff0000, v128
    v_pk_fma_f32 v[236:237], v[236:237], v[204:205], v[212:213]
    v_cvt_pk_bf16_f32 v128, v236, v237
    buffer_load_dwordx4 v[176:179], v5, s[36:39], s27 offen offset:2048
    v_lshlrev_b32 v238, 16, v129
    v_and_b32 v239, 0xffff0000, v129
    v_pk_fma_f32 v[238:239], v[238:239], v[206:207], v[214:215]
    v_cvt_pk_bf16_f32 v129, v238, v239
    v_lshlrev_b32 v240, 16, v130
    v_and_b32 v241, 0xffff0000, v130
    v_pk_fma_f32 v[240:241], v[240:241], v[208:209], v[216:217]
    v_cvt_pk_bf16_f32 v130, v240, v241
    buffer_load_dwordx4 v[180:183], v5, s[36:39], s27 offen offset:3072
    v_lshlrev_b32 v242, 16, v131
    v_and_b32 v243, 0xffff0000, v131
    v_pk_fma_f32 v[242:243], v[242:243], v[210:211], v[218:219]
    v_cvt_pk_bf16_f32 v131, v242, v243
    buffer_load_dwordx4 v[184:187], v6, s[36:39], s27 offen
    s_add_u32 s27, s27, 901120
    s_waitcnt vmcnt(18)
    v_mfma_f32_16x16x32_bf16 v[16:19], v[96:99], v[116:119], v[16:19]
    v_mfma_f32_16x16x32_bf16 v[20:23], v[96:99], v[120:123], v[20:23]
    v_mfma_f32_16x16x32_bf16 v[24:27], v[96:99], v[124:127], v[24:27]
    v_mfma_f32_16x16x32_bf16 v[28:31], v[96:99], v[128:131], v[28:31]
    v_mfma_f32_16x16x32_bf16 v[32:35], v[100:103], v[116:119], v[32:35]
    v_mfma_f32_16x16x32_bf16 v[36:39], v[100:103], v[120:123], v[36:39]
    v_mfma_f32_16x16x32_bf16 v[40:43], v[100:103], v[124:127], v[40:43]
    v_mfma_f32_16x16x32_bf16 v[44:47], v[100:103], v[128:131], v[44:47]
    v_mfma_f32_16x16x32_bf16 v[48:51], v[104:107], v[116:119], v[48:51]
    v_mfma_f32_16x16x32_bf16 v[52:55], v[104:107], v[120:123], v[52:55]
    v_mfma_f32_16x16x32_bf16 v[56:59], v[104:107], v[124:127], v[56:59]
    v_mfma_f32_16x16x32_bf16 v[60:63], v[104:107], v[128:131], v[60:63]
    v_mfma_f32_16x16x32_bf16 v[64:67], v[108:111], v[116:119], v[64:67]
    v_mfma_f32_16x16x32_bf16 v[68:71], v[108:111], v[120:123], v[68:71]
    v_mfma_f32_16x16x32_bf16 v[72:75], v[108:111], v[124:127], v[72:75]
    v_mfma_f32_16x16x32_bf16 v[76:79], v[108:111], v[128:131], v[76:79]
    v_mfma_f32_16x16x32_bf16 v[80:83], v[112:115], v[116:119], v[80:83]
    v_mfma_f32_16x16x32_bf16 v[84:87], v[112:115], v[120:123], v[84:87]
    v_mfma_f32_16x16x32_bf16 v[88:91], v[112:115], v[124:127], v[88:91]
    v_mfma_f32_16x16x32_bf16 v[92:95], v[112:115], v[128:131], v[92:95]
    s_waitcnt vmcnt(14)
    s_waitcnt lgkmcnt(0)
    ds_read_b128 v[204:207], v9 offset:256
    ds_read_b128 v[208:211], v9 offset:320
    ds_read_b128 v[212:215], v9 offset:1280
    ds_read_b128 v[216:219], v9 offset:1344
    v_lshlrev_b32 v236, 16, v152
    v_and_b32 v237, 0xffff0000, v152
    v_pk_fma_f32 v[236:237], v[236:237], v[220:221], v[228:229]
    v_cvt_pk_bf16_f32 v152, v236, v237
    buffer_load_dwordx4 v[116:119], v5, s[32:35], s26 offen offset:0
    v_lshlrev_b32 v238, 16, v153
    v_and_b32 v239, 0xffff0000, v153
    v_pk_fma_f32 v[238:239], v[238:239], v[222:223], v[230:231]
    v_cvt_pk_bf16_f32 v153, v238, v239
    v_lshlrev_b32 v240, 16, v154
    v_and_b32 v241, 0xffff0000, v154
    v_pk_fma_f32 v[240:241], v[240:241], v[224:225], v[232:233]
    v_cvt_pk_bf16_f32 v154, v240, v241
    buffer_load_dwordx4 v[120:123], v5, s[32:35], s26 offen offset:1024
    v_lshlrev_b32 v242, 16, v155
    v_and_b32 v243, 0xffff0000, v155
    v_pk_fma_f32 v[242:243], v[242:243], v[226:227], v[234:235]
    v_cvt_pk_bf16_f32 v155, v242, v243
    v_lshlrev_b32 v236, 16, v156
    v_and_b32 v237, 0xffff0000, v156
    v_pk_fma_f32 v[236:237], v[236:237], v[220:221], v[228:229]
    v_cvt_pk_bf16_f32 v156, v236, v237
    buffer_load_dwordx4 v[124:127], v5, s[32:35], s26 offen offset:2048
    v_lshlrev_b32 v238, 16, v157
    v_and_b32 v239, 0xffff0000, v157
    v_pk_fma_f32 v[238:239], v[238:239], v[222:223], v[230:231]
    v_cvt_pk_bf16_f32 v157, v238, v239
    v_lshlrev_b32 v240, 16, v158
    v_and_b32 v241, 0xffff0000, v158
    v_pk_fma_f32 v[240:241], v[240:241], v[224:225], v[232:233]
    v_cvt_pk_bf16_f32 v158, v240, v241
    buffer_load_dwordx4 v[128:131], v5, s[32:35], s26 offen offset:3072
    s_add_u32 s26, s26, 327680
    v_lshlrev_b32 v242, 16, v159
    v_and_b32 v243, 0xffff0000, v159
    v_pk_fma_f32 v[242:243], v[242:243], v[226:227], v[234:235]
    v_cvt_pk_bf16_f32 v159, v242, v243
    v_lshlrev_b32 v236, 16, v160
    v_and_b32 v237, 0xffff0000, v160
    v_pk_fma_f32 v[236:237], v[236:237], v[220:221], v[228:229]
    v_cvt_pk_bf16_f32 v160, v236, v237
    buffer_load_dwordx4 v[96:99], v5, s[36:39], s27 offen offset:0
    v_lshlrev_b32 v238, 16, v161
    v_and_b32 v239, 0xffff0000, v161
    v_pk_fma_f32 v[238:239], v[238:239], v[222:223], v[230:231]
    v_cvt_pk_bf16_f32 v161, v238, v239
    v_lshlrev_b32 v240, 16, v162
    v_and_b32 v241, 0xffff0000, v162
    v_pk_fma_f32 v[240:241], v[240:241], v[224:225], v[232:233]
    v_cvt_pk_bf16_f32 v162, v240, v241
    buffer_load_dwordx4 v[100:103], v5, s[36:39], s27 offen offset:1024
    v_lshlrev_b32 v242, 16, v163
    v_and_b32 v243, 0xffff0000, v163
    v_pk_fma_f32 v[242:243], v[242:243], v[226:227], v[234:235]
    v_cvt_pk_bf16_f32 v163, v242, v243
    v_lshlrev_b32 v236, 16, v164
    v_and_b32 v237, 0xffff0000, v164
    v_pk_fma_f32 v[236:237], v[236:237], v[220:221], v[228:229]
    v_cvt_pk_bf16_f32 v164, v236, v237
    buffer_load_dwordx4 v[104:107], v5, s[36:39], s27 offen offset:2048
    v_lshlrev_b32 v238, 16, v165
    v_and_b32 v239, 0xffff0000, v165
    v_pk_fma_f32 v[238:239], v[238:239], v[222:223], v[230:231]
    v_cvt_pk_bf16_f32 v165, v238, v239
    v_lshlrev_b32 v240, 16, v166
    v_and_b32 v241, 0xffff0000, v166
    v_pk_fma_f32 v[240:241], v[240:241], v[224:225], v[232:233]
    v_cvt_pk_bf16_f32 v166, v240, v241
    buffer_load_dwordx4 v[108:111], v5, s[36:39], s27 offen offset:3072
    v_lshlrev_b32 v242, 16, v167
    v_and_b32 v243, 0xffff0000, v167
    v_pk_fma_f32 v[242:243], v[242:243], v[226:227], v[234:235]
    v_cvt_pk_bf16_f32 v167, v242, v243
    buffer_load_dwordx4 v[112:115], v6, s[36:39], s27 offen
    s_add_u32 s27, s27, 901120
    s_waitcnt vmcnt(18)
    v_mfma_f32_16x16x32_bf16 v[16:19], v[132:135], v[152:155], v[16:19]
    v_mfma_f32_16x16x32_bf16 v[20:23], v[132:135], v[156:159], v[20:23]
    v_mfma_f32_16x16x32_bf16 v[24:27], v[132:135], v[160:163], v[24:27]
    v_mfma_f32_16x16x32_bf16 v[28:31], v[132:135], v[164:167], v[28:31]
    v_mfma_f32_16x16x32_bf16 v[32:35], v[136:139], v[152:155], v[32:35]
    v_mfma_f32_16x16x32_bf16 v[36:39], v[136:139], v[156:159], v[36:39]
    v_mfma_f32_16x16x32_bf16 v[40:43], v[136:139], v[160:163], v[40:43]
    v_mfma_f32_16x16x32_bf16 v[44:47], v[136:139], v[164:167], v[44:47]
    v_mfma_f32_16x16x32_bf16 v[48:51], v[140:143], v[152:155], v[48:51]
    v_mfma_f32_16x16x32_bf16 v[52:55], v[140:143], v[156:159], v[52:55]
    v_mfma_f32_16x16x32_bf16 v[56:59], v[140:143], v[160:163], v[56:59]
    v_mfma_f32_16x16x32_bf16 v[60:63], v[140:143], v[164:167], v[60:63]
    v_mfma_f32_16x16x32_bf16 v[64:67], v[144:147], v[152:155], v[64:67]
    v_mfma_f32_16x16x32_bf16 v[68:71], v[144:147], v[156:159], v[68:71]
    v_mfma_f32_16x16x32_bf16 v[72:75], v[144:147], v[160:163], v[72:75]
    v_mfma_f32_16x16x32_bf16 v[76:79], v[144:147], v[164:167], v[76:79]
    v_mfma_f32_16x16x32_bf16 v[80:83], v[148:151], v[152:155], v[80:83]
    v_mfma_f32_16x16x32_bf16 v[84:87], v[148:151], v[156:159], v[84:87]
    v_mfma_f32_16x16x32_bf16 v[88:91], v[148:151], v[160:163], v[88:91]
    v_mfma_f32_16x16x32_bf16 v[92:95], v[148:151], v[164:167], v[92:95]
    s_setprio 2
    s_waitcnt vmcnt(14)
    s_waitcnt lgkmcnt(0)
    ds_read_b128 v[220:223], v9 offset:384
    ds_read_b128 v[224:227], v9 offset:448
    ds_read_b128 v[228:231], v9 offset:1408
    ds_read_b128 v[232:235], v9 offset:1472
    v_lshlrev_b32 v236, 16, v188
    v_and_b32 v237, 0xffff0000, v188
    v_pk_fma_f32 v[236:237], v[236:237], v[204:205], v[212:213]
    v_cvt_pk_bf16_f32 v188, v236, v237
    buffer_load_dwordx4 v[152:155], v5, s[32:35], s26 offen offset:0
    v_lshlrev_b32 v238, 16, v189
    v_and_b32 v239, 0xffff0000, v189
    v_pk_fma_f32 v[238:239], v[238:239], v[206:207], v[214:215]
    v_cvt_pk_bf16_f32 v189, v238, v239
    v_lshlrev_b32 v240, 16, v190
    v_and_b32 v241, 0xffff0000, v190
    v_pk_fma_f32 v[240:241], v[240:241], v[208:209], v[216:217]
    v_cvt_pk_bf16_f32 v190, v240, v241
    buffer_load_dwordx4 v[156:159], v5, s[32:35], s26 offen offset:1024
    v_lshlrev_b32 v242, 16, v191
    v_and_b32 v243, 0xffff0000, v191
    v_pk_fma_f32 v[242:243], v[242:243], v[210:211], v[218:219]
    v_cvt_pk_bf16_f32 v191, v242, v243
    v_lshlrev_b32 v236, 16, v192
    v_and_b32 v237, 0xffff0000, v192
    v_pk_fma_f32 v[236:237], v[236:237], v[204:205], v[212:213]
    v_cvt_pk_bf16_f32 v192, v236, v237
    buffer_load_dwordx4 v[160:163], v5, s[32:35], s26 offen offset:2048
    v_lshlrev_b32 v238, 16, v193
    v_and_b32 v239, 0xffff0000, v193
    v_pk_fma_f32 v[238:239], v[238:239], v[206:207], v[214:215]
    v_cvt_pk_bf16_f32 v193, v238, v239
    v_lshlrev_b32 v240, 16, v194
    v_and_b32 v241, 0xffff0000, v194
    v_pk_fma_f32 v[240:241], v[240:241], v[208:209], v[216:217]
    v_cvt_pk_bf16_f32 v194, v240, v241
    buffer_load_dwordx4 v[164:167], v5, s[32:35], s26 offen offset:3072
    s_add_u32 s26, s26, 327680
    v_lshlrev_b32 v242, 16, v195
    v_and_b32 v243, 0xffff0000, v195
    v_pk_fma_f32 v[242:243], v[242:243], v[210:211], v[218:219]
    v_cvt_pk_bf16_f32 v195, v242, v243
    v_lshlrev_b32 v236, 16, v196
    v_and_b32 v237, 0xffff0000, v196
    v_pk_fma_f32 v[236:237], v[236:237], v[204:205], v[212:213]
    v_cvt_pk_bf16_f32 v196, v236, v237
    buffer_load_dwordx4 v[132:135], v5, s[36:39], s27 offen offset:0
    v_lshlrev_b32 v238, 16, v197
    v_and_b32 v239, 0xffff0000, v197
    v_pk_fma_f32 v[238:239], v[238:239], v[206:207], v[214:215]
    v_cvt_pk_bf16_f32 v197, v238, v239
    v_lshlrev_b32 v240, 16, v198
    v_and_b32 v241, 0xffff0000, v198
    v_pk_fma_f32 v[240:241], v[240:241], v[208:209], v[216:217]
    v_cvt_pk_bf16_f32 v198, v240, v241
    buffer_load_dwordx4 v[136:139], v5, s[36:39], s27 offen offset:1024
    v_lshlrev_b32 v242, 16, v199
    v_and_b32 v243, 0xffff0000, v199
    v_pk_fma_f32 v[242:243], v[242:243], v[210:211], v[218:219]
    v_cvt_pk_bf16_f32 v199, v242, v243
    v_lshlrev_b32 v236, 16, v200
    v_and_b32 v237, 0xffff0000, v200
    v_pk_fma_f32 v[236:237], v[236:237], v[204:205], v[212:213]
    v_cvt_pk_bf16_f32 v200, v236, v237
    buffer_load_dwordx4 v[140:143], v5, s[36:39], s27 offen offset:2048
    v_lshlrev_b32 v238, 16, v201
    v_and_b32 v239, 0xffff0000, v201
    v_pk_fma_f32 v[238:239], v[238:239], v[206:207], v[214:215]
    v_cvt_pk_bf16_f32 v201, v238, v239
    v_lshlrev_b32 v240, 16, v202
    v_and_b32 v241, 0xffff0000, v202
    v_pk_fma_f32 v[240:241], v[240:241], v[208:209], v[216:217]
    v_cvt_pk_bf16_f32 v202, v240, v241
    buffer_load_dwordx4 v[144:147], v5, s[36:39], s27 offen offset:3072
    v_lshlrev_b32 v242, 16, v203
    v_and_b32 v243, 0xffff0000, v203
    v_pk_fma_f32 v[242:243], v[242:243], v[210:211], v[218:219]
    v_cvt_pk_bf16_f32 v203, v242, v243
    buffer_load_dwordx4 v[148:151], v6, s[36:39], s27 offen
    s_add_u32 s27, s27, 901120
    s_waitcnt vmcnt(18)
    v_mfma_f32_16x16x32_bf16 v[16:19], v[168:171], v[188:191], v[16:19]
    v_mfma_f32_16x16x32_bf16 v[20:23], v[168:171], v[192:195], v[20:23]
    v_mfma_f32_16x16x32_bf16 v[24:27], v[168:171], v[196:199], v[24:27]
    v_mfma_f32_16x16x32_bf16 v[28:31], v[168:171], v[200:203], v[28:31]
    v_mfma_f32_16x16x32_bf16 v[32:35], v[172:175], v[188:191], v[32:35]
    v_mfma_f32_16x16x32_bf16 v[36:39], v[172:175], v[192:195], v[36:39]
    v_mfma_f32_16x16x32_bf16 v[40:43], v[172:175], v[196:199], v[40:43]
    v_mfma_f32_16x16x32_bf16 v[44:47], v[172:175], v[200:203], v[44:47]
    v_mfma_f32_16x16x32_bf16 v[48:51], v[176:179], v[188:191], v[48:51]
    v_mfma_f32_16x16x32_bf16 v[52:55], v[176:179], v[192:195], v[52:55]
    v_mfma_f32_16x16x32_bf16 v[56:59], v[176:179], v[196:199], v[56:59]
    v_mfma_f32_16x16x32_bf16 v[60:63], v[176:179], v[200:203], v[60:63]
    v_mfma_f32_16x16x32_bf16 v[64:67], v[180:183], v[188:191], v[64:67]
    v_mfma_f32_16x16x32_bf16 v[68:71], v[180:183], v[192:195], v[68:71]
    v_mfma_f32_16x16x32_bf16 v[72:75], v[180:183], v[196:199], v[72:75]
    v_mfma_f32_16x16x32_bf16 v[76:79], v[180:183], v[200:203], v[76:79]
    v_mfma_f32_16x16x32_bf16 v[80:83], v[184:187], v[188:191], v[80:83]
    v_mfma_f32_16x16x32_bf16 v[84:87], v[184:187], v[192:195], v[84:87]
    v_mfma_f32_16x16x32_bf16 v[88:91], v[184:187], v[196:199], v[88:91]
    v_mfma_f32_16x16x32_bf16 v[92:95], v[184:187], v[200:203], v[92:95]
    s_waitcnt vmcnt(14)
    s_waitcnt lgkmcnt(0)
    ds_read_b128 v[204:207], v9 offset:512
    ds_read_b128 v[208:211], v9 offset:576
    ds_read_b128 v[212:215], v9 offset:1536
    ds_read_b128 v[216:219], v9 offset:1600
    v_lshlrev_b32 v236, 16, v116
    v_and_b32 v237, 0xffff0000, v116
    v_pk_fma_f32 v[236:237], v[236:237], v[220:221], v[228:229]
    v_cvt_pk_bf16_f32 v116, v236, v237
    buffer_load_dwordx4 v[188:191], v5, s[32:35], s26 offen offset:0
    v_lshlrev_b32 v238, 16, v117
    v_and_b32 v239, 0xffff0000, v117
    v_pk_fma_f32 v[238:239], v[238:239], v[222:223], v[230:231]
    v_cvt_pk_bf16_f32 v117, v238, v239
    v_lshlrev_b32 v240, 16, v118
    v_and_b32 v241, 0xffff0000, v118
    v_pk_fma_f32 v[240:241], v[240:241], v[224:225], v[232:233]
    v_cvt_pk_bf16_f32 v118, v240, v241
    buffer_load_dwordx4 v[192:195], v5, s[32:35], s26 offen offset:1024
    v_lshlrev_b32 v242, 16, v119
    v_and_b32 v243, 0xffff0000, v119
    v_pk_fma_f32 v[242:243], v[242:243], v[226:227], v[234:235]
    v_cvt_pk_bf16_f32 v119, v242, v243
    v_lshlrev_b32 v236, 16, v120
    v_and_b32 v237, 0xffff0000, v120
    v_pk_fma_f32 v[236:237], v[236:237], v[220:221], v[228:229]
    v_cvt_pk_bf16_f32 v120, v236, v237
    buffer_load_dwordx4 v[196:199], v5, s[32:35], s26 offen offset:2048
    v_lshlrev_b32 v238, 16, v121
    v_and_b32 v239, 0xffff0000, v121
    v_pk_fma_f32 v[238:239], v[238:239], v[222:223], v[230:231]
    v_cvt_pk_bf16_f32 v121, v238, v239
    v_lshlrev_b32 v240, 16, v122
    v_and_b32 v241, 0xffff0000, v122
    v_pk_fma_f32 v[240:241], v[240:241], v[224:225], v[232:233]
    v_cvt_pk_bf16_f32 v122, v240, v241
    buffer_load_dwordx4 v[200:203], v5, s[32:35], s26 offen offset:3072
    s_add_u32 s26, s26, 327680
    v_lshlrev_b32 v242, 16, v123
    v_and_b32 v243, 0xffff0000, v123
    v_pk_fma_f32 v[242:243], v[242:243], v[226:227], v[234:235]
    v_cvt_pk_bf16_f32 v123, v242, v243
    v_lshlrev_b32 v236, 16, v124
    v_and_b32 v237, 0xffff0000, v124
    v_pk_fma_f32 v[236:237], v[236:237], v[220:221], v[228:229]
    v_cvt_pk_bf16_f32 v124, v236, v237
    buffer_load_dwordx4 v[168:171], v5, s[36:39], s27 offen offset:0
    v_lshlrev_b32 v238, 16, v125
    v_and_b32 v239, 0xffff0000, v125
    v_pk_fma_f32 v[238:239], v[238:239], v[222:223], v[230:231]
    v_cvt_pk_bf16_f32 v125, v238, v239
    v_lshlrev_b32 v240, 16, v126
    v_and_b32 v241, 0xffff0000, v126
    v_pk_fma_f32 v[240:241], v[240:241], v[224:225], v[232:233]
    v_cvt_pk_bf16_f32 v126, v240, v241
    buffer_load_dwordx4 v[172:175], v5, s[36:39], s27 offen offset:1024
    v_lshlrev_b32 v242, 16, v127
    v_and_b32 v243, 0xffff0000, v127
    v_pk_fma_f32 v[242:243], v[242:243], v[226:227], v[234:235]
    v_cvt_pk_bf16_f32 v127, v242, v243
    v_lshlrev_b32 v236, 16, v128
    v_and_b32 v237, 0xffff0000, v128
    v_pk_fma_f32 v[236:237], v[236:237], v[220:221], v[228:229]
    v_cvt_pk_bf16_f32 v128, v236, v237
    buffer_load_dwordx4 v[176:179], v5, s[36:39], s27 offen offset:2048
    v_lshlrev_b32 v238, 16, v129
    v_and_b32 v239, 0xffff0000, v129
    v_pk_fma_f32 v[238:239], v[238:239], v[222:223], v[230:231]
    v_cvt_pk_bf16_f32 v129, v238, v239
    v_lshlrev_b32 v240, 16, v130
    v_and_b32 v241, 0xffff0000, v130
    v_pk_fma_f32 v[240:241], v[240:241], v[224:225], v[232:233]
    v_cvt_pk_bf16_f32 v130, v240, v241
    buffer_load_dwordx4 v[180:183], v5, s[36:39], s27 offen offset:3072
    v_lshlrev_b32 v242, 16, v131
    v_and_b32 v243, 0xffff0000, v131
    v_pk_fma_f32 v[242:243], v[242:243], v[226:227], v[234:235]
    v_cvt_pk_bf16_f32 v131, v242, v243
    buffer_load_dwordx4 v[184:187], v6, s[36:39], s27 offen
    s_add_u32 s27, s27, 901120
    s_waitcnt vmcnt(18)
    v_mfma_f32_16x16x32_bf16 v[16:19], v[96:99], v[116:119], v[16:19]
    v_mfma_f32_16x16x32_bf16 v[20:23], v[96:99], v[120:123], v[20:23]
    v_mfma_f32_16x16x32_bf16 v[24:27], v[96:99], v[124:127], v[24:27]
    v_mfma_f32_16x16x32_bf16 v[28:31], v[96:99], v[128:131], v[28:31]
    v_mfma_f32_16x16x32_bf16 v[32:35], v[100:103], v[116:119], v[32:35]
    v_mfma_f32_16x16x32_bf16 v[36:39], v[100:103], v[120:123], v[36:39]
    v_mfma_f32_16x16x32_bf16 v[40:43], v[100:103], v[124:127], v[40:43]
    v_mfma_f32_16x16x32_bf16 v[44:47], v[100:103], v[128:131], v[44:47]
    v_mfma_f32_16x16x32_bf16 v[48:51], v[104:107], v[116:119], v[48:51]
    v_mfma_f32_16x16x32_bf16 v[52:55], v[104:107], v[120:123], v[52:55]
    v_mfma_f32_16x16x32_bf16 v[56:59], v[104:107], v[124:127], v[56:59]
    v_mfma_f32_16x16x32_bf16 v[60:63], v[104:107], v[128:131], v[60:63]
    v_mfma_f32_16x16x32_bf16 v[64:67], v[108:111], v[116:119], v[64:67]
    v_mfma_f32_16x16x32_bf16 v[68:71], v[108:111], v[120:123], v[68:71]
    v_mfma_f32_16x16x32_bf16 v[72:75], v[108:111], v[124:127], v[72:75]
    v_mfma_f32_16x16x32_bf16 v[76:79], v[108:111], v[128:131], v[76:79]
    v_mfma_f32_16x16x32_bf16 v[80:83], v[112:115], v[116:119], v[80:83]
    v_mfma_f32_16x16x32_bf16 v[84:87], v[112:115], v[120:123], v[84:87]
    v_mfma_f32_16x16x32_bf16 v[88:91], v[112:115], v[124:127], v[88:91]
    v_mfma_f32_16x16x32_bf16 v[92:95], v[112:115], v[128:131], v[92:95]
    s_setprio 1
    s_waitcnt vmcnt(14)
    s_waitcnt lgkmcnt(0)
    ds_read_b128 v[220:223], v9 offset:640
    ds_read_b128 v[224:227], v9 offset:704
    ds_read_b128 v[228:231], v9 offset:1664
    ds_read_b128 v[232:235], v9 offset:1728
    v_lshlrev_b32 v236, 16, v152
    v_and_b32 v237, 0xffff0000, v152
    v_pk_fma_f32 v[236:237], v[236:237], v[204:205], v[212:213]
    v_cvt_pk_bf16_f32 v152, v236, v237
    buffer_load_dwordx4 v[116:119], v5, s[32:35], s26 offen offset:0
    v_lshlrev_b32 v238, 16, v153
    v_and_b32 v239, 0xffff0000, v153
    v_pk_fma_f32 v[238:239], v[238:239], v[206:207], v[214:215]
    v_cvt_pk_bf16_f32 v153, v238, v239
    v_lshlrev_b32 v240, 16, v154
    v_and_b32 v241, 0xffff0000, v154
    v_pk_fma_f32 v[240:241], v[240:241], v[208:209], v[216:217]
    v_cvt_pk_bf16_f32 v154, v240, v241
    buffer_load_dwordx4 v[120:123], v5, s[32:35], s26 offen offset:1024
    v_lshlrev_b32 v242, 16, v155
    v_and_b32 v243, 0xffff0000, v155
    v_pk_fma_f32 v[242:243], v[242:243], v[210:211], v[218:219]
    v_cvt_pk_bf16_f32 v155, v242, v243
    v_lshlrev_b32 v236, 16, v156
    v_and_b32 v237, 0xffff0000, v156
    v_pk_fma_f32 v[236:237], v[236:237], v[204:205], v[212:213]
    v_cvt_pk_bf16_f32 v156, v236, v237
    buffer_load_dwordx4 v[124:127], v5, s[32:35], s26 offen offset:2048
    v_lshlrev_b32 v238, 16, v157
    v_and_b32 v239, 0xffff0000, v157
    v_pk_fma_f32 v[238:239], v[238:239], v[206:207], v[214:215]
    v_cvt_pk_bf16_f32 v157, v238, v239
    v_lshlrev_b32 v240, 16, v158
    v_and_b32 v241, 0xffff0000, v158
    v_pk_fma_f32 v[240:241], v[240:241], v[208:209], v[216:217]
    v_cvt_pk_bf16_f32 v158, v240, v241
    buffer_load_dwordx4 v[128:131], v5, s[32:35], s26 offen offset:3072
    s_add_u32 s26, s26, 327680
    v_lshlrev_b32 v242, 16, v159
    v_and_b32 v243, 0xffff0000, v159
    v_pk_fma_f32 v[242:243], v[242:243], v[210:211], v[218:219]
    v_cvt_pk_bf16_f32 v159, v242, v243
    v_lshlrev_b32 v236, 16, v160
    v_and_b32 v237, 0xffff0000, v160
    v_pk_fma_f32 v[236:237], v[236:237], v[204:205], v[212:213]
    v_cvt_pk_bf16_f32 v160, v236, v237
    buffer_load_dwordx4 v[96:99], v5, s[36:39], s27 offen offset:0
    v_lshlrev_b32 v238, 16, v161
    v_and_b32 v239, 0xffff0000, v161
    v_pk_fma_f32 v[238:239], v[238:239], v[206:207], v[214:215]
    v_cvt_pk_bf16_f32 v161, v238, v239
    v_lshlrev_b32 v240, 16, v162
    v_and_b32 v241, 0xffff0000, v162
    v_pk_fma_f32 v[240:241], v[240:241], v[208:209], v[216:217]
    v_cvt_pk_bf16_f32 v162, v240, v241
    buffer_load_dwordx4 v[100:103], v5, s[36:39], s27 offen offset:1024
    v_lshlrev_b32 v242, 16, v163
    v_and_b32 v243, 0xffff0000, v163
    v_pk_fma_f32 v[242:243], v[242:243], v[210:211], v[218:219]
    v_cvt_pk_bf16_f32 v163, v242, v243
    v_lshlrev_b32 v236, 16, v164
    v_and_b32 v237, 0xffff0000, v164
    v_pk_fma_f32 v[236:237], v[236:237], v[204:205], v[212:213]
    v_cvt_pk_bf16_f32 v164, v236, v237
    buffer_load_dwordx4 v[104:107], v5, s[36:39], s27 offen offset:2048
    v_lshlrev_b32 v238, 16, v165
    v_and_b32 v239, 0xffff0000, v165
    v_pk_fma_f32 v[238:239], v[238:239], v[206:207], v[214:215]
    v_cvt_pk_bf16_f32 v165, v238, v239
    v_lshlrev_b32 v240, 16, v166
    v_and_b32 v241, 0xffff0000, v166
    v_pk_fma_f32 v[240:241], v[240:241], v[208:209], v[216:217]
    v_cvt_pk_bf16_f32 v166, v240, v241
    buffer_load_dwordx4 v[108:111], v5, s[36:39], s27 offen offset:3072
    v_lshlrev_b32 v242, 16, v167
    v_and_b32 v243, 0xffff0000, v167
    v_pk_fma_f32 v[242:243], v[242:243], v[210:211], v[218:219]
    v_cvt_pk_bf16_f32 v167, v242, v243
    buffer_load_dwordx4 v[112:115], v6, s[36:39], s27 offen
    s_add_u32 s27, s27, 901120
    s_waitcnt vmcnt(18)
    v_mfma_f32_16x16x32_bf16 v[16:19], v[132:135], v[152:155], v[16:19]
    v_mfma_f32_16x16x32_bf16 v[20:23], v[132:135], v[156:159], v[20:23]
    v_mfma_f32_16x16x32_bf16 v[24:27], v[132:135], v[160:163], v[24:27]
    v_mfma_f32_16x16x32_bf16 v[28:31], v[132:135], v[164:167], v[28:31]
    v_mfma_f32_16x16x32_bf16 v[32:35], v[136:139], v[152:155], v[32:35]
    v_mfma_f32_16x16x32_bf16 v[36:39], v[136:139], v[156:159], v[36:39]
    v_mfma_f32_16x16x32_bf16 v[40:43], v[136:139], v[160:163], v[40:43]
    v_mfma_f32_16x16x32_bf16 v[44:47], v[136:139], v[164:167], v[44:47]
    v_mfma_f32_16x16x32_bf16 v[48:51], v[140:143], v[152:155], v[48:51]
    v_mfma_f32_16x16x32_bf16 v[52:55], v[140:143], v[156:159], v[52:55]
    v_mfma_f32_16x16x32_bf16 v[56:59], v[140:143], v[160:163], v[56:59]
    v_mfma_f32_16x16x32_bf16 v[60:63], v[140:143], v[164:167], v[60:63]
    v_mfma_f32_16x16x32_bf16 v[64:67], v[144:147], v[152:155], v[64:67]
    v_mfma_f32_16x16x32_bf16 v[68:71], v[144:147], v[156:159], v[68:71]
    v_mfma_f32_16x16x32_bf16 v[72:75], v[144:147], v[160:163], v[72:75]
    v_mfma_f32_16x16x32_bf16 v[76:79], v[144:147], v[164:167], v[76:79]
    v_mfma_f32_16x16x32_bf16 v[80:83], v[148:151], v[152:155], v[80:83]
    v_mfma_f32_16x16x32_bf16 v[84:87], v[148:151], v[156:159], v[84:87]
    v_mfma_f32_16x16x32_bf16 v[88:91], v[148:151], v[160:163], v[88:91]
    v_mfma_f32_16x16x32_bf16 v[92:95], v[148:151], v[164:167], v[92:95]
    s_waitcnt vmcnt(14)
    s_waitcnt lgkmcnt(0)
    ds_read_b128 v[204:207], v9 offset:768
    ds_read_b128 v[208:211], v9 offset:832
    ds_read_b128 v[212:215], v9 offset:1792
    ds_read_b128 v[216:219], v9 offset:1856
    v_lshlrev_b32 v236, 16, v188
    v_and_b32 v237, 0xffff0000, v188
    v_pk_fma_f32 v[236:237], v[236:237], v[220:221], v[228:229]
    v_cvt_pk_bf16_f32 v188, v236, v237
    buffer_load_dwordx4 v[152:155], v5, s[32:35], s26 offen offset:0
    v_lshlrev_b32 v238, 16, v189
    v_and_b32 v239, 0xffff0000, v189
    v_pk_fma_f32 v[238:239], v[238:239], v[222:223], v[230:231]
    v_cvt_pk_bf16_f32 v189, v238, v239
    v_lshlrev_b32 v240, 16, v190
    v_and_b32 v241, 0xffff0000, v190
    v_pk_fma_f32 v[240:241], v[240:241], v[224:225], v[232:233]
    v_cvt_pk_bf16_f32 v190, v240, v241
    buffer_load_dwordx4 v[156:159], v5, s[32:35], s26 offen offset:1024
    v_lshlrev_b32 v242, 16, v191
    v_and_b32 v243, 0xffff0000, v191
    v_pk_fma_f32 v[242:243], v[242:243], v[226:227], v[234:235]
    v_cvt_pk_bf16_f32 v191, v242, v243
    v_lshlrev_b32 v236, 16, v192
    v_and_b32 v237, 0xffff0000, v192
    v_pk_fma_f32 v[236:237], v[236:237], v[220:221], v[228:229]
    v_cvt_pk_bf16_f32 v192, v236, v237
    buffer_load_dwordx4 v[160:163], v5, s[32:35], s26 offen offset:2048
    v_lshlrev_b32 v238, 16, v193
    v_and_b32 v239, 0xffff0000, v193
    v_pk_fma_f32 v[238:239], v[238:239], v[222:223], v[230:231]
    v_cvt_pk_bf16_f32 v193, v238, v239
    v_lshlrev_b32 v240, 16, v194
    v_and_b32 v241, 0xffff0000, v194
    v_pk_fma_f32 v[240:241], v[240:241], v[224:225], v[232:233]
    v_cvt_pk_bf16_f32 v194, v240, v241
    buffer_load_dwordx4 v[164:167], v5, s[32:35], s26 offen offset:3072
    s_add_u32 s26, s26, 327680
    v_lshlrev_b32 v242, 16, v195
    v_and_b32 v243, 0xffff0000, v195
    v_pk_fma_f32 v[242:243], v[242:243], v[226:227], v[234:235]
    v_cvt_pk_bf16_f32 v195, v242, v243
    v_lshlrev_b32 v236, 16, v196
    v_and_b32 v237, 0xffff0000, v196
    v_pk_fma_f32 v[236:237], v[236:237], v[220:221], v[228:229]
    v_cvt_pk_bf16_f32 v196, v236, v237
    buffer_load_dwordx4 v[132:135], v5, s[36:39], s27 offen offset:0
    v_lshlrev_b32 v238, 16, v197
    v_and_b32 v239, 0xffff0000, v197
    v_pk_fma_f32 v[238:239], v[238:239], v[222:223], v[230:231]
    v_cvt_pk_bf16_f32 v197, v238, v239
    v_lshlrev_b32 v240, 16, v198
    v_and_b32 v241, 0xffff0000, v198
    v_pk_fma_f32 v[240:241], v[240:241], v[224:225], v[232:233]
    v_cvt_pk_bf16_f32 v198, v240, v241
    buffer_load_dwordx4 v[136:139], v5, s[36:39], s27 offen offset:1024
    v_lshlrev_b32 v242, 16, v199
    v_and_b32 v243, 0xffff0000, v199
    v_pk_fma_f32 v[242:243], v[242:243], v[226:227], v[234:235]
    v_cvt_pk_bf16_f32 v199, v242, v243
    v_lshlrev_b32 v236, 16, v200
    v_and_b32 v237, 0xffff0000, v200
    v_pk_fma_f32 v[236:237], v[236:237], v[220:221], v[228:229]
    v_cvt_pk_bf16_f32 v200, v236, v237
    buffer_load_dwordx4 v[140:143], v5, s[36:39], s27 offen offset:2048
    v_lshlrev_b32 v238, 16, v201
    v_and_b32 v239, 0xffff0000, v201
    v_pk_fma_f32 v[238:239], v[238:239], v[222:223], v[230:231]
    v_cvt_pk_bf16_f32 v201, v238, v239
    v_lshlrev_b32 v240, 16, v202
    v_and_b32 v241, 0xffff0000, v202
    v_pk_fma_f32 v[240:241], v[240:241], v[224:225], v[232:233]
    v_cvt_pk_bf16_f32 v202, v240, v241
    buffer_load_dwordx4 v[144:147], v5, s[36:39], s27 offen offset:3072
    v_lshlrev_b32 v242, 16, v203
    v_and_b32 v243, 0xffff0000, v203
    v_pk_fma_f32 v[242:243], v[242:243], v[226:227], v[234:235]
    v_cvt_pk_bf16_f32 v203, v242, v243
    buffer_load_dwordx4 v[148:151], v6, s[36:39], s27 offen
    s_add_u32 s27, s27, 901120
    s_waitcnt vmcnt(18)
    v_mfma_f32_16x16x32_bf16 v[16:19], v[168:171], v[188:191], v[16:19]
    v_mfma_f32_16x16x32_bf16 v[20:23], v[168:171], v[192:195], v[20:23]
    v_mfma_f32_16x16x32_bf16 v[24:27], v[168:171], v[196:199], v[24:27]
    v_mfma_f32_16x16x32_bf16 v[28:31], v[168:171], v[200:203], v[28:31]
    v_mfma_f32_16x16x32_bf16 v[32:35], v[172:175], v[188:191], v[32:35]
    v_mfma_f32_16x16x32_bf16 v[36:39], v[172:175], v[192:195], v[36:39]
    v_mfma_f32_16x16x32_bf16 v[40:43], v[172:175], v[196:199], v[40:43]
    v_mfma_f32_16x16x32_bf16 v[44:47], v[172:175], v[200:203], v[44:47]
    v_mfma_f32_16x16x32_bf16 v[48:51], v[176:179], v[188:191], v[48:51]
    v_mfma_f32_16x16x32_bf16 v[52:55], v[176:179], v[192:195], v[52:55]
    v_mfma_f32_16x16x32_bf16 v[56:59], v[176:179], v[196:199], v[56:59]
    v_mfma_f32_16x16x32_bf16 v[60:63], v[176:179], v[200:203], v[60:63]
    v_mfma_f32_16x16x32_bf16 v[64:67], v[180:183], v[188:191], v[64:67]
    v_mfma_f32_16x16x32_bf16 v[68:71], v[180:183], v[192:195], v[68:71]
    v_mfma_f32_16x16x32_bf16 v[72:75], v[180:183], v[196:199], v[72:75]
    v_mfma_f32_16x16x32_bf16 v[76:79], v[180:183], v[200:203], v[76:79]
    v_mfma_f32_16x16x32_bf16 v[80:83], v[184:187], v[188:191], v[80:83]
    v_mfma_f32_16x16x32_bf16 v[84:87], v[184:187], v[192:195], v[84:87]
    v_mfma_f32_16x16x32_bf16 v[88:91], v[184:187], v[196:199], v[88:91]
    v_mfma_f32_16x16x32_bf16 v[92:95], v[184:187], v[200:203], v[92:95]
    s_setprio 0
    s_waitcnt vmcnt(14)
    s_waitcnt lgkmcnt(0)
    ds_read_b128 v[220:223], v9 offset:896
    ds_read_b128 v[224:227], v9 offset:960
    ds_read_b128 v[228:231], v9 offset:1920
    ds_read_b128 v[232:235], v9 offset:1984
    v_lshlrev_b32 v236, 16, v116
    v_and_b32 v237, 0xffff0000, v116
    v_pk_fma_f32 v[236:237], v[236:237], v[204:205], v[212:213]
    v_cvt_pk_bf16_f32 v116, v236, v237
    v_lshlrev_b32 v238, 16, v117
    v_and_b32 v239, 0xffff0000, v117
    v_pk_fma_f32 v[238:239], v[238:239], v[206:207], v[214:215]
    v_cvt_pk_bf16_f32 v117, v238, v239
    v_lshlrev_b32 v240, 16, v118
    v_and_b32 v241, 0xffff0000, v118
    v_pk_fma_f32 v[240:241], v[240:241], v[208:209], v[216:217]
    v_cvt_pk_bf16_f32 v118, v240, v241
    v_lshlrev_b32 v242, 16, v119
    v_and_b32 v243, 0xffff0000, v119
    v_pk_fma_f32 v[242:243], v[242:243], v[210:211], v[218:219]
    v_cvt_pk_bf16_f32 v119, v242, v243
    v_lshlrev_b32 v236, 16, v120
    v_and_b32 v237, 0xffff0000, v120
    v_pk_fma_f32 v[236:237], v[236:237], v[204:205], v[212:213]
    v_cvt_pk_bf16_f32 v120, v236, v237
    v_lshlrev_b32 v238, 16, v121
    v_and_b32 v239, 0xffff0000, v121
    v_pk_fma_f32 v[238:239], v[238:239], v[206:207], v[214:215]
    v_cvt_pk_bf16_f32 v121, v238, v239
    v_lshlrev_b32 v240, 16, v122
    v_and_b32 v241, 0xffff0000, v122
    v_pk_fma_f32 v[240:241], v[240:241], v[208:209], v[216:217]
    v_cvt_pk_bf16_f32 v122, v240, v241
    v_lshlrev_b32 v242, 16, v123
    v_and_b32 v243, 0xffff0000, v123
    v_pk_fma_f32 v[242:243], v[242:243], v[210:211], v[218:219]
    v_cvt_pk_bf16_f32 v123, v242, v243
    v_lshlrev_b32 v236, 16, v124
    v_and_b32 v237, 0xffff0000, v124
    v_pk_fma_f32 v[236:237], v[236:237], v[204:205], v[212:213]
    v_cvt_pk_bf16_f32 v124, v236, v237
    v_lshlrev_b32 v238, 16, v125
    v_and_b32 v239, 0xffff0000, v125
    v_pk_fma_f32 v[238:239], v[238:239], v[206:207], v[214:215]
    v_cvt_pk_bf16_f32 v125, v238, v239
    v_lshlrev_b32 v240, 16, v126
    v_and_b32 v241, 0xffff0000, v126
    v_pk_fma_f32 v[240:241], v[240:241], v[208:209], v[216:217]
    v_cvt_pk_bf16_f32 v126, v240, v241
    v_lshlrev_b32 v242, 16, v127
    v_and_b32 v243, 0xffff0000, v127
    v_pk_fma_f32 v[242:243], v[242:243], v[210:211], v[218:219]
    v_cvt_pk_bf16_f32 v127, v242, v243
    v_lshlrev_b32 v236, 16, v128
    v_and_b32 v237, 0xffff0000, v128
    v_pk_fma_f32 v[236:237], v[236:237], v[204:205], v[212:213]
    v_cvt_pk_bf16_f32 v128, v236, v237
    v_lshlrev_b32 v238, 16, v129
    v_and_b32 v239, 0xffff0000, v129
    v_pk_fma_f32 v[238:239], v[238:239], v[206:207], v[214:215]
    v_cvt_pk_bf16_f32 v129, v238, v239
    v_lshlrev_b32 v240, 16, v130
    v_and_b32 v241, 0xffff0000, v130
    v_pk_fma_f32 v[240:241], v[240:241], v[208:209], v[216:217]
    v_cvt_pk_bf16_f32 v130, v240, v241
    v_lshlrev_b32 v242, 16, v131
    v_and_b32 v243, 0xffff0000, v131
    v_pk_fma_f32 v[242:243], v[242:243], v[210:211], v[218:219]
    v_cvt_pk_bf16_f32 v131, v242, v243
    s_waitcnt vmcnt(9)
    v_mfma_f32_16x16x32_bf16 v[16:19], v[96:99], v[116:119], v[16:19]
    v_mfma_f32_16x16x32_bf16 v[20:23], v[96:99], v[120:123], v[20:23]
    v_mfma_f32_16x16x32_bf16 v[24:27], v[96:99], v[124:127], v[24:27]
    v_mfma_f32_16x16x32_bf16 v[28:31], v[96:99], v[128:131], v[28:31]
    v_mfma_f32_16x16x32_bf16 v[32:35], v[100:103], v[116:119], v[32:35]
    v_mfma_f32_16x16x32_bf16 v[36:39], v[100:103], v[120:123], v[36:39]
    v_mfma_f32_16x16x32_bf16 v[40:43], v[100:103], v[124:127], v[40:43]
    v_mfma_f32_16x16x32_bf16 v[44:47], v[100:103], v[128:131], v[44:47]
    v_mfma_f32_16x16x32_bf16 v[48:51], v[104:107], v[116:119], v[48:51]
    v_mfma_f32_16x16x32_bf16 v[52:55], v[104:107], v[120:123], v[52:55]
    v_mfma_f32_16x16x32_bf16 v[56:59], v[104:107], v[124:127], v[56:59]
    v_mfma_f32_16x16x32_bf16 v[60:63], v[104:107], v[128:131], v[60:63]
    v_mfma_f32_16x16x32_bf16 v[64:67], v[108:111], v[116:119], v[64:67]
    v_mfma_f32_16x16x32_bf16 v[68:71], v[108:111], v[120:123], v[68:71]
    v_mfma_f32_16x16x32_bf16 v[72:75], v[108:111], v[124:127], v[72:75]
    v_mfma_f32_16x16x32_bf16 v[76:79], v[108:111], v[128:131], v[76:79]
    v_mfma_f32_16x16x32_bf16 v[80:83], v[112:115], v[116:119], v[80:83]
    v_mfma_f32_16x16x32_bf16 v[84:87], v[112:115], v[120:123], v[84:87]
    v_mfma_f32_16x16x32_bf16 v[88:91], v[112:115], v[124:127], v[88:91]
    v_mfma_f32_16x16x32_bf16 v[92:95], v[112:115], v[128:131], v[92:95]
    s_waitcnt vmcnt(5)
    s_waitcnt lgkmcnt(0)
    v_lshlrev_b32 v236, 16, v152
    v_and_b32 v237, 0xffff0000, v152
    v_pk_fma_f32 v[236:237], v[236:237], v[220:221], v[228:229]
    v_cvt_pk_bf16_f32 v152, v236, v237
    v_lshlrev_b32 v238, 16, v153
    v_and_b32 v239, 0xffff0000, v153
    v_pk_fma_f32 v[238:239], v[238:239], v[222:223], v[230:231]
    v_cvt_pk_bf16_f32 v153, v238, v239
    v_lshlrev_b32 v240, 16, v154
    v_and_b32 v241, 0xffff0000, v154
    v_pk_fma_f32 v[240:241], v[240:241], v[224:225], v[232:233]
    v_cvt_pk_bf16_f32 v154, v240, v241
    v_lshlrev_b32 v242, 16, v155
    v_and_b32 v243, 0xffff0000, v155
    v_pk_fma_f32 v[242:243], v[242:243], v[226:227], v[234:235]
    v_cvt_pk_bf16_f32 v155, v242, v243
    v_lshlrev_b32 v236, 16, v156
    v_and_b32 v237, 0xffff0000, v156
    v_pk_fma_f32 v[236:237], v[236:237], v[220:221], v[228:229]
    v_cvt_pk_bf16_f32 v156, v236, v237
    v_lshlrev_b32 v238, 16, v157
    v_and_b32 v239, 0xffff0000, v157
    v_pk_fma_f32 v[238:239], v[238:239], v[222:223], v[230:231]
    v_cvt_pk_bf16_f32 v157, v238, v239
    v_lshlrev_b32 v240, 16, v158
    v_and_b32 v241, 0xffff0000, v158
    v_pk_fma_f32 v[240:241], v[240:241], v[224:225], v[232:233]
    v_cvt_pk_bf16_f32 v158, v240, v241
    v_lshlrev_b32 v242, 16, v159
    v_and_b32 v243, 0xffff0000, v159
    v_pk_fma_f32 v[242:243], v[242:243], v[226:227], v[234:235]
    v_cvt_pk_bf16_f32 v159, v242, v243
    v_lshlrev_b32 v236, 16, v160
    v_and_b32 v237, 0xffff0000, v160
    v_pk_fma_f32 v[236:237], v[236:237], v[220:221], v[228:229]
    v_cvt_pk_bf16_f32 v160, v236, v237
    v_lshlrev_b32 v238, 16, v161
    v_and_b32 v239, 0xffff0000, v161
    v_pk_fma_f32 v[238:239], v[238:239], v[222:223], v[230:231]
    v_cvt_pk_bf16_f32 v161, v238, v239
    v_lshlrev_b32 v240, 16, v162
    v_and_b32 v241, 0xffff0000, v162
    v_pk_fma_f32 v[240:241], v[240:241], v[224:225], v[232:233]
    v_cvt_pk_bf16_f32 v162, v240, v241
    v_lshlrev_b32 v242, 16, v163
    v_and_b32 v243, 0xffff0000, v163
    v_pk_fma_f32 v[242:243], v[242:243], v[226:227], v[234:235]
    v_cvt_pk_bf16_f32 v163, v242, v243
    v_lshlrev_b32 v236, 16, v164
    v_and_b32 v237, 0xffff0000, v164
    v_pk_fma_f32 v[236:237], v[236:237], v[220:221], v[228:229]
    v_cvt_pk_bf16_f32 v164, v236, v237
    v_lshlrev_b32 v238, 16, v165
    v_and_b32 v239, 0xffff0000, v165
    v_pk_fma_f32 v[238:239], v[238:239], v[222:223], v[230:231]
    v_cvt_pk_bf16_f32 v165, v238, v239
    v_lshlrev_b32 v240, 16, v166
    v_and_b32 v241, 0xffff0000, v166
    v_pk_fma_f32 v[240:241], v[240:241], v[224:225], v[232:233]
    v_cvt_pk_bf16_f32 v166, v240, v241
    v_lshlrev_b32 v242, 16, v167
    v_and_b32 v243, 0xffff0000, v167
    v_pk_fma_f32 v[242:243], v[242:243], v[226:227], v[234:235]
    v_cvt_pk_bf16_f32 v167, v242, v243
    s_waitcnt vmcnt(0)
    v_mfma_f32_16x16x32_bf16 v[16:19], v[132:135], v[152:155], v[16:19]
    v_mfma_f32_16x16x32_bf16 v[20:23], v[132:135], v[156:159], v[20:23]
    v_mfma_f32_16x16x32_bf16 v[24:27], v[132:135], v[160:163], v[24:27]
    v_mfma_f32_16x16x32_bf16 v[28:31], v[132:135], v[164:167], v[28:31]
    v_mfma_f32_16x16x32_bf16 v[32:35], v[136:139], v[152:155], v[32:35]
    v_mfma_f32_16x16x32_bf16 v[36:39], v[136:139], v[156:159], v[36:39]
    v_mfma_f32_16x16x32_bf16 v[40:43], v[136:139], v[160:163], v[40:43]
    v_mfma_f32_16x16x32_bf16 v[44:47], v[136:139], v[164:167], v[44:47]
    v_mfma_f32_16x16x32_bf16 v[48:51], v[140:143], v[152:155], v[48:51]
    v_mfma_f32_16x16x32_bf16 v[52:55], v[140:143], v[156:159], v[52:55]
    v_mfma_f32_16x16x32_bf16 v[56:59], v[140:143], v[160:163], v[56:59]
    v_mfma_f32_16x16x32_bf16 v[60:63], v[140:143], v[164:167], v[60:63]
    v_mfma_f32_16x16x32_bf16 v[64:67], v[144:147], v[152:155], v[64:67]
    v_mfma_f32_16x16x32_bf16 v[68:71], v[144:147], v[156:159], v[68:71]
    v_mfma_f32_16x16x32_bf16 v[72:75], v[144:147], v[160:163], v[72:75]
    v_mfma_f32_16x16x32_bf16 v[76:79], v[144:147], v[164:167], v[76:79]
    v_mfma_f32_16x16x32_bf16 v[80:83], v[148:151], v[152:155], v[80:83]
    v_mfma_f32_16x16x32_bf16 v[84:87], v[148:151], v[156:159], v[84:87]
    v_mfma_f32_16x16x32_bf16 v[88:91], v[148:151], v[160:163], v[88:91]
    v_mfma_f32_16x16x32_bf16 v[92:95], v[148:151], v[164:167], v[92:95]
    s_lshr_b32 s30, s3, 2
    s_mul_i32 s30, s30, 3
    s_mul_i32 s29, s17, 160
    s_lshl_b32 s31, s30, 5
    s_add_u32 s29, s29, s31
    v_lshlrev_b32 v13, 3, v2
    buffer_load_dwordx2 v[96:97], v13, s[40:43], s29 offen offset:0
    buffer_load_dwordx2 v[98:99], v13, s[40:43], s29 offen offset:32
    buffer_load_dwordx2 v[100:101], v13, s[40:43], s29 offen offset:64
    s_mul_i32 s28, s3, 20480
    v_add_u32 v14, s28, v5
    s_nop 7
    ds_write_b128 v14, v[16:19] offset:0
    ds_write_b128 v14, v[32:35] offset:1024
    ds_write_b128 v14, v[48:51] offset:2048
    ds_write_b128 v14, v[64:67] offset:3072
    ds_write_b128 v14, v[80:83] offset:4096
    ds_write_b128 v14, v[20:23] offset:5120
    ds_write_b128 v14, v[36:39] offset:6144
    ds_write_b128 v14, v[52:55] offset:7168
    ds_write_b128 v14, v[68:71] offset:8192
    ds_write_b128 v14, v[84:87] offset:9216
    ds_write_b128 v14, v[24:27] offset:10240
    ds_write_b128 v14, v[40:43] offset:11264
    ds_write_b128 v14, v[56:59] offset:12288
    ds_write_b128 v14, v[72:75] offset:13312
    ds_write_b128 v14, v[88:91] offset:14336
    ds_write_b128 v14, v[28:31] offset:15360
    ds_write_b128 v14, v[44:47] offset:16384
    ds_write_b128 v14, v[60:63] offset:17408
    ds_write_b128 v14, v[76:79] offset:18432
    ds_write_b128 v14, v[92:95] offset:19456
    s_and_b32 s28, s3, 3
    s_mul_i32 s28, s28, 5120
    s_lshr_b32 s29, s3, 2
    s_mul_i32 s29, s29, 3072
    s_add_u32 s28, s28, s29
    v_add_u32 v14, s28, v5
    v_add_u32 v15, 61440, v14
    v_add_u32 v13, 122880, v14
    s_waitcnt lgkmcnt(0)
    s_barrier
    ds_read_b128 v[16:19], v14 offset:0
    ds_read_b128 v[20:23], v14 offset:1024
    ds_read_b128 v[24:27], v14 offset:2048
    ds_read_b128 v[28:31], v14 offset:20480
    ds_read_b128 v[32:35], v14 offset:21504
    ds_read_b128 v[36:39], v14 offset:22528
    ds_read_b128 v[40:43], v14 offset:40960
    ds_read_b128 v[44:47], v14 offset:41984
    ds_read_b128 v[48:51], v14 offset:43008
    ds_read_b128 v[52:55], v15 offset:0
    ds_read_b128 v[56:59], v15 offset:1024
    ds_read_b128 v[60:63], v15 offset:2048
    ds_read_b128 v[64:67], v15 offset:20480
    ds_read_b128 v[68:71], v15 offset:21504
    ds_read_b128 v[72:75], v15 offset:22528
    ds_read_b128 v[76:79], v15 offset:40960
    ds_read_b128 v[80:83], v15 offset:41984
    ds_read_b128 v[84:87], v15 offset:43008
    ds_read_b128 v[88:91], v13 offset:0
    ds_read_b128 v[92:95], v13 offset:1024
    ds_read_b128 v[116:119], v13 offset:2048
    ds_read_b128 v[120:123], v13 offset:20480
    ds_read_b128 v[124:127], v13 offset:21504
    ds_read_b128 v[128:131], v13 offset:22528
    s_waitcnt lgkmcnt(0)
    v_add_f32 v16, v16, v28
    v_add_f32 v40, v40, v52
    v_add_f32 v64, v64, v76
    v_add_f32 v88, v88, v120
    v_add_f32 v16, v16, v40
    v_add_f32 v64, v64, v88
    v_add_f32 v104, v16, v64
    v_add_f32 v17, v17, v29
    v_add_f32 v41, v41, v53
    v_add_f32 v65, v65, v77
    v_add_f32 v89, v89, v121
    v_add_f32 v17, v17, v41
    v_add_f32 v65, v65, v89
    v_add_f32 v105, v17, v65
    v_add_f32 v18, v18, v30
    v_add_f32 v42, v42, v54
    v_add_f32 v66, v66, v78
    v_add_f32 v90, v90, v122
    v_add_f32 v18, v18, v42
    v_add_f32 v66, v66, v90
    v_add_f32 v106, v18, v66
    v_add_f32 v19, v19, v31
    v_add_f32 v43, v43, v55
    v_add_f32 v67, v67, v79
    v_add_f32 v91, v91, v123
    v_add_f32 v19, v19, v43
    v_add_f32 v67, v67, v91
    v_add_f32 v107, v19, v67
    v_add_f32 v20, v20, v32
    v_add_f32 v44, v44, v56
    v_add_f32 v68, v68, v80
    v_add_f32 v92, v92, v124
    v_add_f32 v20, v20, v44
    v_add_f32 v68, v68, v92
    v_add_f32 v108, v20, v68
    v_add_f32 v21, v21, v33
    v_add_f32 v45, v45, v57
    v_add_f32 v69, v69, v81
    v_add_f32 v93, v93, v125
    v_add_f32 v21, v21, v45
    v_add_f32 v69, v69, v93
    v_add_f32 v109, v21, v69
    v_add_f32 v22, v22, v34
    v_add_f32 v46, v46, v58
    v_add_f32 v70, v70, v82
    v_add_f32 v94, v94, v126
    v_add_f32 v22, v22, v46
    v_add_f32 v70, v70, v94
    v_add_f32 v110, v22, v70
    v_add_f32 v23, v23, v35
    v_add_f32 v47, v47, v59
    v_add_f32 v71, v71, v83
    v_add_f32 v95, v95, v127
    v_add_f32 v23, v23, v47
    v_add_f32 v71, v71, v95
    v_add_f32 v111, v23, v71
    v_add_f32 v24, v24, v36
    v_add_f32 v48, v48, v60
    v_add_f32 v72, v72, v84
    v_add_f32 v116, v116, v128
    v_add_f32 v24, v24, v48
    v_add_f32 v72, v72, v116
    v_add_f32 v112, v24, v72
    v_add_f32 v25, v25, v37
    v_add_f32 v49, v49, v61
    v_add_f32 v73, v73, v85
    v_add_f32 v117, v117, v129
    v_add_f32 v25, v25, v49
    v_add_f32 v73, v73, v117
    v_add_f32 v113, v25, v73
    v_add_f32 v26, v26, v38
    v_add_f32 v50, v50, v62
    v_add_f32 v74, v74, v86
    v_add_f32 v118, v118, v130
    v_add_f32 v26, v26, v50
    v_add_f32 v74, v74, v118
    v_add_f32 v114, v26, v74
    v_add_f32 v27, v27, v39
    v_add_f32 v51, v51, v63
    v_add_f32 v75, v75, v87
    v_add_f32 v119, v119, v131
    v_add_f32 v27, v27, v51
    v_add_f32 v75, v75, v119
    v_add_f32 v115, v27, v75
    s_waitcnt vmcnt(0)
    v_mov_b32 v13, 0xc0135761
    v_mov_b32 v14, 0xbdd2d3e8
    v_lshlrev_b32 v16, 16, v96
    v_and_b32 v17, 0xffff0000, v96
    v_lshlrev_b32 v18, 16, v97
    v_and_b32 v19, 0xffff0000, v97
    v_lshlrev_b32 v20, 16, v98
    v_and_b32 v21, 0xffff0000, v98
    v_lshlrev_b32 v22, 16, v99
    v_and_b32 v23, 0xffff0000, v99
    v_lshlrev_b32 v24, 16, v100
    v_and_b32 v25, 0xffff0000, v100
    v_lshlrev_b32 v26, 16, v101
    v_and_b32 v27, 0xffff0000, v101
    v_add_f32 v104, v104, v16
    v_add_f32 v105, v105, v17
    v_add_f32 v106, v106, v18
    v_add_f32 v107, v107, v19
    v_add_f32 v108, v108, v20
    v_add_f32 v109, v109, v21
    v_add_f32 v110, v110, v22
    v_add_f32 v111, v111, v23
    v_add_f32 v112, v112, v24
    v_add_f32 v113, v113, v25
    v_add_f32 v114, v114, v26
    v_add_f32 v115, v115, v27
    v_mul_f32 v16, v104, v104
    v_mul_f32 v17, v105, v105
    v_mul_f32 v18, v106, v106
    v_mul_f32 v19, v107, v107
    v_mul_f32 v20, v108, v108
    v_mul_f32 v21, v109, v109
    v_mul_f32 v22, v110, v110
    v_mul_f32 v23, v111, v111
    v_mul_f32 v24, v112, v112
    v_mul_f32 v25, v113, v113
    v_mul_f32 v26, v114, v114
    v_mul_f32 v27, v115, v115
    v_fma_f32 v16, v16, v14, v13
    v_fma_f32 v17, v17, v14, v13
    v_fma_f32 v18, v18, v14, v13
    v_fma_f32 v19, v19, v14, v13
    v_fma_f32 v20, v20, v14, v13
    v_fma_f32 v21, v21, v14, v13
    v_fma_f32 v22, v22, v14, v13
    v_fma_f32 v23, v23, v14, v13
    v_fma_f32 v24, v24, v14, v13
    v_fma_f32 v25, v25, v14, v13
    v_fma_f32 v26, v26, v14, v13
    v_fma_f32 v27, v27, v14, v13
    v_mul_f32 v16, v16, v104
    v_mul_f32 v17, v17, v105
    v_mul_f32 v18, v18, v106
    v_mul_f32 v19, v19, v107
    v_mul_f32 v20, v20, v108
    v_mul_f32 v21, v21, v109
    v_mul_f32 v22, v22, v110
    v_mul_f32 v23, v23, v111
    v_mul_f32 v24, v24, v112
    v_mul_f32 v25, v25, v113
    v_mul_f32 v26, v26, v114
    v_mul_f32 v27, v27, v115
    v_exp_f32 v16, v16
    v_exp_f32 v17, v17
    v_exp_f32 v18, v18
    v_exp_f32 v19, v19
    v_exp_f32 v20, v20
    v_exp_f32 v21, v21
    v_exp_f32 v22, v22
    v_exp_f32 v23, v23
    v_exp_f32 v24, v24
    v_exp_f32 v25, v25
    v_exp_f32 v26, v26
    v_exp_f32 v27, v27
    v_add_f32 v16, 1.0, v16
    v_add_f32 v17, 1.0, v17
    v_add_f32 v18, 1.0, v18
    v_add_f32 v19, 1.0, v19
    v_add_f32 v20, 1.0, v20
    v_add_f32 v21, 1.0, v21
    v_add_f32 v22, 1.0, v22
    v_add_f32 v23, 1.0, v23
    v_add_f32 v24, 1.0, v24
    v_add_f32 v25, 1.0, v25
    v_add_f32 v26, 1.0, v26
    v_add_f32 v27, 1.0, v27
    v_rcp_f32 v16, v16
    v_rcp_f32 v17, v17
    v_rcp_f32 v18, v18
    v_rcp_f32 v19, v19
    v_rcp_f32 v20, v20
    v_rcp_f32 v21, v21
    v_rcp_f32 v22, v22
    v_rcp_f32 v23, v23
    v_rcp_f32 v24, v24
    v_rcp_f32 v25, v25
    v_rcp_f32 v26, v26
    v_rcp_f32 v27, v27
    v_mul_f32 v104, v104, v16
    v_mul_f32 v105, v105, v17
    v_mul_f32 v106, v106, v18
    v_mul_f32 v107, v107, v19
    v_mul_f32 v108, v108, v20
    v_mul_f32 v109, v109, v21
    v_mul_f32 v110, v110, v22
    v_mul_f32 v111, v111, v23
    v_mul_f32 v112, v112, v24
    v_mul_f32 v113, v113, v25
    v_mul_f32 v114, v114, v26
    v_mul_f32 v115, v115, v27
    v_cvt_pk_bf16_f32 v136, v104, v105
    v_cvt_pk_bf16_f32 v137, v106, v107
    v_cvt_pk_bf16_f32 v138, v108, v109
    v_cvt_pk_bf16_f32 v139, v110, v111
    v_cvt_pk_bf16_f32 v140, v112, v113
    v_cvt_pk_bf16_f32 v141, v114, v115
    s_mul_i32 s24, s17, 5
    s_add_u32 s24, s24, s30
    s_and_b32 s25, s3, 3
    s_lshl_b32 s26, s16, 2
    s_add_u32 s25, s25, s26
    s_lshl_b32 s25, s25, 10
    s_add_u32 s26, s24, 0
    s_lshr_b32 s27, s26, 1
    s_mul_i32 s27, s27, 40960
    s_and_b32 s26, s26, 1
    s_lshl_b32 s26, s26, 3
    s_add_u32 s27, s27, s26
    s_add_u32 s27, s27, s25
    buffer_store_dwordx2 v[136:137], v5, s[48:51], s27 offen
    s_add_u32 s26, s24, 1
    s_lshr_b32 s27, s26, 1
    s_mul_i32 s27, s27, 40960
    s_and_b32 s26, s26, 1
    s_lshl_b32 s26, s26, 3
    s_add_u32 s27, s27, s26
    s_add_u32 s27, s27, s25
    buffer_store_dwordx2 v[138:139], v5, s[48:51], s27 offen
    s_cmp_ge_u32 s3, 4
    s_cbranch_scc1 mlpa1_kernel_sk1
    s_add_u32 s26, s24, 2
    s_lshr_b32 s27, s26, 1
    s_mul_i32 s27, s27, 40960
    s_and_b32 s26, s26, 1
    s_lshl_b32 s26, s26, 3
    s_add_u32 s27, s27, s26
    s_add_u32 s27, s27, s25
    buffer_store_dwordx2 v[140:141], v5, s[48:51], s27 offen
mlpa1_kernel_sk1:
mlpa1_kernel_end:
    s_endpgm

.globl mlpb1_kernel
.p2align 8
.type mlpb1_kernel,@function
mlpb1_kernel:
    s_cmp_ge_u32 s2, 256
    s_cbranch_scc1 mlpb1_kernel_end
    s_load_dwordx2 s[4:5], s[0:1], 96
    s_load_dwordx2 s[10:11], s[0:1], 72
    s_load_dwordx2 s[12:13], s[0:1], 80
    s_bfe_u32 s16, s2, 0x20001
    s_lshl_b32 s16, s16, 3
    s_lshr_b32 s17, s2, 3
    s_and_b32 s18, s17, 7
    s_add_u32 s16, s16, s18
    s_lshr_b32 s17, s17, 3
    s_and_b32 s18, s2, 1
    s_lshl_b32 s18, s18, 2
    s_add_u32 s17, s17, s18
    v_lshrrev_b32 v2, 6, v0
    v_and_b32 v1, 63, v0
    v_readfirstlane_b32 s3, v2
    v_lshrrev_b32 v2, 4, v1
    v_and_b32 v3, 15, v1
    v_lshlrev_b32 v5, 4, v1
    v_add_u32 v6, 4096, v5
    s_lshl_b32 s20, s16, 6
    s_lshl_b32 s21, s3, 4
    s_add_u32 s20, s20, s21
    s_lshr_b32 s21, s20, 4
    s_mul_i32 s21, s21, 20480
    s_mul_i32 s24, s17, 5
    s_lshr_b32 s24, s24, 1
    s_lshl_b32 s24, s24, 10
    s_add_u32 s24, s24, s21
    s_and_b32 s25, s17, 1
    s_waitcnt lgkmcnt(0)
    s_add_u32 s32, s4, 11534336
    s_addc_u32 s33, s5, 0
    s_mov_b32 s34, 2211840
    s_mov_b32 s35, 0x00020000
    s_add_u32 s36, s4, 41943040
    s_addc_u32 s37, s5, 0
    s_mov_b32 s38, 7077888
    s_mov_b32 s39, 0x00020000
    s_mov_b32 s40, s10
    s_mov_b32 s41, s11
    s_mov_b32 s42, 4096
    s_mov_b32 s43, 0x00020000
    s_add_u32 s44, s4, 17825792
    s_addc_u32 s45, s5, 0
    s_mov_b32 s46, 2621440
    s_mov_b32 s47, 0x00020000
    s_mov_b32 s48, s12
    s_mov_b32 s49, s13
    s_mov_b32 s50, 2621440
    s_mov_b32 s51, 0x00020000
    s_mul_i32 s26, s3, 40960
    s_mul_i32 s27, s17, 5120
    s_add_u32 s26, s26, s27
    s_lshl_b32 s27, s3, 17
    s_lshl_b32 s28, s16, 12
    s_add_u32 s27, s27, s28
    s_mul_i32 s29, s16, 81920
    s_mul_i32 s28, s17, 5120
    s_add_u32 s29, s29, s28
    s_and_b32 s28, s3, 1
    s_mul_i32 s28, s28, 40960
    s_add_u32 s29, s29, s28
    s_cmp_ge_u32 s3, 2
    s_cselect_b32 s52, s44, s32
    s_cselect_b32 s53, s45, s33
    s_cselect_b32 s54, s46, s34
    s_mov_b32 s55, 0x00020000
    buffer_load_dwordx4 v[96:99], v5, s[32:35], s26 offen offset:0
    buffer_load_dwordx4 v[100:103], v5, s[32:35], s26 offen offset:1024
    buffer_load_dwordx4 v[104:107], v5, s[32:35], s26 offen offset:2048
    buffer_load_dwordx4 v[108:111], v5, s[32:35], s26 offen offset:3072
    buffer_load_dwordx4 v[112:115], v6, s[32:35], s26 offen
    s_add_u32 s26, s26, 163840
    buffer_load_dwordx4 v[116:119], v5, s[36:39], s27 offen offset:0
    buffer_load_dwordx4 v[120:123], v5, s[36:39], s27 offen offset:1024
    buffer_load_dwordx4 v[124:127], v5, s[36:39], s27 offen offset:2048
    buffer_load_dwordx4 v[128:131], v5, s[36:39], s27 offen offset:3072
    s_add_u32 s27, s27, 524288
    buffer_load_dwordx4 v[132:135], v5, s[32:35], s26 offen offset:0
    buffer_load_dwordx4 v[136:139], v5, s[32:35], s26 offen offset:1024
    buffer_load_dwordx4 v[140:143], v5, s[32:35], s26 offen offset:2048
    buffer_load_dwordx4 v[144:147], v5, s[32:35], s26 offen offset:3072
    buffer_load_dwordx4 v[148:151], v6, s[32:35], s26 offen
    s_add_u32 s26, s26, 163840
    buffer_load_dwordx4 v[152:155], v5, s[36:39], s27 offen offset:0
    buffer_load_dwordx4 v[156:159], v5, s[36:39], s27 offen offset:1024
    buffer_load_dwordx4 v[160:163], v5, s[36:39], s27 offen offset:2048
    buffer_load_dwordx4 v[164:167], v5, s[36:39], s27 offen offset:3072
    s_add_u32 s27, s27, 524288
    buffer_load_dwordx4 v[168:171], v5, s[32:35], s26 offen offset:0
    buffer_load_dwordx4 v[172:175], v5, s[32:35], s26 offen offset:1024
    buffer_load_dwordx4 v[176:179], v5, s[32:35], s26 offen offset:2048
    buffer_load_dwordx4 v[180:183], v5, s[32:35], s26 offen offset:3072
    buffer_load_dwordx4 v[184:187], v6, s[32:35], s26 offen
    s_add_u32 s26, s26, 163840
    buffer_load_dwordx4 v[188:191], v5, s[36:39], s27 offen offset:0
    buffer_load_dwordx4 v[192:195], v5, s[36:39], s27 offen offset:1024
    buffer_load_dwordx4 v[196:199], v5, s[36:39], s27 offen offset:2048
    buffer_load_dwordx4 v[200:203], v5, s[36:39], s27 offen offset:3072
    s_add_u32 s27, s27, 524288
    v_mov_b32 v16, 0
    v_mov_b32 v17, 0
    v_mov_b32 v18, 0
    v_mov_b32 v19, 0
    v_mov_b32 v20, 0
    v_mov_b32 v21, 0
    v_mov_b32 v22, 0
    v_mov_b32 v23, 0
    v_mov_b32 v24, 0
    v_mov_b32 v25, 0
    v_mov_b32 v26, 0
    v_mov_b32 v27, 0
    v_mov_b32 v28, 0
    v_mov_b32 v29, 0
    v_mov_b32 v30, 0
    v_mov_b32 v31, 0
    v_mov_b32 v32, 0
    v_mov_b32 v33, 0
    v_mov_b32 v34, 0
    v_mov_b32 v35, 0
    v_mov_b32 v36, 0
    v_mov_b32 v37, 0
    v_mov_b32 v38, 0
    v_mov_b32 v39, 0
    v_mov_b32 v40, 0
    v_mov_b32 v41, 0
    v_mov_b32 v42, 0
    v_mov_b32 v43, 0
    v_mov_b32 v44, 0
    v_mov_b32 v45, 0
    v_mov_b32 v46, 0
    v_mov_b32 v47, 0
    v_mov_b32 v48, 0
    v_mov_b32 v49, 0
    v_mov_b32 v50, 0
    v_mov_b32 v51, 0
    v_mov_b32 v52, 0
    v_mov_b32 v53, 0
    v_mov_b32 v54, 0
    v_mov_b32 v55, 0
    v_mov_b32 v56, 0
    v_mov_b32 v57, 0
    v_mov_b32 v58, 0
    v_mov_b32 v59, 0
    v_mov_b32 v60, 0
    v_mov_b32 v61, 0
    v_mov_b32 v62, 0
    v_mov_b32 v63, 0
    v_mov_b32 v64, 0
    v_mov_b32 v65, 0
    v_mov_b32 v66, 0
    v_mov_b32 v67, 0
    v_mov_b32 v68, 0
    v_mov_b32 v69, 0
    v_mov_b32 v70, 0
    v_mov_b32 v71, 0
    v_mov_b32 v72, 0
    v_mov_b32 v73, 0
    v_mov_b32 v74, 0
    v_mov_b32 v75, 0
    v_mov_b32 v76, 0
    v_mov_b32 v77, 0
    v_mov_b32 v78, 0
    v_mov_b32 v79, 0
    v_mov_b32 v80, 0
    v_mov_b32 v81, 0
    v_mov_b32 v82, 0
    v_mov_b32 v83, 0
    v_mov_b32 v84, 0
    v_mov_b32 v85, 0
    v_mov_b32 v86, 0
    v_mov_b32 v87, 0
    v_mov_b32 v88, 0
    v_mov_b32 v89, 0
    v_mov_b32 v90, 0
    v_mov_b32 v91, 0
    v_mov_b32 v92, 0
    v_mov_b32 v93, 0
    v_mov_b32 v94, 0
    v_mov_b32 v95, 0
    v_lshrrev_b32 v248, 2, v3
    v_cmp_eq_u32 vcc, v248, v2
    v_and_b32 v248, 1, v3
    v_lshlrev_b32 v248, 4, v248
    v_mov_b32 v249, 0x3f80
    v_lshlrev_b32 v249, v248, v249
    v_cndmask_b32 v249, 0, v249, vcc
    v_and_b32 v248, 2, v3
    v_cmp_eq_u32 vcc, 0, v248
    v_mov_b32 v242, 0
    v_mov_b32 v243, 0
    v_cndmask_b32 v240, 0, v249, vcc
    v_cndmask_b32 v241, v249, 0, vcc
    v_mov_b32 v244, 0
    v_mov_b32 v245, 0
    v_mov_b32 v246, v240
    v_mov_b32 v247, v241
    s_waitcnt vmcnt(18)
    v_mfma_f32_16x16x32_bf16 v[16:19], v[96:99], v[116:119], v[16:19]
    buffer_load_dwordx4 v[204:207], v5, s[32:35], s26 offen offset:0
    v_mfma_f32_16x16x32_bf16 v[20:23], v[96:99], v[120:123], v[20:23]
    buffer_load_dwordx4 v[208:211], v5, s[32:35], s26 offen offset:1024
    v_mfma_f32_16x16x32_bf16 v[24:27], v[96:99], v[124:127], v[24:27]
    buffer_load_dwordx4 v[212:215], v5, s[32:35], s26 offen offset:2048
    v_mfma_f32_16x16x32_bf16 v[28:31], v[96:99], v[128:131], v[28:31]
    buffer_load_dwordx4 v[216:219], v5, s[32:35], s26 offen offset:3072
    v_mfma_f32_16x16x32_bf16 v[32:35], v[100:103], v[116:119], v[32:35]
    buffer_load_dwordx4 v[220:223], v6, s[32:35], s26 offen
    s_add_u32 s26, s26, 163840
    v_mfma_f32_16x16x32_bf16 v[36:39], v[100:103], v[120:123], v[36:39]
    buffer_load_dwordx4 v[224:227], v5, s[36:39], s27 offen offset:0
    v_mfma_f32_16x16x32_bf16 v[40:43], v[100:103], v[124:127], v[40:43]
    buffer_load_dwordx4 v[228:231], v5, s[36:39], s27 offen offset:1024
    v_mfma_f32_16x16x32_bf16 v[44:47], v[100:103], v[128:131], v[44:47]
    buffer_load_dwordx4 v[232:235], v5, s[36:39], s27 offen offset:2048
    v_mfma_f32_16x16x32_bf16 v[48:51], v[104:107], v[116:119], v[48:51]
    buffer_load_dwordx4 v[236:239], v5, s[36:39], s27 offen offset:3072
    s_add_u32 s27, s27, 524288
    v_mfma_f32_16x16x32_bf16 v[52:55], v[104:107], v[120:123], v[52:55]
    v_mfma_f32_16x16x32_bf16 v[56:59], v[104:107], v[124:127], v[56:59]
    v_mfma_f32_16x16x32_bf16 v[60:63], v[104:107], v[128:131], v[60:63]
    v_mfma_f32_16x16x32_bf16 v[64:67], v[108:111], v[116:119], v[64:67]
    v_mfma_f32_16x16x32_bf16 v[68:71], v[108:111], v[120:123], v[68:71]
    v_mfma_f32_16x16x32_bf16 v[72:75], v[108:111], v[124:127], v[72:75]
    v_mfma_f32_16x16x32_bf16 v[76:79], v[108:111], v[128:131], v[76:79]
    v_mfma_f32_16x16x32_bf16 v[80:83], v[112:115], v[116:119], v[80:83]
    v_mfma_f32_16x16x32_bf16 v[84:87], v[112:115], v[120:123], v[84:87]
    v_mfma_f32_16x16x32_bf16 v[88:91], v[112:115], v[124:127], v[88:91]
    v_mfma_f32_16x16x32_bf16 v[92:95], v[112:115], v[128:131], v[92:95]
    s_waitcnt vmcnt(18)
    v_mfma_f32_16x16x32_bf16 v[16:19], v[132:135], v[152:155], v[16:19]
    buffer_load_dwordx4 v[96:99], v5, s[32:35], s26 offen offset:0
    v_mfma_f32_16x16x32_bf16 v[20:23], v[132:135], v[156:159], v[20:23]
    buffer_load_dwordx4 v[100:103], v5, s[32:35], s26 offen offset:1024
    v_mfma_f32_16x16x32_bf16 v[24:27], v[132:135], v[160:163], v[24:27]
    buffer_load_dwordx4 v[104:107], v5, s[32:35], s26 offen offset:2048
    v_mfma_f32_16x16x32_bf16 v[28:31], v[132:135], v[164:167], v[28:31]
    buffer_load_dwordx4 v[108:111], v5, s[32:35], s26 offen offset:3072
    v_mfma_f32_16x16x32_bf16 v[32:35], v[136:139], v[152:155], v[32:35]
    buffer_load_dwordx4 v[112:115], v6, s[32:35], s26 offen
    s_add_u32 s26, s26, 163840
    v_mfma_f32_16x16x32_bf16 v[36:39], v[136:139], v[156:159], v[36:39]
    buffer_load_dwordx4 v[116:119], v5, s[36:39], s27 offen offset:0
    v_mfma_f32_16x16x32_bf16 v[40:43], v[136:139], v[160:163], v[40:43]
    buffer_load_dwordx4 v[120:123], v5, s[36:39], s27 offen offset:1024
    v_mfma_f32_16x16x32_bf16 v[44:47], v[136:139], v[164:167], v[44:47]
    buffer_load_dwordx4 v[124:127], v5, s[36:39], s27 offen offset:2048
    v_mfma_f32_16x16x32_bf16 v[48:51], v[140:143], v[152:155], v[48:51]
    buffer_load_dwordx4 v[128:131], v5, s[36:39], s27 offen offset:3072
    s_add_u32 s27, s27, 524288
    v_mfma_f32_16x16x32_bf16 v[52:55], v[140:143], v[156:159], v[52:55]
    v_mfma_f32_16x16x32_bf16 v[56:59], v[140:143], v[160:163], v[56:59]
    v_mfma_f32_16x16x32_bf16 v[60:63], v[140:143], v[164:167], v[60:63]
    v_mfma_f32_16x16x32_bf16 v[64:67], v[144:147], v[152:155], v[64:67]
    v_mfma_f32_16x16x32_bf16 v[68:71], v[144:147], v[156:159], v[68:71]
    v_mfma_f32_16x16x32_bf16 v[72:75], v[144:147], v[160:163], v[72:75]
    v_mfma_f32_16x16x32_bf16 v[76:79], v[144:147], v[164:167], v[76:79]
    v_mfma_f32_16x16x32_bf16 v[80:83], v[148:151], v[152:155], v[80:83]
    v_mfma_f32_16x16x32_bf16 v[84:87], v[148:151], v[156:159], v[84:87]
    v_mfma_f32_16x16x32_bf16 v[88:91], v[148:151], v[160:163], v[88:91]
    v_mfma_f32_16x16x32_bf16 v[92:95], v[148:151], v[164:167], v[92:95]
    s_waitcnt vmcnt(18)
    v_mfma_f32_16x16x32_bf16 v[16:19], v[168:171], v[188:191], v[16:19]
    buffer_load_dwordx4 v[132:135], v5, s[32:35], s26 offen offset:0
    v_mfma_f32_16x16x32_bf16 v[20:23], v[168:171], v[192:195], v[20:23]
    buffer_load_dwordx4 v[136:139], v5, s[32:35], s26 offen offset:1024
    v_mfma_f32_16x16x32_bf16 v[24:27], v[168:171], v[196:199], v[24:27]
    buffer_load_dwordx4 v[140:143], v5, s[32:35], s26 offen offset:2048
    v_mfma_f32_16x16x32_bf16 v[28:31], v[168:171], v[200:203], v[28:31]
    buffer_load_dwordx4 v[144:147], v5, s[32:35], s26 offen offset:3072
    v_mfma_f32_16x16x32_bf16 v[32:35], v[172:175], v[188:191], v[32:35]
    buffer_load_dwordx4 v[148:151], v6, s[32:35], s26 offen
    s_add_u32 s26, s26, 163840
    v_mfma_f32_16x16x32_bf16 v[36:39], v[172:175], v[192:195], v[36:39]
    buffer_load_dwordx4 v[152:155], v5, s[36:39], s27 offen offset:0
    v_mfma_f32_16x16x32_bf16 v[40:43], v[172:175], v[196:199], v[40:43]
    buffer_load_dwordx4 v[156:159], v5, s[36:39], s27 offen offset:1024
    v_mfma_f32_16x16x32_bf16 v[44:47], v[172:175], v[200:203], v[44:47]
    buffer_load_dwordx4 v[160:163], v5, s[36:39], s27 offen offset:2048
    v_mfma_f32_16x16x32_bf16 v[48:51], v[176:179], v[188:191], v[48:51]
    buffer_load_dwordx4 v[164:167], v5, s[36:39], s27 offen offset:3072
    s_add_u32 s27, s27, 524288
    v_mfma_f32_16x16x32_bf16 v[52:55], v[176:179], v[192:195], v[52:55]
    v_mfma_f32_16x16x32_bf16 v[56:59], v[176:179], v[196:199], v[56:59]
    v_mfma_f32_16x16x32_bf16 v[60:63], v[176:179], v[200:203], v[60:63]
    v_mfma_f32_16x16x32_bf16 v[64:67], v[180:183], v[188:191], v[64:67]
    v_mfma_f32_16x16x32_bf16 v[68:71], v[180:183], v[192:195], v[68:71]
    v_mfma_f32_16x16x32_bf16 v[72:75], v[180:183], v[196:199], v[72:75]
    v_mfma_f32_16x16x32_bf16 v[76:79], v[180:183], v[200:203], v[76:79]
    v_mfma_f32_16x16x32_bf16 v[80:83], v[184:187], v[188:191], v[80:83]
    v_mfma_f32_16x16x32_bf16 v[84:87], v[184:187], v[192:195], v[84:87]
    v_mfma_f32_16x16x32_bf16 v[88:91], v[184:187], v[196:199], v[88:91]
    v_mfma_f32_16x16x32_bf16 v[92:95], v[184:187], v[200:203], v[92:95]
    s_waitcnt vmcnt(18)
    v_mfma_f32_16x16x32_bf16 v[16:19], v[204:207], v[224:227], v[16:19]
    buffer_load_dwordx4 v[168:171], v5, s[32:35], s26 offen offset:0
    v_mfma_f32_16x16x32_bf16 v[20:23], v[204:207], v[228:231], v[20:23]
    buffer_load_dwordx4 v[172:175], v5, s[32:35], s26 offen offset:1024
    v_mfma_f32_16x16x32_bf16 v[24:27], v[204:207], v[232:235], v[24:27]
    buffer_load_dwordx4 v[176:179], v5, s[32:35], s26 offen offset:2048
    v_mfma_f32_16x16x32_bf16 v[28:31], v[204:207], v[236:239], v[28:31]
    buffer_load_dwordx4 v[180:183], v5, s[32:35], s26 offen offset:3072
    v_mfma_f32_16x16x32_bf16 v[32:35], v[208:211], v[224:227], v[32:35]
    buffer_load_dwordx4 v[184:187], v6, s[32:35], s26 offen
    s_add_u32 s26, s26, 163840
    v_mfma_f32_16x16x32_bf16 v[36:39], v[208:211], v[228:231], v[36:39]
    buffer_load_dwordx4 v[188:191], v5, s[36:39], s27 offen offset:0
    v_mfma_f32_16x16x32_bf16 v[40:43], v[208:211], v[232:235], v[40:43]
    buffer_load_dwordx4 v[192:195], v5, s[36:39], s27 offen offset:1024
    v_mfma_f32_16x16x32_bf16 v[44:47], v[208:211], v[236:239], v[44:47]
    buffer_load_dwordx4 v[196:199], v5, s[36:39], s27 offen offset:2048
    v_mfma_f32_16x16x32_bf16 v[48:51], v[212:215], v[224:227], v[48:51]
    buffer_load_dwordx4 v[200:203], v5, s[36:39], s27 offen offset:3072
    s_add_u32 s27, s27, 524288
    v_mfma_f32_16x16x32_bf16 v[52:55], v[212:215], v[228:231], v[52:55]
    v_mfma_f32_16x16x32_bf16 v[56:59], v[212:215], v[232:235], v[56:59]
    v_mfma_f32_16x16x32_bf16 v[60:63], v[212:215], v[236:239], v[60:63]
    v_mfma_f32_16x16x32_bf16 v[64:67], v[216:219], v[224:227], v[64:67]
    v_mfma_f32_16x16x32_bf16 v[68:71], v[216:219], v[228:231], v[68:71]
    v_mfma_f32_16x16x32_bf16 v[72:75], v[216:219], v[232:235], v[72:75]
    v_mfma_f32_16x16x32_bf16 v[76:79], v[216:219], v[236:239], v[76:79]
    v_mfma_f32_16x16x32_bf16 v[80:83], v[220:223], v[224:227], v[80:83]
    v_mfma_f32_16x16x32_bf16 v[84:87], v[220:223], v[228:231], v[84:87]
    v_mfma_f32_16x16x32_bf16 v[88:91], v[220:223], v[232:235], v[88:91]
    v_mfma_f32_16x16x32_bf16 v[92:95], v[220:223], v[236:239], v[92:95]
    s_waitcnt vmcnt(18)
    v_mfma_f32_16x16x32_bf16 v[16:19], v[96:99], v[116:119], v[16:19]
    buffer_load_dwordx4 v[204:207], v5, s[32:35], s26 offen offset:0
    v_mfma_f32_16x16x32_bf16 v[20:23], v[96:99], v[120:123], v[20:23]
    buffer_load_dwordx4 v[208:211], v5, s[32:35], s26 offen offset:1024
    v_mfma_f32_16x16x32_bf16 v[24:27], v[96:99], v[124:127], v[24:27]
    buffer_load_dwordx4 v[212:215], v5, s[32:35], s26 offen offset:2048
    v_mfma_f32_16x16x32_bf16 v[28:31], v[96:99], v[128:131], v[28:31]
    buffer_load_dwordx4 v[216:219], v5, s[32:35], s26 offen offset:3072
    v_mfma_f32_16x16x32_bf16 v[32:35], v[100:103], v[116:119], v[32:35]
    buffer_load_dwordx4 v[220:223], v6, s[32:35], s26 offen
    s_add_u32 s26, s26, 163840
    v_mfma_f32_16x16x32_bf16 v[36:39], v[100:103], v[120:123], v[36:39]
    buffer_load_dwordx4 v[224:227], v5, s[36:39], s27 offen offset:0
    v_mfma_f32_16x16x32_bf16 v[40:43], v[100:103], v[124:127], v[40:43]
    buffer_load_dwordx4 v[228:231], v5, s[36:39], s27 offen offset:1024
    v_mfma_f32_16x16x32_bf16 v[44:47], v[100:103], v[128:131], v[44:47]
    buffer_load_dwordx4 v[232:235], v5, s[36:39], s27 offen offset:2048
    v_mfma_f32_16x16x32_bf16 v[48:51], v[104:107], v[116:119], v[48:51]
    buffer_load_dwordx4 v[236:239], v5, s[36:39], s27 offen offset:3072
    s_add_u32 s27, s27, 524288
    v_mfma_f32_16x16x32_bf16 v[52:55], v[104:107], v[120:123], v[52:55]
    v_mfma_f32_16x16x32_bf16 v[56:59], v[104:107], v[124:127], v[56:59]
    v_mfma_f32_16x16x32_bf16 v[60:63], v[104:107], v[128:131], v[60:63]
    v_mfma_f32_16x16x32_bf16 v[64:67], v[108:111], v[116:119], v[64:67]
    v_mfma_f32_16x16x32_bf16 v[68:71], v[108:111], v[120:123], v[68:71]
    v_mfma_f32_16x16x32_bf16 v[72:75], v[108:111], v[124:127], v[72:75]
    v_mfma_f32_16x16x32_bf16 v[76:79], v[108:111], v[128:131], v[76:79]
    v_mfma_f32_16x16x32_bf16 v[80:83], v[112:115], v[116:119], v[80:83]
    v_mfma_f32_16x16x32_bf16 v[84:87], v[112:115], v[120:123], v[84:87]
    v_mfma_f32_16x16x32_bf16 v[88:91], v[112:115], v[124:127], v[88:91]
    v_mfma_f32_16x16x32_bf16 v[92:95], v[112:115], v[128:131], v[92:95]
    s_waitcnt vmcnt(18)
    v_mfma_f32_16x16x32_bf16 v[16:19], v[132:135], v[152:155], v[16:19]
    buffer_load_dwordx4 v[96:99], v5, s[32:35], s26 offen offset:0
    v_mfma_f32_16x16x32_bf16 v[20:23], v[132:135], v[156:159], v[20:23]
    buffer_load_dwordx4 v[100:103], v5, s[32:35], s26 offen offset:1024
    v_mfma_f32_16x16x32_bf16 v[24:27], v[132:135], v[160:163], v[24:27]
    buffer_load_dwordx4 v[104:107], v5, s[32:35], s26 offen offset:2048
    v_mfma_f32_16x16x32_bf16 v[28:31], v[132:135], v[164:167], v[28:31]
    buffer_load_dwordx4 v[108:111], v5, s[32:35], s26 offen offset:3072
    v_mfma_f32_16x16x32_bf16 v[32:35], v[136:139], v[152:155], v[32:35]
    buffer_load_dwordx4 v[112:115], v6, s[32:35], s26 offen
    s_add_u32 s26, s26, 163840
    v_mfma_f32_16x16x32_bf16 v[36:39], v[136:139], v[156:159], v[36:39]
    buffer_load_dwordx4 v[116:119], v5, s[36:39], s27 offen offset:0
    v_mfma_f32_16x16x32_bf16 v[40:43], v[136:139], v[160:163], v[40:43]
    buffer_load_dwordx4 v[120:123], v5, s[36:39], s27 offen offset:1024
    v_mfma_f32_16x16x32_bf16 v[44:47], v[136:139], v[164:167], v[44:47]
    buffer_load_dwordx4 v[124:127], v5, s[36:39], s27 offen offset:2048
    v_mfma_f32_16x16x32_bf16 v[48:51], v[140:143], v[152:155], v[48:51]
    buffer_load_dwordx4 v[128:131], v5, s[36:39], s27 offen offset:3072
    s_add_u32 s27, s27, 524288
    v_mfma_f32_16x16x32_bf16 v[52:55], v[140:143], v[156:159], v[52:55]
    v_mfma_f32_16x16x32_bf16 v[56:59], v[140:143], v[160:163], v[56:59]
    v_mfma_f32_16x16x32_bf16 v[60:63], v[140:143], v[164:167], v[60:63]
    v_mfma_f32_16x16x32_bf16 v[64:67], v[144:147], v[152:155], v[64:67]
    v_mfma_f32_16x16x32_bf16 v[68:71], v[144:147], v[156:159], v[68:71]
    v_mfma_f32_16x16x32_bf16 v[72:75], v[144:147], v[160:163], v[72:75]
    v_mfma_f32_16x16x32_bf16 v[76:79], v[144:147], v[164:167], v[76:79]
    v_mfma_f32_16x16x32_bf16 v[80:83], v[148:151], v[152:155], v[80:83]
    v_mfma_f32_16x16x32_bf16 v[84:87], v[148:151], v[156:159], v[84:87]
    v_mfma_f32_16x16x32_bf16 v[88:91], v[148:151], v[160:163], v[88:91]
    v_mfma_f32_16x16x32_bf16 v[92:95], v[148:151], v[164:167], v[92:95]
    s_waitcnt vmcnt(18)
    v_mfma_f32_16x16x32_bf16 v[16:19], v[168:171], v[188:191], v[16:19]
    buffer_load_dwordx4 v[132:135], v5, s[32:35], s26 offen offset:0
    v_mfma_f32_16x16x32_bf16 v[20:23], v[168:171], v[192:195], v[20:23]
    buffer_load_dwordx4 v[136:139], v5, s[32:35], s26 offen offset:1024
    v_mfma_f32_16x16x32_bf16 v[24:27], v[168:171], v[196:199], v[24:27]
    buffer_load_dwordx4 v[140:143], v5, s[32:35], s26 offen offset:2048
    v_mfma_f32_16x16x32_bf16 v[28:31], v[168:171], v[200:203], v[28:31]
    buffer_load_dwordx4 v[144:147], v5, s[32:35], s26 offen offset:3072
    v_mfma_f32_16x16x32_bf16 v[32:35], v[172:175], v[188:191], v[32:35]
    buffer_load_dwordx4 v[148:151], v6, s[32:35], s26 offen
    s_add_u32 s26, s26, 163840
    v_mfma_f32_16x16x32_bf16 v[36:39], v[172:175], v[192:195], v[36:39]
    buffer_load_dwordx4 v[152:155], v5, s[36:39], s27 offen offset:0
    v_mfma_f32_16x16x32_bf16 v[40:43], v[172:175], v[196:199], v[40:43]
    buffer_load_dwordx4 v[156:159], v5, s[36:39], s27 offen offset:1024
    v_mfma_f32_16x16x32_bf16 v[44:47], v[172:175], v[200:203], v[44:47]
    buffer_load_dwordx4 v[160:163], v5, s[36:39], s27 offen offset:2048
    v_mfma_f32_16x16x32_bf16 v[48:51], v[176:179], v[188:191], v[48:51]
    buffer_load_dwordx4 v[164:167], v5, s[36:39], s27 offen offset:3072
    s_add_u32 s27, s27, 524288
    v_mfma_f32_16x16x32_bf16 v[52:55], v[176:179], v[192:195], v[52:55]
    v_mfma_f32_16x16x32_bf16 v[56:59], v[176:179], v[196:199], v[56:59]
    v_mfma_f32_16x16x32_bf16 v[60:63], v[176:179], v[200:203], v[60:63]
    v_mfma_f32_16x16x32_bf16 v[64:67], v[180:183], v[188:191], v[64:67]
    v_mfma_f32_16x16x32_bf16 v[68:71], v[180:183], v[192:195], v[68:71]
    v_mfma_f32_16x16x32_bf16 v[72:75], v[180:183], v[196:199], v[72:75]
    v_mfma_f32_16x16x32_bf16 v[76:79], v[180:183], v[200:203], v[76:79]
    v_mfma_f32_16x16x32_bf16 v[80:83], v[184:187], v[188:191], v[80:83]
    v_mfma_f32_16x16x32_bf16 v[84:87], v[184:187], v[192:195], v[84:87]
    v_mfma_f32_16x16x32_bf16 v[88:91], v[184:187], v[196:199], v[88:91]
    v_mfma_f32_16x16x32_bf16 v[92:95], v[184:187], v[200:203], v[92:95]
    s_waitcnt vmcnt(18)
    v_mfma_f32_16x16x32_bf16 v[16:19], v[204:207], v[224:227], v[16:19]
    buffer_load_dwordx4 v[168:171], v5, s[32:35], s26 offen offset:0
    v_mfma_f32_16x16x32_bf16 v[20:23], v[204:207], v[228:231], v[20:23]
    buffer_load_dwordx4 v[172:175], v5, s[32:35], s26 offen offset:1024
    v_mfma_f32_16x16x32_bf16 v[24:27], v[204:207], v[232:235], v[24:27]
    buffer_load_dwordx4 v[176:179], v5, s[32:35], s26 offen offset:2048
    v_mfma_f32_16x16x32_bf16 v[28:31], v[204:207], v[236:239], v[28:31]
    buffer_load_dwordx4 v[180:183], v5, s[32:35], s26 offen offset:3072
    v_mfma_f32_16x16x32_bf16 v[32:35], v[208:211], v[224:227], v[32:35]
    buffer_load_dwordx4 v[184:187], v6, s[32:35], s26 offen
    s_add_u32 s26, s26, 163840
    v_mfma_f32_16x16x32_bf16 v[36:39], v[208:211], v[228:231], v[36:39]
    buffer_load_dwordx4 v[188:191], v5, s[36:39], s27 offen offset:0
    v_mfma_f32_16x16x32_bf16 v[40:43], v[208:211], v[232:235], v[40:43]
    buffer_load_dwordx4 v[192:195], v5, s[36:39], s27 offen offset:1024
    v_mfma_f32_16x16x32_bf16 v[44:47], v[208:211], v[236:239], v[44:47]
    buffer_load_dwordx4 v[196:199], v5, s[36:39], s27 offen offset:2048
    v_mfma_f32_16x16x32_bf16 v[48:51], v[212:215], v[224:227], v[48:51]
    buffer_load_dwordx4 v[200:203], v5, s[36:39], s27 offen offset:3072
    s_add_u32 s27, s27, 524288
    v_mfma_f32_16x16x32_bf16 v[52:55], v[212:215], v[228:231], v[52:55]
    v_mfma_f32_16x16x32_bf16 v[56:59], v[212:215], v[232:235], v[56:59]
    v_mfma_f32_16x16x32_bf16 v[60:63], v[212:215], v[236:239], v[60:63]
    v_mfma_f32_16x16x32_bf16 v[64:67], v[216:219], v[224:227], v[64:67]
    v_mfma_f32_16x16x32_bf16 v[68:71], v[216:219], v[228:231], v[68:71]
    v_mfma_f32_16x16x32_bf16 v[72:75], v[216:219], v[232:235], v[72:75]
    v_mfma_f32_16x16x32_bf16 v[76:79], v[216:219], v[236:239], v[76:79]
    v_mfma_f32_16x16x32_bf16 v[80:83], v[220:223], v[224:227], v[80:83]
    v_mfma_f32_16x16x32_bf16 v[84:87], v[220:223], v[228:231], v[84:87]
    v_mfma_f32_16x16x32_bf16 v[88:91], v[220:223], v[232:235], v[88:91]
    v_mfma_f32_16x16x32_bf16 v[92:95], v[220:223], v[236:239], v[92:95]
    s_waitcnt vmcnt(18)
    v_mfma_f32_16x16x32_bf16 v[16:19], v[96:99], v[116:119], v[16:19]
    buffer_load_dwordx4 v[204:207], v5, s[32:35], s26 offen offset:0
    v_mfma_f32_16x16x32_bf16 v[20:23], v[96:99], v[120:123], v[20:23]
    buffer_load_dwordx4 v[208:211], v5, s[32:35], s26 offen offset:1024
    v_mfma_f32_16x16x32_bf16 v[24:27], v[96:99], v[124:127], v[24:27]
    buffer_load_dwordx4 v[212:215], v5, s[32:35], s26 offen offset:2048
    v_mfma_f32_16x16x32_bf16 v[28:31], v[96:99], v[128:131], v[28:31]
    buffer_load_dwordx4 v[216:219], v5, s[32:35], s26 offen offset:3072
    v_mfma_f32_16x16x32_bf16 v[32:35], v[100:103], v[116:119], v[32:35]
    buffer_load_dwordx4 v[220:223], v6, s[32:35], s26 offen
    s_add_u32 s26, s26, 163840
    v_mfma_f32_16x16x32_bf16 v[36:39], v[100:103], v[120:123], v[36:39]
    buffer_load_dwordx4 v[224:227], v5, s[36:39], s27 offen offset:0
    v_mfma_f32_16x16x32_bf16 v[40:43], v[100:103], v[124:127], v[40:43]
    buffer_load_dwordx4 v[228:231], v5, s[36:39], s27 offen offset:1024
    v_mfma_f32_16x16x32_bf16 v[44:47], v[100:103], v[128:131], v[44:47]
    buffer_load_dwordx4 v[232:235], v5, s[36:39], s27 offen offset:2048
    v_mfma_f32_16x16x32_bf16 v[48:51], v[104:107], v[116:119], v[48:51]
    buffer_load_dwordx4 v[236:239], v5, s[36:39], s27 offen offset:3072
    s_add_u32 s27, s27, 524288
    v_mfma_f32_16x16x32_bf16 v[52:55], v[104:107], v[120:123], v[52:55]
    v_mfma_f32_16x16x32_bf16 v[56:59], v[104:107], v[124:127], v[56:59]
    v_mfma_f32_16x16x32_bf16 v[60:63], v[104:107], v[128:131], v[60:63]
    v_mfma_f32_16x16x32_bf16 v[64:67], v[108:111], v[116:119], v[64:67]
    v_mfma_f32_16x16x32_bf16 v[68:71], v[108:111], v[120:123], v[68:71]
    v_mfma_f32_16x16x32_bf16 v[72:75], v[108:111], v[124:127], v[72:75]
    v_mfma_f32_16x16x32_bf16 v[76:79], v[108:111], v[128:131], v[76:79]
    v_mfma_f32_16x16x32_bf16 v[80:83], v[112:115], v[116:119], v[80:83]
    v_mfma_f32_16x16x32_bf16 v[84:87], v[112:115], v[120:123], v[84:87]
    v_mfma_f32_16x16x32_bf16 v[88:91], v[112:115], v[124:127], v[88:91]
    v_mfma_f32_16x16x32_bf16 v[92:95], v[112:115], v[128:131], v[92:95]
    s_waitcnt vmcnt(18)
    v_mfma_f32_16x16x32_bf16 v[16:19], v[132:135], v[152:155], v[16:19]
    buffer_load_dwordx4 v[96:99], v5, s[32:35], s26 offen offset:0
    v_mfma_f32_16x16x32_bf16 v[20:23], v[132:135], v[156:159], v[20:23]
    buffer_load_dwordx4 v[100:103], v5, s[32:35], s26 offen offset:1024
    v_mfma_f32_16x16x32_bf16 v[24:27], v[132:135], v[160:163], v[24:27]
    buffer_load_dwordx4 v[104:107], v5, s[32:35], s26 offen offset:2048
    v_mfma_f32_16x16x32_bf16 v[28:31], v[132:135], v[164:167], v[28:31]
    buffer_load_dwordx4 v[108:111], v5, s[32:35], s26 offen offset:3072
    v_mfma_f32_16x16x32_bf16 v[32:35], v[136:139], v[152:155], v[32:35]
    buffer_load_dwordx4 v[112:115], v6, s[32:35], s26 offen
    s_add_u32 s26, s26, 163840
    v_mfma_f32_16x16x32_bf16 v[36:39], v[136:139], v[156:159], v[36:39]
    buffer_load_dwordx4 v[116:119], v5, s[36:39], s27 offen offset:0
    v_mfma_f32_16x16x32_bf16 v[40:43], v[136:139], v[160:163], v[40:43]
    buffer_load_dwordx4 v[120:123], v5, s[36:39], s27 offen offset:1024
    v_mfma_f32_16x16x32_bf16 v[44:47], v[136:139], v[164:167], v[44:47]
    buffer_load_dwordx4 v[124:127], v5, s[36:39], s27 offen offset:2048
    v_mfma_f32_16x16x32_bf16 v[48:51], v[140:143], v[152:155], v[48:51]
    buffer_load_dwordx4 v[128:131], v5, s[36:39], s27 offen offset:3072
    s_add_u32 s27, s27, 524288
    v_mfma_f32_16x16x32_bf16 v[52:55], v[140:143], v[156:159], v[52:55]
    v_mfma_f32_16x16x32_bf16 v[56:59], v[140:143], v[160:163], v[56:59]
    v_mfma_f32_16x16x32_bf16 v[60:63], v[140:143], v[164:167], v[60:63]
    v_mfma_f32_16x16x32_bf16 v[64:67], v[144:147], v[152:155], v[64:67]
    v_mfma_f32_16x16x32_bf16 v[68:71], v[144:147], v[156:159], v[68:71]
    v_mfma_f32_16x16x32_bf16 v[72:75], v[144:147], v[160:163], v[72:75]
    v_mfma_f32_16x16x32_bf16 v[76:79], v[144:147], v[164:167], v[76:79]
    v_mfma_f32_16x16x32_bf16 v[80:83], v[148:151], v[152:155], v[80:83]
    v_mfma_f32_16x16x32_bf16 v[84:87], v[148:151], v[156:159], v[84:87]
    v_mfma_f32_16x16x32_bf16 v[88:91], v[148:151], v[160:163], v[88:91]
    v_mfma_f32_16x16x32_bf16 v[92:95], v[148:151], v[164:167], v[92:95]
    s_waitcnt vmcnt(18)
    v_mfma_f32_16x16x32_bf16 v[16:19], v[168:171], v[188:191], v[16:19]
    s_cmp_ge_u32 s3, 2
    s_cselect_b32 s26, s29, s26
    buffer_load_dwordx4 v[132:135], v5, s[52:55], s26 offen offset:0
    v_mfma_f32_16x16x32_bf16 v[20:23], v[168:171], v[192:195], v[20:23]
    buffer_load_dwordx4 v[136:139], v5, s[52:55], s26 offen offset:1024
    v_mfma_f32_16x16x32_bf16 v[24:27], v[168:171], v[196:199], v[24:27]
    buffer_load_dwordx4 v[140:143], v5, s[52:55], s26 offen offset:2048
    v_mfma_f32_16x16x32_bf16 v[28:31], v[168:171], v[200:203], v[28:31]
    buffer_load_dwordx4 v[144:147], v5, s[52:55], s26 offen offset:3072
    v_mfma_f32_16x16x32_bf16 v[32:35], v[172:175], v[188:191], v[32:35]
    buffer_load_dwordx4 v[148:151], v6, s[52:55], s26 offen
    s_add_u32 s26, s26, 163840
    v_mfma_f32_16x16x32_bf16 v[36:39], v[172:175], v[192:195], v[36:39]
    buffer_load_dwordx4 v[152:155], v5, s[36:39], s27 offen offset:0
    v_mfma_f32_16x16x32_bf16 v[40:43], v[172:175], v[196:199], v[40:43]
    buffer_load_dwordx4 v[156:159], v5, s[36:39], s27 offen offset:1024
    v_mfma_f32_16x16x32_bf16 v[44:47], v[172:175], v[200:203], v[44:47]
    buffer_load_dwordx4 v[160:163], v5, s[36:39], s27 offen offset:2048
    v_mfma_f32_16x16x32_bf16 v[48:51], v[176:179], v[188:191], v[48:51]
    buffer_load_dwordx4 v[164:167], v5, s[36:39], s27 offen offset:3072
    s_add_u32 s27, s27, 524288
    v_mfma_f32_16x16x32_bf16 v[52:55], v[176:179], v[192:195], v[52:55]
    v_mfma_f32_16x16x32_bf16 v[56:59], v[176:179], v[196:199], v[56:59]
    v_mfma_f32_16x16x32_bf16 v[60:63], v[176:179], v[200:203], v[60:63]
    v_mfma_f32_16x16x32_bf16 v[64:67], v[180:183], v[188:191], v[64:67]
    v_mfma_f32_16x16x32_bf16 v[68:71], v[180:183], v[192:195], v[68:71]
    v_mfma_f32_16x16x32_bf16 v[72:75], v[180:183], v[196:199], v[72:75]
    v_mfma_f32_16x16x32_bf16 v[76:79], v[180:183], v[200:203], v[76:79]
    v_mfma_f32_16x16x32_bf16 v[80:83], v[184:187], v[188:191], v[80:83]
    v_mfma_f32_16x16x32_bf16 v[84:87], v[184:187], v[192:195], v[84:87]
    v_mfma_f32_16x16x32_bf16 v[88:91], v[184:187], v[196:199], v[88:91]
    v_mfma_f32_16x16x32_bf16 v[92:95], v[184:187], v[200:203], v[92:95]
    s_waitcnt vmcnt(18)
    v_mfma_f32_16x16x32_bf16 v[16:19], v[204:207], v[224:227], v[16:19]
    v_mfma_f32_16x16x32_bf16 v[20:23], v[204:207], v[228:231], v[20:23]
    v_mfma_f32_16x16x32_bf16 v[24:27], v[204:207], v[232:235], v[24:27]
    v_mfma_f32_16x16x32_bf16 v[28:31], v[204:207], v[236:239], v[28:31]
    v_mfma_f32_16x16x32_bf16 v[32:35], v[208:211], v[224:227], v[32:35]
    v_mfma_f32_16x16x32_bf16 v[36:39], v[208:211], v[228:231], v[36:39]
    v_mfma_f32_16x16x32_bf16 v[40:43], v[208:211], v[232:235], v[40:43]
    v_mfma_f32_16x16x32_bf16 v[44:47], v[208:211], v[236:239], v[44:47]
    v_mfma_f32_16x16x32_bf16 v[48:51], v[212:215], v[224:227], v[48:51]
    v_mfma_f32_16x16x32_bf16 v[52:55], v[212:215], v[228:231], v[52:55]
    v_mfma_f32_16x16x32_bf16 v[56:59], v[212:215], v[232:235], v[56:59]
    v_mfma_f32_16x16x32_bf16 v[60:63], v[212:215], v[236:239], v[60:63]
    v_mfma_f32_16x16x32_bf16 v[64:67], v[216:219], v[224:227], v[64:67]
    v_mfma_f32_16x16x32_bf16 v[68:71], v[216:219], v[228:231], v[68:71]
    v_mfma_f32_16x16x32_bf16 v[72:75], v[216:219], v[232:235], v[72:75]
    v_mfma_f32_16x16x32_bf16 v[76:79], v[216:219], v[236:239], v[76:79]
    v_mfma_f32_16x16x32_bf16 v[80:83], v[220:223], v[224:227], v[80:83]
    v_mfma_f32_16x16x32_bf16 v[84:87], v[220:223], v[228:231], v[84:87]
    v_mfma_f32_16x16x32_bf16 v[88:91], v[220:223], v[232:235], v[88:91]
    v_mfma_f32_16x16x32_bf16 v[92:95], v[220:223], v[236:239], v[92:95]
    s_waitcnt vmcnt(9)
    v_mfma_f32_16x16x32_bf16 v[16:19], v[96:99], v[116:119], v[16:19]
    v_mfma_f32_16x16x32_bf16 v[20:23], v[96:99], v[120:123], v[20:23]
    v_mfma_f32_16x16x32_bf16 v[24:27], v[96:99], v[124:127], v[24:27]
    v_mfma_f32_16x16x32_bf16 v[28:31], v[96:99], v[128:131], v[28:31]
    v_mfma_f32_16x16x32_bf16 v[32:35], v[100:103], v[116:119], v[32:35]
    v_mfma_f32_16x16x32_bf16 v[36:39], v[100:103], v[120:123], v[36:39]
    v_mfma_f32_16x16x32_bf16 v[40:43], v[100:103], v[124:127], v[40:43]
    v_mfma_f32_16x16x32_bf16 v[44:47], v[100:103], v[128:131], v[44:47]
    v_mfma_f32_16x16x32_bf16 v[48:51], v[104:107], v[116:119], v[48:51]
    v_mfma_f32_16x16x32_bf16 v[52:55], v[104:107], v[120:123], v[52:55]
    v_mfma_f32_16x16x32_bf16 v[56:59], v[104:107], v[124:127], v[56:59]
    v_mfma_f32_16x16x32_bf16 v[60:63], v[104:107], v[128:131], v[60:63]
    v_mfma_f32_16x16x32_bf16 v[64:67], v[108:111], v[116:119], v[64:67]
    v_mfma_f32_16x16x32_bf16 v[68:71], v[108:111], v[120:123], v[68:71]
    v_mfma_f32_16x16x32_bf16 v[72:75], v[108:111], v[124:127], v[72:75]
    v_mfma_f32_16x16x32_bf16 v[76:79], v[108:111], v[128:131], v[76:79]
    v_mfma_f32_16x16x32_bf16 v[80:83], v[112:115], v[116:119], v[80:83]
    v_mfma_f32_16x16x32_bf16 v[84:87], v[112:115], v[120:123], v[84:87]
    v_mfma_f32_16x16x32_bf16 v[88:91], v[112:115], v[124:127], v[88:91]
    v_mfma_f32_16x16x32_bf16 v[92:95], v[112:115], v[128:131], v[92:95]
    s_waitcnt vmcnt(0)
    s_cmp_lg_u32 s3, 2
    s_cbranch_scc1 mlpb1_kernel_sk1
    v_mov_b32 v152, v240
    v_mov_b32 v153, v241
    v_mov_b32 v154, v242
    v_mov_b32 v155, v243
    v_mov_b32 v156, v244
    v_mov_b32 v157, v245
    v_mov_b32 v158, v246
    v_mov_b32 v159, v247
    s_nop 1
mlpb1_kernel_sk1:
    s_cmp_lg_u32 s3, 3
    s_cbranch_scc1 mlpb1_kernel_sk2
    v_mov_b32 v160, v240
    v_mov_b32 v161, v241
    v_mov_b32 v162, v242
    v_mov_b32 v163, v243
    v_mov_b32 v164, v244
    v_mov_b32 v165, v245
    v_mov_b32 v166, v246
    v_mov_b32 v167, v247
    s_nop 1
mlpb1_kernel_sk2:
    v_mfma_f32_16x16x32_bf16 v[16:19], v[132:135], v[152:155], v[16:19]
    v_mfma_f32_16x16x32_bf16 v[20:23], v[132:135], v[156:159], v[20:23]
    v_mfma_f32_16x16x32_bf16 v[24:27], v[132:135], v[160:163], v[24:27]
    v_mfma_f32_16x16x32_bf16 v[28:31], v[132:135], v[164:167], v[28:31]
    v_mfma_f32_16x16x32_bf16 v[32:35], v[136:139], v[152:155], v[32:35]
    v_mfma_f32_16x16x32_bf16 v[36:39], v[136:139], v[156:159], v[36:39]
    v_mfma_f32_16x16x32_bf16 v[40:43], v[136:139], v[160:163], v[40:43]
    v_mfma_f32_16x16x32_bf16 v[44:47], v[136:139], v[164:167], v[44:47]
    v_mfma_f32_16x16x32_bf16 v[48:51], v[140:143], v[152:155], v[48:51]
    v_mfma_f32_16x16x32_bf16 v[52:55], v[140:143], v[156:159], v[52:55]
    v_mfma_f32_16x16x32_bf16 v[56:59], v[140:143], v[160:163], v[56:59]
    v_mfma_f32_16x16x32_bf16 v[60:63], v[140:143], v[164:167], v[60:63]
    v_mfma_f32_16x16x32_bf16 v[64:67], v[144:147], v[152:155], v[64:67]
    v_mfma_f32_16x16x32_bf16 v[68:71], v[144:147], v[156:159], v[68:71]
    v_mfma_f32_16x16x32_bf16 v[72:75], v[144:147], v[160:163], v[72:75]
    v_mfma_f32_16x16x32_bf16 v[76:79], v[144:147], v[164:167], v[76:79]
    v_mfma_f32_16x16x32_bf16 v[80:83], v[148:151], v[152:155], v[80:83]
    v_mfma_f32_16x16x32_bf16 v[84:87], v[148:151], v[156:159], v[84:87]
    v_mfma_f32_16x16x32_bf16 v[88:91], v[148:151], v[160:163], v[88:91]
    v_mfma_f32_16x16x32_bf16 v[92:95], v[148:151], v[164:167], v[92:95]
    v_add_u32 v9, s20, v3
    v_lshlrev_b32 v9, 1, v9
    buffer_load_ushort v96, v9, s[40:43], 0 offen
    s_mul_i32 s28, s3, 20480
    v_add_u32 v14, s28, v5
    s_nop 7
    s_cmp_eq_u32 s3, 0
    s_cbranch_scc1 mlpb1_kernel_own3
    ds_write_b128 v14, v[16:19] offset:0
    ds_write_b128 v14, v[32:35] offset:1024
    ds_write_b128 v14, v[48:51] offset:2048
    ds_write_b128 v14, v[64:67] offset:3072
    ds_write_b128 v14, v[80:83] offset:4096
    s_branch mlpb1_kernel_own3_d
mlpb1_kernel_own3:
    v_mov_b32 v104, v16
    v_mov_b32 v105, v17
    v_mov_b32 v106, v18
    v_mov_b32 v107, v19
    v_mov_b32 v108, v32
    v_mov_b32 v109, v33
    v_mov_b32 v110, v34
    v_mov_b32 v111, v35
    v_mov_b32 v112, v48
    v_mov_b32 v113, v49
    v_mov_b32 v114, v50
    v_mov_b32 v115, v51
    v_mov_b32 v116, v64
    v_mov_b32 v117, v65
    v_mov_b32 v118, v66
    v_mov_b32 v119, v67
    v_mov_b32 v120, v80
    v_mov_b32 v121, v81
    v_mov_b32 v122, v82
    v_mov_b32 v123, v83
mlpb1_kernel_own3_d:
    s_cmp_eq_u32 s3, 1
    s_cbranch_scc1 mlpb1_kernel_own4
    ds_write_b128 v14, v[20:23] offset:5120
    ds_write_b128 v14, v[36:39] offset:6144
    ds_write_b128 v14, v[52:55] offset:7168
    ds_write_b128 v14, v[68:71] offset:8192
    ds_write_b128 v14, v[84:87] offset:9216
    s_branch mlpb1_kernel_own4_d
mlpb1_kernel_own4:
    v_mov_b32 v104, v20
    v_mov_b32 v105, v21
    v_mov_b32 v106, v22
    v_mov_b32 v107, v23
    v_mov_b32 v108, v36
    v_mov_b32 v109, v37
    v_mov_b32 v110, v38
    v_mov_b32 v111, v39
    v_mov_b32 v112, v52
    v_mov_b32 v113, v53
    v_mov_b32 v114, v54
    v_mov_b32 v115, v55
    v_mov_b32 v116, v68
    v_mov_b32 v117, v69
    v_mov_b32 v118, v70
    v_mov_b32 v119, v71
    v_mov_b32 v120, v84
    v_mov_b32 v121, v85
    v_mov_b32 v122, v86
    v_mov_b32 v123, v87
mlpb1_kernel_own4_d:
    s_cmp_eq_u32 s3, 2
    s_cbranch_scc1 mlpb1_kernel_own5
    ds_write_b128 v14, v[24:27] offset:10240
    ds_write_b128 v14, v[40:43] offset:11264
    ds_write_b128 v14, v[56:59] offset:12288
    ds_write_b128 v14, v[72:75] offset:13312
    ds_write_b128 v14, v[88:91] offset:14336
    s_branch mlpb1_kernel_own5_d
mlpb1_kernel_own5:
    v_mov_b32 v104, v24
    v_mov_b32 v105, v25
    v_mov_b32 v106, v26
    v_mov_b32 v107, v27
    v_mov_b32 v108, v40
    v_mov_b32 v109, v41
    v_mov_b32 v110, v42
    v_mov_b32 v111, v43
    v_mov_b32 v112, v56
    v_mov_b32 v113, v57
    v_mov_b32 v114, v58
    v_mov_b32 v115, v59
    v_mov_b32 v116, v72
    v_mov_b32 v117, v73
    v_mov_b32 v118, v74
    v_mov_b32 v119, v75
    v_mov_b32 v120, v88
    v_mov_b32 v121, v89
    v_mov_b32 v122, v90
    v_mov_b32 v123, v91
mlpb1_kernel_own5_d:
    s_cmp_eq_u32 s3, 3
    s_cbranch_scc1 mlpb1_kernel_own6
    ds_write_b128 v14, v[28:31] offset:15360
    ds_write_b128 v14, v[44:47] offset:16384
    ds_write_b128 v14, v[60:63] offset:17408
    ds_write_b128 v14, v[76:79] offset:18432
    ds_write_b128 v14, v[92:95] offset:19456
    s_branch mlpb1_kernel_own6_d
mlpb1_kernel_own6:
    v_mov_b32 v104, v28
    v_mov_b32 v105, v29
    v_mov_b32 v106, v30
    v_mov_b32 v107, v31
    v_mov_b32 v108, v44
    v_mov_b32 v109, v45
    v_mov_b32 v110, v46
    v_mov_b32 v111, v47
    v_mov_b32 v112, v60
    v_mov_b32 v113, v61
    v_mov_b32 v114, v62
    v_mov_b32 v115, v63
    v_mov_b32 v116, v76
    v_mov_b32 v117, v77
    v_mov_b32 v118, v78
    v_mov_b32 v119, v79
    v_mov_b32 v120, v92
    v_mov_b32 v121, v93
    v_mov_b32 v122, v94
    v_mov_b32 v123, v95
mlpb1_kernel_own6_d:
    s_mul_i32 s29, s3, 5120
    s_add_u32 s28, s3, 1
    s_and_b32 s28, s28, 3
    s_mul_i32 s28, s28, 20480
    s_add_u32 s28, s28, s29
    v_add_u32 v13, s28, v5
    s_add_u32 s28, s3, 2
    s_and_b32 s28, s28, 3
    s_mul_i32 s28, s28, 20480
    s_add_u32 s28, s28, s29
    v_add_u32 v14, s28, v5
    s_add_u32 s28, s3, 3
    s_and_b32 s28, s28, 3
    s_mul_i32 s28, s28, 20480
    s_add_u32 s28, s28, s29
    v_add_u32 v15, s28, v5
    s_waitcnt lgkmcnt(0)
    s_barrier
    ds_read_b128 v[16:19], v13 offset:0
    ds_read_b128 v[20:23], v13 offset:1024
    ds_read_b128 v[24:27], v13 offset:2048
    ds_read_b128 v[28:31], v13 offset:3072
    ds_read_b128 v[32:35], v13 offset:4096
    ds_read_b128 v[36:39], v14 offset:0
    ds_read_b128 v[40:43], v14 offset:1024
    ds_read_b128 v[44:47], v14 offset:2048
    ds_read_b128 v[48:51], v14 offset:3072
    ds_read_b128 v[52:55], v14 offset:4096
    ds_read_b128 v[56:59], v15 offset:0
    ds_read_b128 v[60:63], v15 offset:1024
    ds_read_b128 v[64:67], v15 offset:2048
    ds_read_b128 v[68:71], v15 offset:3072
    ds_read_b128 v[72:75], v15 offset:4096
    s_waitcnt lgkmcnt(5)
    v_add_f32 v16, v16, v36
    v_add_f32 v17, v17, v37
    v_add_f32 v18, v18, v38
    v_add_f32 v19, v19, v39
    v_add_f32 v20, v20, v40
    v_add_f32 v21, v21, v41
    v_add_f32 v22, v22, v42
    v_add_f32 v23, v23, v43
    v_add_f32 v24, v24, v44
    v_add_f32 v25, v25, v45
    v_add_f32 v26, v26, v46
    v_add_f32 v27, v27, v47
    v_add_f32 v28, v28, v48
    v_add_f32 v29, v29, v49
    v_add_f32 v30, v30, v50
    v_add_f32 v31, v31, v51
    v_add_f32 v32, v32, v52
    v_add_f32 v33, v33, v53
    v_add_f32 v34, v34, v54
    v_add_f32 v35, v35, v55
    s_waitcnt lgkmcnt(0)
    v_add_f32 v104, v104, v56
    v_add_f32 v105, v105, v57
    v_add_f32 v106, v106, v58
    v_add_f32 v107, v107, v59
    v_add_f32 v108, v108, v60
    v_add_f32 v109, v109, v61
    v_add_f32 v110, v110, v62
    v_add_f32 v111, v111, v63
    v_add_f32 v112, v112, v64
    v_add_f32 v113, v113, v65
    v_add_f32 v114, v114, v66
    v_add_f32 v115, v115, v67
    v_add_f32 v116, v116, v68
    v_add_f32 v117, v117, v69
    v_add_f32 v118, v118, v70
    v_add_f32 v119, v119, v71
    v_add_f32 v120, v120, v72
    v_add_f32 v121, v121, v73
    v_add_f32 v122, v122, v74
    v_add_f32 v123, v123, v75
    v_add_f32 v104, v104, v16
    v_add_f32 v105, v105, v17
    v_add_f32 v106, v106, v18
    v_add_f32 v107, v107, v19
    v_add_f32 v108, v108, v20
    v_add_f32 v109, v109, v21
    v_add_f32 v110, v110, v22
    v_add_f32 v111, v111, v23
    v_add_f32 v112, v112, v24
    v_add_f32 v113, v113, v25
    v_add_f32 v114, v114, v26
    v_add_f32 v115, v115, v27
    v_add_f32 v116, v116, v28
    v_add_f32 v117, v117, v29
    v_add_f32 v118, v118, v30
    v_add_f32 v119, v119, v31
    v_add_f32 v120, v120, v32
    v_add_f32 v121, v121, v33
    v_add_f32 v122, v122, v34
    v_add_f32 v123, v123, v35
    s_waitcnt vmcnt(0)
    v_lshlrev_b32 v96, 16, v96
    v_add_f32 v104, v104, v96
    v_add_f32 v105, v105, v96
    v_add_f32 v106, v106, v96
    v_add_f32 v107, v107, v96
    v_cvt_pk_bf16_f32 v136, v104, v105
    v_cvt_pk_bf16_f32 v137, v106, v107
    v_add_f32 v108, v108, v96
    v_add_f32 v109, v109, v96
    v_add_f32 v110, v110, v96
    v_add_f32 v111, v111, v96
    v_cvt_pk_bf16_f32 v138, v108, v109
    v_cvt_pk_bf16_f32 v139, v110, v111
    v_add_f32 v112, v112, v96
    v_add_f32 v113, v113, v96
    v_add_f32 v114, v114, v96
    v_add_f32 v115, v115, v96
    v_cvt_pk_bf16_f32 v140, v112, v113
    v_cvt_pk_bf16_f32 v141, v114, v115
    v_add_f32 v116, v116, v96
    v_add_f32 v117, v117, v96
    v_add_f32 v118, v118, v96
    v_add_f32 v119, v119, v96
    v_cvt_pk_bf16_f32 v142, v116, v117
    v_cvt_pk_bf16_f32 v143, v118, v119
    v_add_f32 v120, v120, v96
    v_add_f32 v121, v121, v96
    v_add_f32 v122, v122, v96
    v_add_f32 v123, v123, v96
    v_cvt_pk_bf16_f32 v144, v120, v121
    v_cvt_pk_bf16_f32 v145, v122, v123
    s_barrier
    s_mul_i32 s28, s3, 20480
    v_mul_u32_u24 v9, 176, v3
    v_lshl_add_u32 v9, v2, 3, v9
    v_add_u32 v9, s28, v9
    ds_write_b64 v9, v[136:137] offset:0
    ds_write_b64 v9, v[138:139] offset:32
    ds_write_b64 v9, v[140:141] offset:64
    ds_write_b64 v9, v[142:143] offset:96
    ds_write_b64 v9, v[144:145] offset:128
    s_mul_i32 s29, s17, 160
    s_mul_i32 s30, s20, 1280
    s_add_u32 s29, s29, s30
    v_add_u32 v10, 0, v1
    v_mul_u32_u24 v11, 6554, v10
    v_lshrrev_b32 v11, 16, v11
    v_mul_u32_u24 v12, 10, v11
    v_sub_u32 v12, v10, v12
    v_mul_u32_u24 v13, 176, v11
    v_lshl_add_u32 v13, v12, 4, v13
    v_add_u32 v13, s28, v13
    ds_read_b128 v[16:19], v13
    v_mul_u32_u24 v13, 1280, v11
    v_lshl_add_u32 v32, v12, 4, v13
    v_add_u32 v10, 64, v1
    v_mul_u32_u24 v11, 6554, v10
    v_lshrrev_b32 v11, 16, v11
    v_mul_u32_u24 v12, 10, v11
    v_sub_u32 v12, v10, v12
    v_mul_u32_u24 v13, 176, v11
    v_lshl_add_u32 v13, v12, 4, v13
    v_add_u32 v13, s28, v13
    ds_read_b128 v[20:23], v13
    v_mul_u32_u24 v13, 1280, v11
    v_lshl_add_u32 v33, v12, 4, v13
    v_add_u32 v10, 128, v1
    v_mul_u32_u24 v11, 6554, v10
    v_lshrrev_b32 v11, 16, v11
    v_mul_u32_u24 v12, 10, v11
    v_sub_u32 v12, v10, v12
    v_mul_u32_u24 v13, 176, v11
    v_lshl_add_u32 v13, v12, 4, v13
    v_add_u32 v13, s28, v13
    ds_read_b128 v[24:27], v13
    v_mul_u32_u24 v13, 1280, v11
    v_lshl_add_u32 v34, v12, 4, v13
    v_mov_b32 v13, 0x7ffffff0
    v_cmp_gt_u32 vcc, 32, v1
    s_nop 1
    v_cndmask_b32 v34, v13, v34, vcc
    s_waitcnt lgkmcnt(0)
    buffer_store_dwordx4 v[16:19], v32, s[48:51], s29 offen
    buffer_store_dwordx4 v[20:23], v33, s[48:51], s29 offen
    buffer_store_dwordx4 v[24:27], v34, s[48:51], s29 offen
mlpb1_kernel_end:
    s_endpgm

.section .rodata,"a"
.p2align 6
.amdhsa_kernel qkv0_kernel
  .amdhsa_next_free_vgpr 256
  .amdhsa_next_free_sgpr 102
  .amdhsa_accum_offset 256
  .amdhsa_group_segment_fixed_size 0
  .amdhsa_kernarg_size 104
  .amdhsa_user_sgpr_count 2
  .amdhsa_user_sgpr_kernarg_segment_ptr 1
  .amdhsa_system_sgpr_workgroup_id_x 1
.end_amdhsa_kernel

.p2align 6
.amdhsa_kernel attn0_kernel
  .amdhsa_next_free_vgpr 200
  .amdhsa_next_free_sgpr 102
  .amdhsa_accum_offset 200
  .amdhsa_group_segment_fixed_size 0
  .amdhsa_kernarg_size 104
  .amdhsa_user_sgpr_count 2
  .amdhsa_user_sgpr_kernarg_segment_ptr 1
  .amdhsa_system_sgpr_workgroup_id_x 1
.end_amdhsa_kernel

.p2align 6
.amdhsa_kernel oproj0_kernel
  .amdhsa_next_free_vgpr 212
  .amdhsa_next_free_sgpr 102
  .amdhsa_accum_offset 212
  .amdhsa_group_segment_fixed_size 0
  .amdhsa_kernarg_size 104
  .amdhsa_user_sgpr_count 2
  .amdhsa_user_sgpr_kernarg_segment_ptr 1
  .amdhsa_system_sgpr_workgroup_id_x 1
.end_amdhsa_kernel

.p2align 6
.amdhsa_kernel mlpa0_kernel
  .amdhsa_next_free_vgpr 256
  .amdhsa_next_free_sgpr 102
  .amdhsa_accum_offset 256
  .amdhsa_group_segment_fixed_size 0
  .amdhsa_kernarg_size 104
  .amdhsa_user_sgpr_count 2
  .amdhsa_user_sgpr_kernarg_segment_ptr 1
  .amdhsa_system_sgpr_workgroup_id_x 1
.end_amdhsa_kernel

.p2align 6
.amdhsa_kernel mlpb0_kernel
  .amdhsa_next_free_vgpr 256
  .amdhsa_next_free_sgpr 102
  .amdhsa_accum_offset 256
  .amdhsa_group_segment_fixed_size 0
  .amdhsa_kernarg_size 104
  .amdhsa_user_sgpr_count 2
  .amdhsa_user_sgpr_kernarg_segment_ptr 1
  .amdhsa_system_sgpr_workgroup_id_x 1
.end_amdhsa_kernel

.p2align 6
.amdhsa_kernel qkv1_kernel
  .amdhsa_next_free_vgpr 256
  .amdhsa_next_free_sgpr 102
  .amdhsa_accum_offset 256
  .amdhsa_group_segment_fixed_size 0
  .amdhsa_kernarg_size 104
  .amdhsa_user_sgpr_count 2
  .amdhsa_user_sgpr_kernarg_segment_ptr 1
  .amdhsa_system_sgpr_workgroup_id_x 1
.end_amdhsa_kernel

.p2align 6
.amdhsa_kernel attn1_kernel
  .amdhsa_next_free_vgpr 200
  .amdhsa_next_free_sgpr 102
  .amdhsa_accum_offset 200
  .amdhsa_group_segment_fixed_size 0
  .amdhsa_kernarg_size 104
  .amdhsa_user_sgpr_count 2
  .amdhsa_user_sgpr_kernarg_segment_ptr 1
  .amdhsa_system_sgpr_workgroup_id_x 1
.end_amdhsa_kernel

.p2align 6
.amdhsa_kernel oproj1_kernel
  .amdhsa_next_free_vgpr 212
  .amdhsa_next_free_sgpr 102
  .amdhsa_accum_offset 212
  .amdhsa_group_segment_fixed_size 0
  .amdhsa_kernarg_size 104
  .amdhsa_user_sgpr_count 2
  .amdhsa_user_sgpr_kernarg_segment_ptr 1
  .amdhsa_system_sgpr_workgroup_id_x 1
.end_amdhsa_kernel

.p2align 6
.amdhsa_kernel mlpa1_kernel
  .amdhsa_next_free_vgpr 256
  .amdhsa_next_free_sgpr 102
  .amdhsa_accum_offset 256
  .amdhsa_group_segment_fixed_size 0
  .amdhsa_kernarg_size 104
  .amdhsa_user_sgpr_count 2
  .amdhsa_user_sgpr_kernarg_segment_ptr 1
  .amdhsa_system_sgpr_workgroup_id_x 1
.end_amdhsa_kernel

.p2align 6
.amdhsa_kernel mlpb1_kernel
  .amdhsa_next_free_vgpr 256
  .amdhsa_next_free_sgpr 102
  .amdhsa_accum_offset 256
  .amdhsa_group_segment_fixed_size 0
  .amdhsa_kernarg_size 104
  .amdhsa_user_sgpr_count 2
  .amdhsa_user_sgpr_kernarg_segment_ptr 1
  .amdhsa_system_sgpr_workgroup_id_x 1
.end_amdhsa_kernel
```
